```python
import torch

def _softmax(x, axis=-1):
    return torch.softmax(x, dim=axis)
def _gelu(x):
    return torch.nn.functional.gelu(x, approximate="tanh")
def _silu(x):
    return torch.nn.functional.silu(x)
def _sigmoid(x):
    return torch.sigmoid(x)
def _layernorm(x, axis=-1, eps=1e-5):
    m = x.mean(dim=axis, keepdim=True)
    v = x.var(dim=axis, keepdim=True, unbiased=False)
    return (x - m) / torch.sqrt(v + eps)
def _scatter_add(tgt, idx, src, axis=0):
    return tgt.clone().index_add_(axis, idx, src)
def _segment_sum(src, seg, n):
    out = torch.zeros((n,) + src.shape[1:], dtype=src.dtype)
    return out.index_add_(0, seg, src)
def _pad(x, pw):
    flat = tuple(v for pair in reversed(pw) for v in pair)
    return torch.nn.functional.pad(x, flat)

kernel_name = 'recurrent_scan__mha_block_cached__glu_gated_reglu__prompt'

def setup_inputs():

    _w = (lambda a: (lambda t: t.to(torch.bfloat16) if t.is_floating_point() else t)(torch.as_tensor(a)))
    def _A_setup():
        B, Sq, D = 1, 2048, 640
        H, Sk, Dh = 32, 2048, 128
        return {
            "x": _w((lambda *s: torch.randn(*s, dtype=torch.bfloat16) * 0.05)(B, Sq, D)),
            "k_cache": _w((lambda *s: torch.randn(*s, dtype=torch.bfloat16) * 1.6)(B, H, Sk, Dh)),
            "v_cache": _w((lambda *s: torch.randn(*s, dtype=torch.bfloat16) * 1.6)(B, H, Sk, Dh)),
            "wq": _w((lambda *s: torch.randn(*s, dtype=torch.bfloat16) * 1.6)(D, H * Dh) * (D ** -0.5)),
            "wo": _w((lambda *s: torch.randn(*s, dtype=torch.bfloat16) * 1.6)(H * Dh, D) * ((H * Dh) ** -0.5)),
        }
    _A_in = _A_setup()

    def _B_setup():
        B, S, D, F = 1, 2048, 640, 1728
        return {
            "x": _w((lambda *s: torch.randn(*s, dtype=torch.bfloat16) * 0.05)(B, S, D)),
            "W_gate": _w((lambda *s: torch.randn(*s, dtype=torch.bfloat16) * 0.2)(D, F) * (2.0 / D) ** 0.5),
            "W_up": _w((lambda *s: torch.randn(*s, dtype=torch.bfloat16) * 0.2)(D, F) * (2.0 / D) ** 0.5),
            "W_down": _w((lambda *s: torch.randn(*s, dtype=torch.bfloat16) * 0.2)(F, D) * (1.0 / F) ** 0.5),
        }
    _B_in = _B_setup()

    return {
        "A_x": _A_in["x"],
        "A_k_cache": _A_in["k_cache"],
        "A_v_cache": _A_in["v_cache"],
        "A_wq": _A_in["wq"],
        "A_wo": _A_in["wo"],
        "B_x": _B_in["x"],
        "B_W_gate": _B_in["W_gate"],
        "B_W_up": _B_in["W_up"],
        "B_W_down": _B_in["W_down"],
    }

def reference(A_x, A_k_cache, A_v_cache, A_wq, A_wo, B_x, B_W_gate, B_W_up, B_W_down):
    def _A_ref(x, k_cache, v_cache, wq, wo):
        B, Sq, D = x.shape
        H, Dh = 32, 128
        q = (lambda x, *d: x.permute(*d))((x @ wq).reshape(B, Sq, H, Dh), 0, 2, 1, 3)
        scores = torch.einsum("bhqd,bhkd->bhqk", q, k_cache) * (Dh ** -0.5)
        p = _softmax(scores, axis=-1)
        o = torch.einsum("bhqk,bhkd->bhqd", p, v_cache)
        return (lambda x, *d: x.permute(*d))(o, 0, 2, 1, 3).reshape(B, Sq, H * Dh) @ wo

    def _B_ref(x, W_gate, W_up, W_down):
        gate = torch.einsum("bsd,df->bsf", x, W_gate)
        up = torch.einsum("bsd,df->bsf", x, W_up)
        gate = gate * (lambda x, dt: x.to(dt))(gate > 0, gate.dtype)
        h = gate * up
        return torch.einsum("bsf,fd->bsd", h, W_down)

    x = A_x
    xn = _layernorm(x, axis=-1)
    s = _A_ref(xn, A_k_cache, A_v_cache, A_wq, A_wo)
    g = _silu(_B_ref(xn, B_W_gate, B_W_up, B_W_down))
    return x + s * g
```

```asm
; @launch grid=(256,1,1) block=(256,1,1) lds=163840
.amdgcn_target "amdgcn-amd-amdhsa--gfx950"
.text
.globl recurrent_scan__mha_block_cached__glu_gated_reglu__prompt_kernel
.p2align 8
.type recurrent_scan__mha_block_cached__glu_gated_reglu__prompt_kernel,@function
recurrent_scan__mha_block_cached__glu_gated_reglu__prompt_kernel:
  s_cmp_ge_u32 s2, 256
  s_cbranch_scc1 K1_end
  s_load_dwordx4 s[24:27], s[0:1], 8
  s_load_dwordx2 s[60:61], s[0:1], 24
  s_load_dwordx4 s[64:67], s[0:1], 48
  s_load_dwordx2 s[68:69], s[0:1], 88
  s_load_dwordx2 s[62:63], s[0:1], 80
  s_load_dwordx2 s[92:93], s[0:1], 0
  s_load_dwordx2 s[94:95], s[0:1], 72
  s_load_dwordx2 s[86:87], s[0:1], 32
  s_load_dwordx2 s[88:89], s[0:1], 64
  s_getpc_b64 s[6:7]
  s_lshr_b32 s51, s2, 3
  s_mul_i32 s51, s51, 2688
  v_min_u32 v52, 20, v0
  v_lshlrev_b32 v52, 7, v52
  v_add_u32 v52, s51, v52
  global_load_dword v154, v52, s[6:7]
  v_and_b32 v222, 63, v0
  v_lshrrev_b32 v1, 6, v0
  s_nop 0
  v_readfirstlane_b32 s36, v1
  s_and_b32 s3, s2, 7
  s_lshr_b32 s4, s2, 3
  s_and_b32 s48, s4, 3
  s_lshr_b32 s38, s4, 2
  s_lshl_b32 s37, s3, 2
  s_add_u32 s37, s37, s48
  s_add_u32 s7, s48, s38
  s_and_b32 s7, s7, 3
  s_cmp_eq_u32 s7, 3
  s_cselect_b32 s6, s38, 0
  s_add_u32 s6, s6, s3
  s_and_b32 s6, s6, 7
  s_lshl_b32 s39, s7, 3
  s_add_u32 s39, s39, s6
  s_lshr_b32 s70, s4, 3
  s_lshl_b32 s70, s70, 1
  s_lshr_b32 s6, s3, 1
  s_lshl_b32 s6, s6, 3
  s_add_u32 s70, s70, s6
  s_and_b32 s6, s3, 1
  s_xor_b32 s6, s6, 0
  s_add_u32 s70, s70, s6
  s_and_b32 s71, s4, 7
  s_lshr_b32 s6, s4, 4
  s_xor_b32 s71, s71, s6
  v_lshrrev_b32 v1, 4, v222
  v_bfe_u32 v2, v222, 2, 2
  v_and_b32 v3, 3, v222
  v_and_b32 v4, 15, v222
  v_lshrrev_b32 v5, 3, v222
  v_and_b32 v6, 7, v222
  s_lshl_b32 s6, s36, 6
  v_add_u32 v7, s6, v5
  v_mul_u32_u24 v7, 1280, v7
  v_xor_b32 v8, v6, v1
  v_xor_b32 v9, 4, v8
  v_lshl_add_u32 v8, v8, 4, v7
  v_lshl_add_u32 v9, v9, 4, v7
  v_add_u32 v232, 0, v8
  v_add_u32 v233, 9216, v9
  v_add_u32 v234, 18432, v8
  v_add_u32 v235, 27648, v9
  v_add_u32 v236, 40960, v8
  v_add_u32 v237, 50176, v9
  v_add_u32 v238, 59392, v8
  v_add_u32 v239, 68608, v9
  s_lshl_b32 s6, s36, 4
  v_add_u32 v7, s6, v1
  v_lshlrev_b32 v7, 13, v7
  v_lshlrev_b32 v8, 2, v1
  v_xor_b32 v8, v4, v8
  v_lshl_add_u32 v8, v8, 4, v7
  v_add_u32 v240, 0, v8
  v_add_u32 v241, 31744, v8
  v_add_u32 v242, 63488, v8
  v_add_u32 v243, 95232, v8
  s_and_b32 s6, s36, 1
  s_lshl_b32 s6, s6, 5
  v_add_u32 v7, s6, v5
  v_mul_u32_u24 v7, 3456, v7
  v_and_b32 v8, 2, v5
  v_xor_b32 v8, v6, v8
  v_xor_b32 v9, 4, v8
  v_lshl_add_u32 v8, v8, 4, v7
  v_lshl_add_u32 v9, v9, 4, v7
  v_add_u32 v244, 0, v8
  v_add_u32 v245, 26624, v9
  v_add_u32 v246, 53248, v8
  v_add_u32 v247, 79872, v9
  s_lshl_b32 s43, s36, 13
  s_lshl_b32 s44, s36, 12
  s_lshl_b32 s7, s37, 2
  s_add_u32 s7, s7, s36
  s_lshl_b32 s7, s7, 1
  v_lshrrev_b32 v156, 5, v222
  v_add_u32 v156, s7, v156
  v_mul_u32_u24 v159, 1280, v156
  v_and_b32 v50, 31, v222
  v_lshl_add_u32 v159, v50, 3, v159
  s_waitcnt lgkmcnt(0)
  s_mul_i32 s6, s38, 327680
  s_add_u32 s8, s92, s6
  s_addc_u32 s9, s93, 0
  s_mov_b32 s10, 327680
  s_mov_b32 s11, 0x20000
  s_lshl_b32 s6, s37, 8
  s_add_u32 s12, s60, s6
  s_addc_u32 s13, s61, 0
  s_mov_b32 s14, 0
  s_mov_b32 s15, 0x20000
  s_sub_u32 s14, 5242880, s6
  s_cmp_lt_u32 s36, 2
  s_cselect_b32 s52, s64, s66
  s_cselect_b32 s53, s65, s67
  s_lshl_b32 s6, s39, 7
  s_add_u32 s16, s52, s6
  s_addc_u32 s17, s53, 0
  s_mov_b32 s18, 0
  s_mov_b32 s19, 0x20000
  s_sub_u32 s7, 2211840, s6
  s_cmp_lt_u32 s39, 27
  s_cselect_b32 s18, s7, 0
  s_add_u32 m0, s44, 98304
  s_mov_b32 s41, 0
  buffer_load_dwordx4 v240, s[12:15], s41 offen offset:0  lds
  buffer_load_dwordx4 v241, s[12:15], s41 offen offset:1024  lds
  buffer_load_dwordx4 v242, s[12:15], s41 offen offset:2048  lds
  buffer_load_dwordx4 v243, s[12:15], s41 offen offset:3072  lds
  s_lshl_b32 s6, s37, 19
  s_add_u32 s28, s26, s6
  s_addc_u32 s29, s27, 0
  s_mov_b32 s30, 524288
  s_mov_b32 s31, 0x20000
  s_add_u32 s24, s24, s6
  s_addc_u32 s25, s25, 0
  s_mov_b32 s26, 524288
  s_mov_b32 s27, 0x20000
  s_lshl_b32 s6, s38, 2
  s_add_u32 s6, s6, s36
  s_mul_i32 s6, s6, 753664
  s_add_u32 s6, s6, 4194304
  s_add_u32 m0, s44, 114688
  s_mov_b32 s42, 0
  buffer_load_dwordx4 v244, s[16:19], s42 offen offset:0  lds
  s_add_u32 s32, s68, s6
  s_addc_u32 s33, s69, 0
  s_mov_b32 s34, 745472
  s_mov_b32 s35, 0x20000
  s_add_u32 s20, s68, 62914560
  s_addc_u32 s21, s69, 0
  s_mov_b32 s22, 344064
  s_mov_b32 s23, 0x20000
  s_lshl_b32 s51, s70, 3
  s_add_u32 s51, s51, s71
  s_lshl_b32 s51, s51, 2
  s_add_u32 s51, s51, s36
  buffer_load_dwordx4 v245, s[16:19], s42 offen offset:1024  lds
  s_mul_i32 s64, s51, 5248
  s_xor_b32 s52, s51, 32
  s_mul_i32 s65, s52, 5248
  s_lshl_b32 s60, s51, 5
  s_add_u32 s60, s60, 131072
  s_lshl_b32 s61, s52, 5
  s_add_u32 s61, s61, 131072
  s_lshl_b32 s51, s38, 2
  s_add_u32 s51, s51, s36
  s_lshl_b32 s51, s51, 5
  s_add_u32 s51, s51, s37
  s_lshl_b32 s53, s51, 4
  buffer_load_dwordx4 v246, s[16:19], s42 offen offset:2048  lds
  s_mov_b32 s46, 0
  s_mov_b32 s47, 0
  v_lshl_add_u32 v7, v1, 3, v2
  v_lshlrev_b32 v8, 8, v7
  v_lshl_add_u32 v8, v3, 4, v8
  v_add_u32 v8, 0x10000, v8
  v_xor_b32 v51, s36, v2
  v_xor_b32 v9, 0, v51
  v_lshl_add_u32 v128, v9, 6, v8
  v_add_u32 v132, 0x10000, v128
  v_xor_b32 v9, 1, v51
  v_lshl_add_u32 v129, v9, 6, v8
  v_add_u32 v133, 0x10000, v129
  buffer_load_dwordx4 v247, s[16:19], s42 offen offset:3072  lds
  v_xor_b32 v9, 2, v51
  v_lshl_add_u32 v130, v9, 6, v8
  v_add_u32 v134, 0x10000, v130
  v_xor_b32 v9, 3, v51
  v_lshl_add_u32 v131, v9, 6, v8
  v_add_u32 v135, 0x10000, v131
  v_lshlrev_b32 v8, 7, v7
  v_lshl_add_u32 v8, v3, 3, v8
  v_add_u32 v8, 0x14000, v8
  v_lshrrev_b32 v9, 1, v2
  v_xor_b32 v51, s36, v1
  v_and_b32 v51, 1, v51
  v_lshl_add_u32 v51, v51, 1, v9
  s_add_u32 m0, s43, 0
  s_movk_i32 s40, 0
  buffer_load_dwordx4 v232, s[8:11], s40 offen offset:0  lds
  s_lshr_b32 s6, s36, 1
  s_lshl_b32 s6, s6, 13
  v_add_u32 v8, s6, v8
  v_xor_b32 v9, 0, v51
  v_lshl_add_u32 v136, v9, 5, v8
  v_xor_b32 v140, 0x2000, v136
  v_add_u32 v144, 0x10000, v136
  v_add_u32 v148, 0x10000, v140
  v_xor_b32 v9, 1, v51
  v_lshl_add_u32 v137, v9, 5, v8
  v_xor_b32 v141, 0x2000, v137
  buffer_load_dwordx4 v233, s[8:11], s40 offen offset:1024  lds
  v_add_u32 v145, 0x10000, v137
  v_add_u32 v149, 0x10000, v141
  v_xor_b32 v9, 2, v51
  v_lshl_add_u32 v138, v9, 5, v8
  v_xor_b32 v142, 0x2000, v138
  v_add_u32 v146, 0x10000, v138
  v_add_u32 v150, 0x10000, v142
  v_xor_b32 v9, 3, v51
  v_lshl_add_u32 v139, v9, 5, v8
  v_xor_b32 v143, 0x2000, v139
  buffer_load_dwordx4 v234, s[8:11], s40 offen offset:2048  lds
  v_add_u32 v147, 0x10000, v139
  v_add_u32 v151, 0x10000, v143
  s_lshl_b32 s6, s36, 6
  v_add_u32 v8, s6, v4
  v_lshlrev_b32 v8, 7, v8
  v_lshrrev_b32 v9, 1, v4
  v_xor_b32 v9, v9, v1
  v_lshl_add_u32 v152, v9, 4, v8
  v_xor_b32 v9, 4, v9
  v_lshl_add_u32 v153, v9, 4, v8
  v_lshl_add_u32 v8, v2, 4, v3
  v_lshlrev_b32 v8, 8, v8
  v_xor_b32 v9, v1, v4
  s_lshl_b32 s6, s36, 2
  v_xor_b32 v9, s6, v9
  buffer_load_dwordx4 v235, s[8:11], s40 offen offset:3072  lds
  v_xor_b32 v51, 0, v9
  v_lshl_add_u32 v208, v51, 4, v8
  v_xor_b32 v51, 4, v9
  v_lshl_add_u32 v209, v51, 4, v8
  v_xor_b32 v51, 8, v9
  v_lshl_add_u32 v210, v51, 4, v8
  v_xor_b32 v51, 12, v9
  v_lshl_add_u32 v211, v51, 4, v8
  v_lshl_add_u32 v8, v1, 4, v2
  v_lshlrev_b32 v8, 8, v8
  v_lshl_add_u32 v8, v3, 3, v8
  v_add_u32 v8, 0x10000, v8
  s_add_u32 m0, s43, 4096
  s_nop 0
  buffer_load_dwordx4 v236, s[8:11], s40 offen offset:0  lds
  v_and_b32 v9, 1, v1
  v_lshl_add_u32 v9, v9, 2, v2
  v_xor_b32 v51, 0, v9
  v_lshl_add_u32 v212, v51, 5, v8
  v_xor_b32 v51, 1, v9
  v_lshl_add_u32 v213, v51, 5, v8
  v_xor_b32 v51, 2, v9
  v_lshl_add_u32 v214, v51, 5, v8
  v_xor_b32 v51, 3, v9
  v_lshl_add_u32 v215, v51, 5, v8
  buffer_load_dwordx4 v237, s[8:11], s40 offen offset:1024  lds
  v_xor_b32 v51, 4, v9
  v_lshl_add_u32 v216, v51, 5, v8
  v_xor_b32 v51, 5, v9
  v_lshl_add_u32 v217, v51, 5, v8
  v_xor_b32 v51, 6, v9
  v_lshl_add_u32 v218, v51, 5, v8
  v_xor_b32 v51, 7, v9
  v_lshl_add_u32 v219, v51, 5, v8
  s_lshl_b32 s6, s36, 4
  v_add_u32 v8, s6, v1
  v_lshlrev_b32 v8, 8, v8
  buffer_load_dwordx4 v238, s[8:11], s40 offen offset:2048  lds
  s_lshl_b32 s6, s36, 2
  v_add_u32 v9, s6, v1
  v_xor_b32 v9, v9, v4
  v_lshl_add_u32 v220, v9, 4, v8
  s_and_b32 s6, s36, 1
  s_lshl_b32 s6, s6, 2
  v_add_u32 v9, s6, v1
  v_lshlrev_b32 v9, 1, v9
  v_xor_b32 v9, v9, v4
  v_lshl_add_u32 v221, v9, 4, v8
  v_lshlrev_b32 v223, 4, v222
  v_and_b32 v9, 1, v222
  v_mul_u32_u24 v9, 0xaaaa, v9
  v_add_u32 v9, 0x4444, v9
  v_lshl_or_b32 v224, v9, 16, v9
  buffer_load_dwordx4 v239, s[8:11], s40 offen offset:3072  lds
  v_mov_b32 v192, 0
  v_mov_b32 v193, 0
  v_mov_b32 v194, 0
  v_mov_b32 v195, 0
  v_mov_b32 v196, 0
  v_mov_b32 v197, 0
  v_mov_b32 v198, 0
  v_mov_b32 v199, 0
  v_mov_b32 v200, 0
  v_mov_b32 v201, 0
  v_mov_b32 v202, 0
  v_mov_b32 v203, 0
  v_mov_b32 v204, 0
  v_mov_b32 v205, 0
  v_mov_b32 v206, 0
  v_mov_b32 v207, 0
  buffer_load_dwordx2 v[160:161], v159, s[8:11], 0 offen offset:0
  s_lshr_b32 s6, s2, 1
  s_and_b32 s7, s2, 1
  s_lshl_b32 s7, s7, 2
  s_add_u32 s7, s7, s36
  s_and_b32 s51, s6, 3
  s_lshl_b32 s51, s51, 2
  s_bfe_u32 s52, s6, 0x20002
  s_add_u32 s51, s51, s52
  s_andn2_b32 s52, s6, 15
  s_add_u32 s51, s51, s52
  buffer_load_dwordx2 v[162:163], v159, s[8:11], 0 offen offset:256
  s_mul_i32 s84, s7, 655360
  s_mul_i32 s51, s51, 5120
  s_add_u32 s84, s84, s51
  s_lshl_b32 s97, s7, 7
  s_add_u32 s97, s97, s6
  s_lshl_b32 s97, s97, 2
  s_add_u32 s97, s97, 262144
  buffer_load_dwordx2 v[164:165], v159, s[8:11], 0 offen offset:512
  s_mul_i32 s6, s6, 40960
  s_mul_i32 s7, s7, 160
  s_add_u32 s6, s6, s7
  s_add_u32 s72, s86, s6
  s_addc_u32 s73, s87, 0
  s_mov_b32 s74, 0
  s_mov_b32 s75, 0x20000
  s_sub_u32 s74, 40960, s7
  s_add_u32 s76, s68, 33554432
  s_addc_u32 s77, s69, 0
  s_mov_b32 s78, 5242880
  s_mov_b32 s79, 0x20000
  buffer_load_dwordx2 v[166:167], v159, s[8:11], 0 offen offset:768
  v_add_u32 v52, 0, v222
  v_mul_u32_u24 v53, 6554, v52
  v_lshrrev_b32 v53, 16, v53
  v_mul_u32_u24 v54, 10, v53
  v_sub_u32 v52, v52, v54
  v_mul_u32_u24 v53, 1280, v53
  v_lshl_add_u32 v53, v52, 4, v53
  v_subrev_u32 v228, 0, v53
  v_add_u32 v52, 64, v222
  v_mul_u32_u24 v53, 6554, v52
  v_lshrrev_b32 v53, 16, v53
  v_mul_u32_u24 v54, 10, v53
  v_sub_u32 v52, v52, v54
  buffer_load_dwordx2 v[168:169], v159, s[8:11], 0 offen offset:1024
  v_mul_u32_u24 v53, 1280, v53
  v_lshl_add_u32 v53, v52, 4, v53
  v_subrev_u32 v229, 1024, v53
  v_add_u32 v52, 128, v222
  v_mul_u32_u24 v53, 6554, v52
  v_lshrrev_b32 v53, 16, v53
  v_mul_u32_u24 v54, 10, v53
  v_sub_u32 v52, v52, v54
  v_mul_u32_u24 v53, 1280, v53
  v_lshl_add_u32 v53, v52, 4, v53
  v_subrev_u32 v230, 2048, v53
  s_add_u32 s6, s43, 131072
  v_lshrrev_b32 v8, 2, v222
  v_mul_u32_u24 v8, 160, v8
  v_mul_u32_u24 v9, 40, v3
  v_add3_u32 v227, v8, v9, s6
  s_lshl_b32 s6, s38, 11
  s_add_u32 s6, s6, 63242240
  s_add_u32 s80, s68, s6
  s_addc_u32 s81, s69, 0
  s_mov_b32 s82, 2048
  s_mov_b32 s83, 0x20000
  v_mov_b32 v252, 0x3f803f80
  v_mov_b32 v253, 0x3f803f80
  v_mov_b32 v254, 0x3f803f80
  v_mov_b32 v255, 0x3f803f80
  v_mov_b32 v155, 0
  v_lshlrev_b32 v157, 5, v6
  v_mov_b32 v158, 749568
  s_mov_b32 s4, s62
  s_mov_b32 s5, s63
  s_mov_b32 s6, 256
  s_mov_b32 s7, 0x20000
  s_lshl_b32 s51, s36, 6
  v_add_u32 v226, s51, v4
  v_lshlrev_b32 v226, 3, v226
  s_mov_b64 exec, 0
  s_bitcmp0_b32 s2, 0
  s_cbranch_scc1 K1_walkL
  s_cmp_eq_u32 s36, 0
  s_cbranch_scc1 K1_st0
  s_cmp_eq_u32 s36, 1
  s_cbranch_scc1 K1_st1
  s_cmp_eq_u32 s36, 2
  s_cbranch_scc1 K1_st15
  s_branch K1_st14
K1_walkL:
  s_cmp_eq_u32 s36, 0
  s_cbranch_scc1 K1_st19
  s_cmp_eq_u32 s36, 1
  s_cbranch_scc1 K1_st18
  s_cmp_eq_u32 s36, 2
  s_cbranch_scc1 K1_st17
  s_branch K1_st16
K1_back:
  s_mov_b64 exec, -1
  s_add_u32 m0, s44, 131072
  s_mov_b32 s41, 524288
  buffer_load_dwordx4 v240, s[12:15], s41 offen offset:0  lds
  buffer_load_dwordx4 v241, s[12:15], s41 offen offset:1024  lds
  buffer_load_dwordx4 v242, s[12:15], s41 offen offset:2048  lds
  buffer_load_dwordx4 v243, s[12:15], s41 offen offset:3072  lds
  s_add_u32 m0, s44, 147456
  s_mov_b32 s42, 221184
  buffer_load_dwordx4 v244, s[16:19], s42 offen offset:0  lds
  buffer_load_dwordx4 v245, s[16:19], s42 offen offset:1024  lds
  buffer_load_dwordx4 v246, s[16:19], s42 offen offset:2048  lds
  buffer_load_dwordx4 v247, s[16:19], s42 offen offset:3072  lds
  s_waitcnt vmcnt(13)
  s_barrier
  ds_read_b128 a[128:131], v152 offset:0
  ds_read_b128 a[132:135], v153 offset:0
  ds_read_b128 a[136:139], v152 offset:2048
  ds_read_b128 a[140:143], v153 offset:2048
  ds_read_b128 a[144:147], v152 offset:4096
  ds_read_b128 a[148:151], v153 offset:4096
  ds_read_b128 a[152:155], v152 offset:6144
  ds_read_b128 a[156:159], v153 offset:6144
  ds_read_b64_tr_b16 a[192:193], v128 offset:32768
  ds_read_b64_tr_b16 a[194:195], v128 offset:33792
  ds_read_b64_tr_b16 a[196:197], v128 offset:40960
  ds_read_b64_tr_b16 a[198:199], v128 offset:41984
  ds_read_b64_tr_b16 a[200:201], v128 offset:32776
  ds_read_b64_tr_b16 a[202:203], v128 offset:33800
  ds_read_b64_tr_b16 a[204:205], v128 offset:40968
  ds_read_b64_tr_b16 a[206:207], v128 offset:41992
  s_waitcnt lgkmcnt(6)
  v_mfma_f32_16x16x32_bf16 v[0:3], a[192:195], a[128:131], 0
  s_waitcnt lgkmcnt(4)
  s_add_u32 m0, s43, 32768
  s_movk_i32 s40, 128
  ds_read_b64_tr_b16 a[208:209], v129 offset:32768
  v_mfma_f32_16x16x32_bf16 v[0:3], a[196:199], a[132:135], v[0:3]
  buffer_load_dwordx4 v232, s[8:11], s40 offen offset:0  lds
  v_mfma_f32_16x16x32_bf16 v[4:7], a[196:199], a[140:143], 0
  ds_read_b64_tr_b16 a[210:211], v129 offset:33792
  v_mfma_f32_16x16x32_bf16 v[4:7], a[192:195], a[136:139], v[4:7]
  v_mfma_f32_16x16x32_bf16 v[8:11], a[192:195], a[144:147], 0
  ds_read_b64_tr_b16 a[212:213], v129 offset:40960
  v_mfma_f32_16x16x32_bf16 v[8:11], a[196:199], a[148:151], v[8:11]
  v_mfma_f32_16x16x32_bf16 v[12:15], a[196:199], a[156:159], 0
  ds_read_b64_tr_b16 a[214:215], v129 offset:41984
  v_mfma_f32_16x16x32_bf16 v[12:15], a[192:195], a[152:155], v[12:15]
  v_smfmac_f32_16x16x64_bf16 v[192:195], v[252:255], a[192:199], v224
  s_waitcnt lgkmcnt(2)
  v_mfma_f32_16x16x32_bf16 v[28:31], a[200:203], a[152:155], 0
  ds_read_b64_tr_b16 a[216:217], v129 offset:32776
  buffer_load_dwordx4 v233, s[8:11], s40 offen offset:1024  lds
  v_mfma_f32_16x16x32_bf16 v[28:31], a[204:207], a[156:159], v[28:31]
  v_mfma_f32_16x16x32_bf16 v[24:27], a[204:207], a[148:151], 0
  ds_read_b64_tr_b16 a[218:219], v129 offset:33800
  v_mfma_f32_16x16x32_bf16 v[24:27], a[200:203], a[144:147], v[24:27]
  v_mfma_f32_16x16x32_bf16 v[20:23], a[200:203], a[136:139], 0
  ds_read_b64_tr_b16 a[220:221], v129 offset:40968
  v_mfma_f32_16x16x32_bf16 v[20:23], a[204:207], a[140:143], v[20:23]
  v_mfma_f32_16x16x32_bf16 v[16:19], a[204:207], a[132:135], 0
  ds_read_b64_tr_b16 a[222:223], v129 offset:41992
  v_mfma_f32_16x16x32_bf16 v[16:19], a[200:203], a[128:131], v[16:19]
  v_smfmac_f32_16x16x64_bf16 v[196:199], v[252:255], a[200:207], v224
  buffer_load_dwordx4 v234, s[8:11], s40 offen offset:2048  lds
  v_mfma_f32_16x16x32_bf16 v[32:35], a[208:211], a[128:131], 0
  s_waitcnt lgkmcnt(2)
  ds_read_b64_tr_b16 a[192:193], v130 offset:32768
  v_mfma_f32_16x16x32_bf16 v[32:35], a[212:215], a[132:135], v[32:35]
  v_mfma_f32_16x16x32_bf16 v[36:39], a[212:215], a[140:143], 0
  ds_read_b64_tr_b16 a[194:195], v130 offset:33792
  v_mfma_f32_16x16x32_bf16 v[36:39], a[208:211], a[136:139], v[36:39]
  v_mfma_f32_16x16x32_bf16 v[40:43], a[208:211], a[144:147], 0
  ds_read_b64_tr_b16 a[196:197], v130 offset:40960
  v_mfma_f32_16x16x32_bf16 v[40:43], a[212:215], a[148:151], v[40:43]
  v_mfma_f32_16x16x32_bf16 v[44:47], a[212:215], a[156:159], 0
  ds_read_b64_tr_b16 a[198:199], v130 offset:41984
  v_mfma_f32_16x16x32_bf16 v[44:47], a[208:211], a[152:155], v[44:47]
  buffer_load_dwordx4 v235, s[8:11], s40 offen offset:3072  lds
  v_mfma_f32_16x16x32_bf16 v[60:63], a[216:219], a[152:155], 0
  s_waitcnt lgkmcnt(2)
  ds_read_b64_tr_b16 a[200:201], v130 offset:32776
  v_mfma_f32_16x16x32_bf16 v[60:63], a[220:223], a[156:159], v[60:63]
  v_mfma_f32_16x16x32_bf16 v[56:59], a[220:223], a[148:151], 0
  ds_read_b64_tr_b16 a[202:203], v130 offset:33800
  v_mfma_f32_16x16x32_bf16 v[56:59], a[216:219], a[144:147], v[56:59]
  v_mfma_f32_16x16x32_bf16 v[52:55], a[216:219], a[136:139], 0
  ds_read_b64_tr_b16 a[204:205], v130 offset:40968
  v_mfma_f32_16x16x32_bf16 v[52:55], a[220:223], a[140:143], v[52:55]
  v_mfma_f32_16x16x32_bf16 v[48:51], a[220:223], a[132:135], 0
  s_add_u32 m0, s43, 36864
  ds_read_b64_tr_b16 a[206:207], v130 offset:41992
  v_mfma_f32_16x16x32_bf16 v[48:51], a[216:219], a[128:131], v[48:51]
  buffer_load_dwordx4 v236, s[8:11], s40 offen offset:0  lds
  v_mfma_f32_16x16x32_bf16 v[64:67], a[192:195], a[128:131], 0
  s_waitcnt lgkmcnt(2)
  ds_read_b64_tr_b16 a[208:209], v131 offset:32768
  v_mfma_f32_16x16x32_bf16 v[64:67], a[196:199], a[132:135], v[64:67]
  v_mfma_f32_16x16x32_bf16 v[68:71], a[196:199], a[140:143], 0
  ds_read_b64_tr_b16 a[210:211], v131 offset:33792
  v_mfma_f32_16x16x32_bf16 v[68:71], a[192:195], a[136:139], v[68:71]
  v_mfma_f32_16x16x32_bf16 v[72:75], a[192:195], a[144:147], 0
  ds_read_b64_tr_b16 a[212:213], v131 offset:40960
  v_mfma_f32_16x16x32_bf16 v[72:75], a[196:199], a[148:151], v[72:75]
  v_mfma_f32_16x16x32_bf16 v[76:79], a[196:199], a[156:159], 0
  ds_read_b64_tr_b16 a[214:215], v131 offset:41984
  v_mfma_f32_16x16x32_bf16 v[76:79], a[192:195], a[152:155], v[76:79]
  buffer_load_dwordx4 v237, s[8:11], s40 offen offset:1024  lds
  v_mfma_f32_16x16x32_bf16 v[92:95], a[200:203], a[152:155], 0
  s_waitcnt lgkmcnt(2)
  ds_read_b64_tr_b16 a[216:217], v131 offset:32776
  v_mfma_f32_16x16x32_bf16 v[92:95], a[204:207], a[156:159], v[92:95]
  v_mfma_f32_16x16x32_bf16 v[88:91], a[204:207], a[148:151], 0
  ds_read_b64_tr_b16 a[218:219], v131 offset:33800
  v_mfma_f32_16x16x32_bf16 v[88:91], a[200:203], a[144:147], v[88:91]
  v_mfma_f32_16x16x32_bf16 v[84:87], a[200:203], a[136:139], 0
  ds_read_b64_tr_b16 a[220:221], v131 offset:40968
  v_mfma_f32_16x16x32_bf16 v[84:87], a[204:207], a[140:143], v[84:87]
  v_mfma_f32_16x16x32_bf16 v[80:83], a[204:207], a[132:135], 0
  ds_read_b64_tr_b16 a[222:223], v131 offset:41992
  v_mfma_f32_16x16x32_bf16 v[80:83], a[200:203], a[128:131], v[80:83]
  buffer_load_dwordx4 v238, s[8:11], s40 offen offset:2048  lds
  v_mfma_f32_16x16x32_bf16 v[96:99], a[208:211], a[128:131], 0
  s_waitcnt lgkmcnt(2)
  ds_read_b64_tr_b16 a[192:193], v136 offset:32768
  v_mfma_f32_16x16x32_bf16 v[96:99], a[212:215], a[132:135], v[96:99]
  v_mfma_f32_16x16x32_bf16 v[100:103], a[212:215], a[140:143], 0
  ds_read_b64_tr_b16 a[194:195], v136 offset:33280
  v_mfma_f32_16x16x32_bf16 v[100:103], a[208:211], a[136:139], v[100:103]
  v_mfma_f32_16x16x32_bf16 v[104:107], a[208:211], a[144:147], 0
  ds_read_b64_tr_b16 a[196:197], v136 offset:36864
  v_mfma_f32_16x16x32_bf16 v[104:107], a[212:215], a[148:151], v[104:107]
  v_mfma_f32_16x16x32_bf16 v[108:111], a[212:215], a[156:159], 0
  ds_read_b64_tr_b16 a[198:199], v136 offset:37376
  v_mfma_f32_16x16x32_bf16 v[108:111], a[208:211], a[152:155], v[108:111]
  buffer_load_dwordx4 v239, s[8:11], s40 offen offset:3072  lds
  v_mfma_f32_16x16x32_bf16 v[124:127], a[216:219], a[152:155], 0
  s_waitcnt lgkmcnt(2)
  ds_read_b64_tr_b16 a[200:201], v137 offset:32768
  v_mfma_f32_16x16x32_bf16 v[124:127], a[220:223], a[156:159], v[124:127]
  v_mfma_f32_16x16x32_bf16 v[120:123], a[220:223], a[148:151], 0
  ds_read_b64_tr_b16 a[202:203], v137 offset:33280
  v_mfma_f32_16x16x32_bf16 v[120:123], a[216:219], a[144:147], v[120:123]
  v_mfma_f32_16x16x32_bf16 v[116:119], a[216:219], a[136:139], 0
  ds_read_b64_tr_b16 a[204:205], v137 offset:36864
  v_mfma_f32_16x16x32_bf16 v[116:119], a[220:223], a[140:143], v[116:119]
  v_mfma_f32_16x16x32_bf16 v[112:115], a[220:223], a[132:135], 0
  ds_read_b64_tr_b16 a[206:207], v137 offset:37376
  v_mfma_f32_16x16x32_bf16 v[112:115], a[216:219], a[128:131], v[112:115]
  s_cmp_ge_u32 s39, 27
  s_cbranch_scc1 K1_sd0
  v_mfma_f32_16x16x32_bf16 a[0:3], a[192:195], a[128:131], 0
  s_waitcnt lgkmcnt(2)
  s_add_u32 m0, s44, 65536
  s_mov_b32 s41, 1048576
  ds_read_b64_tr_b16 a[208:209], v138 offset:32768
  v_mfma_f32_16x16x32_bf16 a[0:3], a[196:199], a[132:135], a[0:3]
  buffer_load_dwordx4 v240, s[12:15], s41 offen offset:0  lds
  v_mfma_f32_16x16x32_bf16 a[4:7], a[196:199], a[140:143], 0
  ds_read_b64_tr_b16 a[210:211], v138 offset:33280
  v_mfma_f32_16x16x32_bf16 a[4:7], a[192:195], a[136:139], a[4:7]
  v_mfma_f32_16x16x32_bf16 a[8:11], a[192:195], a[144:147], 0
  ds_read_b64_tr_b16 a[212:213], v138 offset:36864
  v_mfma_f32_16x16x32_bf16 a[8:11], a[196:199], a[148:151], a[8:11]
  v_mfma_f32_16x16x32_bf16 a[12:15], a[196:199], a[156:159], 0
  ds_read_b64_tr_b16 a[214:215], v138 offset:37376
  v_mfma_f32_16x16x32_bf16 a[12:15], a[192:195], a[152:155], a[12:15]
  v_smfmac_f32_16x16x64_bf16 v[200:203], v[252:255], a[192:199], v224
  v_mfma_f32_16x16x32_bf16 a[28:31], a[200:203], a[152:155], 0
  s_waitcnt lgkmcnt(2)
  ds_read_b64_tr_b16 a[216:217], v139 offset:32768
  buffer_load_dwordx4 v241, s[12:15], s41 offen offset:1024  lds
  v_mfma_f32_16x16x32_bf16 a[28:31], a[204:207], a[156:159], a[28:31]
  v_mfma_f32_16x16x32_bf16 a[24:27], a[204:207], a[148:151], 0
  ds_read_b64_tr_b16 a[218:219], v139 offset:33280
  v_mfma_f32_16x16x32_bf16 a[24:27], a[200:203], a[144:147], a[24:27]
  v_mfma_f32_16x16x32_bf16 a[20:23], a[200:203], a[136:139], 0
  ds_read_b64_tr_b16 a[220:221], v139 offset:36864
  v_mfma_f32_16x16x32_bf16 a[20:23], a[204:207], a[140:143], a[20:23]
  v_mfma_f32_16x16x32_bf16 a[16:19], a[204:207], a[132:135], 0
  ds_read_b64_tr_b16 a[222:223], v139 offset:37376
  v_mfma_f32_16x16x32_bf16 a[16:19], a[200:203], a[128:131], a[16:19]
  v_smfmac_f32_16x16x64_bf16 v[204:207], v[252:255], a[200:207], v224
  buffer_load_dwordx4 v242, s[12:15], s41 offen offset:2048  lds
  v_mfma_f32_16x16x32_bf16 a[32:35], a[208:211], a[128:131], 0
  s_waitcnt lgkmcnt(2)
  ds_read_b64_tr_b16 a[192:193], v140 offset:32768
  v_mfma_f32_16x16x32_bf16 a[32:35], a[212:215], a[132:135], a[32:35]
  v_mfma_f32_16x16x32_bf16 a[36:39], a[212:215], a[140:143], 0
  ds_read_b64_tr_b16 a[194:195], v140 offset:33280
  v_mfma_f32_16x16x32_bf16 a[36:39], a[208:211], a[136:139], a[36:39]
  v_mfma_f32_16x16x32_bf16 a[40:43], a[208:211], a[144:147], 0
  ds_read_b64_tr_b16 a[196:197], v140 offset:36864
  v_mfma_f32_16x16x32_bf16 a[40:43], a[212:215], a[148:151], a[40:43]
  v_mfma_f32_16x16x32_bf16 a[44:47], a[212:215], a[156:159], 0
  ds_read_b64_tr_b16 a[198:199], v140 offset:37376
  v_mfma_f32_16x16x32_bf16 a[44:47], a[208:211], a[152:155], a[44:47]
  buffer_load_dwordx4 v243, s[12:15], s41 offen offset:3072  lds
  v_mfma_f32_16x16x32_bf16 a[60:63], a[216:219], a[152:155], 0
  s_waitcnt lgkmcnt(2)
  ds_read_b64_tr_b16 a[200:201], v141 offset:32768
  v_mfma_f32_16x16x32_bf16 a[60:63], a[220:223], a[156:159], a[60:63]
  v_mfma_f32_16x16x32_bf16 a[56:59], a[220:223], a[148:151], 0
  ds_read_b64_tr_b16 a[202:203], v141 offset:33280
  v_mfma_f32_16x16x32_bf16 a[56:59], a[216:219], a[144:147], a[56:59]
  v_mfma_f32_16x16x32_bf16 a[52:55], a[216:219], a[136:139], 0
  ds_read_b64_tr_b16 a[204:205], v141 offset:36864
  v_mfma_f32_16x16x32_bf16 a[52:55], a[220:223], a[140:143], a[52:55]
  v_mfma_f32_16x16x32_bf16 a[48:51], a[220:223], a[132:135], 0
  s_add_u32 m0, s44, 81920
  s_mov_b32 s42, 442368
  ds_read_b64_tr_b16 a[206:207], v141 offset:37376
  v_mfma_f32_16x16x32_bf16 a[48:51], a[216:219], a[128:131], a[48:51]
  buffer_load_dwordx4 v244, s[16:19], s42 offen offset:0  lds
  v_mfma_f32_16x16x32_bf16 a[64:67], a[192:195], a[128:131], 0
  s_waitcnt lgkmcnt(2)
  ds_read_b64_tr_b16 a[208:209], v142 offset:32768
  v_mfma_f32_16x16x32_bf16 a[64:67], a[196:199], a[132:135], a[64:67]
  v_mfma_f32_16x16x32_bf16 a[68:71], a[196:199], a[140:143], 0
  ds_read_b64_tr_b16 a[210:211], v142 offset:33280
  v_mfma_f32_16x16x32_bf16 a[68:71], a[192:195], a[136:139], a[68:71]
  v_mfma_f32_16x16x32_bf16 a[72:75], a[192:195], a[144:147], 0
  ds_read_b64_tr_b16 a[212:213], v142 offset:36864
  v_mfma_f32_16x16x32_bf16 a[72:75], a[196:199], a[148:151], a[72:75]
  v_mfma_f32_16x16x32_bf16 a[76:79], a[196:199], a[156:159], 0
  ds_read_b64_tr_b16 a[214:215], v142 offset:37376
  v_mfma_f32_16x16x32_bf16 a[76:79], a[192:195], a[152:155], a[76:79]
  buffer_load_dwordx4 v245, s[16:19], s42 offen offset:1024  lds
  v_mfma_f32_16x16x32_bf16 a[92:95], a[200:203], a[152:155], 0
  s_waitcnt lgkmcnt(2)
  ds_read_b64_tr_b16 a[216:217], v143 offset:32768
  v_mfma_f32_16x16x32_bf16 a[92:95], a[204:207], a[156:159], a[92:95]
  v_mfma_f32_16x16x32_bf16 a[88:91], a[204:207], a[148:151], 0
  ds_read_b64_tr_b16 a[218:219], v143 offset:33280
  v_mfma_f32_16x16x32_bf16 a[88:91], a[200:203], a[144:147], a[88:91]
  v_mfma_f32_16x16x32_bf16 a[84:87], a[200:203], a[136:139], 0
  ds_read_b64_tr_b16 a[220:221], v143 offset:36864
  v_mfma_f32_16x16x32_bf16 a[84:87], a[204:207], a[140:143], a[84:87]
  v_mfma_f32_16x16x32_bf16 a[80:83], a[204:207], a[132:135], 0
  ds_read_b64_tr_b16 a[222:223], v143 offset:37376
  v_mfma_f32_16x16x32_bf16 a[80:83], a[200:203], a[128:131], a[80:83]
  buffer_load_dwordx4 v246, s[16:19], s42 offen offset:2048  lds
  v_mfma_f32_16x16x32_bf16 a[96:99], a[208:211], a[128:131], 0
  s_waitcnt vmcnt(7) lgkmcnt(0)
  s_barrier
  ds_read_b128 a[160:163], v152 offset:32768
  v_mfma_f32_16x16x32_bf16 a[96:99], a[212:215], a[132:135], a[96:99]
  ds_read_b128 a[164:167], v153 offset:32768
  v_mfma_f32_16x16x32_bf16 a[100:103], a[212:215], a[140:143], 0
  ds_read_b64_tr_b16 a[192:193], v132 offset:0
  v_mfma_f32_16x16x32_bf16 a[100:103], a[208:211], a[136:139], a[100:103]
  ds_read_b64_tr_b16 a[194:195], v132 offset:1024
  v_mfma_f32_16x16x32_bf16 a[104:107], a[208:211], a[144:147], 0
  ds_read_b64_tr_b16 a[196:197], v132 offset:8192
  v_mfma_f32_16x16x32_bf16 a[104:107], a[212:215], a[148:151], a[104:107]
  ds_read_b64_tr_b16 a[198:199], v132 offset:9216
  v_mfma_f32_16x16x32_bf16 a[108:111], a[212:215], a[156:159], 0
  ds_read_b128 a[168:171], v152 offset:34816
  v_mfma_f32_16x16x32_bf16 a[108:111], a[208:211], a[152:155], a[108:111]
  buffer_load_dwordx4 v247, s[16:19], s42 offen offset:3072  lds
  ds_read_b128 a[172:175], v153 offset:34816
  v_mfma_f32_16x16x32_bf16 a[124:127], a[216:219], a[152:155], 0
  ds_read_b128 a[176:179], v152 offset:36864
  v_mfma_f32_16x16x32_bf16 a[124:127], a[220:223], a[156:159], a[124:127]
  ds_read_b128 a[180:183], v153 offset:36864
  v_mfma_f32_16x16x32_bf16 a[120:123], a[220:223], a[148:151], 0
K1_st0:
  s_cbranch_execz K1_st4
  ds_read_b128 a[184:187], v152 offset:38912
  v_mfma_f32_16x16x32_bf16 a[120:123], a[216:219], a[144:147], a[120:123]
  ds_read_b128 a[188:191], v153 offset:38912
  v_mfma_f32_16x16x32_bf16 a[116:119], a[216:219], a[136:139], 0
  ds_read_b64_tr_b16 a[200:201], v132 offset:8
  v_mfma_f32_16x16x32_bf16 a[116:119], a[220:223], a[140:143], a[116:119]
  ds_read_b64_tr_b16 a[202:203], v132 offset:1032
  v_mfma_f32_16x16x32_bf16 a[112:115], a[220:223], a[132:135], 0
  ds_read_b64_tr_b16 a[204:205], v132 offset:8200
  v_mfma_f32_16x16x32_bf16 a[112:115], a[216:219], a[128:131], a[112:115]
  ds_read_b64_tr_b16 a[206:207], v132 offset:9224
K1_rj0:
  s_waitcnt lgkmcnt(6)
  v_mfma_f32_16x16x32_bf16 v[0:3], a[192:195], a[160:163], v[0:3]
  s_add_u32 m0, s43, 0
  s_movk_i32 s40, 256
  ds_read_b64_tr_b16 a[208:209], v133 offset:0
  v_mfma_f32_16x16x32_bf16 v[0:3], a[196:199], a[164:167], v[0:3]
  buffer_load_dwordx4 v232, s[8:11], s40 offen offset:0  lds
  v_mfma_f32_16x16x32_bf16 v[4:7], a[196:199], a[172:175], v[4:7]
  ds_read_b64_tr_b16 a[210:211], v133 offset:1024
  v_lshlrev_b32 v170, 16, v160
  v_mfma_f32_16x16x32_bf16 v[4:7], a[192:195], a[168:171], v[4:7]
  v_and_b32 v171, 0xffff0000, v160
  v_lshlrev_b32 v172, 16, v161
  v_mfma_f32_16x16x32_bf16 v[8:11], a[192:195], a[176:179], v[8:11]
  ds_read_b64_tr_b16 a[212:213], v133 offset:8192
  v_and_b32 v173, 0xffff0000, v161
  v_mfma_f32_16x16x32_bf16 v[8:11], a[196:199], a[180:183], v[8:11]
  s_waitcnt lgkmcnt(3)
  v_lshlrev_b32 v174, 16, v162
  v_and_b32 v175, 0xffff0000, v162
  v_mfma_f32_16x16x32_bf16 v[12:15], a[196:199], a[188:191], v[12:15]
  ds_read_b64_tr_b16 a[214:215], v133 offset:9216
  v_lshlrev_b32 v176, 16, v163
  v_mfma_f32_16x16x32_bf16 v[12:15], a[192:195], a[184:187], v[12:15]
  v_and_b32 v177, 0xffff0000, v163
  v_lshlrev_b32 v178, 16, v164
  v_smfmac_f32_16x16x64_bf16 v[192:195], v[252:255], a[192:199], v224
  v_and_b32 v179, 0xffff0000, v164
  v_lshlrev_b32 v180, 16, v165
  v_mfma_f32_16x16x32_bf16 v[28:31], a[200:203], a[184:187], v[28:31]
  ds_read_b64_tr_b16 a[216:217], v133 offset:8
  buffer_load_dwordx4 v233, s[8:11], s40 offen offset:1024  lds
  v_mfma_f32_16x16x32_bf16 v[28:31], a[204:207], a[188:191], v[28:31]
  v_and_b32 v181, 0xffff0000, v165
  v_lshlrev_b32 v182, 16, v166
  v_mfma_f32_16x16x32_bf16 v[24:27], a[204:207], a[180:183], v[24:27]
  ds_read_b64_tr_b16 a[218:219], v133 offset:1032
  v_and_b32 v183, 0xffff0000, v166
  v_mfma_f32_16x16x32_bf16 v[24:27], a[200:203], a[176:179], v[24:27]
  v_lshlrev_b32 v184, 16, v167
  v_and_b32 v185, 0xffff0000, v167
  v_mfma_f32_16x16x32_bf16 v[20:23], a[200:203], a[168:171], v[20:23]
  ds_read_b64_tr_b16 a[220:221], v133 offset:8200
  v_lshlrev_b32 v186, 16, v168
  v_mfma_f32_16x16x32_bf16 v[20:23], a[204:207], a[172:175], v[20:23]
  v_and_b32 v187, 0xffff0000, v168
  v_lshlrev_b32 v188, 16, v169
  v_mfma_f32_16x16x32_bf16 v[16:19], a[204:207], a[164:167], v[16:19]
  ds_read_b64_tr_b16 a[222:223], v133 offset:9224
  v_and_b32 v189, 0xffff0000, v169
  v_mfma_f32_16x16x32_bf16 v[16:19], a[200:203], a[160:163], v[16:19]
  v_add_f32 v190, v170, v172
  v_add_f32 v191, v171, v173
  v_smfmac_f32_16x16x64_bf16 v[196:199], v[252:255], a[200:207], v224
  s_waitcnt lgkmcnt(2)
  buffer_load_dwordx4 v234, s[8:11], s40 offen offset:2048  lds
  v_mfma_f32_16x16x32_bf16 v[32:35], a[208:211], a[160:163], v[32:35]
  ds_read_b64_tr_b16 a[192:193], v134 offset:0
  v_add_f32 v190, v190, v174
  v_mfma_f32_16x16x32_bf16 v[32:35], a[212:215], a[164:167], v[32:35]
  v_add_f32 v191, v191, v175
  v_add_f32 v190, v190, v176
  v_mfma_f32_16x16x32_bf16 v[36:39], a[212:215], a[172:175], v[36:39]
  ds_read_b64_tr_b16 a[194:195], v134 offset:1024
  v_add_f32 v191, v191, v177
  v_mfma_f32_16x16x32_bf16 v[36:39], a[208:211], a[168:171], v[36:39]
  v_add_f32 v190, v190, v178
  v_add_f32 v191, v191, v179
  v_mfma_f32_16x16x32_bf16 v[40:43], a[208:211], a[176:179], v[40:43]
  ds_read_b64_tr_b16 a[196:197], v134 offset:8192
  v_add_f32 v190, v190, v180
  v_mfma_f32_16x16x32_bf16 v[40:43], a[212:215], a[180:183], v[40:43]
  v_add_f32 v191, v191, v181
  v_add_f32 v190, v190, v182
  v_mfma_f32_16x16x32_bf16 v[44:47], a[212:215], a[188:191], v[44:47]
  ds_read_b64_tr_b16 a[198:199], v134 offset:9216
  v_add_f32 v191, v191, v183
  v_mfma_f32_16x16x32_bf16 v[44:47], a[208:211], a[184:187], v[44:47]
  buffer_load_dwordx4 v235, s[8:11], s40 offen offset:3072  lds
  v_mfma_f32_16x16x32_bf16 v[60:63], a[216:219], a[184:187], v[60:63]
  s_waitcnt lgkmcnt(2)
  ds_read_b64_tr_b16 a[200:201], v134 offset:8
  v_add_f32 v190, v190, v184
  v_mfma_f32_16x16x32_bf16 v[60:63], a[220:223], a[188:191], v[60:63]
  v_add_f32 v191, v191, v185
  v_add_f32 v190, v190, v186
  v_mfma_f32_16x16x32_bf16 v[56:59], a[220:223], a[180:183], v[56:59]
  ds_read_b64_tr_b16 a[202:203], v134 offset:1032
  v_add_f32 v191, v191, v187
  v_mfma_f32_16x16x32_bf16 v[56:59], a[216:219], a[176:179], v[56:59]
  v_add_f32 v190, v190, v188
  v_add_f32 v191, v191, v189
  v_mfma_f32_16x16x32_bf16 v[52:55], a[216:219], a[168:171], v[52:55]
  ds_read_b64_tr_b16 a[204:205], v134 offset:8200
  v_add_f32 v190, v190, v191
  v_mfma_f32_16x16x32_bf16 v[52:55], a[220:223], a[172:175], v[52:55]
  v_mfma_f32_16x16x32_bf16 v[48:51], a[220:223], a[164:167], v[48:51]
  s_add_u32 m0, s43, 4096
  ds_read_b64_tr_b16 a[206:207], v134 offset:9224
  v_add_f32_dpp v190, v190, v190 quad_perm:[1,0,3,2] row_mask:0xf bank_mask:0xf
  v_mfma_f32_16x16x32_bf16 v[48:51], a[216:219], a[160:163], v[48:51]
  buffer_load_dwordx4 v236, s[8:11], s40 offen offset:0  lds
  v_mfma_f32_16x16x32_bf16 v[64:67], a[192:195], a[160:163], v[64:67]
  s_waitcnt lgkmcnt(2)
  ds_read_b64_tr_b16 a[208:209], v135 offset:0
  v_add_f32_dpp v190, v190, v190 quad_perm:[2,3,0,1] row_mask:0xf bank_mask:0xf
  v_mfma_f32_16x16x32_bf16 v[64:67], a[196:199], a[164:167], v[64:67]
  v_mfma_f32_16x16x32_bf16 v[68:71], a[196:199], a[172:175], v[68:71]
  ds_read_b64_tr_b16 a[210:211], v135 offset:1024
  v_add_f32_dpp v190, v190, v190 row_half_mirror row_mask:0xf bank_mask:0xf
  v_mfma_f32_16x16x32_bf16 v[68:71], a[192:195], a[168:171], v[68:71]
  v_mfma_f32_16x16x32_bf16 v[72:75], a[192:195], a[176:179], v[72:75]
  ds_read_b64_tr_b16 a[212:213], v135 offset:8192
  v_add_f32_dpp v190, v190, v190 row_mirror row_mask:0xf bank_mask:0xf
  v_mfma_f32_16x16x32_bf16 v[72:75], a[196:199], a[180:183], v[72:75]
  v_mov_b32 v191, v190
  v_mfma_f32_16x16x32_bf16 v[76:79], a[196:199], a[188:191], v[76:79]
  ds_read_b64_tr_b16 a[214:215], v135 offset:9216
  v_mfma_f32_16x16x32_bf16 v[76:79], a[192:195], a[184:187], v[76:79]
  buffer_load_dwordx4 v237, s[8:11], s40 offen offset:1024  lds
  v_mfma_f32_16x16x32_bf16 v[92:95], a[200:203], a[184:187], v[92:95]
  s_waitcnt lgkmcnt(2)
  ds_read_b64_tr_b16 a[216:217], v135 offset:8
  v_permlane16_swap_b32 v190, v191
  v_mfma_f32_16x16x32_bf16 v[92:95], a[204:207], a[188:191], v[92:95]
  v_add_f32 v190, v190, v191
  v_mul_f32 v190, 0xbacccccd, v190
  v_mfma_f32_16x16x32_bf16 v[88:91], a[204:207], a[180:183], v[88:91]
  ds_read_b64_tr_b16 a[218:219], v135 offset:1032
  v_add_f32 v170, v170, v190
  v_mfma_f32_16x16x32_bf16 v[88:91], a[200:203], a[176:179], v[88:91]
  v_add_f32 v171, v171, v190
  v_add_f32 v172, v172, v190
  v_mfma_f32_16x16x32_bf16 v[84:87], a[200:203], a[168:171], v[84:87]
  ds_read_b64_tr_b16 a[220:221], v135 offset:8200
  v_add_f32 v173, v173, v190
  v_mfma_f32_16x16x32_bf16 v[84:87], a[204:207], a[172:175], v[84:87]
  v_add_f32 v174, v174, v190
  v_add_f32 v175, v175, v190
  v_mfma_f32_16x16x32_bf16 v[80:83], a[204:207], a[164:167], v[80:83]
  ds_read_b64_tr_b16 a[222:223], v135 offset:9224
  v_add_f32 v176, v176, v190
  v_mfma_f32_16x16x32_bf16 v[80:83], a[200:203], a[160:163], v[80:83]
  buffer_load_dwordx4 v238, s[8:11], s40 offen offset:2048  lds
  v_mfma_f32_16x16x32_bf16 v[96:99], a[208:211], a[160:163], v[96:99]
  s_waitcnt lgkmcnt(2)
  ds_read_b64_tr_b16 a[192:193], v144 offset:0
  v_add_f32 v177, v177, v190
  v_mfma_f32_16x16x32_bf16 v[96:99], a[212:215], a[164:167], v[96:99]
  v_add_f32 v178, v178, v190
  v_add_f32 v179, v179, v190
  v_mfma_f32_16x16x32_bf16 v[100:103], a[212:215], a[172:175], v[100:103]
  ds_read_b64_tr_b16 a[194:195], v144 offset:512
  v_add_f32 v180, v180, v190
  v_mfma_f32_16x16x32_bf16 v[100:103], a[208:211], a[168:171], v[100:103]
  v_add_f32 v181, v181, v190
  v_add_f32 v182, v182, v190
  v_mfma_f32_16x16x32_bf16 v[104:107], a[208:211], a[176:179], v[104:107]
  ds_read_b64_tr_b16 a[196:197], v144 offset:4096
  v_add_f32 v183, v183, v190
  v_mfma_f32_16x16x32_bf16 v[104:107], a[212:215], a[180:183], v[104:107]
  v_add_f32 v184, v184, v190
  v_add_f32 v185, v185, v190
  v_mfma_f32_16x16x32_bf16 v[108:111], a[212:215], a[188:191], v[108:111]
  ds_read_b64_tr_b16 a[198:199], v144 offset:4608
  v_add_f32 v186, v186, v190
  v_mfma_f32_16x16x32_bf16 v[108:111], a[208:211], a[184:187], v[108:111]
  buffer_load_dwordx4 v239, s[8:11], s40 offen offset:3072  lds
  v_mfma_f32_16x16x32_bf16 v[124:127], a[216:219], a[184:187], v[124:127]
  s_waitcnt lgkmcnt(2)
  ds_read_b64_tr_b16 a[200:201], v145 offset:0
  v_add_f32 v187, v187, v190
  v_mfma_f32_16x16x32_bf16 v[124:127], a[220:223], a[188:191], v[124:127]
  v_add_f32 v188, v188, v190
  v_add_f32 v189, v189, v190
  v_mfma_f32_16x16x32_bf16 v[120:123], a[220:223], a[180:183], v[120:123]
  ds_read_b64_tr_b16 a[202:203], v145 offset:512
  v_mul_f32 v191, v170, v170
  v_mfma_f32_16x16x32_bf16 v[120:123], a[216:219], a[176:179], v[120:123]
  v_mul_f32 v159, v171, v171
  v_fmac_f32 v191, v172, v172
  v_mfma_f32_16x16x32_bf16 v[116:119], a[216:219], a[168:171], v[116:119]
  ds_read_b64_tr_b16 a[204:205], v145 offset:4096
  v_fmac_f32 v159, v173, v173
  v_mfma_f32_16x16x32_bf16 v[116:119], a[220:223], a[172:175], v[116:119]
  v_fmac_f32 v191, v174, v174
  v_fmac_f32 v159, v175, v175
  v_mfma_f32_16x16x32_bf16 v[112:115], a[220:223], a[164:167], v[112:115]
  ds_read_b64_tr_b16 a[206:207], v145 offset:4608
  v_fmac_f32 v191, v176, v176
  v_mfma_f32_16x16x32_bf16 v[112:115], a[216:219], a[160:163], v[112:115]
  s_cmp_ge_u32 s39, 27
  v_fmac_f32 v159, v177, v177
  v_fmac_f32 v191, v178, v178
  s_cbranch_scc1 K1_sd1
  v_mfma_f32_16x16x32_bf16 a[0:3], a[192:195], a[160:163], a[0:3]
  s_waitcnt lgkmcnt(2)
  s_add_u32 m0, s44, 98304
  s_mov_b32 s41, 1572864
  ds_read_b64_tr_b16 a[208:209], v146 offset:0
  v_fmac_f32 v159, v179, v179
  v_mfma_f32_16x16x32_bf16 a[0:3], a[196:199], a[164:167], a[0:3]
  buffer_load_dwordx4 v240, s[12:15], s41 offen offset:0  lds
  v_mfma_f32_16x16x32_bf16 a[4:7], a[196:199], a[172:175], a[4:7]
  ds_read_b64_tr_b16 a[210:211], v146 offset:512
  v_fmac_f32 v191, v180, v180
  v_mfma_f32_16x16x32_bf16 a[4:7], a[192:195], a[168:171], a[4:7]
  v_fmac_f32 v159, v181, v181
  v_fmac_f32 v191, v182, v182
  v_mfma_f32_16x16x32_bf16 a[8:11], a[192:195], a[176:179], a[8:11]
  ds_read_b64_tr_b16 a[212:213], v146 offset:4096
  v_fmac_f32 v159, v183, v183
  v_mfma_f32_16x16x32_bf16 a[8:11], a[196:199], a[180:183], a[8:11]
  v_fmac_f32 v191, v184, v184
  v_fmac_f32 v159, v185, v185
  v_mfma_f32_16x16x32_bf16 a[12:15], a[196:199], a[188:191], a[12:15]
  ds_read_b64_tr_b16 a[214:215], v146 offset:4608
  v_fmac_f32 v191, v186, v186
  v_mfma_f32_16x16x32_bf16 a[12:15], a[192:195], a[184:187], a[12:15]
  v_fmac_f32 v159, v187, v187
  v_fmac_f32 v191, v188, v188
  v_smfmac_f32_16x16x64_bf16 v[200:203], v[252:255], a[192:199], v224
  v_fmac_f32 v159, v189, v189
  v_add_f32 v191, v191, v159
  v_mfma_f32_16x16x32_bf16 a[28:31], a[200:203], a[184:187], a[28:31]
  s_waitcnt lgkmcnt(2)
  ds_read_b64_tr_b16 a[216:217], v147 offset:0
  buffer_load_dwordx4 v241, s[12:15], s41 offen offset:1024  lds
  v_mfma_f32_16x16x32_bf16 a[28:31], a[204:207], a[188:191], a[28:31]
  v_add_f32_dpp v191, v191, v191 quad_perm:[1,0,3,2] row_mask:0xf bank_mask:0xf
  v_mfma_f32_16x16x32_bf16 a[24:27], a[204:207], a[180:183], a[24:27]
  ds_read_b64_tr_b16 a[218:219], v147 offset:512
  v_mfma_f32_16x16x32_bf16 a[24:27], a[200:203], a[176:179], a[24:27]
  v_add_f32_dpp v191, v191, v191 quad_perm:[2,3,0,1] row_mask:0xf bank_mask:0xf
  v_mfma_f32_16x16x32_bf16 a[20:23], a[200:203], a[168:171], a[20:23]
  ds_read_b64_tr_b16 a[220:221], v147 offset:4096
  v_mfma_f32_16x16x32_bf16 a[20:23], a[204:207], a[172:175], a[20:23]
  v_add_f32_dpp v191, v191, v191 row_half_mirror row_mask:0xf bank_mask:0xf
  v_mfma_f32_16x16x32_bf16 a[16:19], a[204:207], a[164:167], a[16:19]
  ds_read_b64_tr_b16 a[222:223], v147 offset:4608
  v_mfma_f32_16x16x32_bf16 a[16:19], a[200:203], a[160:163], a[16:19]
  v_add_f32_dpp v191, v191, v191 row_mirror row_mask:0xf bank_mask:0xf
  v_smfmac_f32_16x16x64_bf16 v[204:207], v[252:255], a[200:207], v224
  buffer_load_dwordx4 v242, s[12:15], s41 offen offset:2048  lds
  v_mfma_f32_16x16x32_bf16 a[32:35], a[208:211], a[160:163], a[32:35]
  s_waitcnt lgkmcnt(2)
  ds_read_b64_tr_b16 a[192:193], v148 offset:0
  v_mov_b32 v159, v191
  v_mfma_f32_16x16x32_bf16 a[32:35], a[212:215], a[164:167], a[32:35]
  v_mfma_f32_16x16x32_bf16 a[36:39], a[212:215], a[172:175], a[36:39]
  ds_read_b64_tr_b16 a[194:195], v148 offset:512
  v_permlane16_swap_b32 v191, v159
  v_mfma_f32_16x16x32_bf16 a[36:39], a[208:211], a[168:171], a[36:39]
  v_add_f32 v191, v191, v159
  v_mul_f32 v191, 0x3acccccd, v191
  v_mfma_f32_16x16x32_bf16 a[40:43], a[208:211], a[176:179], a[40:43]
  ds_read_b64_tr_b16 a[196:197], v148 offset:4096
  v_cvt_pk_bf16_f32 v190, v190, v190
  v_mfma_f32_16x16x32_bf16 a[40:43], a[212:215], a[180:183], a[40:43]
  v_and_b32 v190, 0xffff0000, v190
  v_cvt_pk_bf16_f32 v191, v191, v191
  v_mfma_f32_16x16x32_bf16 a[44:47], a[212:215], a[188:191], a[44:47]
  ds_read_b64_tr_b16 a[198:199], v148 offset:4608
  v_and_b32 v191, 0xffff0000, v191
  v_mfma_f32_16x16x32_bf16 a[44:47], a[208:211], a[184:187], a[44:47]
  buffer_load_dwordx4 v243, s[12:15], s41 offen offset:3072  lds
  v_mfma_f32_16x16x32_bf16 a[60:63], a[216:219], a[184:187], a[60:63]
  s_waitcnt lgkmcnt(2)
  ds_read_b64_tr_b16 a[200:201], v149 offset:0
  v_add_f32 v191, 0x3727c5ac, v191
  v_mfma_f32_16x16x32_bf16 a[60:63], a[220:223], a[188:191], a[60:63]
  v_cvt_pk_bf16_f32 v191, v191, v191
  v_and_b32 v191, 0xffff0000, v191
  v_mfma_f32_16x16x32_bf16 a[56:59], a[220:223], a[180:183], a[56:59]
  ds_read_b64_tr_b16 a[202:203], v149 offset:512
  v_sqrt_f32 v191, v191
  v_mfma_f32_16x16x32_bf16 a[56:59], a[216:219], a[176:179], a[56:59]
  v_cvt_pk_bf16_f32 v191, v191, v191
  v_and_b32 v191, 0xffff0000, v191
  v_mfma_f32_16x16x32_bf16 a[52:55], a[216:219], a[168:171], a[52:55]
  ds_read_b64_tr_b16 a[204:205], v149 offset:4096
  v_rcp_f32 v191, v191
  v_mfma_f32_16x16x32_bf16 a[52:55], a[220:223], a[172:175], a[52:55]
  v_lshlrev_b32 v156, 3, v156
  v_mfma_f32_16x16x32_bf16 a[48:51], a[220:223], a[164:167], a[48:51]
  s_add_u32 m0, s44, 114688
  s_mov_b32 s42, 663552
  ds_read_b64_tr_b16 a[206:207], v149 offset:4608
  v_mfma_f32_16x16x32_bf16 a[48:51], a[216:219], a[160:163], a[48:51]
  buffer_load_dwordx4 v244, s[16:19], s42 offen offset:0  lds
  v_mfma_f32_16x16x32_bf16 a[64:67], a[192:195], a[160:163], a[64:67]
  s_waitcnt lgkmcnt(2)
  ds_read_b64_tr_b16 a[208:209], v150 offset:0
  v_mfma_f32_16x16x32_bf16 a[64:67], a[196:199], a[164:167], a[64:67]
  v_mfma_f32_16x16x32_bf16 a[68:71], a[196:199], a[172:175], a[68:71]
  ds_read_b64_tr_b16 a[210:211], v150 offset:512
  v_mfma_f32_16x16x32_bf16 a[68:71], a[192:195], a[168:171], a[68:71]
  v_mfma_f32_16x16x32_bf16 a[72:75], a[192:195], a[176:179], a[72:75]
  ds_read_b64_tr_b16 a[212:213], v150 offset:4096
  v_mfma_f32_16x16x32_bf16 a[72:75], a[196:199], a[180:183], a[72:75]
  v_mfma_f32_16x16x32_bf16 a[76:79], a[196:199], a[188:191], a[76:79]
  ds_read_b64_tr_b16 a[214:215], v150 offset:4608
  v_mfma_f32_16x16x32_bf16 a[76:79], a[192:195], a[184:187], a[76:79]
  buffer_load_dwordx4 v245, s[16:19], s42 offen offset:1024  lds
  v_mfma_f32_16x16x32_bf16 a[92:95], a[200:203], a[184:187], a[92:95]
  s_waitcnt lgkmcnt(2)
  ds_read_b64_tr_b16 a[216:217], v151 offset:0
  v_mfma_f32_16x16x32_bf16 a[92:95], a[204:207], a[188:191], a[92:95]
  v_mfma_f32_16x16x32_bf16 a[88:91], a[204:207], a[180:183], a[88:91]
  ds_read_b64_tr_b16 a[218:219], v151 offset:512
  v_mfma_f32_16x16x32_bf16 a[88:91], a[200:203], a[176:179], a[88:91]
  v_mfma_f32_16x16x32_bf16 a[84:87], a[200:203], a[168:171], a[84:87]
  ds_read_b64_tr_b16 a[220:221], v151 offset:4096
  v_mfma_f32_16x16x32_bf16 a[84:87], a[204:207], a[172:175], a[84:87]
  v_mfma_f32_16x16x32_bf16 a[80:83], a[204:207], a[164:167], a[80:83]
  ds_read_b64_tr_b16 a[222:223], v151 offset:4608
  v_mfma_f32_16x16x32_bf16 a[80:83], a[200:203], a[160:163], a[80:83]
  buffer_load_dwordx4 v246, s[16:19], s42 offen offset:2048  lds
  v_mfma_f32_16x16x32_bf16 a[96:99], a[208:211], a[160:163], a[96:99]
  s_waitcnt vmcnt(7) lgkmcnt(0)
  s_barrier
  ds_read_b128 a[128:131], v152 offset:0
  v_mfma_f32_16x16x32_bf16 a[96:99], a[212:215], a[164:167], a[96:99]
  ds_read_b128 a[132:135], v153 offset:0
  v_mfma_f32_16x16x32_bf16 a[100:103], a[212:215], a[172:175], a[100:103]
  ds_read_b64_tr_b16 a[192:193], v128 offset:0
  v_mfma_f32_16x16x32_bf16 a[100:103], a[208:211], a[168:171], a[100:103]
  ds_read_b64_tr_b16 a[194:195], v128 offset:1024
  v_mfma_f32_16x16x32_bf16 a[104:107], a[208:211], a[176:179], a[104:107]
  ds_read_b64_tr_b16 a[196:197], v128 offset:8192
  v_mfma_f32_16x16x32_bf16 a[104:107], a[212:215], a[180:183], a[104:107]
  ds_read_b64_tr_b16 a[198:199], v128 offset:9216
  v_mfma_f32_16x16x32_bf16 a[108:111], a[212:215], a[188:191], a[108:111]
  ds_read_b128 a[136:139], v152 offset:2048
  v_mfma_f32_16x16x32_bf16 a[108:111], a[208:211], a[184:187], a[108:111]
  buffer_load_dwordx4 v247, s[16:19], s42 offen offset:3072  lds
  ds_read_b128 a[140:143], v153 offset:2048
  v_mfma_f32_16x16x32_bf16 a[124:127], a[216:219], a[184:187], a[124:127]
  ds_read_b128 a[144:147], v152 offset:4096
  v_mfma_f32_16x16x32_bf16 a[124:127], a[220:223], a[188:191], a[124:127]
  ds_read_b128 a[148:151], v153 offset:4096
  v_mfma_f32_16x16x32_bf16 a[120:123], a[220:223], a[180:183], a[120:123]
  ds_read_b128 a[152:155], v152 offset:6144
  v_mfma_f32_16x16x32_bf16 a[120:123], a[216:219], a[176:179], a[120:123]
  ds_read_b128 a[156:159], v153 offset:6144
  v_mfma_f32_16x16x32_bf16 a[116:119], a[216:219], a[168:171], a[116:119]
  ds_read_b64_tr_b16 a[200:201], v128 offset:8
  v_mfma_f32_16x16x32_bf16 a[116:119], a[220:223], a[172:175], a[116:119]
  ds_read_b64_tr_b16 a[202:203], v128 offset:1032
  v_mfma_f32_16x16x32_bf16 a[112:115], a[220:223], a[164:167], a[112:115]
  ds_read_b64_tr_b16 a[204:205], v128 offset:8200
  v_mfma_f32_16x16x32_bf16 a[112:115], a[216:219], a[160:163], a[112:115]
  ds_read_b64_tr_b16 a[206:207], v128 offset:9224
K1_rj1:
  s_mov_b32 exec_lo, 1
  s_mov_b32 exec_hi, 1
  buffer_store_dwordx2 v[190:191], v156, s[80:83], 0 offen sc1
  s_mov_b64 exec, 1
  buffer_store_dword v155, v155, s[20:23], s53 offen sc1
  buffer_store_dword v155, v155, s[20:23], s97 offen sc1
  buffer_store_dword v155, v155, s[20:23], s60 offen sc1
  s_mov_b64 exec, -1
  s_waitcnt lgkmcnt(6)
  v_mfma_f32_16x16x32_bf16 v[0:3], a[192:195], a[128:131], v[0:3]
  s_add_u32 m0, s43, 32768
  s_movk_i32 s40, 384
  ds_read_b64_tr_b16 a[208:209], v129 offset:0
  v_mfma_f32_16x16x32_bf16 v[0:3], a[196:199], a[132:135], v[0:3]
  buffer_load_dwordx4 v232, s[8:11], s40 offen offset:0  lds
  v_mfma_f32_16x16x32_bf16 v[4:7], a[196:199], a[140:143], v[4:7]
  ds_read_b64_tr_b16 a[210:211], v129 offset:1024
  v_mfma_f32_16x16x32_bf16 v[4:7], a[192:195], a[136:139], v[4:7]
  v_mfma_f32_16x16x32_bf16 v[8:11], a[192:195], a[144:147], v[8:11]
  ds_read_b64_tr_b16 a[212:213], v129 offset:8192
  v_mfma_f32_16x16x32_bf16 v[8:11], a[196:199], a[148:151], v[8:11]
  s_waitcnt lgkmcnt(3)
  v_mfma_f32_16x16x32_bf16 v[12:15], a[196:199], a[156:159], v[12:15]
  ds_read_b64_tr_b16 a[214:215], v129 offset:9216
  v_mfma_f32_16x16x32_bf16 v[12:15], a[192:195], a[152:155], v[12:15]
  v_smfmac_f32_16x16x64_bf16 v[192:195], v[252:255], a[192:199], v224
  v_mfma_f32_16x16x32_bf16 v[28:31], a[200:203], a[152:155], v[28:31]
  ds_read_b64_tr_b16 a[216:217], v129 offset:8
  buffer_load_dwordx4 v233, s[8:11], s40 offen offset:1024  lds
  v_mfma_f32_16x16x32_bf16 v[28:31], a[204:207], a[156:159], v[28:31]
  v_mfma_f32_16x16x32_bf16 v[24:27], a[204:207], a[148:151], v[24:27]
  ds_read_b64_tr_b16 a[218:219], v129 offset:1032
  v_mfma_f32_16x16x32_bf16 v[24:27], a[200:203], a[144:147], v[24:27]
  v_mfma_f32_16x16x32_bf16 v[20:23], a[200:203], a[136:139], v[20:23]
  ds_read_b64_tr_b16 a[220:221], v129 offset:8200
  v_mfma_f32_16x16x32_bf16 v[20:23], a[204:207], a[140:143], v[20:23]
  v_mfma_f32_16x16x32_bf16 v[16:19], a[204:207], a[132:135], v[16:19]
  ds_read_b64_tr_b16 a[222:223], v129 offset:9224
  v_mfma_f32_16x16x32_bf16 v[16:19], a[200:203], a[128:131], v[16:19]
  v_smfmac_f32_16x16x64_bf16 v[196:199], v[252:255], a[200:207], v224
  s_waitcnt lgkmcnt(2)
  buffer_load_dwordx4 v234, s[8:11], s40 offen offset:2048  lds
  v_mfma_f32_16x16x32_bf16 v[32:35], a[208:211], a[128:131], v[32:35]
  ds_read_b64_tr_b16 a[192:193], v130 offset:0
  v_mfma_f32_16x16x32_bf16 v[32:35], a[212:215], a[132:135], v[32:35]
  v_mfma_f32_16x16x32_bf16 v[36:39], a[212:215], a[140:143], v[36:39]
  ds_read_b64_tr_b16 a[194:195], v130 offset:1024
  v_mfma_f32_16x16x32_bf16 v[36:39], a[208:211], a[136:139], v[36:39]
  v_mfma_f32_16x16x32_bf16 v[40:43], a[208:211], a[144:147], v[40:43]
  ds_read_b64_tr_b16 a[196:197], v130 offset:8192
  v_mfma_f32_16x16x32_bf16 v[40:43], a[212:215], a[148:151], v[40:43]
  v_mfma_f32_16x16x32_bf16 v[44:47], a[212:215], a[156:159], v[44:47]
  ds_read_b64_tr_b16 a[198:199], v130 offset:9216
  v_mfma_f32_16x16x32_bf16 v[44:47], a[208:211], a[152:155], v[44:47]
  buffer_load_dwordx4 v235, s[8:11], s40 offen offset:3072  lds
  v_mfma_f32_16x16x32_bf16 v[60:63], a[216:219], a[152:155], v[60:63]
  s_waitcnt lgkmcnt(2)
  ds_read_b64_tr_b16 a[200:201], v130 offset:8
  v_mfma_f32_16x16x32_bf16 v[60:63], a[220:223], a[156:159], v[60:63]
  v_mfma_f32_16x16x32_bf16 v[56:59], a[220:223], a[148:151], v[56:59]
  ds_read_b64_tr_b16 a[202:203], v130 offset:1032
  v_mfma_f32_16x16x32_bf16 v[56:59], a[216:219], a[144:147], v[56:59]
  v_mfma_f32_16x16x32_bf16 v[52:55], a[216:219], a[136:139], v[52:55]
  ds_read_b64_tr_b16 a[204:205], v130 offset:8200
  v_mfma_f32_16x16x32_bf16 v[52:55], a[220:223], a[140:143], v[52:55]
  v_mfma_f32_16x16x32_bf16 v[48:51], a[220:223], a[132:135], v[48:51]
  s_add_u32 m0, s43, 36864
  ds_read_b64_tr_b16 a[206:207], v130 offset:9224
  v_mfma_f32_16x16x32_bf16 v[48:51], a[216:219], a[128:131], v[48:51]
  buffer_load_dwordx4 v236, s[8:11], s40 offen offset:0  lds
  v_mfma_f32_16x16x32_bf16 v[64:67], a[192:195], a[128:131], v[64:67]
  s_waitcnt lgkmcnt(2)
  ds_read_b64_tr_b16 a[208:209], v131 offset:0
  v_mfma_f32_16x16x32_bf16 v[64:67], a[196:199], a[132:135], v[64:67]
  v_mfma_f32_16x16x32_bf16 v[68:71], a[196:199], a[140:143], v[68:71]
  ds_read_b64_tr_b16 a[210:211], v131 offset:1024
  v_mfma_f32_16x16x32_bf16 v[68:71], a[192:195], a[136:139], v[68:71]
  v_mfma_f32_16x16x32_bf16 v[72:75], a[192:195], a[144:147], v[72:75]
  ds_read_b64_tr_b16 a[212:213], v131 offset:8192
  v_mfma_f32_16x16x32_bf16 v[72:75], a[196:199], a[148:151], v[72:75]
  v_mfma_f32_16x16x32_bf16 v[76:79], a[196:199], a[156:159], v[76:79]
  ds_read_b64_tr_b16 a[214:215], v131 offset:9216
  v_mfma_f32_16x16x32_bf16 v[76:79], a[192:195], a[152:155], v[76:79]
  buffer_load_dwordx4 v237, s[8:11], s40 offen offset:1024  lds
  v_mfma_f32_16x16x32_bf16 v[92:95], a[200:203], a[152:155], v[92:95]
  s_waitcnt lgkmcnt(2)
  ds_read_b64_tr_b16 a[216:217], v131 offset:8
  v_mfma_f32_16x16x32_bf16 v[92:95], a[204:207], a[156:159], v[92:95]
  v_mfma_f32_16x16x32_bf16 v[88:91], a[204:207], a[148:151], v[88:91]
  ds_read_b64_tr_b16 a[218:219], v131 offset:1032
  v_mfma_f32_16x16x32_bf16 v[88:91], a[200:203], a[144:147], v[88:91]
  v_mfma_f32_16x16x32_bf16 v[84:87], a[200:203], a[136:139], v[84:87]
  ds_read_b64_tr_b16 a[220:221], v131 offset:8200
  v_mfma_f32_16x16x32_bf16 v[84:87], a[204:207], a[140:143], v[84:87]
  v_mfma_f32_16x16x32_bf16 v[80:83], a[204:207], a[132:135], v[80:83]
  ds_read_b64_tr_b16 a[222:223], v131 offset:9224
  v_mfma_f32_16x16x32_bf16 v[80:83], a[200:203], a[128:131], v[80:83]
  buffer_load_dwordx4 v238, s[8:11], s40 offen offset:2048  lds
  v_mfma_f32_16x16x32_bf16 v[96:99], a[208:211], a[128:131], v[96:99]
  s_waitcnt lgkmcnt(2)
  ds_read_b64_tr_b16 a[192:193], v136 offset:0
  v_mfma_f32_16x16x32_bf16 v[96:99], a[212:215], a[132:135], v[96:99]
  v_mfma_f32_16x16x32_bf16 v[100:103], a[212:215], a[140:143], v[100:103]
  ds_read_b64_tr_b16 a[194:195], v136 offset:512
  v_mfma_f32_16x16x32_bf16 v[100:103], a[208:211], a[136:139], v[100:103]
  v_mfma_f32_16x16x32_bf16 v[104:107], a[208:211], a[144:147], v[104:107]
  ds_read_b64_tr_b16 a[196:197], v136 offset:4096
  v_mfma_f32_16x16x32_bf16 v[104:107], a[212:215], a[148:151], v[104:107]
  v_mfma_f32_16x16x32_bf16 v[108:111], a[212:215], a[156:159], v[108:111]
  ds_read_b64_tr_b16 a[198:199], v136 offset:4608
  v_mfma_f32_16x16x32_bf16 v[108:111], a[208:211], a[152:155], v[108:111]
  buffer_load_dwordx4 v239, s[8:11], s40 offen offset:3072  lds
  v_mfma_f32_16x16x32_bf16 v[124:127], a[216:219], a[152:155], v[124:127]
  s_waitcnt lgkmcnt(2)
  ds_read_b64_tr_b16 a[200:201], v137 offset:0
  v_mfma_f32_16x16x32_bf16 v[124:127], a[220:223], a[156:159], v[124:127]
  v_mfma_f32_16x16x32_bf16 v[120:123], a[220:223], a[148:151], v[120:123]
  ds_read_b64_tr_b16 a[202:203], v137 offset:512
  v_mfma_f32_16x16x32_bf16 v[120:123], a[216:219], a[144:147], v[120:123]
  v_mfma_f32_16x16x32_bf16 v[116:119], a[216:219], a[136:139], v[116:119]
  ds_read_b64_tr_b16 a[204:205], v137 offset:4096
  v_mfma_f32_16x16x32_bf16 v[116:119], a[220:223], a[140:143], v[116:119]
  v_mfma_f32_16x16x32_bf16 v[112:115], a[220:223], a[132:135], v[112:115]
  ds_read_b64_tr_b16 a[206:207], v137 offset:4608
  v_mfma_f32_16x16x32_bf16 v[112:115], a[216:219], a[128:131], v[112:115]
  s_cmp_ge_u32 s39, 27
  s_cbranch_scc1 K1_sd2
  v_mfma_f32_16x16x32_bf16 a[0:3], a[192:195], a[128:131], a[0:3]
  s_waitcnt lgkmcnt(2)
  s_add_u32 m0, s44, 131072
  s_mov_b32 s41, 2097152
  ds_read_b64_tr_b16 a[208:209], v138 offset:0
  v_mfma_f32_16x16x32_bf16 a[0:3], a[196:199], a[132:135], a[0:3]
  buffer_load_dwordx4 v240, s[12:15], s41 offen offset:0  lds
  v_mfma_f32_16x16x32_bf16 a[4:7], a[196:199], a[140:143], a[4:7]
  ds_read_b64_tr_b16 a[210:211], v138 offset:512
  v_mfma_f32_16x16x32_bf16 a[4:7], a[192:195], a[136:139], a[4:7]
  v_mfma_f32_16x16x32_bf16 a[8:11], a[192:195], a[144:147], a[8:11]
  ds_read_b64_tr_b16 a[212:213], v138 offset:4096
  v_mfma_f32_16x16x32_bf16 a[8:11], a[196:199], a[148:151], a[8:11]
  v_mfma_f32_16x16x32_bf16 a[12:15], a[196:199], a[156:159], a[12:15]
  ds_read_b64_tr_b16 a[214:215], v138 offset:4608
  v_mfma_f32_16x16x32_bf16 a[12:15], a[192:195], a[152:155], a[12:15]
  v_smfmac_f32_16x16x64_bf16 v[200:203], v[252:255], a[192:199], v224
  v_mfma_f32_16x16x32_bf16 a[28:31], a[200:203], a[152:155], a[28:31]
  s_waitcnt lgkmcnt(2)
  ds_read_b64_tr_b16 a[216:217], v139 offset:0
  buffer_load_dwordx4 v241, s[12:15], s41 offen offset:1024  lds
  v_mfma_f32_16x16x32_bf16 a[28:31], a[204:207], a[156:159], a[28:31]
  v_mfma_f32_16x16x32_bf16 a[24:27], a[204:207], a[148:151], a[24:27]
  ds_read_b64_tr_b16 a[218:219], v139 offset:512
  v_mfma_f32_16x16x32_bf16 a[24:27], a[200:203], a[144:147], a[24:27]
  v_mfma_f32_16x16x32_bf16 a[20:23], a[200:203], a[136:139], a[20:23]
  ds_read_b64_tr_b16 a[220:221], v139 offset:4096
  v_mfma_f32_16x16x32_bf16 a[20:23], a[204:207], a[140:143], a[20:23]
  v_mfma_f32_16x16x32_bf16 a[16:19], a[204:207], a[132:135], a[16:19]
  ds_read_b64_tr_b16 a[222:223], v139 offset:4608
  v_mfma_f32_16x16x32_bf16 a[16:19], a[200:203], a[128:131], a[16:19]
  v_smfmac_f32_16x16x64_bf16 v[204:207], v[252:255], a[200:207], v224
  buffer_load_dwordx4 v242, s[12:15], s41 offen offset:2048  lds
  v_mfma_f32_16x16x32_bf16 a[32:35], a[208:211], a[128:131], a[32:35]
  s_waitcnt lgkmcnt(2)
  ds_read_b64_tr_b16 a[192:193], v140 offset:0
  v_mfma_f32_16x16x32_bf16 a[32:35], a[212:215], a[132:135], a[32:35]
  v_mfma_f32_16x16x32_bf16 a[36:39], a[212:215], a[140:143], a[36:39]
  ds_read_b64_tr_b16 a[194:195], v140 offset:512
  v_mfma_f32_16x16x32_bf16 a[36:39], a[208:211], a[136:139], a[36:39]
  v_mfma_f32_16x16x32_bf16 a[40:43], a[208:211], a[144:147], a[40:43]
  ds_read_b64_tr_b16 a[196:197], v140 offset:4096
  v_mfma_f32_16x16x32_bf16 a[40:43], a[212:215], a[148:151], a[40:43]
  v_mfma_f32_16x16x32_bf16 a[44:47], a[212:215], a[156:159], a[44:47]
  ds_read_b64_tr_b16 a[198:199], v140 offset:4608
  v_mfma_f32_16x16x32_bf16 a[44:47], a[208:211], a[152:155], a[44:47]
  buffer_load_dwordx4 v243, s[12:15], s41 offen offset:3072  lds
  v_mfma_f32_16x16x32_bf16 a[60:63], a[216:219], a[152:155], a[60:63]
  s_waitcnt lgkmcnt(2)
  ds_read_b64_tr_b16 a[200:201], v141 offset:0
  v_mfma_f32_16x16x32_bf16 a[60:63], a[220:223], a[156:159], a[60:63]
  v_mfma_f32_16x16x32_bf16 a[56:59], a[220:223], a[148:151], a[56:59]
  ds_read_b64_tr_b16 a[202:203], v141 offset:512
  v_mfma_f32_16x16x32_bf16 a[56:59], a[216:219], a[144:147], a[56:59]
  v_mfma_f32_16x16x32_bf16 a[52:55], a[216:219], a[136:139], a[52:55]
  ds_read_b64_tr_b16 a[204:205], v141 offset:4096
  v_mfma_f32_16x16x32_bf16 a[52:55], a[220:223], a[140:143], a[52:55]
  v_mfma_f32_16x16x32_bf16 a[48:51], a[220:223], a[132:135], a[48:51]
  s_add_u32 m0, s44, 147456
  s_mov_b32 s42, 884736
  ds_read_b64_tr_b16 a[206:207], v141 offset:4608
  v_mfma_f32_16x16x32_bf16 a[48:51], a[216:219], a[128:131], a[48:51]
  buffer_load_dwordx4 v244, s[16:19], s42 offen offset:0  lds
  v_mfma_f32_16x16x32_bf16 a[64:67], a[192:195], a[128:131], a[64:67]
  s_waitcnt lgkmcnt(2)
  ds_read_b64_tr_b16 a[208:209], v142 offset:0
  v_mfma_f32_16x16x32_bf16 a[64:67], a[196:199], a[132:135], a[64:67]
  v_mfma_f32_16x16x32_bf16 a[68:71], a[196:199], a[140:143], a[68:71]
  ds_read_b64_tr_b16 a[210:211], v142 offset:512
  v_mfma_f32_16x16x32_bf16 a[68:71], a[192:195], a[136:139], a[68:71]
  v_mfma_f32_16x16x32_bf16 a[72:75], a[192:195], a[144:147], a[72:75]
  ds_read_b64_tr_b16 a[212:213], v142 offset:4096
  v_mfma_f32_16x16x32_bf16 a[72:75], a[196:199], a[148:151], a[72:75]
  v_mfma_f32_16x16x32_bf16 a[76:79], a[196:199], a[156:159], a[76:79]
  ds_read_b64_tr_b16 a[214:215], v142 offset:4608
  v_mfma_f32_16x16x32_bf16 a[76:79], a[192:195], a[152:155], a[76:79]
  buffer_load_dwordx4 v245, s[16:19], s42 offen offset:1024  lds
  v_mfma_f32_16x16x32_bf16 a[92:95], a[200:203], a[152:155], a[92:95]
  s_waitcnt lgkmcnt(2)
  ds_read_b64_tr_b16 a[216:217], v143 offset:0
  v_mfma_f32_16x16x32_bf16 a[92:95], a[204:207], a[156:159], a[92:95]
K1_st1:
  s_cbranch_execz K1_st5
  v_mfma_f32_16x16x32_bf16 a[88:91], a[204:207], a[148:151], a[88:91]
  ds_read_b64_tr_b16 a[218:219], v143 offset:512
  v_mfma_f32_16x16x32_bf16 a[88:91], a[200:203], a[144:147], a[88:91]
  v_mfma_f32_16x16x32_bf16 a[84:87], a[200:203], a[136:139], a[84:87]
  ds_read_b64_tr_b16 a[220:221], v143 offset:4096
  v_mfma_f32_16x16x32_bf16 a[84:87], a[204:207], a[140:143], a[84:87]
  v_mfma_f32_16x16x32_bf16 a[80:83], a[204:207], a[132:135], a[80:83]
  ds_read_b64_tr_b16 a[222:223], v143 offset:4608
  v_mfma_f32_16x16x32_bf16 a[80:83], a[200:203], a[128:131], a[80:83]
  buffer_load_dwordx4 v246, s[16:19], s42 offen offset:2048  lds
  v_mfma_f32_16x16x32_bf16 a[96:99], a[208:211], a[128:131], a[96:99]
  s_waitcnt vmcnt(7) lgkmcnt(0)
  s_barrier
  ds_read_b128 a[160:163], v152 offset:32768
  v_mfma_f32_16x16x32_bf16 a[96:99], a[212:215], a[132:135], a[96:99]
  ds_read_b128 a[164:167], v153 offset:32768
  v_mfma_f32_16x16x32_bf16 a[100:103], a[212:215], a[140:143], a[100:103]
  ds_read_b64_tr_b16 a[192:193], v128 offset:32768
  v_mfma_f32_16x16x32_bf16 a[100:103], a[208:211], a[136:139], a[100:103]
  ds_read_b64_tr_b16 a[194:195], v128 offset:33792
  v_mfma_f32_16x16x32_bf16 a[104:107], a[208:211], a[144:147], a[104:107]
  ds_read_b64_tr_b16 a[196:197], v128 offset:40960
  v_mfma_f32_16x16x32_bf16 a[104:107], a[212:215], a[148:151], a[104:107]
  ds_read_b64_tr_b16 a[198:199], v128 offset:41984
  v_mfma_f32_16x16x32_bf16 a[108:111], a[212:215], a[156:159], a[108:111]
  ds_read_b128 a[168:171], v152 offset:34816
  v_mfma_f32_16x16x32_bf16 a[108:111], a[208:211], a[152:155], a[108:111]
  buffer_load_dwordx4 v247, s[16:19], s42 offen offset:3072  lds
  ds_read_b128 a[172:175], v153 offset:34816
  v_mfma_f32_16x16x32_bf16 a[124:127], a[216:219], a[152:155], a[124:127]
  ds_read_b128 a[176:179], v152 offset:36864
  v_mfma_f32_16x16x32_bf16 a[124:127], a[220:223], a[156:159], a[124:127]
  ds_read_b128 a[180:183], v153 offset:36864
  v_mfma_f32_16x16x32_bf16 a[120:123], a[220:223], a[148:151], a[120:123]
  ds_read_b128 a[184:187], v152 offset:38912
  v_mfma_f32_16x16x32_bf16 a[120:123], a[216:219], a[144:147], a[120:123]
  ds_read_b128 a[188:191], v153 offset:38912
  v_mfma_f32_16x16x32_bf16 a[116:119], a[216:219], a[136:139], a[116:119]
  ds_read_b64_tr_b16 a[200:201], v128 offset:32776
  v_mfma_f32_16x16x32_bf16 a[116:119], a[220:223], a[140:143], a[116:119]
  ds_read_b64_tr_b16 a[202:203], v128 offset:33800
  v_mfma_f32_16x16x32_bf16 a[112:115], a[220:223], a[132:135], a[112:115]
  ds_read_b64_tr_b16 a[204:205], v128 offset:40968
  v_mfma_f32_16x16x32_bf16 a[112:115], a[216:219], a[128:131], a[112:115]
  ds_read_b64_tr_b16 a[206:207], v128 offset:41992
K1_rj2:
  s_waitcnt lgkmcnt(6)
  v_mfma_f32_16x16x32_bf16 v[0:3], a[192:195], a[160:163], v[0:3]
  s_add_u32 m0, s43, 0
  s_movk_i32 s40, 512
  ds_read_b64_tr_b16 a[208:209], v129 offset:32768
  v_mfma_f32_16x16x32_bf16 v[0:3], a[196:199], a[164:167], v[0:3]
  buffer_load_dwordx4 v232, s[8:11], s40 offen offset:0  lds
  v_mfma_f32_16x16x32_bf16 v[4:7], a[196:199], a[172:175], v[4:7]
  ds_read_b64_tr_b16 a[210:211], v129 offset:33792
  v_mfma_f32_16x16x32_bf16 v[4:7], a[192:195], a[168:171], v[4:7]
  v_mfma_f32_16x16x32_bf16 v[8:11], a[192:195], a[176:179], v[8:11]
  ds_read_b64_tr_b16 a[212:213], v129 offset:40960
  v_mfma_f32_16x16x32_bf16 v[8:11], a[196:199], a[180:183], v[8:11]
  s_waitcnt lgkmcnt(3)
  v_mfma_f32_16x16x32_bf16 v[12:15], a[196:199], a[188:191], v[12:15]
  ds_read_b64_tr_b16 a[214:215], v129 offset:41984
  v_mfma_f32_16x16x32_bf16 v[12:15], a[192:195], a[184:187], v[12:15]
  buffer_load_dwordx4 v233, s[8:11], s40 offen offset:1024  lds
  v_smfmac_f32_16x16x64_bf16 v[192:195], v[252:255], a[192:199], v224
  v_mfma_f32_16x16x32_bf16 v[28:31], a[200:203], a[184:187], v[28:31]
  ds_read_b64_tr_b16 a[216:217], v129 offset:32776
  v_mfma_f32_16x16x32_bf16 v[28:31], a[204:207], a[188:191], v[28:31]
  v_mfma_f32_16x16x32_bf16 v[24:27], a[204:207], a[180:183], v[24:27]
  ds_read_b64_tr_b16 a[218:219], v129 offset:33800
  buffer_load_dwordx4 v234, s[8:11], s40 offen offset:2048  lds
  v_mfma_f32_16x16x32_bf16 v[24:27], a[200:203], a[176:179], v[24:27]
  v_mfma_f32_16x16x32_bf16 v[20:23], a[200:203], a[168:171], v[20:23]
  ds_read_b64_tr_b16 a[220:221], v129 offset:40968
  v_mfma_f32_16x16x32_bf16 v[20:23], a[204:207], a[172:175], v[20:23]
  v_mfma_f32_16x16x32_bf16 v[16:19], a[204:207], a[164:167], v[16:19]
  ds_read_b64_tr_b16 a[222:223], v129 offset:41992
  v_mfma_f32_16x16x32_bf16 v[16:19], a[200:203], a[160:163], v[16:19]
  v_smfmac_f32_16x16x64_bf16 v[196:199], v[252:255], a[200:207], v224
  s_waitcnt lgkmcnt(2)
  buffer_load_dwordx4 v235, s[8:11], s40 offen offset:3072  lds
  v_mfma_f32_16x16x32_bf16 v[32:35], a[208:211], a[160:163], v[32:35]
  ds_read_b64_tr_b16 a[192:193], v130 offset:32768
  v_mfma_f32_16x16x32_bf16 v[32:35], a[212:215], a[164:167], v[32:35]
  v_mfma_f32_16x16x32_bf16 v[36:39], a[212:215], a[172:175], v[36:39]
  ds_read_b64_tr_b16 a[194:195], v130 offset:33792
  v_mfma_f32_16x16x32_bf16 v[36:39], a[208:211], a[168:171], v[36:39]
  v_mfma_f32_16x16x32_bf16 v[40:43], a[208:211], a[176:179], v[40:43]
  s_add_u32 m0, s43, 4096
  ds_read_b64_tr_b16 a[196:197], v130 offset:40960
  v_mfma_f32_16x16x32_bf16 v[40:43], a[212:215], a[180:183], v[40:43]
  buffer_load_dwordx4 v236, s[8:11], s40 offen offset:0  lds
  v_mfma_f32_16x16x32_bf16 v[44:47], a[212:215], a[188:191], v[44:47]
  ds_read_b64_tr_b16 a[198:199], v130 offset:41984
  v_mfma_f32_16x16x32_bf16 v[44:47], a[208:211], a[184:187], v[44:47]
  v_mfma_f32_16x16x32_bf16 v[60:63], a[216:219], a[184:187], v[60:63]
  s_waitcnt lgkmcnt(2)
  ds_read_b64_tr_b16 a[200:201], v130 offset:32776
  v_mfma_f32_16x16x32_bf16 v[60:63], a[220:223], a[188:191], v[60:63]
  v_mfma_f32_16x16x32_bf16 v[56:59], a[220:223], a[180:183], v[56:59]
  ds_read_b64_tr_b16 a[202:203], v130 offset:33800
  v_mfma_f32_16x16x32_bf16 v[56:59], a[216:219], a[176:179], v[56:59]
  buffer_load_dwordx4 v237, s[8:11], s40 offen offset:1024  lds
  v_mfma_f32_16x16x32_bf16 v[52:55], a[216:219], a[168:171], v[52:55]
  ds_read_b64_tr_b16 a[204:205], v130 offset:40968
  v_mfma_f32_16x16x32_bf16 v[52:55], a[220:223], a[172:175], v[52:55]
  v_mfma_f32_16x16x32_bf16 v[48:51], a[220:223], a[164:167], v[48:51]
  ds_read_b64_tr_b16 a[206:207], v130 offset:41992
  v_mfma_f32_16x16x32_bf16 v[48:51], a[216:219], a[160:163], v[48:51]
  buffer_load_dwordx4 v238, s[8:11], s40 offen offset:2048  lds
  v_mfma_f32_16x16x32_bf16 v[64:67], a[192:195], a[160:163], v[64:67]
  s_waitcnt lgkmcnt(2)
  ds_read_b64_tr_b16 a[208:209], v131 offset:32768
  v_mfma_f32_16x16x32_bf16 v[64:67], a[196:199], a[164:167], v[64:67]
  v_mfma_f32_16x16x32_bf16 v[68:71], a[196:199], a[172:175], v[68:71]
  ds_read_b64_tr_b16 a[210:211], v131 offset:33792
  v_mfma_f32_16x16x32_bf16 v[68:71], a[192:195], a[168:171], v[68:71]
  v_mfma_f32_16x16x32_bf16 v[72:75], a[192:195], a[176:179], v[72:75]
  ds_read_b64_tr_b16 a[212:213], v131 offset:40960
  v_mfma_f32_16x16x32_bf16 v[72:75], a[196:199], a[180:183], v[72:75]
  buffer_load_dwordx4 v239, s[8:11], s40 offen offset:3072  lds
  v_mfma_f32_16x16x32_bf16 v[76:79], a[196:199], a[188:191], v[76:79]
  ds_read_b64_tr_b16 a[214:215], v131 offset:41984
  v_mfma_f32_16x16x32_bf16 v[76:79], a[192:195], a[184:187], v[76:79]
  v_mfma_f32_16x16x32_bf16 v[92:95], a[200:203], a[184:187], v[92:95]
  s_waitcnt lgkmcnt(2)
  ds_read_b64_tr_b16 a[216:217], v131 offset:32776
  v_mfma_f32_16x16x32_bf16 v[92:95], a[204:207], a[188:191], v[92:95]
  v_mfma_f32_16x16x32_bf16 v[88:91], a[204:207], a[180:183], v[88:91]
  s_add_u32 m0, s44, 65536
  s_mov_b32 s41, 2621440
  ds_read_b64_tr_b16 a[218:219], v131 offset:33800
  v_mfma_f32_16x16x32_bf16 v[88:91], a[200:203], a[176:179], v[88:91]
  buffer_load_dwordx4 v240, s[12:15], s41 offen offset:0  lds
  v_mfma_f32_16x16x32_bf16 v[84:87], a[200:203], a[168:171], v[84:87]
  ds_read_b64_tr_b16 a[220:221], v131 offset:40968
  v_mfma_f32_16x16x32_bf16 v[84:87], a[204:207], a[172:175], v[84:87]
  v_mfma_f32_16x16x32_bf16 v[80:83], a[204:207], a[164:167], v[80:83]
  ds_read_b64_tr_b16 a[222:223], v131 offset:41992
  v_mfma_f32_16x16x32_bf16 v[80:83], a[200:203], a[160:163], v[80:83]
  buffer_load_dwordx4 v241, s[12:15], s41 offen offset:1024  lds
  v_mfma_f32_16x16x32_bf16 v[96:99], a[208:211], a[160:163], v[96:99]
  s_waitcnt lgkmcnt(2)
  ds_read_b64_tr_b16 a[192:193], v136 offset:32768
  v_mfma_f32_16x16x32_bf16 v[96:99], a[212:215], a[164:167], v[96:99]
  v_mfma_f32_16x16x32_bf16 v[100:103], a[212:215], a[172:175], v[100:103]
  ds_read_b64_tr_b16 a[194:195], v136 offset:33280
  v_mfma_f32_16x16x32_bf16 v[100:103], a[208:211], a[168:171], v[100:103]
  v_mfma_f32_16x16x32_bf16 v[104:107], a[208:211], a[176:179], v[104:107]
  ds_read_b64_tr_b16 a[196:197], v136 offset:36864
  v_mfma_f32_16x16x32_bf16 v[104:107], a[212:215], a[180:183], v[104:107]
  buffer_load_dwordx4 v242, s[12:15], s41 offen offset:2048  lds
  v_mfma_f32_16x16x32_bf16 v[108:111], a[212:215], a[188:191], v[108:111]
  ds_read_b64_tr_b16 a[198:199], v136 offset:37376
  v_mfma_f32_16x16x32_bf16 v[108:111], a[208:211], a[184:187], v[108:111]
  v_mfma_f32_16x16x32_bf16 v[124:127], a[216:219], a[184:187], v[124:127]
  s_waitcnt lgkmcnt(2)
  ds_read_b64_tr_b16 a[200:201], v137 offset:32768
  v_mfma_f32_16x16x32_bf16 v[124:127], a[220:223], a[188:191], v[124:127]
  v_mfma_f32_16x16x32_bf16 v[120:123], a[220:223], a[180:183], v[120:123]
  ds_read_b64_tr_b16 a[202:203], v137 offset:33280
  v_mfma_f32_16x16x32_bf16 v[120:123], a[216:219], a[176:179], v[120:123]
  buffer_load_dwordx4 v243, s[12:15], s41 offen offset:3072  lds
  v_mfma_f32_16x16x32_bf16 v[116:119], a[216:219], a[168:171], v[116:119]
  ds_read_b64_tr_b16 a[204:205], v137 offset:36864
  v_mfma_f32_16x16x32_bf16 v[116:119], a[220:223], a[172:175], v[116:119]
  v_mfma_f32_16x16x32_bf16 v[112:115], a[220:223], a[164:167], v[112:115]
  ds_read_b64_tr_b16 a[206:207], v137 offset:37376
  v_mfma_f32_16x16x32_bf16 v[112:115], a[216:219], a[160:163], v[112:115]
  s_cmp_ge_u32 s39, 27
  s_cbranch_scc1 K1_sd3
  v_mfma_f32_16x16x32_bf16 a[0:3], a[192:195], a[160:163], a[0:3]
  s_waitcnt lgkmcnt(2)
  s_add_u32 m0, s44, 81920
  s_mov_b32 s42, 1105920
  ds_read_b64_tr_b16 a[208:209], v138 offset:32768
  v_mfma_f32_16x16x32_bf16 a[0:3], a[196:199], a[164:167], a[0:3]
  buffer_load_dwordx4 v244, s[16:19], s42 offen offset:0  lds
  v_mfma_f32_16x16x32_bf16 a[4:7], a[196:199], a[172:175], a[4:7]
  ds_read_b64_tr_b16 a[210:211], v138 offset:33280
  v_mfma_f32_16x16x32_bf16 a[4:7], a[192:195], a[168:171], a[4:7]
  v_mfma_f32_16x16x32_bf16 a[8:11], a[192:195], a[176:179], a[8:11]
  ds_read_b64_tr_b16 a[212:213], v138 offset:36864
  v_mfma_f32_16x16x32_bf16 a[8:11], a[196:199], a[180:183], a[8:11]
  buffer_load_dwordx4 v245, s[16:19], s42 offen offset:1024  lds
  v_mfma_f32_16x16x32_bf16 a[12:15], a[196:199], a[188:191], a[12:15]
  ds_read_b64_tr_b16 a[214:215], v138 offset:37376
  v_mfma_f32_16x16x32_bf16 a[12:15], a[192:195], a[184:187], a[12:15]
  v_smfmac_f32_16x16x64_bf16 v[200:203], v[252:255], a[192:199], v224
  v_mfma_f32_16x16x32_bf16 a[28:31], a[200:203], a[184:187], a[28:31]
  s_waitcnt lgkmcnt(2)
  ds_read_b64_tr_b16 a[216:217], v139 offset:32768
  v_mfma_f32_16x16x32_bf16 a[28:31], a[204:207], a[188:191], a[28:31]
  v_mfma_f32_16x16x32_bf16 a[24:27], a[204:207], a[180:183], a[24:27]
  ds_read_b64_tr_b16 a[218:219], v139 offset:33280
  buffer_load_dwordx4 v246, s[16:19], s42 offen offset:2048  lds
  v_mfma_f32_16x16x32_bf16 a[24:27], a[200:203], a[176:179], a[24:27]
  v_mfma_f32_16x16x32_bf16 a[20:23], a[200:203], a[168:171], a[20:23]
  ds_read_b64_tr_b16 a[220:221], v139 offset:36864
  v_mfma_f32_16x16x32_bf16 a[20:23], a[204:207], a[172:175], a[20:23]
  v_mfma_f32_16x16x32_bf16 a[16:19], a[204:207], a[164:167], a[16:19]
  ds_read_b64_tr_b16 a[222:223], v139 offset:37376
  v_mfma_f32_16x16x32_bf16 a[16:19], a[200:203], a[160:163], a[16:19]
  v_smfmac_f32_16x16x64_bf16 v[204:207], v[252:255], a[200:207], v224
  buffer_load_dwordx4 v247, s[16:19], s42 offen offset:3072  lds
  v_mfma_f32_16x16x32_bf16 a[32:35], a[208:211], a[160:163], a[32:35]
  s_waitcnt lgkmcnt(2)
  ds_read_b64_tr_b16 a[192:193], v140 offset:32768
  v_mfma_f32_16x16x32_bf16 a[32:35], a[212:215], a[164:167], a[32:35]
  v_mfma_f32_16x16x32_bf16 a[36:39], a[212:215], a[172:175], a[36:39]
  s_add_u32 m0, s43, 32768
  s_movk_i32 s40, 640
  ds_read_b64_tr_b16 a[194:195], v140 offset:33280
  v_mfma_f32_16x16x32_bf16 a[36:39], a[208:211], a[168:171], a[36:39]
  buffer_load_dwordx4 v232, s[8:11], s40 offen offset:0  lds
  v_mfma_f32_16x16x32_bf16 a[40:43], a[208:211], a[176:179], a[40:43]
  ds_read_b64_tr_b16 a[196:197], v140 offset:36864
  v_mfma_f32_16x16x32_bf16 a[40:43], a[212:215], a[180:183], a[40:43]
  v_mfma_f32_16x16x32_bf16 a[44:47], a[212:215], a[188:191], a[44:47]
  ds_read_b64_tr_b16 a[198:199], v140 offset:37376
  v_mfma_f32_16x16x32_bf16 a[44:47], a[208:211], a[184:187], a[44:47]
  v_mfma_f32_16x16x32_bf16 a[60:63], a[216:219], a[184:187], a[60:63]
  s_waitcnt lgkmcnt(2)
  ds_read_b64_tr_b16 a[200:201], v141 offset:32768
  v_mfma_f32_16x16x32_bf16 a[60:63], a[220:223], a[188:191], a[60:63]
  buffer_load_dwordx4 v233, s[8:11], s40 offen offset:1024  lds
  v_mfma_f32_16x16x32_bf16 a[56:59], a[220:223], a[180:183], a[56:59]
  ds_read_b64_tr_b16 a[202:203], v141 offset:33280
  v_mfma_f32_16x16x32_bf16 a[56:59], a[216:219], a[176:179], a[56:59]
  v_mfma_f32_16x16x32_bf16 a[52:55], a[216:219], a[168:171], a[52:55]
  ds_read_b64_tr_b16 a[204:205], v141 offset:36864
  v_mfma_f32_16x16x32_bf16 a[52:55], a[220:223], a[172:175], a[52:55]
  v_mfma_f32_16x16x32_bf16 a[48:51], a[220:223], a[164:167], a[48:51]
  ds_read_b64_tr_b16 a[206:207], v141 offset:37376
  v_mfma_f32_16x16x32_bf16 a[48:51], a[216:219], a[160:163], a[48:51]
  buffer_load_dwordx4 v234, s[8:11], s40 offen offset:2048  lds
  v_mfma_f32_16x16x32_bf16 a[64:67], a[192:195], a[160:163], a[64:67]
  s_waitcnt lgkmcnt(2)
  ds_read_b64_tr_b16 a[208:209], v142 offset:32768
  v_mfma_f32_16x16x32_bf16 a[64:67], a[196:199], a[164:167], a[64:67]
  v_mfma_f32_16x16x32_bf16 a[68:71], a[196:199], a[172:175], a[68:71]
  ds_read_b64_tr_b16 a[210:211], v142 offset:33280
  v_mfma_f32_16x16x32_bf16 a[68:71], a[192:195], a[168:171], a[68:71]
  buffer_load_dwordx4 v235, s[8:11], s40 offen offset:3072  lds
  v_mfma_f32_16x16x32_bf16 a[72:75], a[192:195], a[176:179], a[72:75]
  ds_read_b64_tr_b16 a[212:213], v142 offset:36864
  v_mfma_f32_16x16x32_bf16 a[72:75], a[196:199], a[180:183], a[72:75]
  v_mfma_f32_16x16x32_bf16 a[76:79], a[196:199], a[188:191], a[76:79]
  ds_read_b64_tr_b16 a[214:215], v142 offset:37376
  v_mfma_f32_16x16x32_bf16 a[76:79], a[192:195], a[184:187], a[76:79]
  v_mfma_f32_16x16x32_bf16 a[92:95], a[200:203], a[184:187], a[92:95]
  s_waitcnt lgkmcnt(2)
  s_add_u32 m0, s43, 36864
  ds_read_b64_tr_b16 a[216:217], v143 offset:32768
  v_mfma_f32_16x16x32_bf16 a[92:95], a[204:207], a[188:191], a[92:95]
  buffer_load_dwordx4 v236, s[8:11], s40 offen offset:0  lds
  v_mfma_f32_16x16x32_bf16 a[88:91], a[204:207], a[180:183], a[88:91]
  ds_read_b64_tr_b16 a[218:219], v143 offset:33280
  v_mfma_f32_16x16x32_bf16 a[88:91], a[200:203], a[176:179], a[88:91]
  v_mfma_f32_16x16x32_bf16 a[84:87], a[200:203], a[168:171], a[84:87]
  ds_read_b64_tr_b16 a[220:221], v143 offset:36864
  v_mfma_f32_16x16x32_bf16 a[84:87], a[204:207], a[172:175], a[84:87]
  v_mfma_f32_16x16x32_bf16 a[80:83], a[204:207], a[164:167], a[80:83]
  ds_read_b64_tr_b16 a[222:223], v143 offset:37376
  v_mfma_f32_16x16x32_bf16 a[80:83], a[200:203], a[160:163], a[80:83]
  buffer_load_dwordx4 v237, s[8:11], s40 offen offset:1024  lds
  v_mfma_f32_16x16x32_bf16 a[96:99], a[208:211], a[160:163], a[96:99]
  s_waitcnt vmcnt(14) lgkmcnt(0)
  s_barrier
  ds_read_b128 a[128:131], v152 offset:0
  v_mfma_f32_16x16x32_bf16 a[96:99], a[212:215], a[164:167], a[96:99]
  ds_read_b128 a[132:135], v153 offset:0
  v_mfma_f32_16x16x32_bf16 a[100:103], a[212:215], a[172:175], a[100:103]
  ds_read_b64_tr_b16 a[192:193], v132 offset:0
  v_mfma_f32_16x16x32_bf16 a[100:103], a[208:211], a[168:171], a[100:103]
  ds_read_b64_tr_b16 a[194:195], v132 offset:1024
  v_mfma_f32_16x16x32_bf16 a[104:107], a[208:211], a[176:179], a[104:107]
  ds_read_b64_tr_b16 a[196:197], v132 offset:8192
  v_mfma_f32_16x16x32_bf16 a[104:107], a[212:215], a[180:183], a[104:107]
  buffer_load_dwordx4 v238, s[8:11], s40 offen offset:2048  lds
  ds_read_b64_tr_b16 a[198:199], v132 offset:9216
  v_mfma_f32_16x16x32_bf16 a[108:111], a[212:215], a[188:191], a[108:111]
  ds_read_b128 a[136:139], v152 offset:2048
  v_mfma_f32_16x16x32_bf16 a[108:111], a[208:211], a[184:187], a[108:111]
  ds_read_b128 a[140:143], v153 offset:2048
  v_mfma_f32_16x16x32_bf16 a[124:127], a[216:219], a[184:187], a[124:127]
  ds_read_b128 a[144:147], v152 offset:4096
  v_mfma_f32_16x16x32_bf16 a[124:127], a[220:223], a[188:191], a[124:127]
  buffer_load_dwordx4 v239, s[8:11], s40 offen offset:3072  lds
  ds_read_b128 a[148:151], v153 offset:4096
  v_mfma_f32_16x16x32_bf16 a[120:123], a[220:223], a[180:183], a[120:123]
  ds_read_b128 a[152:155], v152 offset:6144
  v_mfma_f32_16x16x32_bf16 a[120:123], a[216:219], a[176:179], a[120:123]
  ds_read_b128 a[156:159], v153 offset:6144
  v_mfma_f32_16x16x32_bf16 a[116:119], a[216:219], a[168:171], a[116:119]
  ds_read_b64_tr_b16 a[200:201], v132 offset:8
  v_mfma_f32_16x16x32_bf16 a[116:119], a[220:223], a[172:175], a[116:119]
  ds_read_b64_tr_b16 a[202:203], v132 offset:1032
  v_mfma_f32_16x16x32_bf16 a[112:115], a[220:223], a[164:167], a[112:115]
  ds_read_b64_tr_b16 a[204:205], v132 offset:8200
  v_mfma_f32_16x16x32_bf16 a[112:115], a[216:219], a[160:163], a[112:115]
  ds_read_b64_tr_b16 a[206:207], v132 offset:9224
K1_rj3:
  s_cmp_lg_u32 s36, 0
  s_cbranch_scc1 K1_arrS
  s_lshl_b32 s51, s38, 5
  v_mov_b32 v225, 1
  s_mov_b64 exec, 1
  buffer_atomic_add v225, v223, s[4:7], s51 offen offset:0 sc1
  s_mov_b64 exec, -1
K1_arrS:
  s_waitcnt lgkmcnt(6)
  v_mfma_f32_16x16x32_bf16 v[0:3], a[192:195], a[128:131], v[0:3]
  s_add_u32 m0, s44, 98304
  s_mov_b32 s41, 3145728
  ds_read_b64_tr_b16 a[208:209], v133 offset:0
  v_mfma_f32_16x16x32_bf16 v[0:3], a[196:199], a[132:135], v[0:3]
  buffer_load_dwordx4 v240, s[12:15], s41 offen offset:0  lds
  v_mfma_f32_16x16x32_bf16 v[4:7], a[196:199], a[140:143], v[4:7]
  ds_read_b64_tr_b16 a[210:211], v133 offset:1024
  v_mfma_f32_16x16x32_bf16 v[4:7], a[192:195], a[136:139], v[4:7]
  v_mfma_f32_16x16x32_bf16 v[8:11], a[192:195], a[144:147], v[8:11]
  ds_read_b64_tr_b16 a[212:213], v133 offset:8192
  v_mfma_f32_16x16x32_bf16 v[8:11], a[196:199], a[148:151], v[8:11]
  s_waitcnt lgkmcnt(3)
  v_mfma_f32_16x16x32_bf16 v[12:15], a[196:199], a[156:159], v[12:15]
  ds_read_b64_tr_b16 a[214:215], v133 offset:9216
  v_mfma_f32_16x16x32_bf16 v[12:15], a[192:195], a[152:155], v[12:15]
  v_smfmac_f32_16x16x64_bf16 v[192:195], v[252:255], a[192:199], v224
  v_mfma_f32_16x16x32_bf16 v[28:31], a[200:203], a[152:155], v[28:31]
  ds_read_b64_tr_b16 a[216:217], v133 offset:8
  buffer_load_dwordx4 v241, s[12:15], s41 offen offset:1024  lds
  v_mfma_f32_16x16x32_bf16 v[28:31], a[204:207], a[156:159], v[28:31]
  v_mfma_f32_16x16x32_bf16 v[24:27], a[204:207], a[148:151], v[24:27]
  ds_read_b64_tr_b16 a[218:219], v133 offset:1032
  v_mfma_f32_16x16x32_bf16 v[24:27], a[200:203], a[144:147], v[24:27]
  v_mfma_f32_16x16x32_bf16 v[20:23], a[200:203], a[136:139], v[20:23]
  ds_read_b64_tr_b16 a[220:221], v133 offset:8200
  v_mfma_f32_16x16x32_bf16 v[20:23], a[204:207], a[140:143], v[20:23]
  v_mfma_f32_16x16x32_bf16 v[16:19], a[204:207], a[132:135], v[16:19]
  ds_read_b64_tr_b16 a[222:223], v133 offset:9224
  v_mfma_f32_16x16x32_bf16 v[16:19], a[200:203], a[128:131], v[16:19]
  v_smfmac_f32_16x16x64_bf16 v[196:199], v[252:255], a[200:207], v224
  s_waitcnt lgkmcnt(2)
  buffer_load_dwordx4 v242, s[12:15], s41 offen offset:2048  lds
  v_mfma_f32_16x16x32_bf16 v[32:35], a[208:211], a[128:131], v[32:35]
  ds_read_b64_tr_b16 a[192:193], v134 offset:0
  v_mfma_f32_16x16x32_bf16 v[32:35], a[212:215], a[132:135], v[32:35]
  v_mfma_f32_16x16x32_bf16 v[36:39], a[212:215], a[140:143], v[36:39]
  ds_read_b64_tr_b16 a[194:195], v134 offset:1024
  v_mfma_f32_16x16x32_bf16 v[36:39], a[208:211], a[136:139], v[36:39]
  v_mfma_f32_16x16x32_bf16 v[40:43], a[208:211], a[144:147], v[40:43]
  ds_read_b64_tr_b16 a[196:197], v134 offset:8192
  v_mfma_f32_16x16x32_bf16 v[40:43], a[212:215], a[148:151], v[40:43]
  v_mfma_f32_16x16x32_bf16 v[44:47], a[212:215], a[156:159], v[44:47]
  ds_read_b64_tr_b16 a[198:199], v134 offset:9216
  v_mfma_f32_16x16x32_bf16 v[44:47], a[208:211], a[152:155], v[44:47]
  buffer_load_dwordx4 v243, s[12:15], s41 offen offset:3072  lds
  v_mfma_f32_16x16x32_bf16 v[60:63], a[216:219], a[152:155], v[60:63]
  s_waitcnt lgkmcnt(2)
  ds_read_b64_tr_b16 a[200:201], v134 offset:8
  v_mfma_f32_16x16x32_bf16 v[60:63], a[220:223], a[156:159], v[60:63]
  v_mfma_f32_16x16x32_bf16 v[56:59], a[220:223], a[148:151], v[56:59]
  ds_read_b64_tr_b16 a[202:203], v134 offset:1032
  v_mfma_f32_16x16x32_bf16 v[56:59], a[216:219], a[144:147], v[56:59]
  v_mfma_f32_16x16x32_bf16 v[52:55], a[216:219], a[136:139], v[52:55]
  ds_read_b64_tr_b16 a[204:205], v134 offset:8200
  v_mfma_f32_16x16x32_bf16 v[52:55], a[220:223], a[140:143], v[52:55]
  v_mfma_f32_16x16x32_bf16 v[48:51], a[220:223], a[132:135], v[48:51]
  s_add_u32 m0, s44, 114688
  s_mov_b32 s42, 1327104
  ds_read_b64_tr_b16 a[206:207], v134 offset:9224
  v_mfma_f32_16x16x32_bf16 v[48:51], a[216:219], a[128:131], v[48:51]
  buffer_load_dwordx4 v244, s[16:19], s42 offen offset:0  lds
  v_mfma_f32_16x16x32_bf16 v[64:67], a[192:195], a[128:131], v[64:67]
  s_waitcnt lgkmcnt(2)
  ds_read_b64_tr_b16 a[208:209], v135 offset:0
  v_mfma_f32_16x16x32_bf16 v[64:67], a[196:199], a[132:135], v[64:67]
  v_mfma_f32_16x16x32_bf16 v[68:71], a[196:199], a[140:143], v[68:71]
  ds_read_b64_tr_b16 a[210:211], v135 offset:1024
  v_mfma_f32_16x16x32_bf16 v[68:71], a[192:195], a[136:139], v[68:71]
  v_mfma_f32_16x16x32_bf16 v[72:75], a[192:195], a[144:147], v[72:75]
  ds_read_b64_tr_b16 a[212:213], v135 offset:8192
  v_mfma_f32_16x16x32_bf16 v[72:75], a[196:199], a[148:151], v[72:75]
  v_mfma_f32_16x16x32_bf16 v[76:79], a[196:199], a[156:159], v[76:79]
  ds_read_b64_tr_b16 a[214:215], v135 offset:9216
  v_mfma_f32_16x16x32_bf16 v[76:79], a[192:195], a[152:155], v[76:79]
  buffer_load_dwordx4 v245, s[16:19], s42 offen offset:1024  lds
  v_mfma_f32_16x16x32_bf16 v[92:95], a[200:203], a[152:155], v[92:95]
  s_waitcnt lgkmcnt(2)
  ds_read_b64_tr_b16 a[216:217], v135 offset:8
  v_mfma_f32_16x16x32_bf16 v[92:95], a[204:207], a[156:159], v[92:95]
  v_mfma_f32_16x16x32_bf16 v[88:91], a[204:207], a[148:151], v[88:91]
  ds_read_b64_tr_b16 a[218:219], v135 offset:1032
  v_mfma_f32_16x16x32_bf16 v[88:91], a[200:203], a[144:147], v[88:91]
  v_mfma_f32_16x16x32_bf16 v[84:87], a[200:203], a[136:139], v[84:87]
  ds_read_b64_tr_b16 a[220:221], v135 offset:8200
  v_mfma_f32_16x16x32_bf16 v[84:87], a[204:207], a[140:143], v[84:87]
  v_mfma_f32_16x16x32_bf16 v[80:83], a[204:207], a[132:135], v[80:83]
  ds_read_b64_tr_b16 a[222:223], v135 offset:9224
  v_mfma_f32_16x16x32_bf16 v[80:83], a[200:203], a[128:131], v[80:83]
  buffer_load_dwordx4 v246, s[16:19], s42 offen offset:2048  lds
  v_mfma_f32_16x16x32_bf16 v[96:99], a[208:211], a[128:131], v[96:99]
  s_waitcnt lgkmcnt(2)
  ds_read_b64_tr_b16 a[192:193], v144 offset:0
  v_mfma_f32_16x16x32_bf16 v[96:99], a[212:215], a[132:135], v[96:99]
  v_mfma_f32_16x16x32_bf16 v[100:103], a[212:215], a[140:143], v[100:103]
  ds_read_b64_tr_b16 a[194:195], v144 offset:512
  v_mfma_f32_16x16x32_bf16 v[100:103], a[208:211], a[136:139], v[100:103]
  v_mfma_f32_16x16x32_bf16 v[104:107], a[208:211], a[144:147], v[104:107]
  ds_read_b64_tr_b16 a[196:197], v144 offset:4096
  v_mfma_f32_16x16x32_bf16 v[104:107], a[212:215], a[148:151], v[104:107]
  v_mfma_f32_16x16x32_bf16 v[108:111], a[212:215], a[156:159], v[108:111]
  ds_read_b64_tr_b16 a[198:199], v144 offset:4608
  v_mfma_f32_16x16x32_bf16 v[108:111], a[208:211], a[152:155], v[108:111]
  buffer_load_dwordx4 v247, s[16:19], s42 offen offset:3072  lds
  v_mfma_f32_16x16x32_bf16 v[124:127], a[216:219], a[152:155], v[124:127]
  s_waitcnt lgkmcnt(2)
  ds_read_b64_tr_b16 a[200:201], v145 offset:0
  v_mfma_f32_16x16x32_bf16 v[124:127], a[220:223], a[156:159], v[124:127]
  v_mfma_f32_16x16x32_bf16 v[120:123], a[220:223], a[148:151], v[120:123]
  ds_read_b64_tr_b16 a[202:203], v145 offset:512
  v_mfma_f32_16x16x32_bf16 v[120:123], a[216:219], a[144:147], v[120:123]
  v_mfma_f32_16x16x32_bf16 v[116:119], a[216:219], a[136:139], v[116:119]
  ds_read_b64_tr_b16 a[204:205], v145 offset:4096
  v_mfma_f32_16x16x32_bf16 v[116:119], a[220:223], a[140:143], v[116:119]
  v_mfma_f32_16x16x32_bf16 v[112:115], a[220:223], a[132:135], v[112:115]
  ds_read_b64_tr_b16 a[206:207], v145 offset:4608
  v_mfma_f32_16x16x32_bf16 v[112:115], a[216:219], a[128:131], v[112:115]
  s_cmp_ge_u32 s39, 27
  s_cbranch_scc1 K1_sd4
  v_mfma_f32_16x16x32_bf16 a[0:3], a[192:195], a[128:131], a[0:3]
  s_waitcnt lgkmcnt(2)
  s_add_u32 m0, s43, 0
  s_movk_i32 s40, 768
  ds_read_b64_tr_b16 a[208:209], v146 offset:0
  v_mfma_f32_16x16x32_bf16 a[0:3], a[196:199], a[132:135], a[0:3]
  buffer_load_dwordx4 v232, s[8:11], s40 offen offset:0  lds
  v_mfma_f32_16x16x32_bf16 a[4:7], a[196:199], a[140:143], a[4:7]
  ds_read_b64_tr_b16 a[210:211], v146 offset:512
  v_mfma_f32_16x16x32_bf16 a[4:7], a[192:195], a[136:139], a[4:7]
  v_mfma_f32_16x16x32_bf16 a[8:11], a[192:195], a[144:147], a[8:11]
  ds_read_b64_tr_b16 a[212:213], v146 offset:4096
  v_mfma_f32_16x16x32_bf16 a[8:11], a[196:199], a[148:151], a[8:11]
  v_mfma_f32_16x16x32_bf16 a[12:15], a[196:199], a[156:159], a[12:15]
  ds_read_b64_tr_b16 a[214:215], v146 offset:4608
  v_mfma_f32_16x16x32_bf16 a[12:15], a[192:195], a[152:155], a[12:15]
  v_smfmac_f32_16x16x64_bf16 v[200:203], v[252:255], a[192:199], v224
  v_mfma_f32_16x16x32_bf16 a[28:31], a[200:203], a[152:155], a[28:31]
  s_waitcnt lgkmcnt(2)
  ds_read_b64_tr_b16 a[216:217], v147 offset:0
  buffer_load_dwordx4 v233, s[8:11], s40 offen offset:1024  lds
  v_mfma_f32_16x16x32_bf16 a[28:31], a[204:207], a[156:159], a[28:31]
  v_mfma_f32_16x16x32_bf16 a[24:27], a[204:207], a[148:151], a[24:27]
  ds_read_b64_tr_b16 a[218:219], v147 offset:512
  v_mfma_f32_16x16x32_bf16 a[24:27], a[200:203], a[144:147], a[24:27]
  v_mfma_f32_16x16x32_bf16 a[20:23], a[200:203], a[136:139], a[20:23]
  ds_read_b64_tr_b16 a[220:221], v147 offset:4096
  v_mfma_f32_16x16x32_bf16 a[20:23], a[204:207], a[140:143], a[20:23]
  v_mfma_f32_16x16x32_bf16 a[16:19], a[204:207], a[132:135], a[16:19]
  ds_read_b64_tr_b16 a[222:223], v147 offset:4608
  v_mfma_f32_16x16x32_bf16 a[16:19], a[200:203], a[128:131], a[16:19]
  v_smfmac_f32_16x16x64_bf16 v[204:207], v[252:255], a[200:207], v224
  buffer_load_dwordx4 v234, s[8:11], s40 offen offset:2048  lds
  v_mfma_f32_16x16x32_bf16 a[32:35], a[208:211], a[128:131], a[32:35]
  s_waitcnt lgkmcnt(2)
  ds_read_b64_tr_b16 a[192:193], v148 offset:0
  v_mfma_f32_16x16x32_bf16 a[32:35], a[212:215], a[132:135], a[32:35]
  v_mfma_f32_16x16x32_bf16 a[36:39], a[212:215], a[140:143], a[36:39]
  ds_read_b64_tr_b16 a[194:195], v148 offset:512
  v_mfma_f32_16x16x32_bf16 a[36:39], a[208:211], a[136:139], a[36:39]
  v_mfma_f32_16x16x32_bf16 a[40:43], a[208:211], a[144:147], a[40:43]
  ds_read_b64_tr_b16 a[196:197], v148 offset:4096
  v_mfma_f32_16x16x32_bf16 a[40:43], a[212:215], a[148:151], a[40:43]
  v_mfma_f32_16x16x32_bf16 a[44:47], a[212:215], a[156:159], a[44:47]
  ds_read_b64_tr_b16 a[198:199], v148 offset:4608
  v_mfma_f32_16x16x32_bf16 a[44:47], a[208:211], a[152:155], a[44:47]
  buffer_load_dwordx4 v235, s[8:11], s40 offen offset:3072  lds
  v_mfma_f32_16x16x32_bf16 a[60:63], a[216:219], a[152:155], a[60:63]
  s_waitcnt lgkmcnt(2)
  ds_read_b64_tr_b16 a[200:201], v149 offset:0
  v_mfma_f32_16x16x32_bf16 a[60:63], a[220:223], a[156:159], a[60:63]
  v_mfma_f32_16x16x32_bf16 a[56:59], a[220:223], a[148:151], a[56:59]
  ds_read_b64_tr_b16 a[202:203], v149 offset:512
  v_mfma_f32_16x16x32_bf16 a[56:59], a[216:219], a[144:147], a[56:59]
  v_mfma_f32_16x16x32_bf16 a[52:55], a[216:219], a[136:139], a[52:55]
  ds_read_b64_tr_b16 a[204:205], v149 offset:4096
  v_mfma_f32_16x16x32_bf16 a[52:55], a[220:223], a[140:143], a[52:55]
  v_mfma_f32_16x16x32_bf16 a[48:51], a[220:223], a[132:135], a[48:51]
  s_add_u32 m0, s43, 4096
  ds_read_b64_tr_b16 a[206:207], v149 offset:4608
  v_mfma_f32_16x16x32_bf16 a[48:51], a[216:219], a[128:131], a[48:51]
  buffer_load_dwordx4 v236, s[8:11], s40 offen offset:0  lds
  v_mfma_f32_16x16x32_bf16 a[64:67], a[192:195], a[128:131], a[64:67]
  s_waitcnt lgkmcnt(2)
  ds_read_b64_tr_b16 a[208:209], v150 offset:0
  v_mfma_f32_16x16x32_bf16 a[64:67], a[196:199], a[132:135], a[64:67]
  v_mfma_f32_16x16x32_bf16 a[68:71], a[196:199], a[140:143], a[68:71]
  ds_read_b64_tr_b16 a[210:211], v150 offset:512
  v_mfma_f32_16x16x32_bf16 a[68:71], a[192:195], a[136:139], a[68:71]
  v_mfma_f32_16x16x32_bf16 a[72:75], a[192:195], a[144:147], a[72:75]
  ds_read_b64_tr_b16 a[212:213], v150 offset:4096
  v_mfma_f32_16x16x32_bf16 a[72:75], a[196:199], a[148:151], a[72:75]
  v_mfma_f32_16x16x32_bf16 a[76:79], a[196:199], a[156:159], a[76:79]
  ds_read_b64_tr_b16 a[214:215], v150 offset:4608
  v_mfma_f32_16x16x32_bf16 a[76:79], a[192:195], a[152:155], a[76:79]
  buffer_load_dwordx4 v237, s[8:11], s40 offen offset:1024  lds
  v_mfma_f32_16x16x32_bf16 a[92:95], a[200:203], a[152:155], a[92:95]
  s_waitcnt lgkmcnt(2)
  ds_read_b64_tr_b16 a[216:217], v151 offset:0
  v_mfma_f32_16x16x32_bf16 a[92:95], a[204:207], a[156:159], a[92:95]
  v_mfma_f32_16x16x32_bf16 a[88:91], a[204:207], a[148:151], a[88:91]
  ds_read_b64_tr_b16 a[218:219], v151 offset:512
  v_mfma_f32_16x16x32_bf16 a[88:91], a[200:203], a[144:147], a[88:91]
  v_mfma_f32_16x16x32_bf16 a[84:87], a[200:203], a[136:139], a[84:87]
  ds_read_b64_tr_b16 a[220:221], v151 offset:4096
  v_mfma_f32_16x16x32_bf16 a[84:87], a[204:207], a[140:143], a[84:87]
  v_mfma_f32_16x16x32_bf16 a[80:83], a[204:207], a[132:135], a[80:83]
  ds_read_b64_tr_b16 a[222:223], v151 offset:4608
  v_mfma_f32_16x16x32_bf16 a[80:83], a[200:203], a[128:131], a[80:83]
  buffer_load_dwordx4 v238, s[8:11], s40 offen offset:2048  lds
  v_mfma_f32_16x16x32_bf16 a[96:99], a[208:211], a[128:131], a[96:99]
  s_waitcnt vmcnt(15) lgkmcnt(0)
  s_barrier
  ds_read_b128 a[160:163], v152 offset:32768
  v_mfma_f32_16x16x32_bf16 a[96:99], a[212:215], a[132:135], a[96:99]
  ds_read_b128 a[164:167], v153 offset:32768
  v_mfma_f32_16x16x32_bf16 a[100:103], a[212:215], a[140:143], a[100:103]
  ds_read_b64_tr_b16 a[192:193], v128 offset:0
  v_mfma_f32_16x16x32_bf16 a[100:103], a[208:211], a[136:139], a[100:103]
  ds_read_b64_tr_b16 a[194:195], v128 offset:1024
  v_mfma_f32_16x16x32_bf16 a[104:107], a[208:211], a[144:147], a[104:107]
  ds_read_b64_tr_b16 a[196:197], v128 offset:8192
  v_mfma_f32_16x16x32_bf16 a[104:107], a[212:215], a[148:151], a[104:107]
  ds_read_b64_tr_b16 a[198:199], v128 offset:9216
  v_mfma_f32_16x16x32_bf16 a[108:111], a[212:215], a[156:159], a[108:111]
  ds_read_b128 a[168:171], v152 offset:34816
  v_mfma_f32_16x16x32_bf16 a[108:111], a[208:211], a[152:155], a[108:111]
K1_st2:
  s_cbranch_execz K1_st6
  buffer_load_dwordx4 v239, s[8:11], s40 offen offset:3072  lds
  ds_read_b128 a[172:175], v153 offset:34816
  v_mfma_f32_16x16x32_bf16 a[124:127], a[216:219], a[152:155], a[124:127]
  ds_read_b128 a[176:179], v152 offset:36864
  v_mfma_f32_16x16x32_bf16 a[124:127], a[220:223], a[156:159], a[124:127]
  ds_read_b128 a[180:183], v153 offset:36864
  v_mfma_f32_16x16x32_bf16 a[120:123], a[220:223], a[148:151], a[120:123]
  ds_read_b128 a[184:187], v152 offset:38912
  v_mfma_f32_16x16x32_bf16 a[120:123], a[216:219], a[144:147], a[120:123]
  ds_read_b128 a[188:191], v153 offset:38912
  v_mfma_f32_16x16x32_bf16 a[116:119], a[216:219], a[136:139], a[116:119]
  ds_read_b64_tr_b16 a[200:201], v128 offset:8
  v_mfma_f32_16x16x32_bf16 a[116:119], a[220:223], a[140:143], a[116:119]
  ds_read_b64_tr_b16 a[202:203], v128 offset:1032
  v_mfma_f32_16x16x32_bf16 a[112:115], a[220:223], a[132:135], a[112:115]
  ds_read_b64_tr_b16 a[204:205], v128 offset:8200
  v_mfma_f32_16x16x32_bf16 a[112:115], a[216:219], a[128:131], a[112:115]
  ds_read_b64_tr_b16 a[206:207], v128 offset:9224
K1_rj4:
  s_waitcnt lgkmcnt(6)
  v_mfma_f32_16x16x32_bf16 v[0:3], a[192:195], a[160:163], v[0:3]
  s_add_u32 m0, s44, 131072
  s_mov_b32 s41, 3670016
  ds_read_b64_tr_b16 a[208:209], v129 offset:0
  v_mfma_f32_16x16x32_bf16 v[0:3], a[196:199], a[164:167], v[0:3]
  buffer_load_dwordx4 v240, s[12:15], s41 offen offset:0  lds
  v_mfma_f32_16x16x32_bf16 v[4:7], a[196:199], a[172:175], v[4:7]
  ds_read_b64_tr_b16 a[210:211], v129 offset:1024
  v_mfma_f32_16x16x32_bf16 v[4:7], a[192:195], a[168:171], v[4:7]
  v_mfma_f32_16x16x32_bf16 v[8:11], a[192:195], a[176:179], v[8:11]
  ds_read_b64_tr_b16 a[212:213], v129 offset:8192
  v_mfma_f32_16x16x32_bf16 v[8:11], a[196:199], a[180:183], v[8:11]
  s_waitcnt lgkmcnt(3)
  v_mfma_f32_16x16x32_bf16 v[12:15], a[196:199], a[188:191], v[12:15]
  ds_read_b64_tr_b16 a[214:215], v129 offset:9216
  v_mfma_f32_16x16x32_bf16 v[12:15], a[192:195], a[184:187], v[12:15]
  v_smfmac_f32_16x16x64_bf16 v[192:195], v[252:255], a[192:199], v224
  v_mfma_f32_16x16x32_bf16 v[28:31], a[200:203], a[184:187], v[28:31]
  ds_read_b64_tr_b16 a[216:217], v129 offset:8
  buffer_load_dwordx4 v241, s[12:15], s41 offen offset:1024  lds
  v_mfma_f32_16x16x32_bf16 v[28:31], a[204:207], a[188:191], v[28:31]
  v_mfma_f32_16x16x32_bf16 v[24:27], a[204:207], a[180:183], v[24:27]
  ds_read_b64_tr_b16 a[218:219], v129 offset:1032
  v_mfma_f32_16x16x32_bf16 v[24:27], a[200:203], a[176:179], v[24:27]
  v_mfma_f32_16x16x32_bf16 v[20:23], a[200:203], a[168:171], v[20:23]
  ds_read_b64_tr_b16 a[220:221], v129 offset:8200
  v_mfma_f32_16x16x32_bf16 v[20:23], a[204:207], a[172:175], v[20:23]
  v_mfma_f32_16x16x32_bf16 v[16:19], a[204:207], a[164:167], v[16:19]
  ds_read_b64_tr_b16 a[222:223], v129 offset:9224
  v_mfma_f32_16x16x32_bf16 v[16:19], a[200:203], a[160:163], v[16:19]
  v_smfmac_f32_16x16x64_bf16 v[196:199], v[252:255], a[200:207], v224
  s_waitcnt lgkmcnt(2)
  buffer_load_dwordx4 v242, s[12:15], s41 offen offset:2048  lds
  v_mfma_f32_16x16x32_bf16 v[32:35], a[208:211], a[160:163], v[32:35]
  ds_read_b64_tr_b16 a[192:193], v130 offset:0
  v_mfma_f32_16x16x32_bf16 v[32:35], a[212:215], a[164:167], v[32:35]
  v_mfma_f32_16x16x32_bf16 v[36:39], a[212:215], a[172:175], v[36:39]
  ds_read_b64_tr_b16 a[194:195], v130 offset:1024
  v_mfma_f32_16x16x32_bf16 v[36:39], a[208:211], a[168:171], v[36:39]
  v_mfma_f32_16x16x32_bf16 v[40:43], a[208:211], a[176:179], v[40:43]
  ds_read_b64_tr_b16 a[196:197], v130 offset:8192
  v_mfma_f32_16x16x32_bf16 v[40:43], a[212:215], a[180:183], v[40:43]
  v_mfma_f32_16x16x32_bf16 v[44:47], a[212:215], a[188:191], v[44:47]
  ds_read_b64_tr_b16 a[198:199], v130 offset:9216
  v_mfma_f32_16x16x32_bf16 v[44:47], a[208:211], a[184:187], v[44:47]
  buffer_load_dwordx4 v243, s[12:15], s41 offen offset:3072  lds
  v_mfma_f32_16x16x32_bf16 v[60:63], a[216:219], a[184:187], v[60:63]
  s_waitcnt lgkmcnt(2)
  ds_read_b64_tr_b16 a[200:201], v130 offset:8
  v_mfma_f32_16x16x32_bf16 v[60:63], a[220:223], a[188:191], v[60:63]
  v_mfma_f32_16x16x32_bf16 v[56:59], a[220:223], a[180:183], v[56:59]
  ds_read_b64_tr_b16 a[202:203], v130 offset:1032
  v_mfma_f32_16x16x32_bf16 v[56:59], a[216:219], a[176:179], v[56:59]
  v_mfma_f32_16x16x32_bf16 v[52:55], a[216:219], a[168:171], v[52:55]
  ds_read_b64_tr_b16 a[204:205], v130 offset:8200
  v_mfma_f32_16x16x32_bf16 v[52:55], a[220:223], a[172:175], v[52:55]
  v_mfma_f32_16x16x32_bf16 v[48:51], a[220:223], a[164:167], v[48:51]
  s_add_u32 m0, s44, 147456
  s_mov_b32 s42, 1548288
  ds_read_b64_tr_b16 a[206:207], v130 offset:9224
  v_mfma_f32_16x16x32_bf16 v[48:51], a[216:219], a[160:163], v[48:51]
  buffer_load_dwordx4 v244, s[16:19], s42 offen offset:0  lds
  v_mfma_f32_16x16x32_bf16 v[64:67], a[192:195], a[160:163], v[64:67]
  s_waitcnt lgkmcnt(2)
  ds_read_b64_tr_b16 a[208:209], v131 offset:0
  v_mfma_f32_16x16x32_bf16 v[64:67], a[196:199], a[164:167], v[64:67]
  v_mfma_f32_16x16x32_bf16 v[68:71], a[196:199], a[172:175], v[68:71]
  ds_read_b64_tr_b16 a[210:211], v131 offset:1024
  v_mfma_f32_16x16x32_bf16 v[68:71], a[192:195], a[168:171], v[68:71]
  v_mfma_f32_16x16x32_bf16 v[72:75], a[192:195], a[176:179], v[72:75]
  ds_read_b64_tr_b16 a[212:213], v131 offset:8192
  v_mfma_f32_16x16x32_bf16 v[72:75], a[196:199], a[180:183], v[72:75]
  v_mfma_f32_16x16x32_bf16 v[76:79], a[196:199], a[188:191], v[76:79]
  ds_read_b64_tr_b16 a[214:215], v131 offset:9216
  v_mfma_f32_16x16x32_bf16 v[76:79], a[192:195], a[184:187], v[76:79]
  buffer_load_dwordx4 v245, s[16:19], s42 offen offset:1024  lds
  v_mfma_f32_16x16x32_bf16 v[92:95], a[200:203], a[184:187], v[92:95]
  s_waitcnt lgkmcnt(2)
  ds_read_b64_tr_b16 a[216:217], v131 offset:8
  v_mfma_f32_16x16x32_bf16 v[92:95], a[204:207], a[188:191], v[92:95]
  v_mfma_f32_16x16x32_bf16 v[88:91], a[204:207], a[180:183], v[88:91]
  ds_read_b64_tr_b16 a[218:219], v131 offset:1032
  v_mfma_f32_16x16x32_bf16 v[88:91], a[200:203], a[176:179], v[88:91]
  v_mfma_f32_16x16x32_bf16 v[84:87], a[200:203], a[168:171], v[84:87]
  ds_read_b64_tr_b16 a[220:221], v131 offset:8200
  v_mfma_f32_16x16x32_bf16 v[84:87], a[204:207], a[172:175], v[84:87]
  v_mfma_f32_16x16x32_bf16 v[80:83], a[204:207], a[164:167], v[80:83]
  ds_read_b64_tr_b16 a[222:223], v131 offset:9224
  v_mfma_f32_16x16x32_bf16 v[80:83], a[200:203], a[160:163], v[80:83]
  buffer_load_dwordx4 v246, s[16:19], s42 offen offset:2048  lds
  v_mfma_f32_16x16x32_bf16 v[96:99], a[208:211], a[160:163], v[96:99]
  s_waitcnt lgkmcnt(2)
  ds_read_b64_tr_b16 a[192:193], v136 offset:0
  v_mfma_f32_16x16x32_bf16 v[96:99], a[212:215], a[164:167], v[96:99]
  v_mfma_f32_16x16x32_bf16 v[100:103], a[212:215], a[172:175], v[100:103]
  ds_read_b64_tr_b16 a[194:195], v136 offset:512
  v_mfma_f32_16x16x32_bf16 v[100:103], a[208:211], a[168:171], v[100:103]
  v_mfma_f32_16x16x32_bf16 v[104:107], a[208:211], a[176:179], v[104:107]
  ds_read_b64_tr_b16 a[196:197], v136 offset:4096
  v_mfma_f32_16x16x32_bf16 v[104:107], a[212:215], a[180:183], v[104:107]
  v_mfma_f32_16x16x32_bf16 v[108:111], a[212:215], a[188:191], v[108:111]
  ds_read_b64_tr_b16 a[198:199], v136 offset:4608
  v_mfma_f32_16x16x32_bf16 v[108:111], a[208:211], a[184:187], v[108:111]
  buffer_load_dwordx4 v247, s[16:19], s42 offen offset:3072  lds
  v_mfma_f32_16x16x32_bf16 v[124:127], a[216:219], a[184:187], v[124:127]
  s_waitcnt lgkmcnt(2)
  ds_read_b64_tr_b16 a[200:201], v137 offset:0
  v_mfma_f32_16x16x32_bf16 v[124:127], a[220:223], a[188:191], v[124:127]
  v_mfma_f32_16x16x32_bf16 v[120:123], a[220:223], a[180:183], v[120:123]
  ds_read_b64_tr_b16 a[202:203], v137 offset:512
  v_mfma_f32_16x16x32_bf16 v[120:123], a[216:219], a[176:179], v[120:123]
  v_mfma_f32_16x16x32_bf16 v[116:119], a[216:219], a[168:171], v[116:119]
  ds_read_b64_tr_b16 a[204:205], v137 offset:4096
  v_mfma_f32_16x16x32_bf16 v[116:119], a[220:223], a[172:175], v[116:119]
  v_mfma_f32_16x16x32_bf16 v[112:115], a[220:223], a[164:167], v[112:115]
  ds_read_b64_tr_b16 a[206:207], v137 offset:4608
  v_mfma_f32_16x16x32_bf16 v[112:115], a[216:219], a[160:163], v[112:115]
  s_cmp_ge_u32 s39, 27
  s_cbranch_scc1 K1_sd5
  v_mfma_f32_16x16x32_bf16 a[0:3], a[192:195], a[160:163], a[0:3]
  s_waitcnt lgkmcnt(2)
  s_add_u32 m0, s43, 32768
  s_movk_i32 s40, 896
  ds_read_b64_tr_b16 a[208:209], v138 offset:0
  v_mfma_f32_16x16x32_bf16 a[0:3], a[196:199], a[164:167], a[0:3]
  buffer_load_dwordx4 v232, s[8:11], s40 offen offset:0  lds
  v_mfma_f32_16x16x32_bf16 a[4:7], a[196:199], a[172:175], a[4:7]
  ds_read_b64_tr_b16 a[210:211], v138 offset:512
  v_mfma_f32_16x16x32_bf16 a[4:7], a[192:195], a[168:171], a[4:7]
  v_mfma_f32_16x16x32_bf16 a[8:11], a[192:195], a[176:179], a[8:11]
  ds_read_b64_tr_b16 a[212:213], v138 offset:4096
  v_mfma_f32_16x16x32_bf16 a[8:11], a[196:199], a[180:183], a[8:11]
  v_mfma_f32_16x16x32_bf16 a[12:15], a[196:199], a[188:191], a[12:15]
  ds_read_b64_tr_b16 a[214:215], v138 offset:4608
  v_mfma_f32_16x16x32_bf16 a[12:15], a[192:195], a[184:187], a[12:15]
  v_smfmac_f32_16x16x64_bf16 v[200:203], v[252:255], a[192:199], v224
  v_mfma_f32_16x16x32_bf16 a[28:31], a[200:203], a[184:187], a[28:31]
  s_waitcnt lgkmcnt(2)
  ds_read_b64_tr_b16 a[216:217], v139 offset:0
  buffer_load_dwordx4 v233, s[8:11], s40 offen offset:1024  lds
  v_mfma_f32_16x16x32_bf16 a[28:31], a[204:207], a[188:191], a[28:31]
  v_mfma_f32_16x16x32_bf16 a[24:27], a[204:207], a[180:183], a[24:27]
  ds_read_b64_tr_b16 a[218:219], v139 offset:512
  v_mfma_f32_16x16x32_bf16 a[24:27], a[200:203], a[176:179], a[24:27]
  v_mfma_f32_16x16x32_bf16 a[20:23], a[200:203], a[168:171], a[20:23]
  ds_read_b64_tr_b16 a[220:221], v139 offset:4096
  v_mfma_f32_16x16x32_bf16 a[20:23], a[204:207], a[172:175], a[20:23]
  v_mfma_f32_16x16x32_bf16 a[16:19], a[204:207], a[164:167], a[16:19]
  ds_read_b64_tr_b16 a[222:223], v139 offset:4608
  v_mfma_f32_16x16x32_bf16 a[16:19], a[200:203], a[160:163], a[16:19]
  v_smfmac_f32_16x16x64_bf16 v[204:207], v[252:255], a[200:207], v224
  buffer_load_dwordx4 v234, s[8:11], s40 offen offset:2048  lds
  v_mfma_f32_16x16x32_bf16 a[32:35], a[208:211], a[160:163], a[32:35]
  s_waitcnt lgkmcnt(2)
  ds_read_b64_tr_b16 a[192:193], v140 offset:0
  v_mfma_f32_16x16x32_bf16 a[32:35], a[212:215], a[164:167], a[32:35]
  v_mfma_f32_16x16x32_bf16 a[36:39], a[212:215], a[172:175], a[36:39]
  ds_read_b64_tr_b16 a[194:195], v140 offset:512
  v_mfma_f32_16x16x32_bf16 a[36:39], a[208:211], a[168:171], a[36:39]
  v_mfma_f32_16x16x32_bf16 a[40:43], a[208:211], a[176:179], a[40:43]
  ds_read_b64_tr_b16 a[196:197], v140 offset:4096
  v_mfma_f32_16x16x32_bf16 a[40:43], a[212:215], a[180:183], a[40:43]
  v_mfma_f32_16x16x32_bf16 a[44:47], a[212:215], a[188:191], a[44:47]
  ds_read_b64_tr_b16 a[198:199], v140 offset:4608
  v_mfma_f32_16x16x32_bf16 a[44:47], a[208:211], a[184:187], a[44:47]
  buffer_load_dwordx4 v235, s[8:11], s40 offen offset:3072  lds
  v_mfma_f32_16x16x32_bf16 a[60:63], a[216:219], a[184:187], a[60:63]
  s_waitcnt lgkmcnt(2)
  ds_read_b64_tr_b16 a[200:201], v141 offset:0
  v_mfma_f32_16x16x32_bf16 a[60:63], a[220:223], a[188:191], a[60:63]
  v_mfma_f32_16x16x32_bf16 a[56:59], a[220:223], a[180:183], a[56:59]
  ds_read_b64_tr_b16 a[202:203], v141 offset:512
  v_mfma_f32_16x16x32_bf16 a[56:59], a[216:219], a[176:179], a[56:59]
  v_mfma_f32_16x16x32_bf16 a[52:55], a[216:219], a[168:171], a[52:55]
  ds_read_b64_tr_b16 a[204:205], v141 offset:4096
  v_mfma_f32_16x16x32_bf16 a[52:55], a[220:223], a[172:175], a[52:55]
  v_mfma_f32_16x16x32_bf16 a[48:51], a[220:223], a[164:167], a[48:51]
  s_add_u32 m0, s43, 36864
  ds_read_b64_tr_b16 a[206:207], v141 offset:4608
  v_mfma_f32_16x16x32_bf16 a[48:51], a[216:219], a[160:163], a[48:51]
  buffer_load_dwordx4 v236, s[8:11], s40 offen offset:0  lds
  v_mfma_f32_16x16x32_bf16 a[64:67], a[192:195], a[160:163], a[64:67]
  s_waitcnt lgkmcnt(2)
  ds_read_b64_tr_b16 a[208:209], v142 offset:0
  v_mfma_f32_16x16x32_bf16 a[64:67], a[196:199], a[164:167], a[64:67]
  v_mfma_f32_16x16x32_bf16 a[68:71], a[196:199], a[172:175], a[68:71]
  ds_read_b64_tr_b16 a[210:211], v142 offset:512
  v_mfma_f32_16x16x32_bf16 a[68:71], a[192:195], a[168:171], a[68:71]
  v_mfma_f32_16x16x32_bf16 a[72:75], a[192:195], a[176:179], a[72:75]
  ds_read_b64_tr_b16 a[212:213], v142 offset:4096
  v_mfma_f32_16x16x32_bf16 a[72:75], a[196:199], a[180:183], a[72:75]
  v_mfma_f32_16x16x32_bf16 a[76:79], a[196:199], a[188:191], a[76:79]
  ds_read_b64_tr_b16 a[214:215], v142 offset:4608
  v_mfma_f32_16x16x32_bf16 a[76:79], a[192:195], a[184:187], a[76:79]
  buffer_load_dwordx4 v237, s[8:11], s40 offen offset:1024  lds
  v_mfma_f32_16x16x32_bf16 a[92:95], a[200:203], a[184:187], a[92:95]
  s_waitcnt lgkmcnt(2)
  ds_read_b64_tr_b16 a[216:217], v143 offset:0
  v_mfma_f32_16x16x32_bf16 a[92:95], a[204:207], a[188:191], a[92:95]
  v_mfma_f32_16x16x32_bf16 a[88:91], a[204:207], a[180:183], a[88:91]
  ds_read_b64_tr_b16 a[218:219], v143 offset:512
  v_mfma_f32_16x16x32_bf16 a[88:91], a[200:203], a[176:179], a[88:91]
  v_mfma_f32_16x16x32_bf16 a[84:87], a[200:203], a[168:171], a[84:87]
  ds_read_b64_tr_b16 a[220:221], v143 offset:4096
  v_mfma_f32_16x16x32_bf16 a[84:87], a[204:207], a[172:175], a[84:87]
  v_mfma_f32_16x16x32_bf16 a[80:83], a[204:207], a[164:167], a[80:83]
  ds_read_b64_tr_b16 a[222:223], v143 offset:4608
  v_mfma_f32_16x16x32_bf16 a[80:83], a[200:203], a[160:163], a[80:83]
  buffer_load_dwordx4 v238, s[8:11], s40 offen offset:2048  lds
  v_mfma_f32_16x16x32_bf16 a[96:99], a[208:211], a[160:163], a[96:99]
  s_waitcnt vmcnt(15) lgkmcnt(0)
  s_barrier
  ds_read_b128 a[128:131], v152 offset:0
  v_mfma_f32_16x16x32_bf16 a[96:99], a[212:215], a[164:167], a[96:99]
  ds_read_b128 a[132:135], v153 offset:0
  v_mfma_f32_16x16x32_bf16 a[100:103], a[212:215], a[172:175], a[100:103]
  ds_read_b64_tr_b16 a[192:193], v128 offset:32768
  v_mfma_f32_16x16x32_bf16 a[100:103], a[208:211], a[168:171], a[100:103]
  ds_read_b64_tr_b16 a[194:195], v128 offset:33792
  v_mfma_f32_16x16x32_bf16 a[104:107], a[208:211], a[176:179], a[104:107]
  ds_read_b64_tr_b16 a[196:197], v128 offset:40960
  v_mfma_f32_16x16x32_bf16 a[104:107], a[212:215], a[180:183], a[104:107]
  ds_read_b64_tr_b16 a[198:199], v128 offset:41984
  v_mfma_f32_16x16x32_bf16 a[108:111], a[212:215], a[188:191], a[108:111]
  ds_read_b128 a[136:139], v152 offset:2048
  v_mfma_f32_16x16x32_bf16 a[108:111], a[208:211], a[184:187], a[108:111]
  buffer_load_dwordx4 v239, s[8:11], s40 offen offset:3072  lds
  ds_read_b128 a[140:143], v153 offset:2048
  v_mfma_f32_16x16x32_bf16 a[124:127], a[216:219], a[184:187], a[124:127]
  ds_read_b128 a[144:147], v152 offset:4096
  v_mfma_f32_16x16x32_bf16 a[124:127], a[220:223], a[188:191], a[124:127]
  ds_read_b128 a[148:151], v153 offset:4096
  v_mfma_f32_16x16x32_bf16 a[120:123], a[220:223], a[180:183], a[120:123]
  ds_read_b128 a[152:155], v152 offset:6144
  v_mfma_f32_16x16x32_bf16 a[120:123], a[216:219], a[176:179], a[120:123]
  ds_read_b128 a[156:159], v153 offset:6144
  v_mfma_f32_16x16x32_bf16 a[116:119], a[216:219], a[168:171], a[116:119]
  ds_read_b64_tr_b16 a[200:201], v128 offset:32776
  v_mfma_f32_16x16x32_bf16 a[116:119], a[220:223], a[172:175], a[116:119]
  ds_read_b64_tr_b16 a[202:203], v128 offset:33800
  v_mfma_f32_16x16x32_bf16 a[112:115], a[220:223], a[164:167], a[112:115]
  ds_read_b64_tr_b16 a[204:205], v128 offset:40968
  v_mfma_f32_16x16x32_bf16 a[112:115], a[216:219], a[160:163], a[112:115]
  ds_read_b64_tr_b16 a[206:207], v128 offset:41992
K1_rj5:
  s_waitcnt lgkmcnt(6)
  v_mfma_f32_16x16x32_bf16 v[0:3], a[192:195], a[128:131], v[0:3]
  s_add_u32 m0, s44, 65536
  s_mov_b32 s41, 4194304
  ds_read_b64_tr_b16 a[208:209], v129 offset:32768
  v_mfma_f32_16x16x32_bf16 v[0:3], a[196:199], a[132:135], v[0:3]
  buffer_load_dwordx4 v240, s[12:15], s41 offen offset:0  lds
  v_mfma_f32_16x16x32_bf16 v[4:7], a[196:199], a[140:143], v[4:7]
  ds_read_b64_tr_b16 a[210:211], v129 offset:33792
  v_mfma_f32_16x16x32_bf16 v[4:7], a[192:195], a[136:139], v[4:7]
  v_mfma_f32_16x16x32_bf16 v[8:11], a[192:195], a[144:147], v[8:11]
  ds_read_b64_tr_b16 a[212:213], v129 offset:40960
  v_mfma_f32_16x16x32_bf16 v[8:11], a[196:199], a[148:151], v[8:11]
  s_waitcnt lgkmcnt(3)
  v_mfma_f32_16x16x32_bf16 v[12:15], a[196:199], a[156:159], v[12:15]
  ds_read_b64_tr_b16 a[214:215], v129 offset:41984
  v_mfma_f32_16x16x32_bf16 v[12:15], a[192:195], a[152:155], v[12:15]
  v_smfmac_f32_16x16x64_bf16 v[192:195], v[252:255], a[192:199], v224
  v_mfma_f32_16x16x32_bf16 v[28:31], a[200:203], a[152:155], v[28:31]
  ds_read_b64_tr_b16 a[216:217], v129 offset:32776
  buffer_load_dwordx4 v241, s[12:15], s41 offen offset:1024  lds
  v_mfma_f32_16x16x32_bf16 v[28:31], a[204:207], a[156:159], v[28:31]
  v_mfma_f32_16x16x32_bf16 v[24:27], a[204:207], a[148:151], v[24:27]
  ds_read_b64_tr_b16 a[218:219], v129 offset:33800
  v_mfma_f32_16x16x32_bf16 v[24:27], a[200:203], a[144:147], v[24:27]
  v_mfma_f32_16x16x32_bf16 v[20:23], a[200:203], a[136:139], v[20:23]
  ds_read_b64_tr_b16 a[220:221], v129 offset:40968
  v_mfma_f32_16x16x32_bf16 v[20:23], a[204:207], a[140:143], v[20:23]
  v_mfma_f32_16x16x32_bf16 v[16:19], a[204:207], a[132:135], v[16:19]
  ds_read_b64_tr_b16 a[222:223], v129 offset:41992
  v_mfma_f32_16x16x32_bf16 v[16:19], a[200:203], a[128:131], v[16:19]
  v_smfmac_f32_16x16x64_bf16 v[196:199], v[252:255], a[200:207], v224
  s_waitcnt lgkmcnt(2)
  buffer_load_dwordx4 v242, s[12:15], s41 offen offset:2048  lds
  v_mfma_f32_16x16x32_bf16 v[32:35], a[208:211], a[128:131], v[32:35]
  ds_read_b64_tr_b16 a[192:193], v130 offset:32768
  v_mfma_f32_16x16x32_bf16 v[32:35], a[212:215], a[132:135], v[32:35]
  v_mfma_f32_16x16x32_bf16 v[36:39], a[212:215], a[140:143], v[36:39]
  ds_read_b64_tr_b16 a[194:195], v130 offset:33792
  v_mfma_f32_16x16x32_bf16 v[36:39], a[208:211], a[136:139], v[36:39]
  v_mfma_f32_16x16x32_bf16 v[40:43], a[208:211], a[144:147], v[40:43]
  ds_read_b64_tr_b16 a[196:197], v130 offset:40960
  v_mfma_f32_16x16x32_bf16 v[40:43], a[212:215], a[148:151], v[40:43]
  v_mfma_f32_16x16x32_bf16 v[44:47], a[212:215], a[156:159], v[44:47]
  ds_read_b64_tr_b16 a[198:199], v130 offset:41984
  v_mfma_f32_16x16x32_bf16 v[44:47], a[208:211], a[152:155], v[44:47]
  buffer_load_dwordx4 v243, s[12:15], s41 offen offset:3072  lds
  v_mfma_f32_16x16x32_bf16 v[60:63], a[216:219], a[152:155], v[60:63]
  s_waitcnt lgkmcnt(2)
  ds_read_b64_tr_b16 a[200:201], v130 offset:32776
  v_mfma_f32_16x16x32_bf16 v[60:63], a[220:223], a[156:159], v[60:63]
  v_mfma_f32_16x16x32_bf16 v[56:59], a[220:223], a[148:151], v[56:59]
  ds_read_b64_tr_b16 a[202:203], v130 offset:33800
  v_mfma_f32_16x16x32_bf16 v[56:59], a[216:219], a[144:147], v[56:59]
  v_mfma_f32_16x16x32_bf16 v[52:55], a[216:219], a[136:139], v[52:55]
  ds_read_b64_tr_b16 a[204:205], v130 offset:40968
  v_mfma_f32_16x16x32_bf16 v[52:55], a[220:223], a[140:143], v[52:55]
  v_mfma_f32_16x16x32_bf16 v[48:51], a[220:223], a[132:135], v[48:51]
  s_add_u32 m0, s44, 81920
  s_mov_b32 s42, 1769472
  ds_read_b64_tr_b16 a[206:207], v130 offset:41992
  v_mfma_f32_16x16x32_bf16 v[48:51], a[216:219], a[128:131], v[48:51]
  buffer_load_dwordx4 v244, s[16:19], s42 offen offset:0  lds
  v_mfma_f32_16x16x32_bf16 v[64:67], a[192:195], a[128:131], v[64:67]
  s_waitcnt lgkmcnt(2)
  ds_read_b64_tr_b16 a[208:209], v131 offset:32768
  v_mfma_f32_16x16x32_bf16 v[64:67], a[196:199], a[132:135], v[64:67]
  v_mfma_f32_16x16x32_bf16 v[68:71], a[196:199], a[140:143], v[68:71]
  ds_read_b64_tr_b16 a[210:211], v131 offset:33792
  v_mfma_f32_16x16x32_bf16 v[68:71], a[192:195], a[136:139], v[68:71]
  v_mfma_f32_16x16x32_bf16 v[72:75], a[192:195], a[144:147], v[72:75]
  ds_read_b64_tr_b16 a[212:213], v131 offset:40960
  v_mfma_f32_16x16x32_bf16 v[72:75], a[196:199], a[148:151], v[72:75]
  v_mfma_f32_16x16x32_bf16 v[76:79], a[196:199], a[156:159], v[76:79]
  ds_read_b64_tr_b16 a[214:215], v131 offset:41984
  v_mfma_f32_16x16x32_bf16 v[76:79], a[192:195], a[152:155], v[76:79]
  buffer_load_dwordx4 v245, s[16:19], s42 offen offset:1024  lds
  v_mfma_f32_16x16x32_bf16 v[92:95], a[200:203], a[152:155], v[92:95]
  s_waitcnt lgkmcnt(2)
  ds_read_b64_tr_b16 a[216:217], v131 offset:32776
  v_mfma_f32_16x16x32_bf16 v[92:95], a[204:207], a[156:159], v[92:95]
  v_mfma_f32_16x16x32_bf16 v[88:91], a[204:207], a[148:151], v[88:91]
  ds_read_b64_tr_b16 a[218:219], v131 offset:33800
  v_mfma_f32_16x16x32_bf16 v[88:91], a[200:203], a[144:147], v[88:91]
  v_mfma_f32_16x16x32_bf16 v[84:87], a[200:203], a[136:139], v[84:87]
  ds_read_b64_tr_b16 a[220:221], v131 offset:40968
  v_mfma_f32_16x16x32_bf16 v[84:87], a[204:207], a[140:143], v[84:87]
  v_mfma_f32_16x16x32_bf16 v[80:83], a[204:207], a[132:135], v[80:83]
  ds_read_b64_tr_b16 a[222:223], v131 offset:41992
  v_mfma_f32_16x16x32_bf16 v[80:83], a[200:203], a[128:131], v[80:83]
  buffer_load_dwordx4 v246, s[16:19], s42 offen offset:2048  lds
  v_mfma_f32_16x16x32_bf16 v[96:99], a[208:211], a[128:131], v[96:99]
  s_waitcnt lgkmcnt(2)
  ds_read_b64_tr_b16 a[192:193], v136 offset:32768
  v_mfma_f32_16x16x32_bf16 v[96:99], a[212:215], a[132:135], v[96:99]
  v_mfma_f32_16x16x32_bf16 v[100:103], a[212:215], a[140:143], v[100:103]
  ds_read_b64_tr_b16 a[194:195], v136 offset:33280
  v_mfma_f32_16x16x32_bf16 v[100:103], a[208:211], a[136:139], v[100:103]
  v_mfma_f32_16x16x32_bf16 v[104:107], a[208:211], a[144:147], v[104:107]
  ds_read_b64_tr_b16 a[196:197], v136 offset:36864
  v_mfma_f32_16x16x32_bf16 v[104:107], a[212:215], a[148:151], v[104:107]
  v_mfma_f32_16x16x32_bf16 v[108:111], a[212:215], a[156:159], v[108:111]
  ds_read_b64_tr_b16 a[198:199], v136 offset:37376
  v_mfma_f32_16x16x32_bf16 v[108:111], a[208:211], a[152:155], v[108:111]
  buffer_load_dwordx4 v247, s[16:19], s42 offen offset:3072  lds
  v_mfma_f32_16x16x32_bf16 v[124:127], a[216:219], a[152:155], v[124:127]
  s_waitcnt lgkmcnt(2)
  ds_read_b64_tr_b16 a[200:201], v137 offset:32768
  v_mfma_f32_16x16x32_bf16 v[124:127], a[220:223], a[156:159], v[124:127]
  v_mfma_f32_16x16x32_bf16 v[120:123], a[220:223], a[148:151], v[120:123]
  ds_read_b64_tr_b16 a[202:203], v137 offset:33280
  v_mfma_f32_16x16x32_bf16 v[120:123], a[216:219], a[144:147], v[120:123]
  v_mfma_f32_16x16x32_bf16 v[116:119], a[216:219], a[136:139], v[116:119]
  ds_read_b64_tr_b16 a[204:205], v137 offset:36864
  v_mfma_f32_16x16x32_bf16 v[116:119], a[220:223], a[140:143], v[116:119]
  v_mfma_f32_16x16x32_bf16 v[112:115], a[220:223], a[132:135], v[112:115]
  ds_read_b64_tr_b16 a[206:207], v137 offset:37376
  v_mfma_f32_16x16x32_bf16 v[112:115], a[216:219], a[128:131], v[112:115]
  s_cmp_ge_u32 s39, 27
  s_cbranch_scc1 K1_sd6
  v_mfma_f32_16x16x32_bf16 a[0:3], a[192:195], a[128:131], a[0:3]
  s_waitcnt lgkmcnt(2)
  s_add_u32 m0, s43, 0
  s_movk_i32 s40, 1024
  ds_read_b64_tr_b16 a[208:209], v138 offset:32768
  v_mfma_f32_16x16x32_bf16 a[0:3], a[196:199], a[132:135], a[0:3]
  buffer_load_dwordx4 v232, s[8:11], s40 offen offset:0  lds
  v_mfma_f32_16x16x32_bf16 a[4:7], a[196:199], a[140:143], a[4:7]
  ds_read_b64_tr_b16 a[210:211], v138 offset:33280
  v_mfma_f32_16x16x32_bf16 a[4:7], a[192:195], a[136:139], a[4:7]
  v_mfma_f32_16x16x32_bf16 a[8:11], a[192:195], a[144:147], a[8:11]
  ds_read_b64_tr_b16 a[212:213], v138 offset:36864
  v_mfma_f32_16x16x32_bf16 a[8:11], a[196:199], a[148:151], a[8:11]
  v_mfma_f32_16x16x32_bf16 a[12:15], a[196:199], a[156:159], a[12:15]
  ds_read_b64_tr_b16 a[214:215], v138 offset:37376
  v_mfma_f32_16x16x32_bf16 a[12:15], a[192:195], a[152:155], a[12:15]
  v_smfmac_f32_16x16x64_bf16 v[200:203], v[252:255], a[192:199], v224
  v_mfma_f32_16x16x32_bf16 a[28:31], a[200:203], a[152:155], a[28:31]
  s_waitcnt lgkmcnt(2)
  ds_read_b64_tr_b16 a[216:217], v139 offset:32768
  buffer_load_dwordx4 v233, s[8:11], s40 offen offset:1024  lds
  v_mfma_f32_16x16x32_bf16 a[28:31], a[204:207], a[156:159], a[28:31]
  v_mfma_f32_16x16x32_bf16 a[24:27], a[204:207], a[148:151], a[24:27]
  ds_read_b64_tr_b16 a[218:219], v139 offset:33280
  v_mfma_f32_16x16x32_bf16 a[24:27], a[200:203], a[144:147], a[24:27]
  v_mfma_f32_16x16x32_bf16 a[20:23], a[200:203], a[136:139], a[20:23]
  ds_read_b64_tr_b16 a[220:221], v139 offset:36864
  v_mfma_f32_16x16x32_bf16 a[20:23], a[204:207], a[140:143], a[20:23]
  v_mfma_f32_16x16x32_bf16 a[16:19], a[204:207], a[132:135], a[16:19]
  ds_read_b64_tr_b16 a[222:223], v139 offset:37376
  v_mfma_f32_16x16x32_bf16 a[16:19], a[200:203], a[128:131], a[16:19]
  v_smfmac_f32_16x16x64_bf16 v[204:207], v[252:255], a[200:207], v224
  buffer_load_dwordx4 v234, s[8:11], s40 offen offset:2048  lds
  v_mfma_f32_16x16x32_bf16 a[32:35], a[208:211], a[128:131], a[32:35]
  s_waitcnt lgkmcnt(2)
  ds_read_b64_tr_b16 a[192:193], v140 offset:32768
  v_mfma_f32_16x16x32_bf16 a[32:35], a[212:215], a[132:135], a[32:35]
  v_mfma_f32_16x16x32_bf16 a[36:39], a[212:215], a[140:143], a[36:39]
  ds_read_b64_tr_b16 a[194:195], v140 offset:33280
  v_mfma_f32_16x16x32_bf16 a[36:39], a[208:211], a[136:139], a[36:39]
  v_mfma_f32_16x16x32_bf16 a[40:43], a[208:211], a[144:147], a[40:43]
  ds_read_b64_tr_b16 a[196:197], v140 offset:36864
  v_mfma_f32_16x16x32_bf16 a[40:43], a[212:215], a[148:151], a[40:43]
  v_mfma_f32_16x16x32_bf16 a[44:47], a[212:215], a[156:159], a[44:47]
  ds_read_b64_tr_b16 a[198:199], v140 offset:37376
  v_mfma_f32_16x16x32_bf16 a[44:47], a[208:211], a[152:155], a[44:47]
  buffer_load_dwordx4 v235, s[8:11], s40 offen offset:3072  lds
  v_mfma_f32_16x16x32_bf16 a[60:63], a[216:219], a[152:155], a[60:63]
  s_waitcnt lgkmcnt(2)
  ds_read_b64_tr_b16 a[200:201], v141 offset:32768
  v_mfma_f32_16x16x32_bf16 a[60:63], a[220:223], a[156:159], a[60:63]
  v_mfma_f32_16x16x32_bf16 a[56:59], a[220:223], a[148:151], a[56:59]
  ds_read_b64_tr_b16 a[202:203], v141 offset:33280
  v_mfma_f32_16x16x32_bf16 a[56:59], a[216:219], a[144:147], a[56:59]
  v_mfma_f32_16x16x32_bf16 a[52:55], a[216:219], a[136:139], a[52:55]
  ds_read_b64_tr_b16 a[204:205], v141 offset:36864
  v_mfma_f32_16x16x32_bf16 a[52:55], a[220:223], a[140:143], a[52:55]
  v_mfma_f32_16x16x32_bf16 a[48:51], a[220:223], a[132:135], a[48:51]
  s_add_u32 m0, s43, 4096
  ds_read_b64_tr_b16 a[206:207], v141 offset:37376
  v_mfma_f32_16x16x32_bf16 a[48:51], a[216:219], a[128:131], a[48:51]
  buffer_load_dwordx4 v236, s[8:11], s40 offen offset:0  lds
  v_mfma_f32_16x16x32_bf16 a[64:67], a[192:195], a[128:131], a[64:67]
  s_waitcnt lgkmcnt(2)
  ds_read_b64_tr_b16 a[208:209], v142 offset:32768
  v_mfma_f32_16x16x32_bf16 a[64:67], a[196:199], a[132:135], a[64:67]
  v_mfma_f32_16x16x32_bf16 a[68:71], a[196:199], a[140:143], a[68:71]
  ds_read_b64_tr_b16 a[210:211], v142 offset:33280
  v_mfma_f32_16x16x32_bf16 a[68:71], a[192:195], a[136:139], a[68:71]
  v_mfma_f32_16x16x32_bf16 a[72:75], a[192:195], a[144:147], a[72:75]
  ds_read_b64_tr_b16 a[212:213], v142 offset:36864
  v_mfma_f32_16x16x32_bf16 a[72:75], a[196:199], a[148:151], a[72:75]
  v_mfma_f32_16x16x32_bf16 a[76:79], a[196:199], a[156:159], a[76:79]
  ds_read_b64_tr_b16 a[214:215], v142 offset:37376
  v_mfma_f32_16x16x32_bf16 a[76:79], a[192:195], a[152:155], a[76:79]
  buffer_load_dwordx4 v237, s[8:11], s40 offen offset:1024  lds
  v_mfma_f32_16x16x32_bf16 a[92:95], a[200:203], a[152:155], a[92:95]
  s_waitcnt lgkmcnt(2)
  ds_read_b64_tr_b16 a[216:217], v143 offset:32768
  v_mfma_f32_16x16x32_bf16 a[92:95], a[204:207], a[156:159], a[92:95]
  v_mfma_f32_16x16x32_bf16 a[88:91], a[204:207], a[148:151], a[88:91]
  ds_read_b64_tr_b16 a[218:219], v143 offset:33280
  v_mfma_f32_16x16x32_bf16 a[88:91], a[200:203], a[144:147], a[88:91]
  v_mfma_f32_16x16x32_bf16 a[84:87], a[200:203], a[136:139], a[84:87]
  ds_read_b64_tr_b16 a[220:221], v143 offset:36864
  v_mfma_f32_16x16x32_bf16 a[84:87], a[204:207], a[140:143], a[84:87]
  v_mfma_f32_16x16x32_bf16 a[80:83], a[204:207], a[132:135], a[80:83]
  ds_read_b64_tr_b16 a[222:223], v143 offset:37376
  v_mfma_f32_16x16x32_bf16 a[80:83], a[200:203], a[128:131], a[80:83]
  buffer_load_dwordx4 v238, s[8:11], s40 offen offset:2048  lds
  v_mfma_f32_16x16x32_bf16 a[96:99], a[208:211], a[128:131], a[96:99]
  s_waitcnt vmcnt(15) lgkmcnt(0)
  s_barrier
  ds_read_b128 a[160:163], v152 offset:32768
  v_mfma_f32_16x16x32_bf16 a[96:99], a[212:215], a[132:135], a[96:99]
  ds_read_b128 a[164:167], v153 offset:32768
  v_mfma_f32_16x16x32_bf16 a[100:103], a[212:215], a[140:143], a[100:103]
  ds_read_b64_tr_b16 a[192:193], v132 offset:0
  v_mfma_f32_16x16x32_bf16 a[100:103], a[208:211], a[136:139], a[100:103]
  ds_read_b64_tr_b16 a[194:195], v132 offset:1024
  v_mfma_f32_16x16x32_bf16 a[104:107], a[208:211], a[144:147], a[104:107]
  ds_read_b64_tr_b16 a[196:197], v132 offset:8192
  v_mfma_f32_16x16x32_bf16 a[104:107], a[212:215], a[148:151], a[104:107]
  ds_read_b64_tr_b16 a[198:199], v132 offset:9216
  v_mfma_f32_16x16x32_bf16 a[108:111], a[212:215], a[156:159], a[108:111]
  ds_read_b128 a[168:171], v152 offset:34816
  v_mfma_f32_16x16x32_bf16 a[108:111], a[208:211], a[152:155], a[108:111]
  buffer_load_dwordx4 v239, s[8:11], s40 offen offset:3072  lds
  ds_read_b128 a[172:175], v153 offset:34816
  v_mfma_f32_16x16x32_bf16 a[124:127], a[216:219], a[152:155], a[124:127]
  ds_read_b128 a[176:179], v152 offset:36864
  v_mfma_f32_16x16x32_bf16 a[124:127], a[220:223], a[156:159], a[124:127]
  ds_read_b128 a[180:183], v153 offset:36864
  v_mfma_f32_16x16x32_bf16 a[120:123], a[220:223], a[148:151], a[120:123]
  ds_read_b128 a[184:187], v152 offset:38912
  v_mfma_f32_16x16x32_bf16 a[120:123], a[216:219], a[144:147], a[120:123]
  ds_read_b128 a[188:191], v153 offset:38912
  v_mfma_f32_16x16x32_bf16 a[116:119], a[216:219], a[136:139], a[116:119]
  ds_read_b64_tr_b16 a[200:201], v132 offset:8
  v_mfma_f32_16x16x32_bf16 a[116:119], a[220:223], a[140:143], a[116:119]
  ds_read_b64_tr_b16 a[202:203], v132 offset:1032
  v_mfma_f32_16x16x32_bf16 a[112:115], a[220:223], a[132:135], a[112:115]
  ds_read_b64_tr_b16 a[204:205], v132 offset:8200
  v_mfma_f32_16x16x32_bf16 a[112:115], a[216:219], a[128:131], a[112:115]
  ds_read_b64_tr_b16 a[206:207], v132 offset:9224
K1_rj6:
  s_waitcnt lgkmcnt(6)
  v_mfma_f32_16x16x32_bf16 v[0:3], a[192:195], a[160:163], v[0:3]
  ds_read_b64_tr_b16 a[208:209], v133 offset:0
  v_mfma_f32_16x16x32_bf16 v[0:3], a[196:199], a[164:167], v[0:3]
  buffer_load_dword v225, v157, s[4:7], 0 offen sc1
  v_mfma_f32_16x16x32_bf16 v[4:7], a[196:199], a[172:175], v[4:7]
  ds_read_b64_tr_b16 a[210:211], v133 offset:1024
  v_mfma_f32_16x16x32_bf16 v[4:7], a[192:195], a[168:171], v[4:7]
  v_mfma_f32_16x16x32_bf16 v[8:11], a[192:195], a[176:179], v[8:11]
  ds_read_b64_tr_b16 a[212:213], v133 offset:8192
  v_mfma_f32_16x16x32_bf16 v[8:11], a[196:199], a[180:183], v[8:11]
  s_waitcnt lgkmcnt(3)
  v_mfma_f32_16x16x32_bf16 v[12:15], a[196:199], a[188:191], v[12:15]
  ds_read_b64_tr_b16 a[214:215], v133 offset:9216
  v_mfma_f32_16x16x32_bf16 v[12:15], a[192:195], a[184:187], v[12:15]
  v_smfmac_f32_16x16x64_bf16 v[192:195], v[252:255], a[192:199], v224
  s_add_u32 m0, s44, 98304
  s_mov_b32 s41, 4718592
  v_mfma_f32_16x16x32_bf16 v[28:31], a[200:203], a[184:187], v[28:31]
  ds_read_b64_tr_b16 a[216:217], v133 offset:8
  buffer_load_dwordx4 v240, s[12:15], s41 offen offset:0  lds
  v_mfma_f32_16x16x32_bf16 v[28:31], a[204:207], a[188:191], v[28:31]
  v_mfma_f32_16x16x32_bf16 v[24:27], a[204:207], a[180:183], v[24:27]
  ds_read_b64_tr_b16 a[218:219], v133 offset:1032
  v_mfma_f32_16x16x32_bf16 v[24:27], a[200:203], a[176:179], v[24:27]
K1_st3:
  s_cbranch_execz K1_st7
  v_mfma_f32_16x16x32_bf16 v[20:23], a[200:203], a[168:171], v[20:23]
  ds_read_b64_tr_b16 a[220:221], v133 offset:8200
  v_mfma_f32_16x16x32_bf16 v[20:23], a[204:207], a[172:175], v[20:23]
  v_mfma_f32_16x16x32_bf16 v[16:19], a[204:207], a[164:167], v[16:19]
  ds_read_b64_tr_b16 a[222:223], v133 offset:9224
  v_mfma_f32_16x16x32_bf16 v[16:19], a[200:203], a[160:163], v[16:19]
  v_smfmac_f32_16x16x64_bf16 v[196:199], v[252:255], a[200:207], v224
  s_waitcnt lgkmcnt(2)
  buffer_load_dwordx4 v241, s[12:15], s41 offen offset:1024  lds
  v_mfma_f32_16x16x32_bf16 v[32:35], a[208:211], a[160:163], v[32:35]
  ds_read_b64_tr_b16 a[192:193], v134 offset:0
  v_mfma_f32_16x16x32_bf16 v[32:35], a[212:215], a[164:167], v[32:35]
  v_mfma_f32_16x16x32_bf16 v[36:39], a[212:215], a[172:175], v[36:39]
  ds_read_b64_tr_b16 a[194:195], v134 offset:1024
  v_mfma_f32_16x16x32_bf16 v[36:39], a[208:211], a[168:171], v[36:39]
  v_mfma_f32_16x16x32_bf16 v[40:43], a[208:211], a[176:179], v[40:43]
  ds_read_b64_tr_b16 a[196:197], v134 offset:8192
  v_mfma_f32_16x16x32_bf16 v[40:43], a[212:215], a[180:183], v[40:43]
  buffer_load_dwordx4 v242, s[12:15], s41 offen offset:2048  lds
  v_mfma_f32_16x16x32_bf16 v[44:47], a[212:215], a[188:191], v[44:47]
  ds_read_b64_tr_b16 a[198:199], v134 offset:9216
  v_mfma_f32_16x16x32_bf16 v[44:47], a[208:211], a[184:187], v[44:47]
  v_mfma_f32_16x16x32_bf16 v[60:63], a[216:219], a[184:187], v[60:63]
  s_waitcnt lgkmcnt(2)
  ds_read_b64_tr_b16 a[200:201], v134 offset:8
  v_mfma_f32_16x16x32_bf16 v[60:63], a[220:223], a[188:191], v[60:63]
  v_mfma_f32_16x16x32_bf16 v[56:59], a[220:223], a[180:183], v[56:59]
  ds_read_b64_tr_b16 a[202:203], v134 offset:1032
  v_mfma_f32_16x16x32_bf16 v[56:59], a[216:219], a[176:179], v[56:59]
  v_mfma_f32_16x16x32_bf16 v[52:55], a[216:219], a[168:171], v[52:55]
  ds_read_b64_tr_b16 a[204:205], v134 offset:8200
  v_mfma_f32_16x16x32_bf16 v[52:55], a[220:223], a[172:175], v[52:55]
  buffer_load_dwordx4 v243, s[12:15], s41 offen offset:3072  lds
  v_mfma_f32_16x16x32_bf16 v[48:51], a[220:223], a[164:167], v[48:51]
  ds_read_b64_tr_b16 a[206:207], v134 offset:9224
  v_mfma_f32_16x16x32_bf16 v[48:51], a[216:219], a[160:163], v[48:51]
  v_mfma_f32_16x16x32_bf16 v[64:67], a[192:195], a[160:163], v[64:67]
  s_waitcnt lgkmcnt(2)
  ds_read_b64_tr_b16 a[208:209], v135 offset:0
  v_mfma_f32_16x16x32_bf16 v[64:67], a[196:199], a[164:167], v[64:67]
  v_mfma_f32_16x16x32_bf16 v[68:71], a[196:199], a[172:175], v[68:71]
  ds_read_b64_tr_b16 a[210:211], v135 offset:1024
  v_mfma_f32_16x16x32_bf16 v[68:71], a[192:195], a[168:171], v[68:71]
  v_mfma_f32_16x16x32_bf16 v[72:75], a[192:195], a[176:179], v[72:75]
  s_add_u32 m0, s44, 114688
  s_mov_b32 s42, 1990656
  ds_read_b64_tr_b16 a[212:213], v135 offset:8192
  v_mfma_f32_16x16x32_bf16 v[72:75], a[196:199], a[180:183], v[72:75]
  buffer_load_dwordx4 v244, s[16:19], s42 offen offset:0  lds
  v_mfma_f32_16x16x32_bf16 v[76:79], a[196:199], a[188:191], v[76:79]
  ds_read_b64_tr_b16 a[214:215], v135 offset:9216
  v_mfma_f32_16x16x32_bf16 v[76:79], a[192:195], a[184:187], v[76:79]
  v_mfma_f32_16x16x32_bf16 v[92:95], a[200:203], a[184:187], v[92:95]
  s_waitcnt lgkmcnt(2)
  ds_read_b64_tr_b16 a[216:217], v135 offset:8
  v_mfma_f32_16x16x32_bf16 v[92:95], a[204:207], a[188:191], v[92:95]
  v_mfma_f32_16x16x32_bf16 v[88:91], a[204:207], a[180:183], v[88:91]
  ds_read_b64_tr_b16 a[218:219], v135 offset:1032
  v_mfma_f32_16x16x32_bf16 v[88:91], a[200:203], a[176:179], v[88:91]
  v_mfma_f32_16x16x32_bf16 v[84:87], a[200:203], a[168:171], v[84:87]
  ds_read_b64_tr_b16 a[220:221], v135 offset:8200
  v_mfma_f32_16x16x32_bf16 v[84:87], a[204:207], a[172:175], v[84:87]
  buffer_load_dwordx4 v245, s[16:19], s42 offen offset:1024  lds
  v_mfma_f32_16x16x32_bf16 v[80:83], a[204:207], a[164:167], v[80:83]
  ds_read_b64_tr_b16 a[222:223], v135 offset:9224
  v_mfma_f32_16x16x32_bf16 v[80:83], a[200:203], a[160:163], v[80:83]
  v_mfma_f32_16x16x32_bf16 v[96:99], a[208:211], a[160:163], v[96:99]
  s_waitcnt lgkmcnt(2)
  ds_read_b64_tr_b16 a[192:193], v144 offset:0
  v_mfma_f32_16x16x32_bf16 v[96:99], a[212:215], a[164:167], v[96:99]
  v_mfma_f32_16x16x32_bf16 v[100:103], a[212:215], a[172:175], v[100:103]
  ds_read_b64_tr_b16 a[194:195], v144 offset:512
  v_mfma_f32_16x16x32_bf16 v[100:103], a[208:211], a[168:171], v[100:103]
  v_mfma_f32_16x16x32_bf16 v[104:107], a[208:211], a[176:179], v[104:107]
  ds_read_b64_tr_b16 a[196:197], v144 offset:4096
  v_mfma_f32_16x16x32_bf16 v[104:107], a[212:215], a[180:183], v[104:107]
  buffer_load_dwordx4 v246, s[16:19], s42 offen offset:2048  lds
  v_mfma_f32_16x16x32_bf16 v[108:111], a[212:215], a[188:191], v[108:111]
  ds_read_b64_tr_b16 a[198:199], v144 offset:4608
  v_mfma_f32_16x16x32_bf16 v[108:111], a[208:211], a[184:187], v[108:111]
  v_mfma_f32_16x16x32_bf16 v[124:127], a[216:219], a[184:187], v[124:127]
  s_waitcnt lgkmcnt(2)
  ds_read_b64_tr_b16 a[200:201], v145 offset:0
  v_mfma_f32_16x16x32_bf16 v[124:127], a[220:223], a[188:191], v[124:127]
  v_mfma_f32_16x16x32_bf16 v[120:123], a[220:223], a[180:183], v[120:123]
  ds_read_b64_tr_b16 a[202:203], v145 offset:512
  v_mfma_f32_16x16x32_bf16 v[120:123], a[216:219], a[176:179], v[120:123]
  v_mfma_f32_16x16x32_bf16 v[116:119], a[216:219], a[168:171], v[116:119]
  ds_read_b64_tr_b16 a[204:205], v145 offset:4096
  v_mfma_f32_16x16x32_bf16 v[116:119], a[220:223], a[172:175], v[116:119]
  buffer_load_dwordx4 v247, s[16:19], s42 offen offset:3072  lds
  v_mfma_f32_16x16x32_bf16 v[112:115], a[220:223], a[164:167], v[112:115]
  ds_read_b64_tr_b16 a[206:207], v145 offset:4608
  v_mfma_f32_16x16x32_bf16 v[112:115], a[216:219], a[160:163], v[112:115]
  s_cmp_ge_u32 s39, 27
  s_cbranch_scc1 K1_sd7
  v_mfma_f32_16x16x32_bf16 a[0:3], a[192:195], a[160:163], a[0:3]
  s_waitcnt lgkmcnt(2)
  ds_read_b64_tr_b16 a[208:209], v146 offset:0
  v_mfma_f32_16x16x32_bf16 a[0:3], a[196:199], a[164:167], a[0:3]
  v_mfma_f32_16x16x32_bf16 a[4:7], a[196:199], a[172:175], a[4:7]
  s_add_u32 m0, s43, 32768
  s_movk_i32 s40, 1152
  ds_read_b64_tr_b16 a[210:211], v146 offset:512
  v_mfma_f32_16x16x32_bf16 a[4:7], a[192:195], a[168:171], a[4:7]
  buffer_load_dwordx4 v232, s[8:11], s40 offen offset:0  lds
  v_mfma_f32_16x16x32_bf16 a[8:11], a[192:195], a[176:179], a[8:11]
  ds_read_b64_tr_b16 a[212:213], v146 offset:4096
  v_mfma_f32_16x16x32_bf16 a[8:11], a[196:199], a[180:183], a[8:11]
  v_mfma_f32_16x16x32_bf16 a[12:15], a[196:199], a[188:191], a[12:15]
  ds_read_b64_tr_b16 a[214:215], v146 offset:4608
  v_mfma_f32_16x16x32_bf16 a[12:15], a[192:195], a[184:187], a[12:15]
  v_smfmac_f32_16x16x64_bf16 v[200:203], v[252:255], a[192:199], v224
  v_mfma_f32_16x16x32_bf16 a[28:31], a[200:203], a[184:187], a[28:31]
  s_waitcnt lgkmcnt(2)
  ds_read_b64_tr_b16 a[216:217], v147 offset:0
  v_mfma_f32_16x16x32_bf16 a[28:31], a[204:207], a[188:191], a[28:31]
  v_mfma_f32_16x16x32_bf16 a[24:27], a[204:207], a[180:183], a[24:27]
  ds_read_b64_tr_b16 a[218:219], v147 offset:512
  buffer_load_dwordx4 v233, s[8:11], s40 offen offset:1024  lds
  v_mfma_f32_16x16x32_bf16 a[24:27], a[200:203], a[176:179], a[24:27]
  v_mfma_f32_16x16x32_bf16 a[20:23], a[200:203], a[168:171], a[20:23]
  ds_read_b64_tr_b16 a[220:221], v147 offset:4096
  v_mfma_f32_16x16x32_bf16 a[20:23], a[204:207], a[172:175], a[20:23]
  v_mfma_f32_16x16x32_bf16 a[16:19], a[204:207], a[164:167], a[16:19]
  ds_read_b64_tr_b16 a[222:223], v147 offset:4608
  v_mfma_f32_16x16x32_bf16 a[16:19], a[200:203], a[160:163], a[16:19]
  v_smfmac_f32_16x16x64_bf16 v[204:207], v[252:255], a[200:207], v224
  v_mfma_f32_16x16x32_bf16 a[32:35], a[208:211], a[160:163], a[32:35]
  s_waitcnt lgkmcnt(2)
  ds_read_b64_tr_b16 a[192:193], v148 offset:0
  v_mfma_f32_16x16x32_bf16 a[32:35], a[212:215], a[164:167], a[32:35]
  buffer_load_dwordx4 v234, s[8:11], s40 offen offset:2048  lds
  v_mfma_f32_16x16x32_bf16 a[36:39], a[212:215], a[172:175], a[36:39]
  ds_read_b64_tr_b16 a[194:195], v148 offset:512
  v_mfma_f32_16x16x32_bf16 a[36:39], a[208:211], a[168:171], a[36:39]
  v_mfma_f32_16x16x32_bf16 a[40:43], a[208:211], a[176:179], a[40:43]
  ds_read_b64_tr_b16 a[196:197], v148 offset:4096
  v_mfma_f32_16x16x32_bf16 a[40:43], a[212:215], a[180:183], a[40:43]
  v_mfma_f32_16x16x32_bf16 a[44:47], a[212:215], a[188:191], a[44:47]
  ds_read_b64_tr_b16 a[198:199], v148 offset:4608
  v_mfma_f32_16x16x32_bf16 a[44:47], a[208:211], a[184:187], a[44:47]
  v_mfma_f32_16x16x32_bf16 a[60:63], a[216:219], a[184:187], a[60:63]
  s_waitcnt lgkmcnt(2)
  ds_read_b64_tr_b16 a[200:201], v149 offset:0
  v_mfma_f32_16x16x32_bf16 a[60:63], a[220:223], a[188:191], a[60:63]
  buffer_load_dwordx4 v235, s[8:11], s40 offen offset:3072  lds
  v_mfma_f32_16x16x32_bf16 a[56:59], a[220:223], a[180:183], a[56:59]
  ds_read_b64_tr_b16 a[202:203], v149 offset:512
  v_mfma_f32_16x16x32_bf16 a[56:59], a[216:219], a[176:179], a[56:59]
  v_mfma_f32_16x16x32_bf16 a[52:55], a[216:219], a[168:171], a[52:55]
  ds_read_b64_tr_b16 a[204:205], v149 offset:4096
  v_mfma_f32_16x16x32_bf16 a[52:55], a[220:223], a[172:175], a[52:55]
  v_mfma_f32_16x16x32_bf16 a[48:51], a[220:223], a[164:167], a[48:51]
  ds_read_b64_tr_b16 a[206:207], v149 offset:4608
  v_mfma_f32_16x16x32_bf16 a[48:51], a[216:219], a[160:163], a[48:51]
  v_mfma_f32_16x16x32_bf16 a[64:67], a[192:195], a[160:163], a[64:67]
  s_waitcnt lgkmcnt(2)
  s_add_u32 m0, s43, 36864
  ds_read_b64_tr_b16 a[208:209], v150 offset:0
  v_mfma_f32_16x16x32_bf16 a[64:67], a[196:199], a[164:167], a[64:67]
  buffer_load_dwordx4 v236, s[8:11], s40 offen offset:0  lds
  v_mfma_f32_16x16x32_bf16 a[68:71], a[196:199], a[172:175], a[68:71]
  ds_read_b64_tr_b16 a[210:211], v150 offset:512
  v_mfma_f32_16x16x32_bf16 a[68:71], a[192:195], a[168:171], a[68:71]
  v_mfma_f32_16x16x32_bf16 a[72:75], a[192:195], a[176:179], a[72:75]
  ds_read_b64_tr_b16 a[212:213], v150 offset:4096
  v_mfma_f32_16x16x32_bf16 a[72:75], a[196:199], a[180:183], a[72:75]
  v_mfma_f32_16x16x32_bf16 a[76:79], a[196:199], a[188:191], a[76:79]
  ds_read_b64_tr_b16 a[214:215], v150 offset:4608
  v_mfma_f32_16x16x32_bf16 a[76:79], a[192:195], a[184:187], a[76:79]
  v_mfma_f32_16x16x32_bf16 a[92:95], a[200:203], a[184:187], a[92:95]
  s_waitcnt lgkmcnt(2)
  ds_read_b64_tr_b16 a[216:217], v151 offset:0
  v_mfma_f32_16x16x32_bf16 a[92:95], a[204:207], a[188:191], a[92:95]
  buffer_load_dwordx4 v237, s[8:11], s40 offen offset:1024  lds
  v_mfma_f32_16x16x32_bf16 a[88:91], a[204:207], a[180:183], a[88:91]
  ds_read_b64_tr_b16 a[218:219], v151 offset:512
  v_mfma_f32_16x16x32_bf16 a[88:91], a[200:203], a[176:179], a[88:91]
  v_mfma_f32_16x16x32_bf16 a[84:87], a[200:203], a[168:171], a[84:87]
  ds_read_b64_tr_b16 a[220:221], v151 offset:4096
  v_mfma_f32_16x16x32_bf16 a[84:87], a[204:207], a[172:175], a[84:87]
  v_mfma_f32_16x16x32_bf16 a[80:83], a[204:207], a[164:167], a[80:83]
  ds_read_b64_tr_b16 a[222:223], v151 offset:4608
  v_mfma_f32_16x16x32_bf16 a[80:83], a[200:203], a[160:163], a[80:83]
  buffer_load_dwordx4 v238, s[8:11], s40 offen offset:2048  lds
  v_mfma_f32_16x16x32_bf16 a[96:99], a[208:211], a[160:163], a[96:99]
  s_waitcnt vmcnt(16) lgkmcnt(0)
  s_barrier
  ds_read_b128 a[128:131], v152 offset:0
  v_mfma_f32_16x16x32_bf16 a[96:99], a[212:215], a[164:167], a[96:99]
  ds_read_b128 a[132:135], v153 offset:0
  v_mfma_f32_16x16x32_bf16 a[100:103], a[212:215], a[172:175], a[100:103]
  ds_read_b64_tr_b16 a[192:193], v128 offset:0
  v_mfma_f32_16x16x32_bf16 a[100:103], a[208:211], a[168:171], a[100:103]
  ds_read_b64_tr_b16 a[194:195], v128 offset:1024
  v_mfma_f32_16x16x32_bf16 a[104:107], a[208:211], a[176:179], a[104:107]
  ds_read_b64_tr_b16 a[196:197], v128 offset:8192
  v_mfma_f32_16x16x32_bf16 a[104:107], a[212:215], a[180:183], a[104:107]
  ds_read_b64_tr_b16 a[198:199], v128 offset:9216
  v_mfma_f32_16x16x32_bf16 a[108:111], a[212:215], a[188:191], a[108:111]
  ds_read_b128 a[136:139], v152 offset:2048
  v_mfma_f32_16x16x32_bf16 a[108:111], a[208:211], a[184:187], a[108:111]
  buffer_load_dwordx4 v239, s[8:11], s40 offen offset:3072  lds
  ds_read_b128 a[140:143], v153 offset:2048
  v_mfma_f32_16x16x32_bf16 a[124:127], a[216:219], a[184:187], a[124:127]
  ds_read_b128 a[144:147], v152 offset:4096
  v_mfma_f32_16x16x32_bf16 a[124:127], a[220:223], a[188:191], a[124:127]
  ds_read_b128 a[148:151], v153 offset:4096
  v_mfma_f32_16x16x32_bf16 a[120:123], a[220:223], a[180:183], a[120:123]
  ds_read_b128 a[152:155], v152 offset:6144
  v_mfma_f32_16x16x32_bf16 a[120:123], a[216:219], a[176:179], a[120:123]
  ds_read_b128 a[156:159], v153 offset:6144
  v_mfma_f32_16x16x32_bf16 a[116:119], a[216:219], a[168:171], a[116:119]
  ds_read_b64_tr_b16 a[200:201], v128 offset:8
  v_mfma_f32_16x16x32_bf16 a[116:119], a[220:223], a[172:175], a[116:119]
  ds_read_b64_tr_b16 a[202:203], v128 offset:1032
  v_mfma_f32_16x16x32_bf16 a[112:115], a[220:223], a[164:167], a[112:115]
  ds_read_b64_tr_b16 a[204:205], v128 offset:8200
  v_mfma_f32_16x16x32_bf16 a[112:115], a[216:219], a[160:163], a[112:115]
  ds_read_b64_tr_b16 a[206:207], v128 offset:9224
K1_rj7:
  s_mov_b32 s54, 0x100000
  s_waitcnt vmcnt(16)
  v_mov_b32 v225, v225
K1_spinS:
  v_cmp_gt_u32 vcc, 32, v225
  s_nop 4
  s_cbranch_vccz K1_spinS_ok
  s_sleep 2
  buffer_load_dword v225, v157, s[4:7], 0 offen sc1
  s_sub_u32 s54, s54, 1
  s_cmp_lg_u32 s54, 0
  s_waitcnt vmcnt(0)
  s_cbranch_scc1 K1_spinS
K1_spinS_ok:
  s_waitcnt lgkmcnt(6)
  v_mfma_f32_16x16x32_bf16 v[0:3], a[192:195], a[128:131], v[0:3]
  ds_read_b64_tr_b16 a[208:209], v129 offset:0
  v_mfma_f32_16x16x32_bf16 v[0:3], a[196:199], a[132:135], v[0:3]
  buffer_load_dwordx2 v[232:233], v226, s[80:83], 0 offen offset:0 sc1
  v_mfma_f32_16x16x32_bf16 v[4:7], a[196:199], a[140:143], v[4:7]
  ds_read_b64_tr_b16 a[210:211], v129 offset:1024
  v_mfma_f32_16x16x32_bf16 v[4:7], a[192:195], a[136:139], v[4:7]
  v_mfma_f32_16x16x32_bf16 v[8:11], a[192:195], a[144:147], v[8:11]
  ds_read_b64_tr_b16 a[212:213], v129 offset:8192
  v_mfma_f32_16x16x32_bf16 v[8:11], a[196:199], a[148:151], v[8:11]
  s_waitcnt lgkmcnt(3)
  v_mfma_f32_16x16x32_bf16 v[12:15], a[196:199], a[156:159], v[12:15]
  ds_read_b64_tr_b16 a[214:215], v129 offset:9216
  v_mfma_f32_16x16x32_bf16 v[12:15], a[192:195], a[152:155], v[12:15]
  v_smfmac_f32_16x16x64_bf16 v[192:195], v[252:255], a[192:199], v224
  v_mfma_f32_16x16x32_bf16 v[28:31], a[200:203], a[152:155], v[28:31]
  ds_read_b64_tr_b16 a[216:217], v129 offset:8
  v_mfma_f32_16x16x32_bf16 v[28:31], a[204:207], a[156:159], v[28:31]
  v_mfma_f32_16x16x32_bf16 v[24:27], a[204:207], a[148:151], v[24:27]
  ds_read_b64_tr_b16 a[218:219], v129 offset:1032
  v_mfma_f32_16x16x32_bf16 v[24:27], a[200:203], a[144:147], v[24:27]
  v_mfma_f32_16x16x32_bf16 v[20:23], a[200:203], a[136:139], v[20:23]
  ds_read_b64_tr_b16 a[220:221], v129 offset:8200
  buffer_load_dwordx2 v[234:235], v226, s[80:83], 0 offen offset:128 sc1
  v_mfma_f32_16x16x32_bf16 v[20:23], a[204:207], a[140:143], v[20:23]
  v_mfma_f32_16x16x32_bf16 v[16:19], a[204:207], a[132:135], v[16:19]
  ds_read_b64_tr_b16 a[222:223], v129 offset:9224
  v_mfma_f32_16x16x32_bf16 v[16:19], a[200:203], a[128:131], v[16:19]
  v_smfmac_f32_16x16x64_bf16 v[196:199], v[252:255], a[200:207], v224
  s_waitcnt lgkmcnt(2)
  v_mfma_f32_16x16x32_bf16 v[32:35], a[208:211], a[128:131], v[32:35]
  ds_read_b64_tr_b16 a[192:193], v130 offset:0
  v_mfma_f32_16x16x32_bf16 v[32:35], a[212:215], a[132:135], v[32:35]
  v_mfma_f32_16x16x32_bf16 v[36:39], a[212:215], a[140:143], v[36:39]
  ds_read_b64_tr_b16 a[194:195], v130 offset:1024
  v_mfma_f32_16x16x32_bf16 v[36:39], a[208:211], a[136:139], v[36:39]
  v_mfma_f32_16x16x32_bf16 v[40:43], a[208:211], a[144:147], v[40:43]
  ds_read_b64_tr_b16 a[196:197], v130 offset:8192
  v_mfma_f32_16x16x32_bf16 v[40:43], a[212:215], a[148:151], v[40:43]
  buffer_load_dwordx2 v[236:237], v226, s[80:83], 0 offen offset:256 sc1
  v_mfma_f32_16x16x32_bf16 v[44:47], a[212:215], a[156:159], v[44:47]
  ds_read_b64_tr_b16 a[198:199], v130 offset:9216
  v_mfma_f32_16x16x32_bf16 v[44:47], a[208:211], a[152:155], v[44:47]
  v_mfma_f32_16x16x32_bf16 v[60:63], a[216:219], a[152:155], v[60:63]
  s_waitcnt lgkmcnt(2)
  ds_read_b64_tr_b16 a[200:201], v130 offset:8
  v_mfma_f32_16x16x32_bf16 v[60:63], a[220:223], a[156:159], v[60:63]
  v_mfma_f32_16x16x32_bf16 v[56:59], a[220:223], a[148:151], v[56:59]
  ds_read_b64_tr_b16 a[202:203], v130 offset:1032
  v_mfma_f32_16x16x32_bf16 v[56:59], a[216:219], a[144:147], v[56:59]
  v_mfma_f32_16x16x32_bf16 v[52:55], a[216:219], a[136:139], v[52:55]
  ds_read_b64_tr_b16 a[204:205], v130 offset:8200
  v_mfma_f32_16x16x32_bf16 v[52:55], a[220:223], a[140:143], v[52:55]
  v_mfma_f32_16x16x32_bf16 v[48:51], a[220:223], a[132:135], v[48:51]
  ds_read_b64_tr_b16 a[206:207], v130 offset:9224
  v_mfma_f32_16x16x32_bf16 v[48:51], a[216:219], a[128:131], v[48:51]
  v_mfma_f32_16x16x32_bf16 v[64:67], a[192:195], a[128:131], v[64:67]
  s_waitcnt lgkmcnt(2)
  ds_read_b64_tr_b16 a[208:209], v131 offset:0
  v_mfma_f32_16x16x32_bf16 v[64:67], a[196:199], a[132:135], v[64:67]
  buffer_load_dwordx2 v[238:239], v226, s[80:83], 0 offen offset:384 sc1
  v_mfma_f32_16x16x32_bf16 v[68:71], a[196:199], a[140:143], v[68:71]
  ds_read_b64_tr_b16 a[210:211], v131 offset:1024
  v_mfma_f32_16x16x32_bf16 v[68:71], a[192:195], a[136:139], v[68:71]
  v_mfma_f32_16x16x32_bf16 v[72:75], a[192:195], a[144:147], v[72:75]
  ds_read_b64_tr_b16 a[212:213], v131 offset:8192
  v_mfma_f32_16x16x32_bf16 v[72:75], a[196:199], a[148:151], v[72:75]
  v_mfma_f32_16x16x32_bf16 v[76:79], a[196:199], a[156:159], v[76:79]
  ds_read_b64_tr_b16 a[214:215], v131 offset:9216
  v_mfma_f32_16x16x32_bf16 v[76:79], a[192:195], a[152:155], v[76:79]
  v_mfma_f32_16x16x32_bf16 v[92:95], a[200:203], a[152:155], v[92:95]
  s_waitcnt lgkmcnt(2)
  ds_read_b64_tr_b16 a[216:217], v131 offset:8
  v_mfma_f32_16x16x32_bf16 v[92:95], a[204:207], a[156:159], v[92:95]
  v_mfma_f32_16x16x32_bf16 v[88:91], a[204:207], a[148:151], v[88:91]
  s_add_u32 m0, s43, 131072
  s_movk_i32 s52, 0
  ds_read_b64_tr_b16 a[218:219], v131 offset:1032
  v_mfma_f32_16x16x32_bf16 v[88:91], a[200:203], a[144:147], v[88:91]
  buffer_load_dwordx4 v228, s[72:75], s52 offen offset:0 lds
  v_mfma_f32_16x16x32_bf16 v[84:87], a[200:203], a[136:139], v[84:87]
  ds_read_b64_tr_b16 a[220:221], v131 offset:8200
  v_mfma_f32_16x16x32_bf16 v[84:87], a[204:207], a[140:143], v[84:87]
  v_mfma_f32_16x16x32_bf16 v[80:83], a[204:207], a[132:135], v[80:83]
  ds_read_b64_tr_b16 a[222:223], v131 offset:9224
  v_mfma_f32_16x16x32_bf16 v[80:83], a[200:203], a[128:131], v[80:83]
  v_mfma_f32_16x16x32_bf16 v[96:99], a[208:211], a[128:131], v[96:99]
  s_waitcnt lgkmcnt(2)
  ds_read_b64_tr_b16 a[192:193], v136 offset:0
  v_mfma_f32_16x16x32_bf16 v[96:99], a[212:215], a[132:135], v[96:99]
  v_mfma_f32_16x16x32_bf16 v[100:103], a[212:215], a[140:143], v[100:103]
  ds_read_b64_tr_b16 a[194:195], v136 offset:512
  v_mfma_f32_16x16x32_bf16 v[100:103], a[208:211], a[136:139], v[100:103]
  v_mfma_f32_16x16x32_bf16 v[104:107], a[208:211], a[144:147], v[104:107]
  ds_read_b64_tr_b16 a[196:197], v136 offset:4096
  v_mfma_f32_16x16x32_bf16 v[104:107], a[212:215], a[148:151], v[104:107]
  v_mfma_f32_16x16x32_bf16 v[108:111], a[212:215], a[156:159], v[108:111]
  ds_read_b64_tr_b16 a[198:199], v136 offset:4608
  v_mfma_f32_16x16x32_bf16 v[108:111], a[208:211], a[152:155], v[108:111]
  buffer_load_dwordx4 v229, s[72:75], s52 offen offset:1024 lds
  v_mfma_f32_16x16x32_bf16 v[124:127], a[216:219], a[152:155], v[124:127]
  s_waitcnt lgkmcnt(2)
  ds_read_b64_tr_b16 a[200:201], v137 offset:0
  v_mfma_f32_16x16x32_bf16 v[124:127], a[220:223], a[156:159], v[124:127]
  v_mfma_f32_16x16x32_bf16 v[120:123], a[220:223], a[148:151], v[120:123]
  ds_read_b64_tr_b16 a[202:203], v137 offset:512
  v_mfma_f32_16x16x32_bf16 v[120:123], a[216:219], a[144:147], v[120:123]
  v_mfma_f32_16x16x32_bf16 v[116:119], a[216:219], a[136:139], v[116:119]
  ds_read_b64_tr_b16 a[204:205], v137 offset:4096
  v_mfma_f32_16x16x32_bf16 v[116:119], a[220:223], a[140:143], v[116:119]
  v_mfma_f32_16x16x32_bf16 v[112:115], a[220:223], a[132:135], v[112:115]
  ds_read_b64_tr_b16 a[206:207], v137 offset:4608
  v_mfma_f32_16x16x32_bf16 v[112:115], a[216:219], a[128:131], v[112:115]
  s_cmp_ge_u32 s39, 27
  s_cbranch_scc1 K1_sd8
  v_mfma_f32_16x16x32_bf16 a[0:3], a[192:195], a[128:131], a[0:3]
  s_waitcnt lgkmcnt(2)
  ds_read_b64_tr_b16 a[208:209], v138 offset:0
  v_mfma_f32_16x16x32_bf16 a[0:3], a[196:199], a[132:135], a[0:3]
  buffer_load_dwordx4 v230, s[72:75], s52 offen offset:2048 lds
  v_mfma_f32_16x16x32_bf16 a[4:7], a[196:199], a[140:143], a[4:7]
  ds_read_b64_tr_b16 a[210:211], v138 offset:512
  v_mfma_f32_16x16x32_bf16 a[4:7], a[192:195], a[136:139], a[4:7]
  v_mfma_f32_16x16x32_bf16 a[8:11], a[192:195], a[144:147], a[8:11]
  ds_read_b64_tr_b16 a[212:213], v138 offset:4096
  v_mfma_f32_16x16x32_bf16 a[8:11], a[196:199], a[148:151], a[8:11]
  v_mfma_f32_16x16x32_bf16 a[12:15], a[196:199], a[156:159], a[12:15]
  ds_read_b64_tr_b16 a[214:215], v138 offset:4608
  v_mfma_f32_16x16x32_bf16 a[12:15], a[192:195], a[152:155], a[12:15]
  v_smfmac_f32_16x16x64_bf16 v[200:203], v[252:255], a[192:199], v224
  v_mfma_f32_16x16x32_bf16 a[28:31], a[200:203], a[152:155], a[28:31]
  s_waitcnt lgkmcnt(2)
  ds_read_b64_tr_b16 a[216:217], v139 offset:0
  v_mfma_f32_16x16x32_bf16 a[28:31], a[204:207], a[156:159], a[28:31]
  v_mfma_f32_16x16x32_bf16 a[24:27], a[204:207], a[148:151], a[24:27]
  ds_read_b64_tr_b16 a[218:219], v139 offset:512
  v_mfma_f32_16x16x32_bf16 a[24:27], a[200:203], a[144:147], a[24:27]
  s_add_u32 m0, s43, 133632
  s_movk_i32 s52, 20480
  v_mfma_f32_16x16x32_bf16 a[20:23], a[200:203], a[136:139], a[20:23]
  ds_read_b64_tr_b16 a[220:221], v139 offset:4096
  buffer_load_dwordx4 v228, s[72:75], s52 offen offset:0 lds
  v_mfma_f32_16x16x32_bf16 a[20:23], a[204:207], a[140:143], a[20:23]
  v_mfma_f32_16x16x32_bf16 a[16:19], a[204:207], a[132:135], a[16:19]
  ds_read_b64_tr_b16 a[222:223], v139 offset:4608
  v_mfma_f32_16x16x32_bf16 a[16:19], a[200:203], a[128:131], a[16:19]
  v_smfmac_f32_16x16x64_bf16 v[204:207], v[252:255], a[200:207], v224
  v_mfma_f32_16x16x32_bf16 a[32:35], a[208:211], a[128:131], a[32:35]
  s_waitcnt lgkmcnt(2)
  ds_read_b64_tr_b16 a[192:193], v140 offset:0
  v_mfma_f32_16x16x32_bf16 a[32:35], a[212:215], a[132:135], a[32:35]
  v_mfma_f32_16x16x32_bf16 a[36:39], a[212:215], a[140:143], a[36:39]
  ds_read_b64_tr_b16 a[194:195], v140 offset:512
  v_mfma_f32_16x16x32_bf16 a[36:39], a[208:211], a[136:139], a[36:39]
  v_mfma_f32_16x16x32_bf16 a[40:43], a[208:211], a[144:147], a[40:43]
  ds_read_b64_tr_b16 a[196:197], v140 offset:4096
  v_mfma_f32_16x16x32_bf16 a[40:43], a[212:215], a[148:151], a[40:43]
  buffer_load_dwordx4 v229, s[72:75], s52 offen offset:1024 lds
  v_mfma_f32_16x16x32_bf16 a[44:47], a[212:215], a[156:159], a[44:47]
  ds_read_b64_tr_b16 a[198:199], v140 offset:4608
  v_mfma_f32_16x16x32_bf16 a[44:47], a[208:211], a[152:155], a[44:47]
  v_mfma_f32_16x16x32_bf16 a[60:63], a[216:219], a[152:155], a[60:63]
  s_waitcnt lgkmcnt(2)
  ds_read_b64_tr_b16 a[200:201], v141 offset:0
  v_mfma_f32_16x16x32_bf16 a[60:63], a[220:223], a[156:159], a[60:63]
  v_mfma_f32_16x16x32_bf16 a[56:59], a[220:223], a[148:151], a[56:59]
  ds_read_b64_tr_b16 a[202:203], v141 offset:512
  v_mfma_f32_16x16x32_bf16 a[56:59], a[216:219], a[144:147], a[56:59]
  v_mfma_f32_16x16x32_bf16 a[52:55], a[216:219], a[136:139], a[52:55]
  ds_read_b64_tr_b16 a[204:205], v141 offset:4096
  v_mfma_f32_16x16x32_bf16 a[52:55], a[220:223], a[140:143], a[52:55]
  v_mfma_f32_16x16x32_bf16 a[48:51], a[220:223], a[132:135], a[48:51]
  ds_read_b64_tr_b16 a[206:207], v141 offset:4608
  v_mfma_f32_16x16x32_bf16 a[48:51], a[216:219], a[128:131], a[48:51]
  v_mfma_f32_16x16x32_bf16 a[64:67], a[192:195], a[128:131], a[64:67]
  s_waitcnt lgkmcnt(2)
  ds_read_b64_tr_b16 a[208:209], v142 offset:0
  v_mfma_f32_16x16x32_bf16 a[64:67], a[196:199], a[132:135], a[64:67]
  buffer_load_dwordx4 v230, s[72:75], s52 offen offset:2048 lds
  v_mfma_f32_16x16x32_bf16 a[68:71], a[196:199], a[140:143], a[68:71]
  ds_read_b64_tr_b16 a[210:211], v142 offset:512
  v_mfma_f32_16x16x32_bf16 a[68:71], a[192:195], a[136:139], a[68:71]
  v_mfma_f32_16x16x32_bf16 a[72:75], a[192:195], a[144:147], a[72:75]
  ds_read_b64_tr_b16 a[212:213], v142 offset:4096
  v_mfma_f32_16x16x32_bf16 a[72:75], a[196:199], a[148:151], a[72:75]
  v_mfma_f32_16x16x32_bf16 a[76:79], a[196:199], a[156:159], a[76:79]
  ds_read_b64_tr_b16 a[214:215], v142 offset:4608
  v_mfma_f32_16x16x32_bf16 a[76:79], a[192:195], a[152:155], a[76:79]
  v_mfma_f32_16x16x32_bf16 a[92:95], a[200:203], a[152:155], a[92:95]
  s_waitcnt lgkmcnt(2)
  ds_read_b64_tr_b16 a[216:217], v143 offset:0
  v_mfma_f32_16x16x32_bf16 a[92:95], a[204:207], a[156:159], a[92:95]
  v_mfma_f32_16x16x32_bf16 a[88:91], a[204:207], a[148:151], a[88:91]
  ds_read_b64_tr_b16 a[218:219], v143 offset:512
  v_mfma_f32_16x16x32_bf16 a[88:91], a[200:203], a[144:147], a[88:91]
  v_mfma_f32_16x16x32_bf16 a[84:87], a[200:203], a[136:139], a[84:87]
  ds_read_b64_tr_b16 a[220:221], v143 offset:4096
  v_mfma_f32_16x16x32_bf16 a[84:87], a[204:207], a[140:143], a[84:87]
  v_mfma_f32_16x16x32_bf16 a[80:83], a[204:207], a[132:135], a[80:83]
  ds_read_b64_tr_b16 a[222:223], v143 offset:4608
  v_mfma_f32_16x16x32_bf16 a[80:83], a[200:203], a[128:131], a[80:83]
  v_mfma_f32_16x16x32_bf16 a[96:99], a[208:211], a[128:131], a[96:99]
  s_waitcnt vmcnt(10) lgkmcnt(0)
  s_barrier
  ds_read_b128 a[160:163], v152 offset:32768
  v_mfma_f32_16x16x32_bf16 a[96:99], a[212:215], a[132:135], a[96:99]
  ds_read_b128 a[164:167], v153 offset:32768
  v_mfma_f32_16x16x32_bf16 a[100:103], a[212:215], a[140:143], a[100:103]
  ds_read_b64_tr_b16 a[192:193], v128 offset:32768
  v_mfma_f32_16x16x32_bf16 a[100:103], a[208:211], a[136:139], a[100:103]
  ds_read_b64_tr_b16 a[194:195], v128 offset:33792
  v_mfma_f32_16x16x32_bf16 a[104:107], a[208:211], a[144:147], a[104:107]
  ds_read_b64_tr_b16 a[196:197], v128 offset:40960
  v_mfma_f32_16x16x32_bf16 a[104:107], a[212:215], a[148:151], a[104:107]
  ds_read_b64_tr_b16 a[198:199], v128 offset:41984
  v_mfma_f32_16x16x32_bf16 a[108:111], a[212:215], a[156:159], a[108:111]
  ds_read_b128 a[168:171], v152 offset:34816
  v_mfma_f32_16x16x32_bf16 a[108:111], a[208:211], a[152:155], a[108:111]
  ds_read_b128 a[172:175], v153 offset:34816
  v_mfma_f32_16x16x32_bf16 a[124:127], a[216:219], a[152:155], a[124:127]
  ds_read_b128 a[176:179], v152 offset:36864
  v_mfma_f32_16x16x32_bf16 a[124:127], a[220:223], a[156:159], a[124:127]
  ds_read_b128 a[180:183], v153 offset:36864
  v_mfma_f32_16x16x32_bf16 a[120:123], a[220:223], a[148:151], a[120:123]
  ds_read_b128 a[184:187], v152 offset:38912
  v_mfma_f32_16x16x32_bf16 a[120:123], a[216:219], a[144:147], a[120:123]
  ds_read_b128 a[188:191], v153 offset:38912
  v_mfma_f32_16x16x32_bf16 a[116:119], a[216:219], a[136:139], a[116:119]
  ds_read_b64_tr_b16 a[200:201], v128 offset:32776
  v_mfma_f32_16x16x32_bf16 a[116:119], a[220:223], a[140:143], a[116:119]
  ds_read_b64_tr_b16 a[202:203], v128 offset:33800
  v_mfma_f32_16x16x32_bf16 a[112:115], a[220:223], a[132:135], a[112:115]
  ds_read_b64_tr_b16 a[204:205], v128 offset:40968
  v_mfma_f32_16x16x32_bf16 a[112:115], a[216:219], a[128:131], a[112:115]
  ds_read_b64_tr_b16 a[206:207], v128 offset:41992
K1_rj8:
  s_waitcnt lgkmcnt(6)
  v_mfma_f32_16x16x32_bf16 v[0:3], a[192:195], a[160:163], v[0:3]
  s_add_u32 m0, s44, 0
  ds_read_b64_tr_b16 a[208:209], v136 offset:32768
  v_mfma_f32_16x16x32_bf16 v[0:3], a[196:199], a[164:167], v[0:3]
  buffer_load_dwordx4 v220, s[24:27], s46 offen offset:0  lds
  v_mfma_f32_16x16x32_bf16 v[4:7], a[196:199], a[172:175], v[4:7]
  ds_read_b64_tr_b16 a[210:211], v136 offset:33280
  v_mfma_f32_16x16x32_bf16 v[4:7], a[192:195], a[168:171], v[4:7]
  v_mfma_f32_16x16x32_bf16 v[8:11], a[192:195], a[176:179], v[8:11]
  ds_read_b64_tr_b16 a[212:213], v136 offset:36864
  v_mfma_f32_16x16x32_bf16 v[8:11], a[196:199], a[180:183], v[8:11]
  s_waitcnt lgkmcnt(3)
  v_mfma_f32_16x16x32_bf16 v[12:15], a[196:199], a[188:191], v[12:15]
  ds_read_b64_tr_b16 a[214:215], v136 offset:37376
  v_mfma_f32_16x16x32_bf16 v[12:15], a[192:195], a[184:187], v[12:15]
  v_smfmac_f32_16x16x64_bf16 v[192:195], v[252:255], a[192:199], v224
  v_and_b32 v240, 15, v222
  v_lshlrev_b32 v240, 4, v240
  v_mfma_f32_16x16x32_bf16 v[28:31], a[200:203], a[184:187], v[28:31]
  s_lshl_b32 s51, s36, 9
  ds_read_b64_tr_b16 a[216:217], v137 offset:32768
  buffer_load_dwordx4 v220, s[24:27], s46 offen offset:1024  lds
  v_mfma_f32_16x16x32_bf16 v[28:31], a[204:207], a[188:191], v[28:31]
  s_add_u32 s51, s51, 137216
  v_mfma_f32_16x16x32_bf16 v[24:27], a[204:207], a[180:183], v[24:27]
  ds_read_b64_tr_b16 a[218:219], v137 offset:33280
  v_add_u32 v240, s51, v240
  v_mfma_f32_16x16x32_bf16 v[24:27], a[200:203], a[176:179], v[24:27]
  v_xor_b32 v241, 512, v240
  v_xor_b32 v242, 1024, v240
  v_mfma_f32_16x16x32_bf16 v[20:23], a[200:203], a[168:171], v[20:23]
  ds_read_b64_tr_b16 a[220:221], v137 offset:36864
  v_xor_b32 v243, 1536, v240
  v_mfma_f32_16x16x32_bf16 v[20:23], a[204:207], a[172:175], v[20:23]
  v_cmp_gt_u32 vcc, 16, v222
  s_waitcnt vmcnt(11)
  v_mul_f32 v244, 0x3e0293ee, v233
  v_mfma_f32_16x16x32_bf16 v[16:19], a[204:207], a[164:167], v[16:19]
  ds_read_b64_tr_b16 a[222:223], v137 offset:37376
  v_cvt_pk_bf16_f32 v248, v232, v232
  v_mfma_f32_16x16x32_bf16 v[16:19], a[200:203], a[160:163], v[16:19]
  s_waitcnt vmcnt(10)
  v_mul_f32 v245, 0x3e0293ee, v235
  v_cvt_pk_bf16_f32 v249, v234, v234
  v_smfmac_f32_16x16x64_bf16 v[196:199], v[252:255], a[200:207], v224
  s_waitcnt lgkmcnt(2)
  buffer_load_dwordx4 v220, s[24:27], s46 offen offset:2048  lds
  v_mfma_f32_16x16x32_bf16 a[0:3], a[208:211], a[160:163], a[0:3]
  ds_read_b64_tr_b16 a[192:193], v129 offset:32768
  s_waitcnt vmcnt(10)
  v_mul_f32 v246, 0x3e0293ee, v237
  v_mfma_f32_16x16x32_bf16 a[0:3], a[212:215], a[164:167], a[0:3]
  v_cvt_pk_bf16_f32 v250, v236, v236
  s_waitcnt vmcnt(9)
  v_mul_f32 v247, 0x3e0293ee, v239
  v_mfma_f32_16x16x32_bf16 a[4:7], a[212:215], a[172:175], a[4:7]
  ds_read_b64_tr_b16 a[194:195], v129 offset:33792
  v_cvt_pk_bf16_f32 v251, v238, v238
  v_mfma_f32_16x16x32_bf16 a[4:7], a[208:211], a[168:171], a[4:7]
  v_cndmask_b32 v248, 0, v248, vcc
  v_cndmask_b32 v249, 0, v249, vcc
  v_mfma_f32_16x16x32_bf16 a[8:11], a[208:211], a[176:179], a[8:11]
  ds_read_b64_tr_b16 a[196:197], v129 offset:40960
  v_cndmask_b32 v250, 0, v250, vcc
  v_mfma_f32_16x16x32_bf16 a[8:11], a[212:215], a[180:183], a[8:11]
  v_cndmask_b32 v251, 0, v251, vcc
  v_add_f32 v193, v192, v193
  v_mfma_f32_16x16x32_bf16 a[12:15], a[212:215], a[188:191], a[12:15]
  ds_read_b64_tr_b16 a[198:199], v129 offset:41984
  v_add_f32 v197, v196, v197
  v_mfma_f32_16x16x32_bf16 a[12:15], a[208:211], a[184:187], a[12:15]
  buffer_load_dwordx4 v220, s[24:27], s46 offen offset:3072  lds
  v_smfmac_f32_16x16x64_bf16 v[200:203], v[252:255], a[208:215], v224
  s_add_u32 s46, s46, 16384
  v_cvt_pk_bf16_f32 v192, v193, v193
K1_st4:
  s_cbranch_execz K1_st8
  v_cvt_pk_bf16_f32 v196, v197, v197
  v_mfma_f32_16x16x32_bf16 a[28:31], a[216:219], a[184:187], a[28:31]
  s_waitcnt lgkmcnt(2)
  ds_read_b64_tr_b16 a[200:201], v129 offset:32776
  v_and_b32 v192, 0xffff0000, v192
  v_mfma_f32_16x16x32_bf16 a[28:31], a[220:223], a[188:191], a[28:31]
  v_and_b32 v196, 0xffff0000, v196
  v_sub_f32 v193, v193, v192
  v_mfma_f32_16x16x32_bf16 a[24:27], a[220:223], a[180:183], a[24:27]
  ds_read_b64_tr_b16 a[202:203], v129 offset:33800
  v_sub_f32 v197, v197, v196
  v_mfma_f32_16x16x32_bf16 a[24:27], a[216:219], a[176:179], a[24:27]
  v_cvt_pk_bf16_f32 v194, v193, v193
  v_cvt_pk_bf16_f32 v198, v197, v197
  v_mfma_f32_16x16x32_bf16 a[20:23], a[216:219], a[168:171], a[20:23]
  ds_read_b64_tr_b16 a[204:205], v129 offset:40968
  v_and_b32 v194, 0xffff0000, v194
  v_mfma_f32_16x16x32_bf16 a[20:23], a[220:223], a[172:175], a[20:23]
  s_add_u32 m0, s44, 16384
  v_and_b32 v198, 0xffff0000, v198
  v_sub_f32 v193, v193, v194
  v_mfma_f32_16x16x32_bf16 a[16:19], a[220:223], a[164:167], a[16:19]
  ds_read_b64_tr_b16 a[206:207], v129 offset:41992
  buffer_load_dwordx4 v220, s[24:27], s46 offen offset:0  lds
  v_mfma_f32_16x16x32_bf16 a[16:19], a[216:219], a[160:163], a[16:19]
  v_sub_f32 v197, v197, v198
  v_cvt_pk_bf16_f32 v192, v192, v194
  v_smfmac_f32_16x16x64_bf16 v[204:207], v[252:255], a[216:223], v224
  v_cvt_pk_bf16_f32 v196, v196, v198
  v_cvt_pk_bf16_f32 v193, v193, 0
  v_mfma_f32_16x16x32_bf16 v[32:35], a[192:195], a[160:163], v[32:35]
  s_waitcnt lgkmcnt(2)
  ds_read_b64_tr_b16 a[208:209], v130 offset:32768
  v_cvt_pk_bf16_f32 v197, v197, 0
  v_mfma_f32_16x16x32_bf16 v[32:35], a[196:199], a[164:167], v[32:35]
  v_mov_b32 v194, 0
  v_mov_b32 v198, 0
  v_mfma_f32_16x16x32_bf16 v[36:39], a[196:199], a[172:175], v[36:39]
  ds_read_b64_tr_b16 a[210:211], v130 offset:33792
  v_mov_b32 v195, 0
  v_mfma_f32_16x16x32_bf16 v[36:39], a[192:195], a[168:171], v[36:39]
  v_mov_b32 v199, 0
  v_mfma_f32_16x16x32_bf16 v[40:43], a[192:195], a[176:179], v[40:43]
  ds_read_b64_tr_b16 a[212:213], v130 offset:40960
  ds_write_b128 v240, v[192:195] offset:0
  v_mfma_f32_16x16x32_bf16 v[40:43], a[196:199], a[180:183], v[40:43]
  buffer_load_dwordx4 v220, s[24:27], s46 offen offset:1024  lds
  v_mfma_f32_16x16x32_bf16 v[44:47], a[196:199], a[188:191], v[44:47]
  ds_read_b64_tr_b16 a[214:215], v130 offset:41984
  ds_write_b128 v240, v[196:199] offset:256
  v_mfma_f32_16x16x32_bf16 v[44:47], a[192:195], a[184:187], v[44:47]
  v_add_f32 v201, v200, v201
  v_add_f32 v205, v204, v205
  v_mfma_f32_16x16x32_bf16 v[60:63], a[200:203], a[184:187], v[60:63]
  s_waitcnt lgkmcnt(4)
  ds_read_b64_tr_b16 a[216:217], v130 offset:32776
  v_cvt_pk_bf16_f32 v200, v201, v201
  v_mfma_f32_16x16x32_bf16 v[60:63], a[204:207], a[188:191], v[60:63]
  v_cvt_pk_bf16_f32 v204, v205, v205
  v_and_b32 v200, 0xffff0000, v200
  v_mfma_f32_16x16x32_bf16 v[56:59], a[204:207], a[180:183], v[56:59]
  ds_read_b64_tr_b16 a[218:219], v130 offset:33800
  v_and_b32 v204, 0xffff0000, v204
  v_mfma_f32_16x16x32_bf16 v[56:59], a[200:203], a[176:179], v[56:59]
  v_sub_f32 v201, v201, v200
  v_sub_f32 v205, v205, v204
  v_mfma_f32_16x16x32_bf16 v[52:55], a[200:203], a[168:171], v[52:55]
  ds_read_b64_tr_b16 a[220:221], v130 offset:40968
  v_cvt_pk_bf16_f32 v202, v201, v201
  v_mfma_f32_16x16x32_bf16 v[52:55], a[204:207], a[172:175], v[52:55]
  buffer_load_dwordx4 v220, s[24:27], s46 offen offset:2048  lds
  v_mfma_f32_16x16x32_bf16 v[48:51], a[204:207], a[164:167], v[48:51]
  ds_read_b64_tr_b16 a[222:223], v130 offset:41992
  v_cvt_pk_bf16_f32 v206, v205, v205
  v_mfma_f32_16x16x32_bf16 v[48:51], a[200:203], a[160:163], v[48:51]
  v_and_b32 v202, 0xffff0000, v202
  v_and_b32 v206, 0xffff0000, v206
  v_mfma_f32_16x16x32_bf16 v[64:67], a[208:211], a[160:163], v[64:67]
  s_waitcnt lgkmcnt(2)
  ds_read_b64_tr_b16 a[192:193], v131 offset:32768
  v_sub_f32 v201, v201, v202
  v_mfma_f32_16x16x32_bf16 v[64:67], a[212:215], a[164:167], v[64:67]
  v_sub_f32 v205, v205, v206
  v_cvt_pk_bf16_f32 v200, v200, v202
  v_mfma_f32_16x16x32_bf16 v[68:71], a[212:215], a[172:175], v[68:71]
  ds_read_b64_tr_b16 a[194:195], v131 offset:33792
  v_cvt_pk_bf16_f32 v204, v204, v206
  v_mfma_f32_16x16x32_bf16 v[68:71], a[208:211], a[168:171], v[68:71]
  v_cvt_pk_bf16_f32 v201, v201, 0
  v_cvt_pk_bf16_f32 v205, v205, 0
  v_mfma_f32_16x16x32_bf16 v[72:75], a[208:211], a[176:179], v[72:75]
  ds_read_b64_tr_b16 a[196:197], v131 offset:40960
  v_mov_b32 v202, 0
  v_mfma_f32_16x16x32_bf16 v[72:75], a[212:215], a[180:183], v[72:75]
  buffer_load_dwordx4 v220, s[24:27], s46 offen offset:3072  lds
  v_mfma_f32_16x16x32_bf16 v[76:79], a[212:215], a[188:191], v[76:79]
  s_add_u32 s46, s46, 16384
  ds_read_b64_tr_b16 a[198:199], v131 offset:41984
  v_mov_b32 v206, 0
  v_mfma_f32_16x16x32_bf16 v[76:79], a[208:211], a[184:187], v[76:79]
  v_mov_b32 v203, 0
  v_mov_b32 v207, 0
  v_mfma_f32_16x16x32_bf16 v[92:95], a[216:219], a[184:187], v[92:95]
  s_waitcnt lgkmcnt(2)
  ds_read_b64_tr_b16 a[200:201], v131 offset:32776
  ds_write_b128 v240, v[200:203] offset:8192
  v_mfma_f32_16x16x32_bf16 v[92:95], a[220:223], a[188:191], v[92:95]
  ds_write_b128 v240, v[204:207] offset:8448
  v_mfma_f32_16x16x32_bf16 v[88:91], a[220:223], a[180:183], v[88:91]
  ds_read_b64_tr_b16 a[202:203], v131 offset:33800
  v_mfma_f32_16x16x32_bf16 v[88:91], a[216:219], a[176:179], v[88:91]
  v_mfma_f32_16x16x32_bf16 v[84:87], a[216:219], a[168:171], v[84:87]
  s_add_u32 m0, s44, 65536
  ds_read_b64_tr_b16 a[204:205], v131 offset:40968
  v_mov_b32 v192, v248
  v_mfma_f32_16x16x32_bf16 v[84:87], a[220:223], a[172:175], v[84:87]
  buffer_load_dwordx4 v221, s[28:31], s47 offen offset:0  lds
  v_mfma_f32_16x16x32_bf16 v[80:83], a[220:223], a[164:167], v[80:83]
  ds_read_b64_tr_b16 a[206:207], v131 offset:41992
  v_mov_b32 v193, v248
  v_mfma_f32_16x16x32_bf16 v[80:83], a[216:219], a[160:163], v[80:83]
  v_mov_b32 v194, v249
  v_mov_b32 v195, v249
  v_mfma_f32_16x16x32_bf16 v[96:99], a[192:195], a[160:163], v[96:99]
  s_waitcnt lgkmcnt(2)
  ds_read_b64_tr_b16 a[208:209], v138 offset:32768
  v_mov_b32 v196, v250
  v_mfma_f32_16x16x32_bf16 v[96:99], a[196:199], a[164:167], v[96:99]
  v_mov_b32 v197, v250
  v_mov_b32 v198, v251
  v_mfma_f32_16x16x32_bf16 v[100:103], a[196:199], a[172:175], v[100:103]
  ds_read_b64_tr_b16 a[210:211], v138 offset:33280
  v_mov_b32 v199, v251
  v_mfma_f32_16x16x32_bf16 v[100:103], a[192:195], a[168:171], v[100:103]
  v_mov_b32 v200, v251
  v_mov_b32 v201, v251
  v_mfma_f32_16x16x32_bf16 v[104:107], a[192:195], a[176:179], v[104:107]
  s_waitcnt lgkmcnt(0)
  s_barrier
  ds_read_b64_tr_b16 a[212:213], v138 offset:36864
  v_mfma_f32_16x16x32_bf16 v[104:107], a[196:199], a[180:183], v[104:107]
  buffer_load_dwordx4 v221, s[28:31], s47 offen offset:1024  lds
  v_mfma_f32_16x16x32_bf16 v[108:111], a[196:199], a[188:191], v[108:111]
  ds_read_b64_tr_b16 a[214:215], v138 offset:37376
  ds_read_b128 a[128:131], v240 offset:0
  v_mfma_f32_16x16x32_bf16 v[108:111], a[192:195], a[184:187], v[108:111]
  ds_read_b128 a[132:135], v240 offset:256
  ds_read_b128 a[136:139], v241 offset:0
  v_mfma_f32_16x16x32_bf16 v[124:127], a[200:203], a[184:187], v[124:127]
  ds_read_b64_tr_b16 a[216:217], v139 offset:32768
  ds_read_b128 a[140:143], v241 offset:256
  v_mfma_f32_16x16x32_bf16 v[124:127], a[204:207], a[188:191], v[124:127]
  ds_read_b128 a[144:147], v242 offset:0
  ds_read_b128 a[148:151], v242 offset:256
  v_mfma_f32_16x16x32_bf16 v[120:123], a[204:207], a[180:183], v[120:123]
  ds_read_b64_tr_b16 a[218:219], v139 offset:33280
  ds_read_b128 a[152:155], v243 offset:0
  v_mfma_f32_16x16x32_bf16 v[120:123], a[200:203], a[176:179], v[120:123]
  ds_read_b128 a[156:159], v243 offset:256
  ds_read_b128 a[224:227], v240 offset:8192
  v_mfma_f32_16x16x32_bf16 v[116:119], a[200:203], a[168:171], v[116:119]
  ds_read_b64_tr_b16 a[220:221], v139 offset:36864
  ds_read_b128 a[228:231], v240 offset:8448
  v_mfma_f32_16x16x32_bf16 v[116:119], a[204:207], a[172:175], v[116:119]
  buffer_load_dwordx4 v221, s[28:31], s47 offen offset:2048  lds
  v_mfma_f32_16x16x32_bf16 v[112:115], a[204:207], a[164:167], v[112:115]
  ds_read_b64_tr_b16 a[222:223], v139 offset:37376
  ds_read_b128 a[232:235], v241 offset:8192
  v_mfma_f32_16x16x32_bf16 v[112:115], a[200:203], a[160:163], v[112:115]
  s_waitcnt lgkmcnt(8)
  ds_read_b128 a[236:239], v241 offset:8448
  ds_read_b128 a[240:243], v242 offset:8192
  v_mfma_f32_16x16x32_bf16 v[0:3], a[128:131], v[192:195], v[0:3]
  ds_read_b128 a[244:247], v242 offset:8448
  ds_read_b128 a[248:251], v243 offset:8192
  v_mfma_f32_16x16x32_bf16 v[4:7], a[128:131], v[194:197], v[4:7]
  ds_read_b128 a[252:255], v243 offset:8448
  v_mfma_f32_16x16x32_bf16 v[8:11], a[128:131], v[196:199], v[8:11]
  v_mfma_f32_16x16x32_bf16 v[12:15], a[128:131], v[198:201], v[12:15]
  v_mfma_f32_16x16x32_bf16 v[16:19], a[132:135], v[192:195], v[16:19]
  v_mfma_f32_16x16x32_bf16 v[20:23], a[132:135], v[194:197], v[20:23]
  buffer_load_dwordx4 v221, s[28:31], s47 offen offset:3072  lds
  v_mfma_f32_16x16x32_bf16 v[24:27], a[132:135], v[196:199], v[24:27]
  s_add_u32 s47, s47, 16384
  v_mfma_f32_16x16x32_bf16 v[28:31], a[132:135], v[198:201], v[28:31]
  v_mfma_f32_16x16x32_bf16 v[32:35], a[136:139], v[192:195], v[32:35]
  v_mfma_f32_16x16x32_bf16 v[36:39], a[136:139], v[194:197], v[36:39]
  v_mfma_f32_16x16x32_bf16 v[40:43], a[136:139], v[196:199], v[40:43]
  v_mfma_f32_16x16x32_bf16 v[44:47], a[136:139], v[198:201], v[44:47]
  v_mfma_f32_16x16x32_bf16 v[48:51], a[140:143], v[192:195], v[48:51]
  s_add_u32 m0, s44, 81920
  v_mfma_f32_16x16x32_bf16 v[52:55], a[140:143], v[194:197], v[52:55]
  buffer_load_dwordx4 v221, s[28:31], s47 offen offset:0  lds
  v_mfma_f32_16x16x32_bf16 v[56:59], a[140:143], v[196:199], v[56:59]
  v_mul_f32 v12, v12, v247
  v_mul_f32 v13, v13, v247
  v_mfma_f32_16x16x32_bf16 v[60:63], a[140:143], v[198:201], v[60:63]
  v_mul_f32 v14, v14, v247
  v_mul_f32 v15, v15, v247
  v_mfma_f32_16x16x32_bf16 v[64:67], a[144:147], v[192:195], v[64:67]
  v_mul_f32 v28, v28, v247
  v_mul_f32 v29, v29, v247
  v_mfma_f32_16x16x32_bf16 v[68:71], a[144:147], v[194:197], v[68:71]
  v_mul_f32 v30, v30, v247
  v_mul_f32 v31, v31, v247
  v_mfma_f32_16x16x32_bf16 v[72:75], a[144:147], v[196:199], v[72:75]
  v_cvt_pk_bf16_f32 v176, v12, v13
  v_cvt_pk_bf16_f32 v177, v14, v15
  v_mfma_f32_16x16x32_bf16 v[76:79], a[144:147], v[198:201], v[76:79]
  v_cvt_pk_bf16_f32 v178, v28, v29
  v_cvt_pk_bf16_f32 v179, v30, v31
  v_mfma_f32_16x16x32_bf16 v[80:83], a[148:151], v[192:195], v[80:83]
  v_mul_f32 v44, v44, v247
  v_mul_f32 v45, v45, v247
  v_mfma_f32_16x16x32_bf16 v[84:87], a[148:151], v[194:197], v[84:87]
  buffer_load_dwordx4 v221, s[28:31], s47 offen offset:1024  lds
  v_mfma_f32_16x16x32_bf16 v[88:91], a[148:151], v[196:199], v[88:91]
  v_mul_f32 v46, v46, v247
  v_mul_f32 v47, v47, v247
  v_mfma_f32_16x16x32_bf16 v[92:95], a[148:151], v[198:201], v[92:95]
  s_waitcnt lgkmcnt(0)
  v_mul_f32 v60, v60, v247
  v_mul_f32 v61, v61, v247
  v_mfma_f32_16x16x32_bf16 v[96:99], a[152:155], v[192:195], v[96:99]
  v_mul_f32 v62, v62, v247
  v_mul_f32 v63, v63, v247
  v_mfma_f32_16x16x32_bf16 v[100:103], a[152:155], v[194:197], v[100:103]
  v_cvt_pk_bf16_f32 v180, v44, v45
  v_cvt_pk_bf16_f32 v181, v46, v47
  v_mfma_f32_16x16x32_bf16 v[104:107], a[152:155], v[196:199], v[104:107]
  v_cvt_pk_bf16_f32 v182, v60, v61
  v_cvt_pk_bf16_f32 v183, v62, v63
  v_mfma_f32_16x16x32_bf16 v[108:111], a[152:155], v[198:201], v[108:111]
  v_mul_f32 v76, v76, v247
  v_mul_f32 v77, v77, v247
  v_mfma_f32_16x16x32_bf16 v[112:115], a[156:159], v[192:195], v[112:115]
  v_mul_f32 v78, v78, v247
  v_mul_f32 v79, v79, v247
  v_mfma_f32_16x16x32_bf16 v[116:119], a[156:159], v[194:197], v[116:119]
  buffer_load_dwordx4 v221, s[28:31], s47 offen offset:2048  lds
  v_mfma_f32_16x16x32_bf16 v[120:123], a[156:159], v[196:199], v[120:123]
  v_mul_f32 v92, v92, v247
  v_mul_f32 v93, v93, v247
  v_mfma_f32_16x16x32_bf16 v[124:127], a[156:159], v[198:201], v[124:127]
  v_mul_f32 v94, v94, v247
  v_mul_f32 v95, v95, v247
  v_mfma_f32_16x16x32_bf16 a[32:35], a[208:211], a[160:163], a[32:35]
  ds_read_b64_tr_b16 a[192:193], v140 offset:32768
  v_cvt_pk_bf16_f32 v184, v76, v77
  v_mfma_f32_16x16x32_bf16 a[32:35], a[212:215], a[164:167], a[32:35]
  v_cvt_pk_bf16_f32 v185, v78, v79
  v_cvt_pk_bf16_f32 v186, v92, v93
  v_mfma_f32_16x16x32_bf16 a[36:39], a[212:215], a[172:175], a[36:39]
  ds_read_b64_tr_b16 a[194:195], v140 offset:33280
  v_cvt_pk_bf16_f32 v187, v94, v95
  v_mfma_f32_16x16x32_bf16 a[36:39], a[208:211], a[168:171], a[36:39]
  v_mfma_f32_16x16x32_bf16 a[40:43], a[208:211], a[176:179], a[40:43]
  ds_read_b64_tr_b16 a[196:197], v140 offset:36864
  v_mfma_f32_16x16x32_bf16 a[40:43], a[212:215], a[180:183], a[40:43]
  buffer_load_dwordx4 v221, s[28:31], s47 offen offset:3072  lds
  v_mfma_f32_16x16x32_bf16 a[44:47], a[212:215], a[188:191], a[44:47]
  s_add_u32 s47, s47, 16384
  ds_read_b64_tr_b16 a[198:199], v140 offset:37376
  v_mul_f32 v108, v108, v247
  v_mfma_f32_16x16x32_bf16 a[44:47], a[208:211], a[184:187], a[44:47]
  v_mul_f32 v109, v109, v247
  v_mul_f32 v110, v110, v247
  v_mfma_f32_16x16x32_bf16 a[60:63], a[216:219], a[184:187], a[60:63]
  ds_read_b64_tr_b16 a[200:201], v141 offset:32768
  v_mul_f32 v111, v111, v247
  v_mfma_f32_16x16x32_bf16 a[60:63], a[220:223], a[188:191], a[60:63]
  v_mul_f32 v124, v124, v247
  v_mul_f32 v125, v125, v247
  v_mfma_f32_16x16x32_bf16 a[56:59], a[220:223], a[180:183], a[56:59]
  ds_read_b64_tr_b16 a[202:203], v141 offset:33280
  v_mul_f32 v126, v126, v247
  v_mfma_f32_16x16x32_bf16 a[56:59], a[216:219], a[176:179], a[56:59]
  v_mul_f32 v127, v127, v247
  v_cvt_pk_bf16_f32 v188, v108, v109
  v_mfma_f32_16x16x32_bf16 a[52:55], a[216:219], a[168:171], a[52:55]
  ds_read_b64_tr_b16 a[204:205], v141 offset:36864
  v_cvt_pk_bf16_f32 v189, v110, v111
  v_mfma_f32_16x16x32_bf16 a[52:55], a[220:223], a[172:175], a[52:55]
  v_cvt_pk_bf16_f32 v190, v124, v125
  v_cvt_pk_bf16_f32 v191, v126, v127
  v_mfma_f32_16x16x32_bf16 a[48:51], a[220:223], a[164:167], a[48:51]
  ds_read_b64_tr_b16 a[206:207], v141 offset:37376
  v_mul_f32 v8, v8, v246
  v_mfma_f32_16x16x32_bf16 a[48:51], a[216:219], a[160:163], a[48:51]
  s_waitcnt lgkmcnt(3)
  v_mul_f32 v9, v9, v246
  v_mul_f32 v10, v10, v246
  v_mfma_f32_16x16x32_bf16 a[64:67], a[192:195], a[160:163], a[64:67]
  ds_read_b64_tr_b16 a[208:209], v142 offset:32768
  v_mul_f32 v11, v11, v246
  v_mfma_f32_16x16x32_bf16 a[64:67], a[196:199], a[164:167], a[64:67]
  v_mul_f32 v24, v24, v246
  v_mul_f32 v25, v25, v246
  v_mfma_f32_16x16x32_bf16 a[68:71], a[196:199], a[172:175], a[68:71]
  ds_read_b64_tr_b16 a[210:211], v142 offset:33280
  v_mul_f32 v26, v26, v246
  v_mfma_f32_16x16x32_bf16 a[68:71], a[192:195], a[168:171], a[68:71]
  v_mul_f32 v27, v27, v246
  v_cvt_pk_bf16_f32 v160, v8, v9
  v_mfma_f32_16x16x32_bf16 a[72:75], a[192:195], a[176:179], a[72:75]
  ds_read_b64_tr_b16 a[212:213], v142 offset:36864
  v_cvt_pk_bf16_f32 v161, v10, v11
  v_mfma_f32_16x16x32_bf16 a[72:75], a[196:199], a[180:183], a[72:75]
  v_cvt_pk_bf16_f32 v162, v24, v25
  v_cvt_pk_bf16_f32 v163, v26, v27
  v_mfma_f32_16x16x32_bf16 a[76:79], a[196:199], a[188:191], a[76:79]
  ds_read_b64_tr_b16 a[214:215], v142 offset:37376
  v_mul_f32 v40, v40, v246
  v_mfma_f32_16x16x32_bf16 a[76:79], a[192:195], a[184:187], a[76:79]
  s_waitcnt lgkmcnt(3)
  v_mul_f32 v41, v41, v246
  v_mul_f32 v42, v42, v246
  v_mfma_f32_16x16x32_bf16 a[92:95], a[200:203], a[184:187], a[92:95]
  ds_read_b64_tr_b16 a[216:217], v143 offset:32768
  v_mul_f32 v43, v43, v246
  v_mfma_f32_16x16x32_bf16 a[92:95], a[204:207], a[188:191], a[92:95]
  v_mul_f32 v56, v56, v246
  v_mul_f32 v57, v57, v246
  v_mfma_f32_16x16x32_bf16 a[88:91], a[204:207], a[180:183], a[88:91]
  ds_read_b64_tr_b16 a[218:219], v143 offset:33280
  v_mul_f32 v58, v58, v246
  v_mfma_f32_16x16x32_bf16 a[88:91], a[200:203], a[176:179], a[88:91]
  v_mul_f32 v59, v59, v246
  v_cvt_pk_bf16_f32 v164, v40, v41
  v_mfma_f32_16x16x32_bf16 a[84:87], a[200:203], a[168:171], a[84:87]
  ds_read_b64_tr_b16 a[220:221], v143 offset:36864
  v_cvt_pk_bf16_f32 v165, v42, v43
  v_mfma_f32_16x16x32_bf16 a[84:87], a[204:207], a[172:175], a[84:87]
  v_cvt_pk_bf16_f32 v166, v56, v57
  v_cvt_pk_bf16_f32 v167, v58, v59
  v_mfma_f32_16x16x32_bf16 a[80:83], a[204:207], a[164:167], a[80:83]
  ds_read_b64_tr_b16 a[222:223], v143 offset:37376
  v_mul_f32 v72, v72, v246
  v_mfma_f32_16x16x32_bf16 a[80:83], a[200:203], a[160:163], a[80:83]
  s_waitcnt lgkmcnt(3)
  v_mul_f32 v73, v73, v246
  v_mul_f32 v74, v74, v246
  v_mfma_f32_16x16x32_bf16 a[96:99], a[208:211], a[160:163], a[96:99]
  v_mul_f32 v75, v75, v246
  v_mul_f32 v88, v88, v246
  v_mfma_f32_16x16x32_bf16 a[96:99], a[212:215], a[164:167], a[96:99]
  v_mul_f32 v89, v89, v246
  v_mul_f32 v90, v90, v246
  v_mfma_f32_16x16x32_bf16 a[100:103], a[212:215], a[172:175], a[100:103]
  s_waitcnt vmcnt(12) lgkmcnt(0)
  s_barrier
  v_mul_f32 v91, v91, v246
  v_cvt_pk_bf16_f32 v168, v72, v73
  v_mfma_f32_16x16x32_bf16 a[100:103], a[208:211], a[168:171], a[100:103]
  ds_read_b128 a[128:131], v208 offset:0
  v_cvt_pk_bf16_f32 v169, v74, v75
  v_cvt_pk_bf16_f32 v170, v88, v89
  v_mfma_f32_16x16x32_bf16 a[104:107], a[208:211], a[176:179], a[104:107]
  v_cvt_pk_bf16_f32 v171, v90, v91
  v_mul_f32 v104, v104, v246
  v_mfma_f32_16x16x32_bf16 a[104:107], a[212:215], a[180:183], a[104:107]
  ds_read_b128 a[132:135], v209 offset:0
  v_mul_f32 v105, v105, v246
  v_mul_f32 v106, v106, v246
  v_mfma_f32_16x16x32_bf16 a[108:111], a[212:215], a[188:191], a[108:111]
  v_mul_f32 v107, v107, v246
  v_mul_f32 v120, v120, v246
  v_mfma_f32_16x16x32_bf16 a[108:111], a[208:211], a[184:187], a[108:111]
  ds_read_b128 a[136:139], v210 offset:0
  v_mul_f32 v121, v121, v246
  v_mul_f32 v122, v122, v246
  v_mfma_f32_16x16x32_bf16 a[124:127], a[216:219], a[184:187], a[124:127]
  v_mul_f32 v123, v123, v246
  v_cvt_pk_bf16_f32 v172, v104, v105
  v_mfma_f32_16x16x32_bf16 a[124:127], a[220:223], a[188:191], a[124:127]
  ds_read_b128 a[140:143], v211 offset:0
  v_cvt_pk_bf16_f32 v173, v106, v107
  v_cvt_pk_bf16_f32 v174, v120, v121
  v_mfma_f32_16x16x32_bf16 a[120:123], a[220:223], a[180:183], a[120:123]
  v_cvt_pk_bf16_f32 v175, v122, v123
  v_mul_f32 v4, v4, v245
  v_mfma_f32_16x16x32_bf16 a[120:123], a[216:219], a[176:179], a[120:123]
  ds_read_b128 a[144:147], v208 offset:1024
  v_mul_f32 v5, v5, v245
  v_mul_f32 v6, v6, v245
  v_mfma_f32_16x16x32_bf16 a[116:119], a[216:219], a[168:171], a[116:119]
  v_mul_f32 v7, v7, v245
  v_mul_f32 v20, v20, v245
  v_mfma_f32_16x16x32_bf16 a[116:119], a[220:223], a[172:175], a[116:119]
  ds_read_b128 a[148:151], v209 offset:1024
  v_mul_f32 v21, v21, v245
  v_mul_f32 v22, v22, v245
  v_mfma_f32_16x16x32_bf16 a[112:115], a[220:223], a[164:167], a[112:115]
  v_mul_f32 v23, v23, v245
  v_cvt_pk_bf16_f32 v144, v4, v5
  v_mfma_f32_16x16x32_bf16 a[112:115], a[216:219], a[160:163], a[112:115]
  ds_read_b128 a[152:155], v210 offset:1024
  v_cvt_pk_bf16_f32 v145, v6, v7
  v_cvt_pk_bf16_f32 v146, v20, v21
  v_mfma_f32_16x16x32_bf16 a[0:3], a[224:227], v[192:195], a[0:3]
  v_cvt_pk_bf16_f32 v147, v22, v23
  v_mul_f32 v36, v36, v245
  v_mfma_f32_16x16x32_bf16 a[4:7], a[224:227], v[194:197], a[4:7]
  ds_read_b128 a[156:159], v211 offset:1024
  v_mul_f32 v37, v37, v245
  v_mul_f32 v38, v38, v245
  v_mfma_f32_16x16x32_bf16 a[8:11], a[224:227], v[196:199], a[8:11]
  v_mul_f32 v39, v39, v245
  v_mul_f32 v52, v52, v245
  v_mfma_f32_16x16x32_bf16 a[12:15], a[224:227], v[198:201], a[12:15]
  v_mul_f32 v53, v53, v245
  v_mul_f32 v54, v54, v245
  v_mfma_f32_16x16x32_bf16 a[16:19], a[228:231], v[192:195], a[16:19]
  v_mul_f32 v55, v55, v245
  v_cvt_pk_bf16_f32 v148, v36, v37
  v_mfma_f32_16x16x32_bf16 a[20:23], a[228:231], v[194:197], a[20:23]
  v_cvt_pk_bf16_f32 v149, v38, v39
  v_cvt_pk_bf16_f32 v150, v52, v53
  v_mfma_f32_16x16x32_bf16 a[24:27], a[228:231], v[196:199], a[24:27]
  v_cvt_pk_bf16_f32 v151, v54, v55
  v_mul_f32 v68, v68, v245
  v_mfma_f32_16x16x32_bf16 a[28:31], a[228:231], v[198:201], a[28:31]
  v_mul_f32 v69, v69, v245
  v_mul_f32 v70, v70, v245
  v_mfma_f32_16x16x32_bf16 a[32:35], a[232:235], v[192:195], a[32:35]
  ds_read_b128 a[160:163], v208 offset:2048
  v_mul_f32 v71, v71, v245
  v_mul_f32 v84, v84, v245
  v_mfma_f32_16x16x32_bf16 a[36:39], a[232:235], v[194:197], a[36:39]
  v_mul_f32 v85, v85, v245
  v_mul_f32 v86, v86, v245
  v_mfma_f32_16x16x32_bf16 a[40:43], a[232:235], v[196:199], a[40:43]
  ds_read_b128 a[164:167], v209 offset:2048
  v_mul_f32 v87, v87, v245
  v_cvt_pk_bf16_f32 v152, v68, v69
  v_mfma_f32_16x16x32_bf16 a[44:47], a[232:235], v[198:201], a[44:47]
  v_cvt_pk_bf16_f32 v153, v70, v71
  v_cvt_pk_bf16_f32 v154, v84, v85
  v_mfma_f32_16x16x32_bf16 a[48:51], a[236:239], v[192:195], a[48:51]
  ds_read_b128 a[168:171], v210 offset:2048
  v_cvt_pk_bf16_f32 v155, v86, v87
  v_mul_f32 v100, v100, v245
  v_mfma_f32_16x16x32_bf16 a[52:55], a[236:239], v[194:197], a[52:55]
  v_mul_f32 v101, v101, v245
  v_mul_f32 v102, v102, v245
  v_mfma_f32_16x16x32_bf16 a[56:59], a[236:239], v[196:199], a[56:59]
  ds_read_b128 a[172:175], v211 offset:2048
  v_mul_f32 v103, v103, v245
  v_mul_f32 v116, v116, v245
  v_mfma_f32_16x16x32_bf16 a[60:63], a[236:239], v[198:201], a[60:63]
  v_mul_f32 v117, v117, v245
  v_mul_f32 v118, v118, v245
  v_mfma_f32_16x16x32_bf16 a[64:67], a[240:243], v[192:195], a[64:67]
  ds_read_b128 a[176:179], v208 offset:3072
  v_mul_f32 v119, v119, v245
  v_cvt_pk_bf16_f32 v156, v100, v101
  v_mfma_f32_16x16x32_bf16 a[68:71], a[240:243], v[194:197], a[68:71]
  v_cvt_pk_bf16_f32 v157, v102, v103
  v_cvt_pk_bf16_f32 v158, v116, v117
  v_mfma_f32_16x16x32_bf16 a[72:75], a[240:243], v[196:199], a[72:75]
  ds_read_b128 a[180:183], v209 offset:3072
  v_cvt_pk_bf16_f32 v159, v118, v119
  v_mul_f32 v0, v0, v244
  v_mfma_f32_16x16x32_bf16 a[76:79], a[240:243], v[198:201], a[76:79]
  v_mul_f32 v1, v1, v244
  v_mul_f32 v2, v2, v244
  v_mfma_f32_16x16x32_bf16 a[80:83], a[244:247], v[192:195], a[80:83]
  ds_read_b128 a[184:187], v210 offset:3072
  v_mul_f32 v3, v3, v244
  v_mul_f32 v16, v16, v244
  v_mfma_f32_16x16x32_bf16 a[84:87], a[244:247], v[194:197], a[84:87]
  v_mul_f32 v17, v17, v244
  v_mul_f32 v18, v18, v244
  v_mfma_f32_16x16x32_bf16 a[88:91], a[244:247], v[196:199], a[88:91]
  ds_read_b128 a[188:191], v211 offset:3072
  v_mul_f32 v19, v19, v244
  v_cvt_pk_bf16_f32 v128, v0, v1
  v_mfma_f32_16x16x32_bf16 a[92:95], a[244:247], v[198:201], a[92:95]
  v_cvt_pk_bf16_f32 v129, v2, v3
  v_cvt_pk_bf16_f32 v130, v16, v17
  v_mfma_f32_16x16x32_bf16 a[96:99], a[248:251], v[192:195], a[96:99]
  v_cvt_pk_bf16_f32 v131, v18, v19
  v_mul_f32 v32, v32, v244
  v_mfma_f32_16x16x32_bf16 a[100:103], a[248:251], v[194:197], a[100:103]
  v_mul_f32 v33, v33, v244
  v_mul_f32 v34, v34, v244
  v_mfma_f32_16x16x32_bf16 a[104:107], a[248:251], v[196:199], a[104:107]
  v_mul_f32 v35, v35, v244
  v_mul_f32 v48, v48, v244
  v_mfma_f32_16x16x32_bf16 a[108:111], a[248:251], v[198:201], a[108:111]
  v_mul_f32 v49, v49, v244
  v_mul_f32 v50, v50, v244
  v_mfma_f32_16x16x32_bf16 a[112:115], a[252:255], v[192:195], a[112:115]
  v_mul_f32 v51, v51, v244
  v_cvt_pk_bf16_f32 v132, v32, v33
  v_mfma_f32_16x16x32_bf16 a[116:119], a[252:255], v[194:197], a[116:119]
  v_cvt_pk_bf16_f32 v133, v34, v35
  v_cvt_pk_bf16_f32 v134, v48, v49
  v_mfma_f32_16x16x32_bf16 a[120:123], a[252:255], v[196:199], a[120:123]
  v_cvt_pk_bf16_f32 v135, v50, v51
  v_mul_f32 v64, v64, v244
  v_mfma_f32_16x16x32_bf16 a[124:127], a[252:255], v[198:201], a[124:127]
  s_waitcnt lgkmcnt(0)
  v_mul_f32 v65, v65, v244
  v_mul_f32 v66, v66, v244
  v_mul_f32 v67, v67, v244
  v_mul_f32 v80, v80, v244
  v_mul_f32 v81, v81, v244
  v_mul_f32 v82, v82, v244
  v_mul_f32 v83, v83, v244
  v_cvt_pk_bf16_f32 v136, v64, v65
  v_cvt_pk_bf16_f32 v137, v66, v67
  v_cvt_pk_bf16_f32 v138, v80, v81
  v_cvt_pk_bf16_f32 v139, v82, v83
  v_mul_f32 v96, v96, v244
  v_mul_f32 v97, v97, v244
  v_mul_f32 v98, v98, v244
  v_mul_f32 v99, v99, v244
  v_mul_f32 v112, v112, v244
  v_mul_f32 v113, v113, v244
  v_mul_f32 v114, v114, v244
  v_mul_f32 v115, v115, v244
  v_cvt_pk_bf16_f32 v140, v96, v97
  v_cvt_pk_bf16_f32 v141, v98, v99
  v_cvt_pk_bf16_f32 v142, v112, v113
  v_cvt_pk_bf16_f32 v143, v114, v115
  s_add_u32 m0, s44, 32768
  s_nop 0
  buffer_load_dwordx4 v220, s[24:27], s46 offen offset:0  lds
  buffer_load_dwordx4 v220, s[24:27], s46 offen offset:1024  lds
  buffer_load_dwordx4 v220, s[24:27], s46 offen offset:2048  lds
  buffer_load_dwordx4 v220, s[24:27], s46 offen offset:3072  lds
  s_add_u32 s46, s46, 16384
  s_andn2_b32 s51, s70, 1
  s_mul_i32 s51, s51, 753664
  s_add_u32 s51, s51, 4194304
  s_add_u32 s8, s68, s51
  s_addc_u32 s9, s69, 0
  s_mov_b32 s10, 1507328
  s_mov_b32 s11, 0x20000
  s_add_u32 s80, s68, 50331648
  s_addc_u32 s81, s69, 0
  s_mov_b32 s82, 5373952
  s_mov_b32 s83, 0x20000
  s_mul_i32 s51, s71, 655360
  s_add_u32 s51, s51, 33554432
  s_add_u32 s12, s68, s51
  s_addc_u32 s13, s69, 0
  s_mov_b32 s14, 655360
  s_mov_b32 s15, 0x20000
  s_mul_i32 s51, s71, 160
  s_add_u32 s16, s88, s51
  s_addc_u32 s17, s89, 0
  s_mov_b32 s18, 0
  s_mov_b32 s19, 0x20000
  s_sub_u32 s18, 2211840, s51
  s_and_b32 s52, s70, 1
  s_lshl_b32 s51, s36, 1
  s_add_u32 s51, s51, s52
  s_mul_i32 s41, s51, 81920
  s_lshl_b32 s51, s51, 16
  s_mul_i32 s49, s52, 753664
  s_add_u32 s42, s51, s49
  s_add_u32 s40, s51, 753664
  s_sub_u32 s40, s40, s49
  s_mul_i32 s58, s36, 20480
  s_lshl_b32 s59, s36, 10
  s_add_u32 s59, s59, 524288
  s_add_u32 s59, s59, s49
  s_mul_i32 s85, s36, 2560
  s_add_u32 s85, s85, 131072
  s_mov_b32 s57, 0
  s_mov_b32 s56, 10752
  v_and_b32 v226, 31, v222
  v_lshlrev_b32 v226, 4, v226
  v_mfma_f32_16x16x32_bf16 v[0:3], a[128:131], v[128:131], 0
  v_accvgpr_read_b32 v32, a0
  v_accvgpr_read_b32 v33, a1
  v_mfma_f32_16x16x32_bf16 v[0:3], a[132:135], v[132:135], v[0:3]
  v_accvgpr_read_b32 v34, a2
  v_accvgpr_read_b32 v35, a3
  v_mfma_f32_16x16x32_bf16 v[0:3], a[136:139], v[136:139], v[0:3]
  v_accvgpr_read_b32 v36, a4
  v_accvgpr_read_b32 v37, a5
  v_mfma_f32_16x16x32_bf16 v[0:3], a[140:143], v[140:143], v[0:3]
  v_accvgpr_read_b32 v38, a6
  v_accvgpr_read_b32 v39, a7
  v_mfma_f32_16x16x32_bf16 v[4:7], a[140:143], v[156:159], 0
  v_accvgpr_read_b32 v40, a8
  v_accvgpr_read_b32 v41, a9
  v_mfma_f32_16x16x32_bf16 v[4:7], a[136:139], v[152:155], v[4:7]
  v_accvgpr_read_b32 v42, a10
  v_accvgpr_read_b32 v43, a11
  v_mfma_f32_16x16x32_bf16 v[4:7], a[132:135], v[148:151], v[4:7]
  v_accvgpr_read_b32 v44, a12
  v_accvgpr_read_b32 v45, a13
  v_mfma_f32_16x16x32_bf16 v[4:7], a[128:131], v[144:147], v[4:7]
  v_accvgpr_read_b32 v46, a14
  v_accvgpr_read_b32 v47, a15
  v_mfma_f32_16x16x32_bf16 v[8:11], a[128:131], v[160:163], 0
  v_accvgpr_read_b32 v48, a16
  v_accvgpr_read_b32 v49, a17
  v_mfma_f32_16x16x32_bf16 v[8:11], a[132:135], v[164:167], v[8:11]
  v_accvgpr_read_b32 v50, a18
  v_accvgpr_read_b32 v51, a19
  v_mfma_f32_16x16x32_bf16 v[8:11], a[136:139], v[168:171], v[8:11]
  v_accvgpr_read_b32 v52, a20
K1_st5:
  s_cbranch_execz K1_st9
  v_accvgpr_read_b32 v53, a21
  v_mfma_f32_16x16x32_bf16 v[8:11], a[140:143], v[172:175], v[8:11]
  v_accvgpr_read_b32 v54, a22
  v_accvgpr_read_b32 v55, a23
  v_mfma_f32_16x16x32_bf16 v[12:15], a[140:143], v[188:191], 0
  v_accvgpr_read_b32 v56, a24
  v_accvgpr_read_b32 v57, a25
  v_mfma_f32_16x16x32_bf16 v[12:15], a[136:139], v[184:187], v[12:15]
  v_accvgpr_read_b32 v58, a26
  v_accvgpr_read_b32 v59, a27
  v_mfma_f32_16x16x32_bf16 v[12:15], a[132:135], v[180:183], v[12:15]
  v_accvgpr_read_b32 v60, a28
  v_accvgpr_read_b32 v61, a29
  v_mfma_f32_16x16x32_bf16 v[12:15], a[128:131], v[176:179], v[12:15]
  v_accvgpr_read_b32 v62, a30
  v_accvgpr_read_b32 v63, a31
  v_mfma_f32_16x16x32_bf16 v[28:31], a[144:147], v[176:179], 0
  v_accvgpr_read_b32 v64, a32
  v_accvgpr_read_b32 v65, a33
  v_mfma_f32_16x16x32_bf16 v[28:31], a[148:151], v[180:183], v[28:31]
  v_accvgpr_read_b32 v66, a34
  v_accvgpr_read_b32 v67, a35
  v_mfma_f32_16x16x32_bf16 v[28:31], a[152:155], v[184:187], v[28:31]
  v_accvgpr_read_b32 v68, a36
  v_accvgpr_read_b32 v69, a37
  v_mfma_f32_16x16x32_bf16 v[28:31], a[156:159], v[188:191], v[28:31]
  v_accvgpr_read_b32 v70, a38
  v_accvgpr_read_b32 v71, a39
  v_mfma_f32_16x16x32_bf16 v[24:27], a[156:159], v[172:175], 0
  v_accvgpr_read_b32 v72, a40
  v_accvgpr_read_b32 v73, a41
  v_mfma_f32_16x16x32_bf16 v[24:27], a[152:155], v[168:171], v[24:27]
  v_accvgpr_read_b32 v74, a42
  v_accvgpr_read_b32 v75, a43
  v_mfma_f32_16x16x32_bf16 v[24:27], a[148:151], v[164:167], v[24:27]
  v_accvgpr_read_b32 v76, a44
  v_accvgpr_read_b32 v77, a45
  v_mfma_f32_16x16x32_bf16 v[24:27], a[144:147], v[160:163], v[24:27]
  v_accvgpr_read_b32 v78, a46
  v_accvgpr_read_b32 v79, a47
  v_mfma_f32_16x16x32_bf16 v[20:23], a[144:147], v[144:147], 0
  v_accvgpr_read_b32 v80, a48
  v_accvgpr_read_b32 v81, a49
  v_mfma_f32_16x16x32_bf16 v[20:23], a[148:151], v[148:151], v[20:23]
  v_accvgpr_read_b32 v82, a50
  v_accvgpr_read_b32 v83, a51
  v_mfma_f32_16x16x32_bf16 v[20:23], a[152:155], v[152:155], v[20:23]
  v_accvgpr_read_b32 v84, a52
  v_accvgpr_read_b32 v85, a53
  v_mfma_f32_16x16x32_bf16 v[20:23], a[156:159], v[156:159], v[20:23]
  v_accvgpr_read_b32 v86, a54
  v_accvgpr_read_b32 v87, a55
  v_mfma_f32_16x16x32_bf16 v[16:19], a[156:159], v[140:143], 0
  v_accvgpr_read_b32 v88, a56
  v_accvgpr_read_b32 v89, a57
  v_mfma_f32_16x16x32_bf16 v[16:19], a[152:155], v[136:139], v[16:19]
  v_accvgpr_read_b32 v90, a58
  v_accvgpr_read_b32 v91, a59
  v_mfma_f32_16x16x32_bf16 v[16:19], a[148:151], v[132:135], v[16:19]
  v_accvgpr_read_b32 v92, a60
  v_accvgpr_read_b32 v93, a61
  v_mfma_f32_16x16x32_bf16 v[16:19], a[144:147], v[128:131], v[16:19]
  v_accvgpr_read_b32 v94, a62
  v_accvgpr_read_b32 v95, a63
  s_lshl_b32 s51, s39, 1
  s_and_b32 s52, s36, 1
  s_add_u32 s51, s51, s52
  s_add_u32 s51, s51, 128
  s_lshl_b32 s51, s51, 12
  s_xor_b32 s52, s51, 4096
  s_cmp_lt_u32 s36, 2
  s_cbranch_scc0 K1_hB
  v_accvgpr_read_b32 v96, a64
  v_accvgpr_read_b32 v97, a65
  v_accvgpr_read_b32 v98, a66
  v_accvgpr_read_b32 v99, a67
  v_accvgpr_read_b32 v100, a80
  v_accvgpr_read_b32 v101, a81
  v_accvgpr_read_b32 v102, a82
  v_accvgpr_read_b32 v103, a83
  v_max_f32 v32, 0, v32
  v_max_f32 v33, 0, v33
  v_max_f32 v34, 0, v34
  v_max_f32 v35, 0, v35
  v_max_f32 v48, 0, v48
  v_max_f32 v49, 0, v49
  v_max_f32 v50, 0, v50
  v_max_f32 v51, 0, v51
  v_pk_mul_f32 v[96:97], v[32:33], v[96:97]
  v_pk_mul_f32 v[98:99], v[34:35], v[98:99]
  v_pk_mul_f32 v[100:101], v[48:49], v[100:101]
  v_pk_mul_f32 v[102:103], v[50:51], v[102:103]
  v_cvt_pk_bf16_f32 v32, v96, v97
  v_cvt_pk_bf16_f32 v33, v98, v99
  v_cvt_pk_bf16_f32 v34, v100, v101
  v_cvt_pk_bf16_f32 v35, v102, v103
  buffer_store_dwordx4 v[32:35], v223, s[32:35], s51 offen offset:0 sc1
  v_accvgpr_read_b32 v104, a68
  v_accvgpr_read_b32 v105, a69
  v_accvgpr_read_b32 v106, a70
  v_accvgpr_read_b32 v107, a71
  v_accvgpr_read_b32 v108, a84
  v_accvgpr_read_b32 v109, a85
  v_accvgpr_read_b32 v110, a86
  v_accvgpr_read_b32 v111, a87
  v_max_f32 v36, 0, v36
  v_max_f32 v37, 0, v37
  v_max_f32 v38, 0, v38
  v_max_f32 v39, 0, v39
  v_max_f32 v52, 0, v52
  v_max_f32 v53, 0, v53
  v_max_f32 v54, 0, v54
  v_max_f32 v55, 0, v55
  v_pk_mul_f32 v[104:105], v[36:37], v[104:105]
  v_pk_mul_f32 v[106:107], v[38:39], v[106:107]
  v_pk_mul_f32 v[108:109], v[52:53], v[108:109]
  v_pk_mul_f32 v[110:111], v[54:55], v[110:111]
  v_cvt_pk_bf16_f32 v36, v104, v105
  v_cvt_pk_bf16_f32 v37, v106, v107
  v_cvt_pk_bf16_f32 v38, v108, v109
  v_cvt_pk_bf16_f32 v39, v110, v111
  buffer_store_dwordx4 v[36:39], v223, s[32:35], s51 offen offset:1024 sc1
  v_accvgpr_read_b32 v96, a72
  v_accvgpr_read_b32 v97, a73
  v_accvgpr_read_b32 v98, a74
  v_accvgpr_read_b32 v99, a75
  v_accvgpr_read_b32 v100, a88
  v_accvgpr_read_b32 v101, a89
  v_accvgpr_read_b32 v102, a90
  v_accvgpr_read_b32 v103, a91
  v_max_f32 v40, 0, v40
  v_max_f32 v41, 0, v41
  v_max_f32 v42, 0, v42
  v_max_f32 v43, 0, v43
  v_max_f32 v56, 0, v56
  v_max_f32 v57, 0, v57
  v_max_f32 v58, 0, v58
  v_max_f32 v59, 0, v59
  v_pk_mul_f32 v[96:97], v[40:41], v[96:97]
  v_pk_mul_f32 v[98:99], v[42:43], v[98:99]
  v_pk_mul_f32 v[100:101], v[56:57], v[100:101]
  v_pk_mul_f32 v[102:103], v[58:59], v[102:103]
  v_cvt_pk_bf16_f32 v40, v96, v97
  v_cvt_pk_bf16_f32 v41, v98, v99
  v_cvt_pk_bf16_f32 v42, v100, v101
  v_cvt_pk_bf16_f32 v43, v102, v103
  buffer_store_dwordx4 v[40:43], v223, s[32:35], s51 offen offset:2048 sc1
  v_accvgpr_read_b32 v104, a76
  v_accvgpr_read_b32 v105, a77
  v_accvgpr_read_b32 v106, a78
  v_accvgpr_read_b32 v107, a79
  v_accvgpr_read_b32 v108, a92
  v_accvgpr_read_b32 v109, a93
  v_accvgpr_read_b32 v110, a94
  v_accvgpr_read_b32 v111, a95
  v_max_f32 v44, 0, v44
  v_max_f32 v45, 0, v45
  v_max_f32 v46, 0, v46
  v_max_f32 v47, 0, v47
  v_max_f32 v60, 0, v60
  v_max_f32 v61, 0, v61
  v_max_f32 v62, 0, v62
  v_max_f32 v63, 0, v63
  v_pk_mul_f32 v[104:105], v[44:45], v[104:105]
  v_pk_mul_f32 v[106:107], v[46:47], v[106:107]
  v_pk_mul_f32 v[108:109], v[60:61], v[108:109]
  v_pk_mul_f32 v[110:111], v[62:63], v[110:111]
  v_cvt_pk_bf16_f32 v44, v104, v105
  v_cvt_pk_bf16_f32 v45, v106, v107
  v_cvt_pk_bf16_f32 v46, v108, v109
  v_cvt_pk_bf16_f32 v47, v110, v111
  buffer_store_dwordx4 v[44:47], v223, s[32:35], s51 offen offset:3072 sc1
  v_accvgpr_read_b32 v96, a96
  v_accvgpr_read_b32 v97, a97
  v_accvgpr_read_b32 v98, a98
  v_accvgpr_read_b32 v99, a99
  v_accvgpr_read_b32 v100, a112
  v_accvgpr_read_b32 v101, a113
  v_accvgpr_read_b32 v102, a114
  v_accvgpr_read_b32 v103, a115
  v_max_f32 v64, 0, v64
  v_max_f32 v65, 0, v65
  v_max_f32 v66, 0, v66
  v_max_f32 v67, 0, v67
  v_max_f32 v80, 0, v80
  v_max_f32 v81, 0, v81
  v_max_f32 v82, 0, v82
  v_max_f32 v83, 0, v83
  v_pk_mul_f32 v[96:97], v[64:65], v[96:97]
  v_pk_mul_f32 v[98:99], v[66:67], v[98:99]
  v_pk_mul_f32 v[100:101], v[80:81], v[100:101]
  v_pk_mul_f32 v[102:103], v[82:83], v[102:103]
  v_cvt_pk_bf16_f32 v64, v96, v97
  v_cvt_pk_bf16_f32 v65, v98, v99
  v_cvt_pk_bf16_f32 v66, v100, v101
  v_cvt_pk_bf16_f32 v67, v102, v103
  buffer_store_dwordx4 v[64:67], v223, s[32:35], s52 offen offset:0 sc1
  v_accvgpr_read_b32 v104, a100
  v_accvgpr_read_b32 v105, a101
  v_accvgpr_read_b32 v106, a102
  v_accvgpr_read_b32 v107, a103
  v_accvgpr_read_b32 v108, a116
  v_accvgpr_read_b32 v109, a117
  v_accvgpr_read_b32 v110, a118
  v_accvgpr_read_b32 v111, a119
  v_max_f32 v68, 0, v68
  v_max_f32 v69, 0, v69
  v_max_f32 v70, 0, v70
  v_max_f32 v71, 0, v71
  v_max_f32 v84, 0, v84
  v_max_f32 v85, 0, v85
  v_max_f32 v86, 0, v86
  v_max_f32 v87, 0, v87
  v_pk_mul_f32 v[104:105], v[68:69], v[104:105]
  v_pk_mul_f32 v[106:107], v[70:71], v[106:107]
  v_pk_mul_f32 v[108:109], v[84:85], v[108:109]
  v_pk_mul_f32 v[110:111], v[86:87], v[110:111]
  v_cvt_pk_bf16_f32 v68, v104, v105
  v_cvt_pk_bf16_f32 v69, v106, v107
  v_cvt_pk_bf16_f32 v70, v108, v109
  v_cvt_pk_bf16_f32 v71, v110, v111
  buffer_store_dwordx4 v[68:71], v223, s[32:35], s52 offen offset:1024 sc1
  v_accvgpr_read_b32 v96, a104
  v_accvgpr_read_b32 v97, a105
  v_accvgpr_read_b32 v98, a106
  v_accvgpr_read_b32 v99, a107
  v_accvgpr_read_b32 v100, a120
  v_accvgpr_read_b32 v101, a121
  v_accvgpr_read_b32 v102, a122
  v_accvgpr_read_b32 v103, a123
  v_max_f32 v72, 0, v72
  v_max_f32 v73, 0, v73
  v_max_f32 v74, 0, v74
  v_max_f32 v75, 0, v75
  v_max_f32 v88, 0, v88
  v_max_f32 v89, 0, v89
  v_max_f32 v90, 0, v90
  v_max_f32 v91, 0, v91
  v_pk_mul_f32 v[96:97], v[72:73], v[96:97]
  v_pk_mul_f32 v[98:99], v[74:75], v[98:99]
  v_pk_mul_f32 v[100:101], v[88:89], v[100:101]
  v_pk_mul_f32 v[102:103], v[90:91], v[102:103]
  v_cvt_pk_bf16_f32 v72, v96, v97
  v_cvt_pk_bf16_f32 v73, v98, v99
  v_cvt_pk_bf16_f32 v74, v100, v101
  v_cvt_pk_bf16_f32 v75, v102, v103
  buffer_store_dwordx4 v[72:75], v223, s[32:35], s52 offen offset:2048 sc1
  v_accvgpr_read_b32 v104, a108
  v_accvgpr_read_b32 v105, a109
  v_accvgpr_read_b32 v106, a110
  v_accvgpr_read_b32 v107, a111
  v_accvgpr_read_b32 v108, a124
  v_accvgpr_read_b32 v109, a125
  v_accvgpr_read_b32 v110, a126
  v_accvgpr_read_b32 v111, a127
  v_max_f32 v76, 0, v76
  v_max_f32 v77, 0, v77
  v_max_f32 v78, 0, v78
  v_max_f32 v79, 0, v79
  v_max_f32 v92, 0, v92
  v_max_f32 v93, 0, v93
  v_max_f32 v94, 0, v94
  v_max_f32 v95, 0, v95
  v_pk_mul_f32 v[104:105], v[76:77], v[104:105]
  v_pk_mul_f32 v[106:107], v[78:79], v[106:107]
  v_pk_mul_f32 v[108:109], v[92:93], v[108:109]
  v_pk_mul_f32 v[110:111], v[94:95], v[110:111]
  v_cvt_pk_bf16_f32 v76, v104, v105
  v_cvt_pk_bf16_f32 v77, v106, v107
  v_cvt_pk_bf16_f32 v78, v108, v109
  v_cvt_pk_bf16_f32 v79, v110, v111
  buffer_store_dwordx4 v[76:79], v223, s[32:35], s52 offen offset:3072 sc1
  s_branch K1_hdone
K1_hB:
  v_accvgpr_read_b32 v96, a64
  v_accvgpr_read_b32 v97, a65
  v_accvgpr_read_b32 v98, a66
  v_accvgpr_read_b32 v99, a67
  v_accvgpr_read_b32 v100, a80
  v_accvgpr_read_b32 v101, a81
  v_accvgpr_read_b32 v102, a82
  v_accvgpr_read_b32 v103, a83
  v_max_f32 v96, 0, v96
  v_max_f32 v97, 0, v97
  v_max_f32 v98, 0, v98
  v_max_f32 v99, 0, v99
  v_max_f32 v100, 0, v100
  v_max_f32 v101, 0, v101
  v_max_f32 v102, 0, v102
  v_max_f32 v103, 0, v103
  v_pk_mul_f32 v[96:97], v[32:33], v[96:97]
  v_pk_mul_f32 v[98:99], v[34:35], v[98:99]
  v_pk_mul_f32 v[100:101], v[48:49], v[100:101]
  v_pk_mul_f32 v[102:103], v[50:51], v[102:103]
  v_cvt_pk_bf16_f32 v32, v96, v97
  v_cvt_pk_bf16_f32 v33, v98, v99
  v_cvt_pk_bf16_f32 v34, v100, v101
  v_cvt_pk_bf16_f32 v35, v102, v103
  buffer_store_dwordx4 v[32:35], v223, s[32:35], s51 offen offset:0 sc1
  v_accvgpr_read_b32 v104, a68
  v_accvgpr_read_b32 v105, a69
  v_accvgpr_read_b32 v106, a70
  v_accvgpr_read_b32 v107, a71
  v_accvgpr_read_b32 v108, a84
  v_accvgpr_read_b32 v109, a85
  v_accvgpr_read_b32 v110, a86
  v_accvgpr_read_b32 v111, a87
  v_max_f32 v104, 0, v104
  v_max_f32 v105, 0, v105
  v_max_f32 v106, 0, v106
  v_max_f32 v107, 0, v107
  v_max_f32 v108, 0, v108
  v_max_f32 v109, 0, v109
  v_max_f32 v110, 0, v110
  v_max_f32 v111, 0, v111
  v_pk_mul_f32 v[104:105], v[36:37], v[104:105]
  v_pk_mul_f32 v[106:107], v[38:39], v[106:107]
  v_pk_mul_f32 v[108:109], v[52:53], v[108:109]
  v_pk_mul_f32 v[110:111], v[54:55], v[110:111]
  v_cvt_pk_bf16_f32 v36, v104, v105
  v_cvt_pk_bf16_f32 v37, v106, v107
  v_cvt_pk_bf16_f32 v38, v108, v109
  v_cvt_pk_bf16_f32 v39, v110, v111
  buffer_store_dwordx4 v[36:39], v223, s[32:35], s51 offen offset:1024 sc1
  v_accvgpr_read_b32 v96, a72
  v_accvgpr_read_b32 v97, a73
  v_accvgpr_read_b32 v98, a74
  v_accvgpr_read_b32 v99, a75
  v_accvgpr_read_b32 v100, a88
  v_accvgpr_read_b32 v101, a89
  v_accvgpr_read_b32 v102, a90
  v_accvgpr_read_b32 v103, a91
  v_max_f32 v96, 0, v96
  v_max_f32 v97, 0, v97
  v_max_f32 v98, 0, v98
  v_max_f32 v99, 0, v99
  v_max_f32 v100, 0, v100
  v_max_f32 v101, 0, v101
  v_max_f32 v102, 0, v102
  v_max_f32 v103, 0, v103
  v_pk_mul_f32 v[96:97], v[40:41], v[96:97]
  v_pk_mul_f32 v[98:99], v[42:43], v[98:99]
  v_pk_mul_f32 v[100:101], v[56:57], v[100:101]
  v_pk_mul_f32 v[102:103], v[58:59], v[102:103]
  v_cvt_pk_bf16_f32 v40, v96, v97
  v_cvt_pk_bf16_f32 v41, v98, v99
  v_cvt_pk_bf16_f32 v42, v100, v101
  v_cvt_pk_bf16_f32 v43, v102, v103
  buffer_store_dwordx4 v[40:43], v223, s[32:35], s51 offen offset:2048 sc1
  v_accvgpr_read_b32 v104, a76
  v_accvgpr_read_b32 v105, a77
  v_accvgpr_read_b32 v106, a78
  v_accvgpr_read_b32 v107, a79
  v_accvgpr_read_b32 v108, a92
  v_accvgpr_read_b32 v109, a93
  v_accvgpr_read_b32 v110, a94
  v_accvgpr_read_b32 v111, a95
  v_max_f32 v104, 0, v104
  v_max_f32 v105, 0, v105
  v_max_f32 v106, 0, v106
  v_max_f32 v107, 0, v107
  v_max_f32 v108, 0, v108
  v_max_f32 v109, 0, v109
  v_max_f32 v110, 0, v110
  v_max_f32 v111, 0, v111
  v_pk_mul_f32 v[104:105], v[44:45], v[104:105]
  v_pk_mul_f32 v[106:107], v[46:47], v[106:107]
  v_pk_mul_f32 v[108:109], v[60:61], v[108:109]
  v_pk_mul_f32 v[110:111], v[62:63], v[110:111]
  v_cvt_pk_bf16_f32 v44, v104, v105
  v_cvt_pk_bf16_f32 v45, v106, v107
  v_cvt_pk_bf16_f32 v46, v108, v109
  v_cvt_pk_bf16_f32 v47, v110, v111
  buffer_store_dwordx4 v[44:47], v223, s[32:35], s51 offen offset:3072 sc1
  v_accvgpr_read_b32 v96, a96
  v_accvgpr_read_b32 v97, a97
  v_accvgpr_read_b32 v98, a98
  v_accvgpr_read_b32 v99, a99
  v_accvgpr_read_b32 v100, a112
  v_accvgpr_read_b32 v101, a113
  v_accvgpr_read_b32 v102, a114
  v_accvgpr_read_b32 v103, a115
  v_max_f32 v96, 0, v96
  v_max_f32 v97, 0, v97
  v_max_f32 v98, 0, v98
  v_max_f32 v99, 0, v99
  v_max_f32 v100, 0, v100
  v_max_f32 v101, 0, v101
  v_max_f32 v102, 0, v102
  v_max_f32 v103, 0, v103
  v_pk_mul_f32 v[96:97], v[64:65], v[96:97]
  v_pk_mul_f32 v[98:99], v[66:67], v[98:99]
  v_pk_mul_f32 v[100:101], v[80:81], v[100:101]
  v_pk_mul_f32 v[102:103], v[82:83], v[102:103]
  v_cvt_pk_bf16_f32 v64, v96, v97
  v_cvt_pk_bf16_f32 v65, v98, v99
  v_cvt_pk_bf16_f32 v66, v100, v101
  v_cvt_pk_bf16_f32 v67, v102, v103
  buffer_store_dwordx4 v[64:67], v223, s[32:35], s52 offen offset:0 sc1
  v_accvgpr_read_b32 v104, a100
  v_accvgpr_read_b32 v105, a101
  v_accvgpr_read_b32 v106, a102
  v_accvgpr_read_b32 v107, a103
  v_accvgpr_read_b32 v108, a116
  v_accvgpr_read_b32 v109, a117
  v_accvgpr_read_b32 v110, a118
  v_accvgpr_read_b32 v111, a119
  v_max_f32 v104, 0, v104
  v_max_f32 v105, 0, v105
  v_max_f32 v106, 0, v106
  v_max_f32 v107, 0, v107
  v_max_f32 v108, 0, v108
  v_max_f32 v109, 0, v109
  v_max_f32 v110, 0, v110
  v_max_f32 v111, 0, v111
  v_pk_mul_f32 v[104:105], v[68:69], v[104:105]
  v_pk_mul_f32 v[106:107], v[70:71], v[106:107]
  v_pk_mul_f32 v[108:109], v[84:85], v[108:109]
  v_pk_mul_f32 v[110:111], v[86:87], v[110:111]
  v_cvt_pk_bf16_f32 v68, v104, v105
  v_cvt_pk_bf16_f32 v69, v106, v107
  v_cvt_pk_bf16_f32 v70, v108, v109
  v_cvt_pk_bf16_f32 v71, v110, v111
  buffer_store_dwordx4 v[68:71], v223, s[32:35], s52 offen offset:1024 sc1
  v_accvgpr_read_b32 v96, a104
  v_accvgpr_read_b32 v97, a105
  v_accvgpr_read_b32 v98, a106
  v_accvgpr_read_b32 v99, a107
  v_accvgpr_read_b32 v100, a120
  v_accvgpr_read_b32 v101, a121
  v_accvgpr_read_b32 v102, a122
  v_accvgpr_read_b32 v103, a123
  v_max_f32 v96, 0, v96
  v_max_f32 v97, 0, v97
  v_max_f32 v98, 0, v98
  v_max_f32 v99, 0, v99
  v_max_f32 v100, 0, v100
  v_max_f32 v101, 0, v101
  v_max_f32 v102, 0, v102
  v_max_f32 v103, 0, v103
  v_pk_mul_f32 v[96:97], v[72:73], v[96:97]
  v_pk_mul_f32 v[98:99], v[74:75], v[98:99]
  v_pk_mul_f32 v[100:101], v[88:89], v[100:101]
  v_pk_mul_f32 v[102:103], v[90:91], v[102:103]
  v_cvt_pk_bf16_f32 v72, v96, v97
  v_cvt_pk_bf16_f32 v73, v98, v99
  v_cvt_pk_bf16_f32 v74, v100, v101
  v_cvt_pk_bf16_f32 v75, v102, v103
  buffer_store_dwordx4 v[72:75], v223, s[32:35], s52 offen offset:2048 sc1
  v_accvgpr_read_b32 v104, a108
  v_accvgpr_read_b32 v105, a109
  v_accvgpr_read_b32 v106, a110
  v_accvgpr_read_b32 v107, a111
  v_accvgpr_read_b32 v108, a124
  v_accvgpr_read_b32 v109, a125
  v_accvgpr_read_b32 v110, a126
  v_accvgpr_read_b32 v111, a127
  v_max_f32 v104, 0, v104
  v_max_f32 v105, 0, v105
  v_max_f32 v106, 0, v106
  v_max_f32 v107, 0, v107
  v_max_f32 v108, 0, v108
  v_max_f32 v109, 0, v109
  v_max_f32 v110, 0, v110
  v_max_f32 v111, 0, v111
  v_pk_mul_f32 v[104:105], v[76:77], v[104:105]
  v_pk_mul_f32 v[106:107], v[78:79], v[106:107]
  v_pk_mul_f32 v[108:109], v[92:93], v[108:109]
  v_pk_mul_f32 v[110:111], v[94:95], v[110:111]
  v_cvt_pk_bf16_f32 v76, v104, v105
  v_cvt_pk_bf16_f32 v77, v106, v107
  v_cvt_pk_bf16_f32 v78, v108, v109
  v_cvt_pk_bf16_f32 v79, v110, v111
  buffer_store_dwordx4 v[76:79], v223, s[32:35], s52 offen offset:3072 sc1
K1_hdone:
  v_mov_b32 v232, 0
  v_mov_b32 v233, 0
  v_mov_b32 v234, 0
  v_mov_b32 v235, 0
  v_mov_b32 v236, 0
  v_mov_b32 v237, 0
  v_mov_b32 v238, 0
  v_mov_b32 v239, 0
  v_mov_b32 v240, 0
  v_mov_b32 v241, 0
  v_mov_b32 v242, 0
  v_mov_b32 v243, 0
  v_mov_b32 v244, 0
  v_mov_b32 v245, 0
  v_mov_b32 v246, 0
  v_mov_b32 v247, 0
  v_mov_b32 v248, 0
  v_mov_b32 v249, 0
  v_mov_b32 v250, 0
  v_mov_b32 v251, 0
  v_and_b32 v252, 2, v222
  v_cmp_eq_u32 vcc, 0, v252
  s_nop 1
  v_cndmask_b32 v252, 0, v255, vcc
  v_cndmask_b32 v253, 0, v255, vcc
  v_cndmask_b32 v254, 0, v255, vcc
  v_cndmask_b32 v255, 0, v255, vcc
  v_accvgpr_write_b32 a232, 0
  v_accvgpr_write_b32 a233, 0
  v_accvgpr_write_b32 a234, 0
  v_accvgpr_write_b32 a235, 0
  v_accvgpr_write_b32 a236, 0
  v_accvgpr_write_b32 a237, 0
  v_accvgpr_write_b32 a238, 0
  v_accvgpr_write_b32 a239, 0
  v_accvgpr_write_b32 a240, 0
  v_accvgpr_write_b32 a241, 0
  v_accvgpr_write_b32 a242, 0
  v_accvgpr_write_b32 a243, 0
  v_accvgpr_write_b32 a244, 0
  v_accvgpr_write_b32 a245, 0
  v_accvgpr_write_b32 a246, 0
  v_accvgpr_write_b32 a247, 0
  v_max3_f32 v192, v0, v1, v2
  v_max3_f32 v193, v3, v16, v17
  v_max3_f32 v196, v4, v5, v6
  v_max3_f32 v197, v7, v20, v21
  v_max3_f32 v200, v8, v9, v10
  v_max3_f32 v201, v11, v24, v25
  v_max3_f32 v204, v12, v13, v14
  v_max3_f32 v205, v15, v28, v29
  v_max3_f32 v192, v192, v18, v19
  v_max3_f32 v196, v196, v22, v23
  v_max3_f32 v200, v200, v26, v27
  v_max3_f32 v204, v204, v30, v31
  v_max_f32 v192, v192, v193
  v_max_f32 v196, v196, v197
  v_max_f32 v200, v200, v201
  v_max_f32 v204, v204, v205
  v_mov_b32 v193, v192
  v_mov_b32 v197, v196
  v_mov_b32 v201, v200
  v_mov_b32 v205, v204
  v_permlane16_swap_b32 v192, v193
  v_permlane16_swap_b32 v196, v197
  v_permlane16_swap_b32 v200, v201
  v_permlane16_swap_b32 v204, v205
  v_max_f32 v192, v192, v193
  v_max_f32 v196, v196, v197
  v_max_f32 v200, v200, v201
  v_max_f32 v204, v204, v205
  v_mov_b32 v193, v192
  v_mov_b32 v197, v196
  v_mov_b32 v201, v200
  v_mov_b32 v205, v204
  v_permlane32_swap_b32 v192, v193
  v_permlane32_swap_b32 v196, v197
  v_permlane32_swap_b32 v200, v201
  v_permlane32_swap_b32 v204, v205
  v_max_f32 v192, v192, v193
  v_max_f32 v196, v196, v197
  v_max_f32 v200, v200, v201
  v_max_f32 v204, v204, v205
  v_sub_f32 v193, 0, v192
  v_sub_f32 v197, 0, v196
  v_sub_f32 v201, 0, v200
  v_sub_f32 v205, 0, v204
  v_sub_f32 v194, 0, v192
  v_sub_f32 v198, 0, v196
  v_sub_f32 v202, 0, v200
  v_sub_f32 v206, 0, v204
  v_sub_f32 v195, 0, v192
  v_sub_f32 v199, 0, v196
  v_sub_f32 v203, 0, v200
  v_sub_f32 v207, 0, v204
  v_sub_f32 v192, 0, v192
  v_sub_f32 v196, 0, v196
  v_sub_f32 v200, 0, v200
  v_sub_f32 v204, 0, v204
  v_pk_add_f32 v[0:1], v[0:1], v[194:195]
  v_pk_add_f32 v[2:3], v[2:3], v[194:195]
  v_pk_add_f32 v[16:17], v[16:17], v[194:195]
  v_pk_add_f32 v[18:19], v[18:19], v[194:195]
  v_pk_add_f32 v[4:5], v[4:5], v[198:199]
  v_pk_add_f32 v[6:7], v[6:7], v[198:199]
  v_pk_add_f32 v[20:21], v[20:21], v[198:199]
  v_pk_add_f32 v[22:23], v[22:23], v[198:199]
  v_pk_add_f32 v[8:9], v[8:9], v[202:203]
  v_pk_add_f32 v[10:11], v[10:11], v[202:203]
  v_pk_add_f32 v[24:25], v[24:25], v[202:203]
  v_pk_add_f32 v[26:27], v[26:27], v[202:203]
  v_pk_add_f32 v[12:13], v[12:13], v[206:207]
  v_pk_add_f32 v[14:15], v[14:15], v[206:207]
  v_pk_add_f32 v[28:29], v[28:29], v[206:207]
  v_pk_add_f32 v[30:31], v[30:31], v[206:207]
  v_mfma_f32_16x16x32_bf16 v[32:35], a[160:163], v[128:131], v[192:195]
  v_exp_f32 v0, v0
  v_mfma_f32_16x16x32_bf16 v[32:35], a[164:167], v[132:135], v[32:35]
  v_exp_f32 v1, v1
  v_mfma_f32_16x16x32_bf16 v[32:35], a[168:171], v[136:139], v[32:35]
  s_add_u32 m0, s44, 49152
  v_cvt_pk_bf16_f32 v64, v0, v1
  v_mfma_f32_16x16x32_bf16 v[32:35], a[172:175], v[140:143], v[32:35]
  buffer_load_dwordx4 v220, s[24:27], s46 offen offset:0  lds
  v_mfma_f32_16x16x32_bf16 v[36:39], a[172:175], v[156:159], v[196:199]
  v_exp_f32 v2, v2
  v_mfma_f32_16x16x32_bf16 v[36:39], a[168:171], v[152:155], v[36:39]
  v_exp_f32 v3, v3
  v_mfma_f32_16x16x32_bf16 v[36:39], a[164:167], v[148:151], v[36:39]
  v_cvt_pk_bf16_f32 v65, v2, v3
  v_mfma_f32_16x16x32_bf16 v[36:39], a[160:163], v[144:147], v[36:39]
  v_exp_f32 v4, v4
  v_mfma_f32_16x16x32_bf16 v[40:43], a[160:163], v[160:163], v[200:203]
  v_mfma_f32_16x16x32_bf16 v[40:43], a[164:167], v[164:167], v[40:43]
  v_exp_f32 v5, v5
  v_mfma_f32_16x16x32_bf16 v[40:43], a[168:171], v[168:171], v[40:43]
  v_cvt_pk_bf16_f32 v76, v4, v5
  v_mfma_f32_16x16x32_bf16 v[40:43], a[172:175], v[172:175], v[40:43]
  buffer_load_dwordx4 v220, s[24:27], s46 offen offset:1024  lds
  v_mfma_f32_16x16x32_bf16 v[44:47], a[172:175], v[188:191], v[204:207]
  v_exp_f32 v6, v6
  v_mfma_f32_16x16x32_bf16 v[44:47], a[168:171], v[184:187], v[44:47]
  v_exp_f32 v7, v7
  v_mfma_f32_16x16x32_bf16 v[44:47], a[164:167], v[180:183], v[44:47]
  v_cvt_pk_bf16_f32 v77, v6, v7
  v_mfma_f32_16x16x32_bf16 v[44:47], a[160:163], v[176:179], v[44:47]
K1_st6:
  s_cbranch_execz K1_st10
  v_exp_f32 v8, v8
  v_mfma_f32_16x16x32_bf16 v[60:63], a[176:179], v[176:179], v[204:207]
  v_mfma_f32_16x16x32_bf16 v[60:63], a[180:183], v[180:183], v[60:63]
  v_exp_f32 v9, v9
  v_mfma_f32_16x16x32_bf16 v[60:63], a[184:187], v[184:187], v[60:63]
  v_cvt_pk_bf16_f32 v88, v8, v9
  v_mfma_f32_16x16x32_bf16 v[60:63], a[188:191], v[188:191], v[60:63]
  buffer_load_dwordx4 v220, s[24:27], s46 offen offset:2048  lds
  v_mfma_f32_16x16x32_bf16 v[56:59], a[188:191], v[172:175], v[200:203]
  v_exp_f32 v10, v10
  v_mfma_f32_16x16x32_bf16 v[56:59], a[184:187], v[168:171], v[56:59]
  v_exp_f32 v11, v11
  v_mfma_f32_16x16x32_bf16 v[56:59], a[180:183], v[164:167], v[56:59]
  v_cvt_pk_bf16_f32 v89, v10, v11
  v_mfma_f32_16x16x32_bf16 v[56:59], a[176:179], v[160:163], v[56:59]
  v_exp_f32 v12, v12
  v_mfma_f32_16x16x32_bf16 v[52:55], a[176:179], v[144:147], v[196:199]
  v_mfma_f32_16x16x32_bf16 v[52:55], a[180:183], v[148:151], v[52:55]
  v_exp_f32 v13, v13
  v_mfma_f32_16x16x32_bf16 v[52:55], a[184:187], v[152:155], v[52:55]
  v_cvt_pk_bf16_f32 v100, v12, v13
  v_mfma_f32_16x16x32_bf16 v[52:55], a[188:191], v[156:159], v[52:55]
  buffer_load_dwordx4 v220, s[24:27], s46 offen offset:3072  lds
  v_mfma_f32_16x16x32_bf16 v[48:51], a[188:191], v[140:143], v[192:195]
  s_add_u32 s46, s46, 16384
  v_exp_f32 v14, v14
  v_mfma_f32_16x16x32_bf16 v[48:51], a[184:187], v[136:139], v[48:51]
  v_exp_f32 v15, v15
  v_mfma_f32_16x16x32_bf16 v[48:51], a[180:183], v[132:135], v[48:51]
  v_cvt_pk_bf16_f32 v101, v14, v15
  v_mfma_f32_16x16x32_bf16 v[48:51], a[176:179], v[128:131], v[48:51]
  s_add_u32 m0, s44, 98304
  s_nop 0
  buffer_load_dwordx4 v221, s[28:31], s47 offen offset:0  lds
  buffer_load_dwordx4 v221, s[28:31], s47 offen offset:1024  lds
  buffer_load_dwordx4 v221, s[28:31], s47 offen offset:2048  lds
  buffer_load_dwordx4 v221, s[28:31], s47 offen offset:3072  lds
  s_add_u32 s47, s47, 16384
  v_exp_f32 v16, v16
  v_exp_f32 v17, v17
  v_exp_f32 v18, v18
  v_exp_f32 v19, v19
  v_exp_f32 v20, v20
  v_exp_f32 v21, v21
  v_exp_f32 v22, v22
  v_exp_f32 v23, v23
  v_exp_f32 v24, v24
  v_exp_f32 v25, v25
  v_exp_f32 v26, v26
  v_exp_f32 v27, v27
  v_exp_f32 v28, v28
  v_exp_f32 v29, v29
  v_exp_f32 v30, v30
  v_exp_f32 v31, v31
  v_cvt_pk_bf16_f32 v66, v16, v17
  v_cvt_pk_bf16_f32 v67, v18, v19
  v_cvt_pk_bf16_f32 v78, v20, v21
  v_cvt_pk_bf16_f32 v79, v22, v23
  v_cvt_pk_bf16_f32 v90, v24, v25
  v_cvt_pk_bf16_f32 v91, v26, v27
  v_cvt_pk_bf16_f32 v102, v28, v29
  v_cvt_pk_bf16_f32 v103, v30, v31
  s_waitcnt vmcnt(24) lgkmcnt(0)
  s_barrier
  ds_read_b128 a[128:131], v208 offset:16384
  ds_read_b128 a[132:135], v209 offset:16384
  ds_read_b128 a[136:139], v210 offset:16384
  ds_read_b128 a[140:143], v211 offset:16384
  ds_read_b128 a[144:147], v208 offset:17408
  ds_read_b128 a[148:151], v209 offset:17408
  ds_read_b128 a[152:155], v210 offset:17408
  ds_read_b128 a[156:159], v211 offset:17408
  ds_read_b64_tr_b16 a[216:217], v215 offset:0
  ds_read_b64_tr_b16 a[218:219], v215 offset:1024
  ds_read_b64_tr_b16 a[220:221], v215 offset:2048
  ds_read_b64_tr_b16 a[222:223], v215 offset:3072
  ds_read_b64_tr_b16 a[224:225], v216 offset:0
  ds_read_b64_tr_b16 a[226:227], v216 offset:1024
  ds_read_b64_tr_b16 a[228:229], v216 offset:2048
  ds_read_b64_tr_b16 a[230:231], v216 offset:3072
  v_exp_f32 v32, v32
  v_exp_f32 v33, v33
  v_exp_f32 v34, v34
  v_exp_f32 v35, v35
  v_exp_f32 v36, v36
  v_exp_f32 v37, v37
  v_exp_f32 v38, v38
  v_exp_f32 v39, v39
  v_exp_f32 v40, v40
  v_exp_f32 v41, v41
  v_exp_f32 v42, v42
  v_exp_f32 v43, v43
  v_exp_f32 v44, v44
  v_exp_f32 v45, v45
  v_exp_f32 v46, v46
  v_exp_f32 v47, v47
  s_waitcnt vmcnt(8)
  v_mov_b32 v225, 1
  s_mov_b64 exec, 1
  buffer_store_dword v225, v223, s[20:23], s53 offen sc1
  s_mov_b64 exec, -1
  s_waitcnt lgkmcnt(15)
  v_mfma_f32_16x16x32_bf16 v[0:3], a[128:131], v[128:131], v[192:195]
  s_waitcnt lgkmcnt(14)
  v_exp_f32 v48, v48
  v_mfma_f32_16x16x32_bf16 v[0:3], a[132:135], v[132:135], v[0:3]
  s_waitcnt lgkmcnt(13)
  s_add_u32 m0, s44, 0
  ds_read_b128 a[160:163], v208 offset:18432
  ds_read_b128 a[164:167], v209 offset:18432
  v_mfma_f32_16x16x32_bf16 v[0:3], a[136:139], v[136:139], v[0:3]
  s_waitcnt lgkmcnt(14)
  buffer_load_dwordx4 v220, s[24:27], s46 offen offset:0  lds
  v_mfma_f32_16x16x32_bf16 v[0:3], a[140:143], v[140:143], v[0:3]
  v_exp_f32 v49, v49
  v_mfma_f32_16x16x32_bf16 v[4:7], a[140:143], v[156:159], v[196:199]
  v_cvt_pk_bf16_f32 v68, v32, v33
  v_cvt_pk_bf16_f32 v69, v34, v35
  v_mfma_f32_16x16x32_bf16 v[4:7], a[136:139], v[152:155], v[4:7]
  v_exp_f32 v50, v50
  v_mfma_f32_16x16x32_bf16 v[4:7], a[132:135], v[148:151], v[4:7]
  v_exp_f32 v51, v51
  v_mfma_f32_16x16x32_bf16 v[4:7], a[128:131], v[144:147], v[4:7]
  v_cvt_pk_bf16_f32 v80, v36, v37
  v_cvt_pk_bf16_f32 v81, v38, v39
  v_mfma_f32_16x16x32_bf16 v[8:11], a[128:131], v[160:163], v[200:203]
  v_exp_f32 v52, v52
  v_mfma_f32_16x16x32_bf16 v[8:11], a[132:135], v[164:167], v[8:11]
  ds_read_b128 a[168:171], v210 offset:18432
  ds_read_b128 a[172:175], v211 offset:18432
  v_mfma_f32_16x16x32_bf16 v[8:11], a[136:139], v[168:171], v[8:11]
  buffer_load_dwordx4 v220, s[24:27], s46 offen offset:1024  lds
  v_mfma_f32_16x16x32_bf16 v[8:11], a[140:143], v[172:175], v[8:11]
  v_exp_f32 v53, v53
  v_mfma_f32_16x16x32_bf16 v[12:15], a[140:143], v[188:191], v[204:207]
  v_cvt_pk_bf16_f32 v92, v40, v41
  v_cvt_pk_bf16_f32 v93, v42, v43
  v_mfma_f32_16x16x32_bf16 v[12:15], a[136:139], v[184:187], v[12:15]
  v_exp_f32 v54, v54
  v_mfma_f32_16x16x32_bf16 v[12:15], a[132:135], v[180:183], v[12:15]
  v_exp_f32 v55, v55
  v_mfma_f32_16x16x32_bf16 v[12:15], a[128:131], v[176:179], v[12:15]
  s_waitcnt lgkmcnt(0)
  v_cvt_pk_bf16_f32 v104, v44, v45
  v_cvt_pk_bf16_f32 v105, v46, v47
  v_mfma_f32_16x16x32_bf16 v[28:31], a[144:147], v[176:179], v[204:207]
  v_exp_f32 v56, v56
  v_mfma_f32_16x16x32_bf16 v[28:31], a[148:151], v[180:183], v[28:31]
  ds_read_b128 a[176:179], v208 offset:19456
  ds_read_b128 a[180:183], v209 offset:19456
  v_mfma_f32_16x16x32_bf16 v[28:31], a[152:155], v[184:187], v[28:31]
  v_mfma_f32_16x16x32_bf16 v[28:31], a[156:159], v[188:191], v[28:31]
  v_exp_f32 v57, v57
  v_mfma_f32_16x16x32_bf16 v[24:27], a[156:159], v[172:175], v[200:203]
  v_cvt_pk_bf16_f32 v70, v48, v49
  v_cvt_pk_bf16_f32 v71, v50, v51
  v_mfma_f32_16x16x32_bf16 v[24:27], a[152:155], v[168:171], v[24:27]
  v_exp_f32 v58, v58
  v_mfma_f32_16x16x32_bf16 v[24:27], a[148:151], v[164:167], v[24:27]
  v_exp_f32 v59, v59
  v_mfma_f32_16x16x32_bf16 v[24:27], a[144:147], v[160:163], v[24:27]
  v_cvt_pk_bf16_f32 v82, v52, v53
  v_cvt_pk_bf16_f32 v83, v54, v55
  v_mfma_f32_16x16x32_bf16 v[20:23], a[144:147], v[144:147], v[196:199]
  v_exp_f32 v60, v60
  v_mfma_f32_16x16x32_bf16 v[20:23], a[148:151], v[148:151], v[20:23]
  ds_read_b128 a[184:187], v210 offset:19456
  ds_read_b128 a[188:191], v211 offset:19456
  v_mfma_f32_16x16x32_bf16 v[20:23], a[152:155], v[152:155], v[20:23]
  v_mfma_f32_16x16x32_bf16 v[20:23], a[156:159], v[156:159], v[20:23]
  v_exp_f32 v61, v61
  v_mfma_f32_16x16x32_bf16 v[16:19], a[156:159], v[140:143], v[192:195]
  v_cvt_pk_bf16_f32 v94, v56, v57
  v_cvt_pk_bf16_f32 v95, v58, v59
  v_mfma_f32_16x16x32_bf16 v[16:19], a[152:155], v[136:139], v[16:19]
  v_exp_f32 v62, v62
  v_mfma_f32_16x16x32_bf16 v[16:19], a[148:151], v[132:135], v[16:19]
  v_exp_f32 v63, v63
  v_mfma_f32_16x16x32_bf16 v[16:19], a[144:147], v[128:131], v[16:19]
  v_cvt_pk_bf16_f32 v106, v60, v61
  v_cvt_pk_bf16_f32 v107, v62, v63
  v_mfma_f32_16x16x32_bf16 v[32:35], a[160:163], v[128:131], v[192:195]
  v_exp_f32 v0, v0
  v_mfma_f32_16x16x32_bf16 v[32:35], a[164:167], v[132:135], v[32:35]
  ds_read_b64_tr_b16 a[192:193], v212 offset:0
  ds_read_b64_tr_b16 a[194:195], v212 offset:1024
  v_mfma_f32_16x16x32_bf16 v[32:35], a[168:171], v[136:139], v[32:35]
  buffer_load_dwordx4 v220, s[24:27], s46 offen offset:2048  lds
  v_mfma_f32_16x16x32_bf16 v[32:35], a[172:175], v[140:143], v[32:35]
  v_exp_f32 v1, v1
  v_mfma_f32_16x16x32_bf16 v[36:39], a[172:175], v[156:159], v[196:199]
  v_cvt_pk_bf16_f32 v72, v0, v1
  v_mfma_f32_16x16x32_bf16 v[36:39], a[168:171], v[152:155], v[36:39]
  v_exp_f32 v2, v2
  v_mfma_f32_16x16x32_bf16 v[36:39], a[164:167], v[148:151], v[36:39]
  ds_read_b64_tr_b16 a[196:197], v212 offset:2048
  v_mfma_f32_16x16x32_bf16 v[36:39], a[160:163], v[144:147], v[36:39]
  v_exp_f32 v3, v3
  v_smfmac_f32_16x16x64_bf16 a[232:235], v[252:255], v[64:71], v224
  v_cvt_pk_bf16_f32 v73, v2, v3
  v_mfma_f32_16x16x32_bf16 v[40:43], a[160:163], v[160:163], v[200:203]
  v_exp_f32 v4, v4
  v_mfma_f32_16x16x32_bf16 v[40:43], a[164:167], v[164:167], v[40:43]
  ds_read_b64_tr_b16 a[198:199], v212 offset:3072
  ds_read_b64_tr_b16 a[200:201], v213 offset:0
  v_mfma_f32_16x16x32_bf16 v[40:43], a[168:171], v[168:171], v[40:43]
  buffer_load_dwordx4 v220, s[24:27], s46 offen offset:3072  lds
  v_mfma_f32_16x16x32_bf16 v[40:43], a[172:175], v[172:175], v[40:43]
  s_add_u32 s46, s46, 16384
  v_exp_f32 v5, v5
  v_mfma_f32_16x16x32_bf16 v[44:47], a[172:175], v[188:191], v[204:207]
  v_cvt_pk_bf16_f32 v84, v4, v5
  v_mfma_f32_16x16x32_bf16 v[44:47], a[168:171], v[184:187], v[44:47]
  v_exp_f32 v6, v6
  v_mfma_f32_16x16x32_bf16 v[44:47], a[164:167], v[180:183], v[44:47]
  ds_read_b64_tr_b16 a[202:203], v213 offset:1024
  v_mfma_f32_16x16x32_bf16 v[44:47], a[160:163], v[176:179], v[44:47]
  v_exp_f32 v7, v7
  v_smfmac_f32_16x16x64_bf16 a[236:239], v[252:255], v[76:83], v224
  s_waitcnt lgkmcnt(1)
  v_cvt_pk_bf16_f32 v85, v6, v7
  v_mfma_f32_16x16x32_bf16 v[60:63], a[176:179], v[176:179], v[204:207]
  v_exp_f32 v8, v8
  v_mfma_f32_16x16x32_bf16 v[60:63], a[180:183], v[180:183], v[60:63]
  s_add_u32 m0, s44, 114688
  ds_read_b64_tr_b16 a[204:205], v213 offset:2048
  ds_read_b64_tr_b16 a[206:207], v213 offset:3072
  v_mfma_f32_16x16x32_bf16 v[60:63], a[184:187], v[184:187], v[60:63]
  buffer_load_dwordx4 v221, s[28:31], s47 offen offset:0  lds
  v_mfma_f32_16x16x32_bf16 v[60:63], a[188:191], v[188:191], v[60:63]
  v_exp_f32 v9, v9
  v_mfma_f32_16x16x32_bf16 v[56:59], a[188:191], v[172:175], v[200:203]
  v_cvt_pk_bf16_f32 v96, v8, v9
  v_mfma_f32_16x16x32_bf16 v[56:59], a[184:187], v[168:171], v[56:59]
  v_exp_f32 v10, v10
  v_mfma_f32_16x16x32_bf16 v[56:59], a[180:183], v[164:167], v[56:59]
  ds_read_b64_tr_b16 a[208:209], v214 offset:0
  v_mfma_f32_16x16x32_bf16 v[56:59], a[176:179], v[160:163], v[56:59]
  v_exp_f32 v11, v11
  v_smfmac_f32_16x16x64_bf16 a[240:243], v[252:255], v[88:95], v224
  v_cvt_pk_bf16_f32 v97, v10, v11
  v_mfma_f32_16x16x32_bf16 v[52:55], a[176:179], v[144:147], v[196:199]
  v_exp_f32 v12, v12
  v_mfma_f32_16x16x32_bf16 v[52:55], a[180:183], v[148:151], v[52:55]
  ds_read_b64_tr_b16 a[210:211], v214 offset:1024
  ds_read_b64_tr_b16 a[212:213], v214 offset:2048
  v_mfma_f32_16x16x32_bf16 v[52:55], a[184:187], v[152:155], v[52:55]
  buffer_load_dwordx4 v221, s[28:31], s47 offen offset:1024  lds
  v_mfma_f32_16x16x32_bf16 v[52:55], a[188:191], v[156:159], v[52:55]
  v_exp_f32 v13, v13
  v_mfma_f32_16x16x32_bf16 v[48:51], a[188:191], v[140:143], v[192:195]
  v_cvt_pk_bf16_f32 v108, v12, v13
  v_mfma_f32_16x16x32_bf16 v[48:51], a[184:187], v[136:139], v[48:51]
  v_exp_f32 v14, v14
  v_mfma_f32_16x16x32_bf16 v[48:51], a[180:183], v[132:135], v[48:51]
  ds_read_b64_tr_b16 a[214:215], v214 offset:3072
  v_mfma_f32_16x16x32_bf16 v[48:51], a[176:179], v[128:131], v[48:51]
  v_exp_f32 v15, v15
  v_smfmac_f32_16x16x64_bf16 a[244:247], v[252:255], v[100:107], v224
  v_cvt_pk_bf16_f32 v109, v14, v15
  v_mfma_f32_16x16x32_bf16 a[0:3], a[192:195], v[64:67], 0
  v_exp_f32 v16, v16
  v_mfma_f32_16x16x32_bf16 a[0:3], a[196:199], v[68:71], a[0:3]
  v_exp_f32 v17, v17
  v_mfma_f32_16x16x32_bf16 a[4:7], a[196:199], v[80:83], 0
  v_cvt_pk_bf16_f32 v74, v16, v17
  v_mfma_f32_16x16x32_bf16 a[4:7], a[192:195], v[76:79], a[4:7]
  v_exp_f32 v18, v18
  v_mfma_f32_16x16x32_bf16 a[8:11], a[192:195], v[88:91], 0
  v_mfma_f32_16x16x32_bf16 a[8:11], a[196:199], v[92:95], a[8:11]
  buffer_load_dwordx4 v221, s[28:31], s47 offen offset:2048  lds
  v_mfma_f32_16x16x32_bf16 a[12:15], a[196:199], v[104:107], 0
  v_exp_f32 v19, v19
  v_mfma_f32_16x16x32_bf16 a[12:15], a[192:195], v[100:103], a[12:15]
  s_waitcnt lgkmcnt(0)
  v_cvt_pk_bf16_f32 v75, v18, v19
  v_mfma_f32_16x16x32_bf16 a[28:31], a[200:203], v[100:103], 0
  v_exp_f32 v20, v20
  v_mfma_f32_16x16x32_bf16 a[28:31], a[204:207], v[104:107], a[28:31]
  ds_read_b64_tr_b16 a[192:193], v217 offset:0
  ds_read_b64_tr_b16 a[194:195], v217 offset:1024
  v_mfma_f32_16x16x32_bf16 a[24:27], a[204:207], v[92:95], 0
  v_exp_f32 v21, v21
  v_mfma_f32_16x16x32_bf16 a[24:27], a[200:203], v[88:91], a[24:27]
  ds_read_b64_tr_b16 a[196:197], v217 offset:2048
  v_cvt_pk_bf16_f32 v86, v20, v21
  v_mfma_f32_16x16x32_bf16 a[20:23], a[200:203], v[76:79], 0
  v_exp_f32 v22, v22
  v_mfma_f32_16x16x32_bf16 a[20:23], a[204:207], v[80:83], a[20:23]
  ds_read_b64_tr_b16 a[198:199], v217 offset:3072
  v_mfma_f32_16x16x32_bf16 a[16:19], a[204:207], v[68:71], 0
  v_exp_f32 v23, v23
  v_mfma_f32_16x16x32_bf16 a[16:19], a[200:203], v[64:67], a[16:19]
  v_cvt_pk_bf16_f32 v87, v22, v23
  v_mfma_f32_16x16x32_bf16 a[32:35], a[208:211], v[64:67], 0
  v_exp_f32 v24, v24
  v_mfma_f32_16x16x32_bf16 a[32:35], a[212:215], v[68:71], a[32:35]
  ds_read_b64_tr_b16 a[200:201], v218 offset:0
  ds_read_b64_tr_b16 a[202:203], v218 offset:1024
  v_mfma_f32_16x16x32_bf16 a[36:39], a[212:215], v[80:83], 0
  v_exp_f32 v25, v25
  v_mfma_f32_16x16x32_bf16 a[36:39], a[208:211], v[76:79], a[36:39]
  ds_read_b64_tr_b16 a[204:205], v218 offset:2048
  ds_read_b64_tr_b16 a[206:207], v218 offset:3072
  v_mfma_f32_16x16x32_bf16 a[40:43], a[208:211], v[88:91], 0
  buffer_load_dwordx4 v221, s[28:31], s47 offen offset:3072  lds
  v_mfma_f32_16x16x32_bf16 a[40:43], a[212:215], v[92:95], a[40:43]
  s_add_u32 s47, s47, 16384
  v_exp_f32 v26, v26
  v_mfma_f32_16x16x32_bf16 a[44:47], a[212:215], v[104:107], 0
  v_exp_f32 v27, v27
  v_mfma_f32_16x16x32_bf16 a[44:47], a[208:211], v[100:103], a[44:47]
  v_cvt_pk_bf16_f32 v98, v24, v25
  v_cvt_pk_bf16_f32 v99, v26, v27
  v_mfma_f32_16x16x32_bf16 a[60:63], a[216:219], v[100:103], 0
  v_exp_f32 v28, v28
  v_mfma_f32_16x16x32_bf16 a[60:63], a[220:223], v[104:107], a[60:63]
  ds_read_b64_tr_b16 a[208:209], v219 offset:0
  ds_read_b64_tr_b16 a[210:211], v219 offset:1024
  v_mfma_f32_16x16x32_bf16 a[56:59], a[220:223], v[92:95], 0
  v_exp_f32 v29, v29
  v_mfma_f32_16x16x32_bf16 a[56:59], a[216:219], v[88:91], a[56:59]
  ds_read_b64_tr_b16 a[212:213], v219 offset:2048
  ds_read_b64_tr_b16 a[214:215], v219 offset:3072
  v_mfma_f32_16x16x32_bf16 a[52:55], a[216:219], v[76:79], 0
  v_exp_f32 v30, v30
  v_mfma_f32_16x16x32_bf16 a[52:55], a[220:223], v[80:83], a[52:55]
  v_exp_f32 v31, v31
  v_mfma_f32_16x16x32_bf16 a[48:51], a[220:223], v[68:71], 0
  v_cvt_pk_bf16_f32 v110, v28, v29
  v_cvt_pk_bf16_f32 v111, v30, v31
  v_mfma_f32_16x16x32_bf16 a[48:51], a[216:219], v[64:67], a[48:51]
  v_mfma_f32_16x16x32_bf16 a[64:67], a[224:227], v[64:67], 0
  s_waitcnt vmcnt(17) lgkmcnt(0)
  s_barrier
  v_exp_f32 v32, v32
  v_mfma_f32_16x16x32_bf16 a[64:67], a[228:231], v[68:71], a[64:67]
  ds_read_b128 a[128:131], v208 offset:32768
  v_mfma_f32_16x16x32_bf16 a[68:71], a[228:231], v[80:83], 0
  v_exp_f32 v33, v33
  v_mfma_f32_16x16x32_bf16 a[68:71], a[224:227], v[76:79], a[68:71]
  ds_read_b128 a[132:135], v209 offset:32768
  v_mfma_f32_16x16x32_bf16 a[72:75], a[224:227], v[88:91], 0
  v_exp_f32 v34, v34
  v_mfma_f32_16x16x32_bf16 a[72:75], a[228:231], v[92:95], a[72:75]
  ds_read_b128 a[136:139], v210 offset:32768
  ds_read_b128 a[140:143], v211 offset:32768
  v_mfma_f32_16x16x32_bf16 a[76:79], a[228:231], v[104:107], 0
  v_exp_f32 v35, v35
  v_mfma_f32_16x16x32_bf16 a[76:79], a[224:227], v[100:103], a[76:79]
  ds_read_b128 a[144:147], v208 offset:33792
  v_mfma_f32_16x16x32_bf16 a[92:95], a[192:195], v[100:103], 0
  v_exp_f32 v36, v36
  v_mfma_f32_16x16x32_bf16 a[92:95], a[196:199], v[104:107], a[92:95]
  ds_read_b128 a[148:151], v209 offset:33792
  v_mfma_f32_16x16x32_bf16 a[88:91], a[196:199], v[92:95], 0
  v_exp_f32 v37, v37
  v_mfma_f32_16x16x32_bf16 a[88:91], a[192:195], v[88:91], a[88:91]
  ds_read_b128 a[152:155], v210 offset:33792
  v_mfma_f32_16x16x32_bf16 a[84:87], a[192:195], v[76:79], 0
  v_exp_f32 v38, v38
  v_mfma_f32_16x16x32_bf16 a[84:87], a[196:199], v[80:83], a[84:87]
  ds_read_b128 a[156:159], v211 offset:33792
  v_mfma_f32_16x16x32_bf16 a[80:83], a[196:199], v[68:71], 0
  v_exp_f32 v39, v39
  v_mfma_f32_16x16x32_bf16 a[80:83], a[192:195], v[64:67], a[80:83]
  ds_read_b64_tr_b16 a[216:217], v215 offset:16384
  v_mfma_f32_16x16x32_bf16 a[96:99], a[200:203], v[64:67], 0
  v_exp_f32 v40, v40
  v_mfma_f32_16x16x32_bf16 a[96:99], a[204:207], v[68:71], a[96:99]
  ds_read_b64_tr_b16 a[218:219], v215 offset:17408
  ds_read_b64_tr_b16 a[220:221], v215 offset:18432
  v_mfma_f32_16x16x32_bf16 a[100:103], a[204:207], v[80:83], 0
  v_exp_f32 v41, v41
  v_mfma_f32_16x16x32_bf16 a[100:103], a[200:203], v[76:79], a[100:103]
  v_exp_f32 v42, v42
  v_mfma_f32_16x16x32_bf16 a[104:107], a[200:203], v[88:91], 0
  ds_read_b64_tr_b16 a[222:223], v215 offset:19456
  v_mfma_f32_16x16x32_bf16 a[104:107], a[204:207], v[92:95], a[104:107]
  ds_read_b64_tr_b16 a[224:225], v216 offset:16384
  v_mfma_f32_16x16x32_bf16 a[108:111], a[204:207], v[104:107], 0
  v_exp_f32 v43, v43
  v_mfma_f32_16x16x32_bf16 a[108:111], a[200:203], v[100:103], a[108:111]
  ds_read_b64_tr_b16 a[226:227], v216 offset:17408
  v_mfma_f32_16x16x32_bf16 a[124:127], a[208:211], v[100:103], 0
  v_exp_f32 v44, v44
  v_mfma_f32_16x16x32_bf16 a[124:127], a[212:215], v[104:107], a[124:127]
  ds_read_b64_tr_b16 a[228:229], v216 offset:18432
  v_mfma_f32_16x16x32_bf16 a[120:123], a[212:215], v[92:95], 0
  v_exp_f32 v45, v45
  v_mfma_f32_16x16x32_bf16 a[120:123], a[208:211], v[88:91], a[120:123]
  ds_read_b64_tr_b16 a[230:231], v216 offset:19456
  v_mfma_f32_16x16x32_bf16 a[116:119], a[208:211], v[76:79], 0
  v_exp_f32 v46, v46
  v_mfma_f32_16x16x32_bf16 a[116:119], a[212:215], v[80:83], a[116:119]
  v_exp_f32 v47, v47
  v_mfma_f32_16x16x32_bf16 a[112:115], a[212:215], v[68:71], 0
  v_mfma_f32_16x16x32_bf16 a[112:115], a[208:211], v[64:67], a[112:115]
  s_waitcnt lgkmcnt(1)
  v_mfma_f32_16x16x32_bf16 v[0:3], a[128:131], v[128:131], v[192:195]
  v_exp_f32 v48, v48
  v_mfma_f32_16x16x32_bf16 v[0:3], a[132:135], v[132:135], v[0:3]
  s_add_u32 m0, s44, 16384
  ds_read_b128 a[160:163], v208 offset:34816
  ds_read_b128 a[164:167], v209 offset:34816
  v_mfma_f32_16x16x32_bf16 v[0:3], a[136:139], v[136:139], v[0:3]
  buffer_load_dwordx4 v220, s[24:27], s46 offen offset:0  lds
  v_mfma_f32_16x16x32_bf16 v[0:3], a[140:143], v[140:143], v[0:3]
  v_exp_f32 v49, v49
  v_mfma_f32_16x16x32_bf16 v[4:7], a[140:143], v[156:159], v[196:199]
  v_cvt_pk_bf16_f32 v68, v32, v33
  v_cvt_pk_bf16_f32 v69, v34, v35
  v_mfma_f32_16x16x32_bf16 v[4:7], a[136:139], v[152:155], v[4:7]
  v_exp_f32 v50, v50
  v_mfma_f32_16x16x32_bf16 v[4:7], a[132:135], v[148:151], v[4:7]
  v_exp_f32 v51, v51
  v_mfma_f32_16x16x32_bf16 v[4:7], a[128:131], v[144:147], v[4:7]
  v_cvt_pk_bf16_f32 v80, v36, v37
  v_cvt_pk_bf16_f32 v81, v38, v39
  v_mfma_f32_16x16x32_bf16 v[8:11], a[128:131], v[160:163], v[200:203]
  v_exp_f32 v52, v52
  v_mfma_f32_16x16x32_bf16 v[8:11], a[132:135], v[164:167], v[8:11]
  ds_read_b128 a[168:171], v210 offset:34816
  ds_read_b128 a[172:175], v211 offset:34816
  v_mfma_f32_16x16x32_bf16 v[8:11], a[136:139], v[168:171], v[8:11]
  buffer_load_dwordx4 v220, s[24:27], s46 offen offset:1024  lds
  v_mfma_f32_16x16x32_bf16 v[8:11], a[140:143], v[172:175], v[8:11]
  v_exp_f32 v53, v53
  v_mfma_f32_16x16x32_bf16 v[12:15], a[140:143], v[188:191], v[204:207]
  v_cvt_pk_bf16_f32 v92, v40, v41
  v_cvt_pk_bf16_f32 v93, v42, v43
  v_mfma_f32_16x16x32_bf16 v[12:15], a[136:139], v[184:187], v[12:15]
  v_exp_f32 v54, v54
  v_mfma_f32_16x16x32_bf16 v[12:15], a[132:135], v[180:183], v[12:15]
  v_exp_f32 v55, v55
  v_mfma_f32_16x16x32_bf16 v[12:15], a[128:131], v[176:179], v[12:15]
  v_cvt_pk_bf16_f32 v104, v44, v45
  v_cvt_pk_bf16_f32 v105, v46, v47
  v_mfma_f32_16x16x32_bf16 v[28:31], a[144:147], v[176:179], v[204:207]
  v_exp_f32 v56, v56
  v_mfma_f32_16x16x32_bf16 v[28:31], a[148:151], v[180:183], v[28:31]
  ds_read_b128 a[176:179], v208 offset:35840
  ds_read_b128 a[180:183], v209 offset:35840
  v_mfma_f32_16x16x32_bf16 v[28:31], a[152:155], v[184:187], v[28:31]
  v_mfma_f32_16x16x32_bf16 v[28:31], a[156:159], v[188:191], v[28:31]
  v_exp_f32 v57, v57
  v_mfma_f32_16x16x32_bf16 v[24:27], a[156:159], v[172:175], v[200:203]
  v_cvt_pk_bf16_f32 v70, v48, v49
  v_cvt_pk_bf16_f32 v71, v50, v51
  v_mfma_f32_16x16x32_bf16 v[24:27], a[152:155], v[168:171], v[24:27]
  v_exp_f32 v58, v58
  v_mfma_f32_16x16x32_bf16 v[24:27], a[148:151], v[164:167], v[24:27]
  v_exp_f32 v59, v59
  v_mfma_f32_16x16x32_bf16 v[24:27], a[144:147], v[160:163], v[24:27]
  v_cvt_pk_bf16_f32 v82, v52, v53
  v_cvt_pk_bf16_f32 v83, v54, v55
  v_mfma_f32_16x16x32_bf16 v[20:23], a[144:147], v[144:147], v[196:199]
  v_exp_f32 v60, v60
  v_mfma_f32_16x16x32_bf16 v[20:23], a[148:151], v[148:151], v[20:23]
  ds_read_b128 a[184:187], v210 offset:35840
  ds_read_b128 a[188:191], v211 offset:35840
  v_mfma_f32_16x16x32_bf16 v[20:23], a[152:155], v[152:155], v[20:23]
  v_mfma_f32_16x16x32_bf16 v[20:23], a[156:159], v[156:159], v[20:23]
  v_exp_f32 v61, v61
  v_mfma_f32_16x16x32_bf16 v[16:19], a[156:159], v[140:143], v[192:195]
  v_cvt_pk_bf16_f32 v94, v56, v57
  v_cvt_pk_bf16_f32 v95, v58, v59
  v_mfma_f32_16x16x32_bf16 v[16:19], a[152:155], v[136:139], v[16:19]
  v_exp_f32 v62, v62
  v_mfma_f32_16x16x32_bf16 v[16:19], a[148:151], v[132:135], v[16:19]
  v_exp_f32 v63, v63
  v_mfma_f32_16x16x32_bf16 v[16:19], a[144:147], v[128:131], v[16:19]
  s_waitcnt lgkmcnt(0)
  v_cvt_pk_bf16_f32 v106, v60, v61
  v_cvt_pk_bf16_f32 v107, v62, v63
  v_mfma_f32_16x16x32_bf16 v[32:35], a[160:163], v[128:131], v[192:195]
  v_exp_f32 v0, v0
  v_mfma_f32_16x16x32_bf16 v[32:35], a[164:167], v[132:135], v[32:35]
  ds_read_b64_tr_b16 a[192:193], v212 offset:16384
  ds_read_b64_tr_b16 a[194:195], v212 offset:17408
  v_mfma_f32_16x16x32_bf16 v[32:35], a[168:171], v[136:139], v[32:35]
  buffer_load_dwordx4 v220, s[24:27], s46 offen offset:2048  lds
  v_mfma_f32_16x16x32_bf16 v[32:35], a[172:175], v[140:143], v[32:35]
  v_exp_f32 v1, v1
  v_mfma_f32_16x16x32_bf16 v[36:39], a[172:175], v[156:159], v[196:199]
  v_cvt_pk_bf16_f32 v64, v0, v1
  v_mfma_f32_16x16x32_bf16 v[36:39], a[168:171], v[152:155], v[36:39]
  v_exp_f32 v2, v2
  v_mfma_f32_16x16x32_bf16 v[36:39], a[164:167], v[148:151], v[36:39]
  ds_read_b64_tr_b16 a[196:197], v212 offset:18432
  v_mfma_f32_16x16x32_bf16 v[36:39], a[160:163], v[144:147], v[36:39]
  v_exp_f32 v3, v3
  v_smfmac_f32_16x16x64_bf16 a[232:235], v[252:255], v[68:75], v224
  v_cvt_pk_bf16_f32 v65, v2, v3
  v_mfma_f32_16x16x32_bf16 v[40:43], a[160:163], v[160:163], v[200:203]
  v_exp_f32 v4, v4
  v_mfma_f32_16x16x32_bf16 v[40:43], a[164:167], v[164:167], v[40:43]
  ds_read_b64_tr_b16 a[198:199], v212 offset:19456
  ds_read_b64_tr_b16 a[200:201], v213 offset:16384
  v_mfma_f32_16x16x32_bf16 v[40:43], a[168:171], v[168:171], v[40:43]
  buffer_load_dwordx4 v220, s[24:27], s46 offen offset:3072  lds
  v_mfma_f32_16x16x32_bf16 v[40:43], a[172:175], v[172:175], v[40:43]
  s_add_u32 s46, s46, 16384
  v_exp_f32 v5, v5
  v_mfma_f32_16x16x32_bf16 v[44:47], a[172:175], v[188:191], v[204:207]
  v_cvt_pk_bf16_f32 v76, v4, v5
  v_mfma_f32_16x16x32_bf16 v[44:47], a[168:171], v[184:187], v[44:47]
  v_exp_f32 v6, v6
  v_mfma_f32_16x16x32_bf16 v[44:47], a[164:167], v[180:183], v[44:47]
  ds_read_b64_tr_b16 a[202:203], v213 offset:17408
  v_mfma_f32_16x16x32_bf16 v[44:47], a[160:163], v[176:179], v[44:47]
  v_exp_f32 v7, v7
  v_smfmac_f32_16x16x64_bf16 a[236:239], v[252:255], v[80:87], v224
  v_cvt_pk_bf16_f32 v77, v6, v7
  v_mfma_f32_16x16x32_bf16 v[60:63], a[176:179], v[176:179], v[204:207]
  v_exp_f32 v8, v8
  v_mfma_f32_16x16x32_bf16 v[60:63], a[180:183], v[180:183], v[60:63]
  s_add_u32 m0, s44, 65536
  ds_read_b64_tr_b16 a[204:205], v213 offset:18432
  ds_read_b64_tr_b16 a[206:207], v213 offset:19456
  v_mfma_f32_16x16x32_bf16 v[60:63], a[184:187], v[184:187], v[60:63]
  buffer_load_dwordx4 v221, s[28:31], s47 offen offset:0  lds
  v_mfma_f32_16x16x32_bf16 v[60:63], a[188:191], v[188:191], v[60:63]
  v_exp_f32 v9, v9
  v_mfma_f32_16x16x32_bf16 v[56:59], a[188:191], v[172:175], v[200:203]
  v_cvt_pk_bf16_f32 v88, v8, v9
  v_mfma_f32_16x16x32_bf16 v[56:59], a[184:187], v[168:171], v[56:59]
  v_exp_f32 v10, v10
  v_mfma_f32_16x16x32_bf16 v[56:59], a[180:183], v[164:167], v[56:59]
  ds_read_b64_tr_b16 a[208:209], v214 offset:16384
  v_mfma_f32_16x16x32_bf16 v[56:59], a[176:179], v[160:163], v[56:59]
  v_exp_f32 v11, v11
  v_smfmac_f32_16x16x64_bf16 a[240:243], v[252:255], v[92:99], v224
  v_cvt_pk_bf16_f32 v89, v10, v11
  v_mfma_f32_16x16x32_bf16 v[52:55], a[176:179], v[144:147], v[196:199]
  v_exp_f32 v12, v12
  v_mfma_f32_16x16x32_bf16 v[52:55], a[180:183], v[148:151], v[52:55]
  ds_read_b64_tr_b16 a[210:211], v214 offset:17408
  ds_read_b64_tr_b16 a[212:213], v214 offset:18432
  v_mfma_f32_16x16x32_bf16 v[52:55], a[184:187], v[152:155], v[52:55]
  buffer_load_dwordx4 v221, s[28:31], s47 offen offset:1024  lds
  v_mfma_f32_16x16x32_bf16 v[52:55], a[188:191], v[156:159], v[52:55]
  v_exp_f32 v13, v13
  v_mfma_f32_16x16x32_bf16 v[48:51], a[188:191], v[140:143], v[192:195]
  v_cvt_pk_bf16_f32 v100, v12, v13
  v_mfma_f32_16x16x32_bf16 v[48:51], a[184:187], v[136:139], v[48:51]
  v_exp_f32 v14, v14
  v_mfma_f32_16x16x32_bf16 v[48:51], a[180:183], v[132:135], v[48:51]
  ds_read_b64_tr_b16 a[214:215], v214 offset:19456
  v_mfma_f32_16x16x32_bf16 v[48:51], a[176:179], v[128:131], v[48:51]
  v_exp_f32 v15, v15
  v_smfmac_f32_16x16x64_bf16 a[244:247], v[252:255], v[104:111], v224
  s_waitcnt lgkmcnt(1)
  v_cvt_pk_bf16_f32 v101, v14, v15
  v_mfma_f32_16x16x32_bf16 a[0:3], a[192:195], v[72:75], a[0:3]
  v_exp_f32 v16, v16
  v_mfma_f32_16x16x32_bf16 a[0:3], a[196:199], v[68:71], a[0:3]
  v_exp_f32 v17, v17
  v_mfma_f32_16x16x32_bf16 a[4:7], a[196:199], v[80:83], a[4:7]
  v_cvt_pk_bf16_f32 v66, v16, v17
  v_mfma_f32_16x16x32_bf16 a[4:7], a[192:195], v[84:87], a[4:7]
  v_exp_f32 v18, v18
  v_mfma_f32_16x16x32_bf16 a[8:11], a[192:195], v[96:99], a[8:11]
  v_mfma_f32_16x16x32_bf16 a[8:11], a[196:199], v[92:95], a[8:11]
  buffer_load_dwordx4 v221, s[28:31], s47 offen offset:2048  lds
  v_mfma_f32_16x16x32_bf16 a[12:15], a[196:199], v[104:107], a[12:15]
  v_exp_f32 v19, v19
  v_mfma_f32_16x16x32_bf16 a[12:15], a[192:195], v[108:111], a[12:15]
  v_cvt_pk_bf16_f32 v67, v18, v19
  v_mfma_f32_16x16x32_bf16 a[28:31], a[200:203], v[108:111], a[28:31]
  v_exp_f32 v20, v20
  v_mfma_f32_16x16x32_bf16 a[28:31], a[204:207], v[104:107], a[28:31]
  ds_read_b64_tr_b16 a[192:193], v217 offset:16384
  ds_read_b64_tr_b16 a[194:195], v217 offset:17408
  v_mfma_f32_16x16x32_bf16 a[24:27], a[204:207], v[92:95], a[24:27]
  v_exp_f32 v21, v21
  v_mfma_f32_16x16x32_bf16 a[24:27], a[200:203], v[96:99], a[24:27]
  ds_read_b64_tr_b16 a[196:197], v217 offset:18432
  v_cvt_pk_bf16_f32 v78, v20, v21
  v_mfma_f32_16x16x32_bf16 a[20:23], a[200:203], v[84:87], a[20:23]
  v_exp_f32 v22, v22
  v_mfma_f32_16x16x32_bf16 a[20:23], a[204:207], v[80:83], a[20:23]
  ds_read_b64_tr_b16 a[198:199], v217 offset:19456
  v_mfma_f32_16x16x32_bf16 a[16:19], a[204:207], v[68:71], a[16:19]
  v_exp_f32 v23, v23
  v_mfma_f32_16x16x32_bf16 a[16:19], a[200:203], v[72:75], a[16:19]
  v_cvt_pk_bf16_f32 v79, v22, v23
  v_mfma_f32_16x16x32_bf16 a[32:35], a[208:211], v[72:75], a[32:35]
  s_waitcnt lgkmcnt(2)
  v_exp_f32 v24, v24
  v_mfma_f32_16x16x32_bf16 a[32:35], a[212:215], v[68:71], a[32:35]
  ds_read_b64_tr_b16 a[200:201], v218 offset:16384
  ds_read_b64_tr_b16 a[202:203], v218 offset:17408
  v_mfma_f32_16x16x32_bf16 a[36:39], a[212:215], v[80:83], a[36:39]
K1_st7:
  s_cbranch_execz K1_st11
  v_exp_f32 v25, v25
  v_mfma_f32_16x16x32_bf16 a[36:39], a[208:211], v[84:87], a[36:39]
  ds_read_b64_tr_b16 a[204:205], v218 offset:18432
  ds_read_b64_tr_b16 a[206:207], v218 offset:19456
  v_mfma_f32_16x16x32_bf16 a[40:43], a[208:211], v[96:99], a[40:43]
  buffer_load_dwordx4 v221, s[28:31], s47 offen offset:3072  lds
  v_mfma_f32_16x16x32_bf16 a[40:43], a[212:215], v[92:95], a[40:43]
  s_add_u32 s47, s47, 16384
  v_exp_f32 v26, v26
  v_mfma_f32_16x16x32_bf16 a[44:47], a[212:215], v[104:107], a[44:47]
  v_exp_f32 v27, v27
  v_mfma_f32_16x16x32_bf16 a[44:47], a[208:211], v[108:111], a[44:47]
  v_cvt_pk_bf16_f32 v90, v24, v25
  v_cvt_pk_bf16_f32 v91, v26, v27
  v_mfma_f32_16x16x32_bf16 a[60:63], a[216:219], v[108:111], a[60:63]
  v_exp_f32 v28, v28
  v_mfma_f32_16x16x32_bf16 a[60:63], a[220:223], v[104:107], a[60:63]
  ds_read_b64_tr_b16 a[208:209], v219 offset:16384
  ds_read_b64_tr_b16 a[210:211], v219 offset:17408
  v_mfma_f32_16x16x32_bf16 a[56:59], a[220:223], v[92:95], a[56:59]
  v_exp_f32 v29, v29
  v_mfma_f32_16x16x32_bf16 a[56:59], a[216:219], v[96:99], a[56:59]
  ds_read_b64_tr_b16 a[212:213], v219 offset:18432
  ds_read_b64_tr_b16 a[214:215], v219 offset:19456
  v_mfma_f32_16x16x32_bf16 a[52:55], a[216:219], v[84:87], a[52:55]
  v_exp_f32 v30, v30
  v_mfma_f32_16x16x32_bf16 a[52:55], a[220:223], v[80:83], a[52:55]
  v_exp_f32 v31, v31
  v_mfma_f32_16x16x32_bf16 a[48:51], a[220:223], v[68:71], a[48:51]
  v_cvt_pk_bf16_f32 v102, v28, v29
  v_cvt_pk_bf16_f32 v103, v30, v31
  v_mfma_f32_16x16x32_bf16 a[48:51], a[216:219], v[72:75], a[48:51]
  v_mfma_f32_16x16x32_bf16 a[64:67], a[224:227], v[72:75], a[64:67]
  s_waitcnt vmcnt(17) lgkmcnt(0)
  s_barrier
  v_exp_f32 v32, v32
  v_mfma_f32_16x16x32_bf16 a[64:67], a[228:231], v[68:71], a[64:67]
  ds_read_b128 a[128:131], v208 offset:49152
  v_mfma_f32_16x16x32_bf16 a[68:71], a[228:231], v[80:83], a[68:71]
  v_exp_f32 v33, v33
  v_mfma_f32_16x16x32_bf16 a[68:71], a[224:227], v[84:87], a[68:71]
  ds_read_b128 a[132:135], v209 offset:49152
  v_mfma_f32_16x16x32_bf16 a[72:75], a[224:227], v[96:99], a[72:75]
  v_exp_f32 v34, v34
  v_mfma_f32_16x16x32_bf16 a[72:75], a[228:231], v[92:95], a[72:75]
  ds_read_b128 a[136:139], v210 offset:49152
  ds_read_b128 a[140:143], v211 offset:49152
  v_mfma_f32_16x16x32_bf16 a[76:79], a[228:231], v[104:107], a[76:79]
  v_exp_f32 v35, v35
  v_mfma_f32_16x16x32_bf16 a[76:79], a[224:227], v[108:111], a[76:79]
  ds_read_b128 a[144:147], v208 offset:50176
  v_mfma_f32_16x16x32_bf16 a[92:95], a[192:195], v[108:111], a[92:95]
  v_exp_f32 v36, v36
  v_mfma_f32_16x16x32_bf16 a[92:95], a[196:199], v[104:107], a[92:95]
  ds_read_b128 a[148:151], v209 offset:50176
  v_mfma_f32_16x16x32_bf16 a[88:91], a[196:199], v[92:95], a[88:91]
  v_exp_f32 v37, v37
  v_mfma_f32_16x16x32_bf16 a[88:91], a[192:195], v[96:99], a[88:91]
  ds_read_b128 a[152:155], v210 offset:50176
  v_mfma_f32_16x16x32_bf16 a[84:87], a[192:195], v[84:87], a[84:87]
  v_exp_f32 v38, v38
  v_mfma_f32_16x16x32_bf16 a[84:87], a[196:199], v[80:83], a[84:87]
  ds_read_b128 a[156:159], v211 offset:50176
  v_mfma_f32_16x16x32_bf16 a[80:83], a[196:199], v[68:71], a[80:83]
  v_exp_f32 v39, v39
  v_mfma_f32_16x16x32_bf16 a[80:83], a[192:195], v[72:75], a[80:83]
  ds_read_b64_tr_b16 a[216:217], v215 offset:32768
  v_mfma_f32_16x16x32_bf16 a[96:99], a[200:203], v[72:75], a[96:99]
  v_exp_f32 v40, v40
  v_mfma_f32_16x16x32_bf16 a[96:99], a[204:207], v[68:71], a[96:99]
  ds_read_b64_tr_b16 a[218:219], v215 offset:33792
  ds_read_b64_tr_b16 a[220:221], v215 offset:34816
  v_mfma_f32_16x16x32_bf16 a[100:103], a[204:207], v[80:83], a[100:103]
  v_exp_f32 v41, v41
  v_mfma_f32_16x16x32_bf16 a[100:103], a[200:203], v[84:87], a[100:103]
  v_exp_f32 v42, v42
  v_mfma_f32_16x16x32_bf16 a[104:107], a[200:203], v[96:99], a[104:107]
  ds_read_b64_tr_b16 a[222:223], v215 offset:35840
  v_mfma_f32_16x16x32_bf16 a[104:107], a[204:207], v[92:95], a[104:107]
  ds_read_b64_tr_b16 a[224:225], v216 offset:32768
  v_mfma_f32_16x16x32_bf16 a[108:111], a[204:207], v[104:107], a[108:111]
  v_exp_f32 v43, v43
  v_mfma_f32_16x16x32_bf16 a[108:111], a[200:203], v[108:111], a[108:111]
  ds_read_b64_tr_b16 a[226:227], v216 offset:33792
  v_mfma_f32_16x16x32_bf16 a[124:127], a[208:211], v[108:111], a[124:127]
  v_exp_f32 v44, v44
  v_mfma_f32_16x16x32_bf16 a[124:127], a[212:215], v[104:107], a[124:127]
  ds_read_b64_tr_b16 a[228:229], v216 offset:34816
  v_mfma_f32_16x16x32_bf16 a[120:123], a[212:215], v[92:95], a[120:123]
  v_exp_f32 v45, v45
  v_mfma_f32_16x16x32_bf16 a[120:123], a[208:211], v[96:99], a[120:123]
  ds_read_b64_tr_b16 a[230:231], v216 offset:35840
  v_mfma_f32_16x16x32_bf16 a[116:119], a[208:211], v[84:87], a[116:119]
  v_exp_f32 v46, v46
  v_mfma_f32_16x16x32_bf16 a[116:119], a[212:215], v[80:83], a[116:119]
  v_exp_f32 v47, v47
  v_mfma_f32_16x16x32_bf16 a[112:115], a[212:215], v[68:71], a[112:115]
  v_mfma_f32_16x16x32_bf16 a[112:115], a[208:211], v[72:75], a[112:115]
  s_waitcnt lgkmcnt(1)
  v_mfma_f32_16x16x32_bf16 v[0:3], a[128:131], v[128:131], v[192:195]
  v_exp_f32 v48, v48
  v_mfma_f32_16x16x32_bf16 v[0:3], a[132:135], v[132:135], v[0:3]
  s_add_u32 m0, s44, 32768
  ds_read_b128 a[160:163], v208 offset:51200
  ds_read_b128 a[164:167], v209 offset:51200
  v_mfma_f32_16x16x32_bf16 v[0:3], a[136:139], v[136:139], v[0:3]
  buffer_load_dwordx4 v220, s[24:27], s46 offen offset:0  lds
  v_mfma_f32_16x16x32_bf16 v[0:3], a[140:143], v[140:143], v[0:3]
  v_exp_f32 v49, v49
  v_mfma_f32_16x16x32_bf16 v[4:7], a[140:143], v[156:159], v[196:199]
  v_cvt_pk_bf16_f32 v68, v32, v33
  v_cvt_pk_bf16_f32 v69, v34, v35
  v_mfma_f32_16x16x32_bf16 v[4:7], a[136:139], v[152:155], v[4:7]
  v_exp_f32 v50, v50
  v_mfma_f32_16x16x32_bf16 v[4:7], a[132:135], v[148:151], v[4:7]
  v_exp_f32 v51, v51
  v_mfma_f32_16x16x32_bf16 v[4:7], a[128:131], v[144:147], v[4:7]
  v_cvt_pk_bf16_f32 v80, v36, v37
  v_cvt_pk_bf16_f32 v81, v38, v39
  v_mfma_f32_16x16x32_bf16 v[8:11], a[128:131], v[160:163], v[200:203]
  v_exp_f32 v52, v52
  v_mfma_f32_16x16x32_bf16 v[8:11], a[132:135], v[164:167], v[8:11]
  ds_read_b128 a[168:171], v210 offset:51200
  ds_read_b128 a[172:175], v211 offset:51200
  v_mfma_f32_16x16x32_bf16 v[8:11], a[136:139], v[168:171], v[8:11]
  buffer_load_dwordx4 v220, s[24:27], s46 offen offset:1024  lds
  v_mfma_f32_16x16x32_bf16 v[8:11], a[140:143], v[172:175], v[8:11]
  v_exp_f32 v53, v53
  v_mfma_f32_16x16x32_bf16 v[12:15], a[140:143], v[188:191], v[204:207]
  v_cvt_pk_bf16_f32 v92, v40, v41
  v_cvt_pk_bf16_f32 v93, v42, v43
  v_mfma_f32_16x16x32_bf16 v[12:15], a[136:139], v[184:187], v[12:15]
  v_exp_f32 v54, v54
  v_mfma_f32_16x16x32_bf16 v[12:15], a[132:135], v[180:183], v[12:15]
  v_exp_f32 v55, v55
  v_mfma_f32_16x16x32_bf16 v[12:15], a[128:131], v[176:179], v[12:15]
  v_cvt_pk_bf16_f32 v104, v44, v45
  v_cvt_pk_bf16_f32 v105, v46, v47
  v_mfma_f32_16x16x32_bf16 v[28:31], a[144:147], v[176:179], v[204:207]
  v_exp_f32 v56, v56
  v_mfma_f32_16x16x32_bf16 v[28:31], a[148:151], v[180:183], v[28:31]
  ds_read_b128 a[176:179], v208 offset:52224
  ds_read_b128 a[180:183], v209 offset:52224
  v_mfma_f32_16x16x32_bf16 v[28:31], a[152:155], v[184:187], v[28:31]
  v_mfma_f32_16x16x32_bf16 v[28:31], a[156:159], v[188:191], v[28:31]
  v_exp_f32 v57, v57
  v_mfma_f32_16x16x32_bf16 v[24:27], a[156:159], v[172:175], v[200:203]
  v_cvt_pk_bf16_f32 v70, v48, v49
  v_cvt_pk_bf16_f32 v71, v50, v51
  v_mfma_f32_16x16x32_bf16 v[24:27], a[152:155], v[168:171], v[24:27]
  v_exp_f32 v58, v58
  v_mfma_f32_16x16x32_bf16 v[24:27], a[148:151], v[164:167], v[24:27]
  v_exp_f32 v59, v59
  v_mfma_f32_16x16x32_bf16 v[24:27], a[144:147], v[160:163], v[24:27]
  v_cvt_pk_bf16_f32 v82, v52, v53
  v_cvt_pk_bf16_f32 v83, v54, v55
  v_mfma_f32_16x16x32_bf16 v[20:23], a[144:147], v[144:147], v[196:199]
  v_exp_f32 v60, v60
  v_mfma_f32_16x16x32_bf16 v[20:23], a[148:151], v[148:151], v[20:23]
  ds_read_b128 a[184:187], v210 offset:52224
  ds_read_b128 a[188:191], v211 offset:52224
  v_mfma_f32_16x16x32_bf16 v[20:23], a[152:155], v[152:155], v[20:23]
  v_mfma_f32_16x16x32_bf16 v[20:23], a[156:159], v[156:159], v[20:23]
  v_exp_f32 v61, v61
  v_mfma_f32_16x16x32_bf16 v[16:19], a[156:159], v[140:143], v[192:195]
  v_cvt_pk_bf16_f32 v94, v56, v57
  v_cvt_pk_bf16_f32 v95, v58, v59
  v_mfma_f32_16x16x32_bf16 v[16:19], a[152:155], v[136:139], v[16:19]
  v_exp_f32 v62, v62
  v_mfma_f32_16x16x32_bf16 v[16:19], a[148:151], v[132:135], v[16:19]
  v_exp_f32 v63, v63
  v_mfma_f32_16x16x32_bf16 v[16:19], a[144:147], v[128:131], v[16:19]
  s_waitcnt lgkmcnt(0)
  v_cvt_pk_bf16_f32 v106, v60, v61
  v_cvt_pk_bf16_f32 v107, v62, v63
  v_mfma_f32_16x16x32_bf16 v[32:35], a[160:163], v[128:131], v[192:195]
  v_exp_f32 v0, v0
  v_mfma_f32_16x16x32_bf16 v[32:35], a[164:167], v[132:135], v[32:35]
  ds_read_b64_tr_b16 a[192:193], v212 offset:32768
  v_mfma_f32_16x16x32_bf16 v[32:35], a[168:171], v[136:139], v[32:35]
  ds_read_b64_tr_b16 a[194:195], v212 offset:33792
  v_mfma_f32_16x16x32_bf16 v[32:35], a[172:175], v[140:143], v[32:35]
  v_exp_f32 v1, v1
  v_mfma_f32_16x16x32_bf16 v[36:39], a[172:175], v[156:159], v[196:199]
  ds_read_b64_tr_b16 a[196:197], v212 offset:34816
  v_cvt_pk_bf16_f32 v72, v0, v1
  v_mfma_f32_16x16x32_bf16 v[36:39], a[168:171], v[152:155], v[36:39]
  buffer_load_dwordx4 v220, s[24:27], s46 offen offset:2048  lds
  v_mfma_f32_16x16x32_bf16 v[36:39], a[164:167], v[148:151], v[36:39]
  v_exp_f32 v2, v2
  v_mfma_f32_16x16x32_bf16 v[36:39], a[160:163], v[144:147], v[36:39]
  ds_read_b64_tr_b16 a[198:199], v212 offset:35840
  ds_read_b64_tr_b16 a[200:201], v213 offset:32768
  v_smfmac_f32_16x16x64_bf16 a[232:235], v[252:255], v[64:71], v224
  v_exp_f32 v3, v3
  v_mfma_f32_16x16x32_bf16 v[40:43], a[160:163], v[160:163], v[200:203]
  ds_read_b64_tr_b16 a[202:203], v213 offset:33792
  v_cvt_pk_bf16_f32 v73, v2, v3
  v_mfma_f32_16x16x32_bf16 v[40:43], a[164:167], v[164:167], v[40:43]
  v_exp_f32 v4, v4
  v_mfma_f32_16x16x32_bf16 v[40:43], a[168:171], v[168:171], v[40:43]
  ds_read_b64_tr_b16 a[204:205], v213 offset:34816
  ds_read_b64_tr_b16 a[206:207], v213 offset:35840
  v_mfma_f32_16x16x32_bf16 v[40:43], a[172:175], v[172:175], v[40:43]
  v_exp_f32 v5, v5
  v_mfma_f32_16x16x32_bf16 v[44:47], a[172:175], v[188:191], v[204:207]
  ds_read_b64_tr_b16 a[208:209], v214 offset:32768
  v_cvt_pk_bf16_f32 v84, v4, v5
  v_mfma_f32_16x16x32_bf16 v[44:47], a[168:171], v[184:187], v[44:47]
  buffer_load_dwordx4 v220, s[24:27], s46 offen offset:3072  lds
  v_mfma_f32_16x16x32_bf16 v[44:47], a[164:167], v[180:183], v[44:47]
  s_add_u32 s46, s46, 16384
  v_exp_f32 v6, v6
  v_mfma_f32_16x16x32_bf16 v[44:47], a[160:163], v[176:179], v[44:47]
  ds_read_b64_tr_b16 a[210:211], v214 offset:33792
  ds_read_b64_tr_b16 a[212:213], v214 offset:34816
  v_smfmac_f32_16x16x64_bf16 a[236:239], v[252:255], v[76:83], v224
  v_exp_f32 v7, v7
  v_mfma_f32_16x16x32_bf16 v[60:63], a[176:179], v[176:179], v[204:207]
  ds_read_b64_tr_b16 a[214:215], v214 offset:35840
  v_cvt_pk_bf16_f32 v85, v6, v7
  v_mfma_f32_16x16x32_bf16 v[60:63], a[180:183], v[180:183], v[60:63]
  v_exp_f32 v8, v8
  v_mfma_f32_16x16x32_bf16 v[60:63], a[184:187], v[184:187], v[60:63]
  ds_read_b64_tr_b16 a[128:129], v227 offset:0
  ds_read_b64_tr_b16 a[130:131], v227 offset:2560
  v_mfma_f32_16x16x32_bf16 v[60:63], a[188:191], v[188:191], v[60:63]
  v_exp_f32 v9, v9
  v_mfma_f32_16x16x32_bf16 v[56:59], a[188:191], v[172:175], v[200:203]
  ds_read_b64_tr_b16 a[132:133], v227 offset:8
  v_cvt_pk_bf16_f32 v96, v8, v9
  v_mfma_f32_16x16x32_bf16 v[56:59], a[184:187], v[168:171], v[56:59]
  s_add_u32 m0, s44, 81920
  ds_read_b64_tr_b16 a[134:135], v227 offset:2568
  ds_read_b64_tr_b16 a[136:137], v227 offset:16
  v_mfma_f32_16x16x32_bf16 v[56:59], a[180:183], v[164:167], v[56:59]
  buffer_load_dwordx4 v221, s[28:31], s47 offen offset:0  lds
  v_mfma_f32_16x16x32_bf16 v[56:59], a[176:179], v[160:163], v[56:59]
  v_exp_f32 v10, v10
  v_smfmac_f32_16x16x64_bf16 a[240:243], v[252:255], v[88:95], v224
  v_exp_f32 v11, v11
  v_mfma_f32_16x16x32_bf16 v[52:55], a[176:179], v[144:147], v[196:199]
  ds_read_b64_tr_b16 a[138:139], v227 offset:2576
  v_cvt_pk_bf16_f32 v97, v10, v11
  v_mfma_f32_16x16x32_bf16 v[52:55], a[180:183], v[148:151], v[52:55]
  ds_read_b64_tr_b16 a[140:141], v227 offset:24
  ds_read_b64_tr_b16 a[142:143], v227 offset:2584
  v_mfma_f32_16x16x32_bf16 v[52:55], a[184:187], v[152:155], v[52:55]
  v_exp_f32 v12, v12
  v_mfma_f32_16x16x32_bf16 v[52:55], a[188:191], v[156:159], v[52:55]
  v_exp_f32 v13, v13
  v_mfma_f32_16x16x32_bf16 v[48:51], a[188:191], v[140:143], v[192:195]
  ds_read_b64_tr_b16 a[144:145], v227 offset:32
  v_cvt_pk_bf16_f32 v108, v12, v13
  v_mfma_f32_16x16x32_bf16 v[48:51], a[184:187], v[136:139], v[48:51]
  ds_read_b64_tr_b16 a[146:147], v227 offset:2592
  v_mfma_f32_16x16x32_bf16 v[48:51], a[180:183], v[132:135], v[48:51]
  buffer_load_dwordx4 v221, s[28:31], s47 offen offset:1024  lds
  v_mfma_f32_16x16x32_bf16 v[48:51], a[176:179], v[128:131], v[48:51]
  v_exp_f32 v14, v14
  v_smfmac_f32_16x16x64_bf16 a[244:247], v[252:255], v[100:107], v224
  s_waitcnt lgkmcnt(2)
  v_exp_f32 v15, v15
  s_nop 0
  v_cvt_pk_bf16_f32 v109, v14, v15
  v_mfma_f32_16x16x32_bf16 a[0:3], a[192:195], v[64:67], a[0:3]
  v_exp_f32 v16, v16
  v_mfma_f32_16x16x32_bf16 a[0:3], a[196:199], v[68:71], a[0:3]
  buffer_load_dwordx4 v221, s[28:31], s47 offen offset:2048  lds
  v_mfma_f32_16x16x32_bf16 a[4:7], a[196:199], v[80:83], a[4:7]
  v_exp_f32 v17, v17
  v_mfma_f32_16x16x32_bf16 a[4:7], a[192:195], v[76:79], a[4:7]
  v_cvt_pk_bf16_f32 v74, v16, v17
  v_mfma_f32_16x16x32_bf16 a[8:11], a[192:195], v[88:91], a[8:11]
  v_exp_f32 v18, v18
  v_mfma_f32_16x16x32_bf16 a[8:11], a[196:199], v[92:95], a[8:11]
  buffer_load_dwordx4 v221, s[28:31], s47 offen offset:3072  lds
  v_mfma_f32_16x16x32_bf16 a[12:15], a[196:199], v[104:107], a[12:15]
  s_add_u32 s47, s47, 16384
  v_exp_f32 v19, v19
  v_mfma_f32_16x16x32_bf16 a[12:15], a[192:195], v[100:103], a[12:15]
  v_cvt_pk_bf16_f32 v75, v18, v19
  v_mfma_f32_16x16x32_bf16 a[28:31], a[200:203], v[100:103], a[28:31]
  v_exp_f32 v20, v20
  v_mfma_f32_16x16x32_bf16 a[28:31], a[204:207], v[104:107], a[28:31]
  ds_read_b64_tr_b16 a[192:193], v217 offset:32768
  ds_read_b64_tr_b16 a[194:195], v217 offset:33792
  v_mfma_f32_16x16x32_bf16 a[24:27], a[204:207], v[92:95], a[24:27]
  s_lshl_b32 s52, s70, 9
  ds_read_b64_tr_b16 a[196:197], v217 offset:34816
  ds_read_b64_tr_b16 a[198:199], v217 offset:35840
  v_mfma_f32_16x16x32_bf16 a[24:27], a[200:203], v[88:91], a[24:27]
  buffer_load_dword v225, v226, s[20:23], s52 offen sc1
  v_mfma_f32_16x16x32_bf16 a[20:23], a[200:203], v[76:79], a[20:23]
  v_exp_f32 v21, v21
  v_mfma_f32_16x16x32_bf16 a[20:23], a[204:207], v[80:83], a[20:23]
  v_cvt_pk_bf16_f32 v86, v20, v21
  v_mfma_f32_16x16x32_bf16 a[16:19], a[204:207], v[68:71], a[16:19]
  v_exp_f32 v22, v22
  v_mfma_f32_16x16x32_bf16 a[16:19], a[200:203], v[64:67], a[16:19]
  buffer_store_dwordx4 a[128:131], v223, s[76:79], s84 offen offset:0 sc1
  v_mfma_f32_16x16x32_bf16 a[32:35], a[208:211], v[64:67], a[32:35]
  v_exp_f32 v23, v23
  v_mfma_f32_16x16x32_bf16 a[32:35], a[212:215], v[68:71], a[32:35]
  ds_read_b64_tr_b16 a[200:201], v218 offset:32768
  v_cvt_pk_bf16_f32 v87, v22, v23
  v_mfma_f32_16x16x32_bf16 a[36:39], a[212:215], v[80:83], a[36:39]
  v_exp_f32 v24, v24
  v_mfma_f32_16x16x32_bf16 a[36:39], a[208:211], v[76:79], a[36:39]
  ds_read_b64_tr_b16 a[202:203], v218 offset:33792
  ds_read_b64_tr_b16 a[204:205], v218 offset:34816
  ds_read_b64_tr_b16 a[206:207], v218 offset:35840
  v_mfma_f32_16x16x32_bf16 a[40:43], a[208:211], v[88:91], a[40:43]
  buffer_store_dwordx4 a[132:135], v223, s[76:79], s84 offen offset:1024 sc1
  v_exp_f32 v25, v25
  v_mfma_f32_16x16x32_bf16 a[40:43], a[212:215], v[92:95], a[40:43]
  v_cvt_pk_bf16_f32 v98, v24, v25
  v_mfma_f32_16x16x32_bf16 a[44:47], a[212:215], v[104:107], a[44:47]
  v_exp_f32 v26, v26
  v_mfma_f32_16x16x32_bf16 a[44:47], a[208:211], v[100:103], a[44:47]
  buffer_store_dwordx4 a[136:139], v223, s[76:79], s84 offen offset:2048 sc1
  v_mfma_f32_16x16x32_bf16 a[60:63], a[216:219], v[100:103], a[60:63]
  v_exp_f32 v27, v27
  v_mfma_f32_16x16x32_bf16 a[60:63], a[220:223], v[104:107], a[60:63]
  ds_read_b64_tr_b16 a[208:209], v219 offset:32768
  v_cvt_pk_bf16_f32 v99, v26, v27
  v_mfma_f32_16x16x32_bf16 a[56:59], a[220:223], v[92:95], a[56:59]
  v_exp_f32 v28, v28
  v_mfma_f32_16x16x32_bf16 a[56:59], a[216:219], v[88:91], a[56:59]
  ds_read_b64_tr_b16 a[210:211], v219 offset:33792
  ds_read_b64_tr_b16 a[212:213], v219 offset:34816
  ds_read_b64_tr_b16 a[214:215], v219 offset:35840
  v_mfma_f32_16x16x32_bf16 a[52:55], a[216:219], v[76:79], a[52:55]
  buffer_store_dwordx4 a[140:143], v223, s[76:79], s84 offen offset:3072 sc1
  v_exp_f32 v29, v29
  v_mfma_f32_16x16x32_bf16 a[52:55], a[220:223], v[80:83], a[52:55]
  v_cvt_pk_bf16_f32 v110, v28, v29
  v_mfma_f32_16x16x32_bf16 a[48:51], a[220:223], v[68:71], a[48:51]
  s_add_u32 s84, s84, 4096
  v_exp_f32 v30, v30
  v_mfma_f32_16x16x32_bf16 a[48:51], a[216:219], v[64:67], a[48:51]
  s_waitcnt lgkmcnt(12)
  buffer_store_dwordx4 a[144:147], v223, s[76:79], s84 offen offset:0 sc1
  v_exp_f32 v31, v31
  s_nop 0
  v_cvt_pk_bf16_f32 v111, v30, v31
  s_sub_u32 s51, 10752, s43
  v_add_u32 v227, s51, v227
  v_mfma_f32_16x16x32_bf16 a[64:67], a[224:227], v[64:67], a[64:67]
  s_waitcnt vmcnt(22) lgkmcnt(0)
  s_barrier
  v_exp_f32 v32, v32
  v_mfma_f32_16x16x32_bf16 a[64:67], a[228:231], v[68:71], a[64:67]
  ds_read_b128 a[128:131], v208 offset:0
  v_mfma_f32_16x16x32_bf16 a[68:71], a[228:231], v[80:83], a[68:71]
  v_exp_f32 v33, v33
  v_mfma_f32_16x16x32_bf16 a[68:71], a[224:227], v[76:79], a[68:71]
  ds_read_b128 a[132:135], v209 offset:0
  v_mfma_f32_16x16x32_bf16 a[72:75], a[224:227], v[88:91], a[72:75]
  v_exp_f32 v34, v34
  v_mfma_f32_16x16x32_bf16 a[72:75], a[228:231], v[92:95], a[72:75]
  s_add_u32 m0, s85, s57
  ds_read_b128 a[136:139], v210 offset:0
  ds_read_b128 a[140:143], v211 offset:0
  v_mfma_f32_16x16x32_bf16 a[76:79], a[228:231], v[104:107], a[76:79]
  buffer_load_dwordx4 v228, s[16:19], s58 offen offset:0 lds
  v_mfma_f32_16x16x32_bf16 a[76:79], a[224:227], v[100:103], a[76:79]
  v_exp_f32 v35, v35
  v_mfma_f32_16x16x32_bf16 a[92:95], a[192:195], v[100:103], a[92:95]
  ds_read_b128 a[144:147], v208 offset:1024
  v_mfma_f32_16x16x32_bf16 a[92:95], a[196:199], v[104:107], a[92:95]
  v_exp_f32 v36, v36
  v_mfma_f32_16x16x32_bf16 a[88:91], a[196:199], v[92:95], a[88:91]
  ds_read_b128 a[148:151], v209 offset:1024
  ds_read_b128 a[152:155], v210 offset:1024
  v_mfma_f32_16x16x32_bf16 a[88:91], a[192:195], v[88:91], a[88:91]
  v_exp_f32 v37, v37
  v_mfma_f32_16x16x32_bf16 a[84:87], a[192:195], v[76:79], a[84:87]
  v_exp_f32 v38, v38
  v_mfma_f32_16x16x32_bf16 a[84:87], a[196:199], v[80:83], a[84:87]
  ds_read_b128 a[156:159], v211 offset:1024
  v_mfma_f32_16x16x32_bf16 a[80:83], a[196:199], v[68:71], a[80:83]
  v_exp_f32 v39, v39
  v_mfma_f32_16x16x32_bf16 a[80:83], a[192:195], v[64:67], a[80:83]
  ds_read_b64_tr_b16 a[216:217], v215 offset:49152
  v_mfma_f32_16x16x32_bf16 a[96:99], a[200:203], v[64:67], a[96:99]
  buffer_load_dwordx4 v229, s[16:19], s58 offen offset:1024 lds
  v_mfma_f32_16x16x32_bf16 a[96:99], a[204:207], v[68:71], a[96:99]
  v_exp_f32 v40, v40
  v_mfma_f32_16x16x32_bf16 a[100:103], a[204:207], v[80:83], a[100:103]
  ds_read_b64_tr_b16 a[218:219], v215 offset:50176
  ds_read_b64_tr_b16 a[220:221], v215 offset:51200
  v_mfma_f32_16x16x32_bf16 a[100:103], a[200:203], v[76:79], a[100:103]
  v_exp_f32 v41, v41
  v_mfma_f32_16x16x32_bf16 a[104:107], a[200:203], v[88:91], a[104:107]
  v_exp_f32 v42, v42
  v_mfma_f32_16x16x32_bf16 a[104:107], a[204:207], v[92:95], a[104:107]
  ds_read_b64_tr_b16 a[222:223], v215 offset:52224
  ds_read_b64_tr_b16 a[224:225], v216 offset:49152
  v_mfma_f32_16x16x32_bf16 a[108:111], a[204:207], v[104:107], a[108:111]
  v_exp_f32 v43, v43
  v_mfma_f32_16x16x32_bf16 a[108:111], a[200:203], v[100:103], a[108:111]
  ds_read_b64_tr_b16 a[226:227], v216 offset:50176
  v_mfma_f32_16x16x32_bf16 a[124:127], a[208:211], v[100:103], a[124:127]
  v_exp_f32 v44, v44
  v_mfma_f32_16x16x32_bf16 a[124:127], a[212:215], v[104:107], a[124:127]
  ds_read_b64_tr_b16 a[228:229], v216 offset:51200
  v_mfma_f32_16x16x32_bf16 a[120:123], a[212:215], v[92:95], a[120:123]
  v_exp_f32 v45, v45
  v_mfma_f32_16x16x32_bf16 a[120:123], a[208:211], v[88:91], a[120:123]
  buffer_load_dwordx4 v230, s[16:19], s58 offen offset:2048 lds
  v_mfma_f32_16x16x32_bf16 a[116:119], a[208:211], v[76:79], a[116:119]
  s_add_u32 s58, s58, 81920
  ds_read_b64_tr_b16 a[230:231], v216 offset:52224
  v_mfma_f32_16x16x32_bf16 a[116:119], a[212:215], v[80:83], a[116:119]
  v_exp_f32 v46, v46
  v_mfma_f32_16x16x32_bf16 a[112:115], a[212:215], v[68:71], a[112:115]
  v_exp_f32 v47, v47
  v_mfma_f32_16x16x32_bf16 a[112:115], a[208:211], v[64:67], a[112:115]
  s_mov_b32 s57, s56
  s_add_u32 s56, s56, 10752
  s_cmp_eq_u32 s56, 32256
  s_cselect_b32 s56, 0, s56
  s_sub_u32 s49, s56, s57
  v_add_u32 v227, s49, v227
  s_mov_b32 s54, 0x100000
  s_waitcnt vmcnt(8)
  v_mov_b32 v225, v225
K1_spinA:
  v_cmp_gt_u32 vcc, 1, v225
  s_nop 4
  s_cbranch_vccz K1_spinA_ok
  s_sleep 2
  buffer_load_dword v225, v226, s[20:23], s52 offen sc1
  s_sub_u32 s54, s54, 1
  s_cmp_lg_u32 s54, 0
  s_waitcnt vmcnt(0)
  s_cbranch_scc1 K1_spinA
K1_spinA_ok:
  s_waitcnt lgkmcnt(1)
  v_mfma_f32_16x16x32_bf16 v[0:3], a[128:131], v[128:131], v[192:195]
  v_exp_f32 v48, v48
  v_mfma_f32_16x16x32_bf16 v[0:3], a[132:135], v[132:135], v[0:3]
  ds_read_b128 a[160:163], v208 offset:2048
  ds_read_b128 a[164:167], v209 offset:2048
  v_mfma_f32_16x16x32_bf16 v[0:3], a[136:139], v[136:139], v[0:3]
  buffer_load_dwordx4 v[112:115], v223, s[8:11], s59 offen sc1
  v_mfma_f32_16x16x32_bf16 v[0:3], a[140:143], v[140:143], v[0:3]
  s_add_u32 s59, s59, 4096
  v_exp_f32 v49, v49
  v_mfma_f32_16x16x32_bf16 v[4:7], a[140:143], v[156:159], v[196:199]
  v_cvt_pk_bf16_f32 v68, v32, v33
  v_cvt_pk_bf16_f32 v69, v34, v35
  v_mfma_f32_16x16x32_bf16 v[4:7], a[136:139], v[152:155], v[4:7]
  v_exp_f32 v50, v50
  v_mfma_f32_16x16x32_bf16 v[4:7], a[132:135], v[148:151], v[4:7]
  v_exp_f32 v51, v51
  v_mfma_f32_16x16x32_bf16 v[4:7], a[128:131], v[144:147], v[4:7]
  v_cvt_pk_bf16_f32 v80, v36, v37
  v_cvt_pk_bf16_f32 v81, v38, v39
  v_mfma_f32_16x16x32_bf16 v[8:11], a[128:131], v[160:163], v[200:203]
  v_exp_f32 v52, v52
  v_mfma_f32_16x16x32_bf16 v[8:11], a[132:135], v[164:167], v[8:11]
  ds_read_b128 a[168:171], v210 offset:2048
  ds_read_b128 a[172:175], v211 offset:2048
  v_mfma_f32_16x16x32_bf16 v[8:11], a[136:139], v[168:171], v[8:11]
  buffer_load_dwordx4 v[116:119], v223, s[8:11], s59 offen sc1
  v_mfma_f32_16x16x32_bf16 v[8:11], a[140:143], v[172:175], v[8:11]
  s_add_u32 s59, s59, 4096
  v_exp_f32 v53, v53
  v_mfma_f32_16x16x32_bf16 v[12:15], a[140:143], v[188:191], v[204:207]
  v_cvt_pk_bf16_f32 v92, v40, v41
  v_cvt_pk_bf16_f32 v93, v42, v43
  v_mfma_f32_16x16x32_bf16 v[12:15], a[136:139], v[184:187], v[12:15]
  v_exp_f32 v54, v54
  v_mfma_f32_16x16x32_bf16 v[12:15], a[132:135], v[180:183], v[12:15]
  v_exp_f32 v55, v55
  v_mfma_f32_16x16x32_bf16 v[12:15], a[128:131], v[176:179], v[12:15]
  v_cvt_pk_bf16_f32 v104, v44, v45
  v_cvt_pk_bf16_f32 v105, v46, v47
  v_mfma_f32_16x16x32_bf16 v[28:31], a[144:147], v[176:179], v[204:207]
  v_exp_f32 v56, v56
  v_mfma_f32_16x16x32_bf16 v[28:31], a[148:151], v[180:183], v[28:31]
  s_add_u32 m0, s44, 49152
  ds_read_b128 a[176:179], v208 offset:3072
  ds_read_b128 a[180:183], v209 offset:3072
  v_mfma_f32_16x16x32_bf16 v[28:31], a[152:155], v[184:187], v[28:31]
  buffer_load_dwordx4 v220, s[24:27], s46 offen offset:0  lds
  v_mfma_f32_16x16x32_bf16 v[28:31], a[156:159], v[188:191], v[28:31]
  v_exp_f32 v57, v57
  v_mfma_f32_16x16x32_bf16 v[24:27], a[156:159], v[172:175], v[200:203]
  v_cvt_pk_bf16_f32 v70, v48, v49
  v_cvt_pk_bf16_f32 v71, v50, v51
  v_mfma_f32_16x16x32_bf16 v[24:27], a[152:155], v[168:171], v[24:27]
  v_exp_f32 v58, v58
  v_mfma_f32_16x16x32_bf16 v[24:27], a[148:151], v[164:167], v[24:27]
  v_exp_f32 v59, v59
  v_mfma_f32_16x16x32_bf16 v[24:27], a[144:147], v[160:163], v[24:27]
  v_cvt_pk_bf16_f32 v82, v52, v53
  v_cvt_pk_bf16_f32 v83, v54, v55
  v_mfma_f32_16x16x32_bf16 v[20:23], a[144:147], v[144:147], v[196:199]
  v_exp_f32 v60, v60
  v_mfma_f32_16x16x32_bf16 v[20:23], a[148:151], v[148:151], v[20:23]
  ds_read_b128 a[184:187], v210 offset:3072
  ds_read_b128 a[188:191], v211 offset:3072
  v_mfma_f32_16x16x32_bf16 v[20:23], a[152:155], v[152:155], v[20:23]
  buffer_load_dwordx4 v220, s[24:27], s46 offen offset:1024  lds
  v_mfma_f32_16x16x32_bf16 v[20:23], a[156:159], v[156:159], v[20:23]
  v_exp_f32 v61, v61
  v_mfma_f32_16x16x32_bf16 v[16:19], a[156:159], v[140:143], v[192:195]
  v_cvt_pk_bf16_f32 v94, v56, v57
  v_cvt_pk_bf16_f32 v95, v58, v59
  v_mfma_f32_16x16x32_bf16 v[16:19], a[152:155], v[136:139], v[16:19]
  v_exp_f32 v62, v62
  v_mfma_f32_16x16x32_bf16 v[16:19], a[148:151], v[132:135], v[16:19]
  v_exp_f32 v63, v63
  v_mfma_f32_16x16x32_bf16 v[16:19], a[144:147], v[128:131], v[16:19]
  s_waitcnt lgkmcnt(0)
  v_cvt_pk_bf16_f32 v106, v60, v61
  v_cvt_pk_bf16_f32 v107, v62, v63
  v_mfma_f32_16x16x32_bf16 v[32:35], a[160:163], v[128:131], v[192:195]
  v_exp_f32 v0, v0
  v_mfma_f32_16x16x32_bf16 v[32:35], a[164:167], v[132:135], v[32:35]
  ds_read_b64_tr_b16 a[192:193], v212 offset:49152
  ds_read_b64_tr_b16 a[194:195], v212 offset:50176
  v_mfma_f32_16x16x32_bf16 v[32:35], a[168:171], v[136:139], v[32:35]
  buffer_load_dwordx4 v220, s[24:27], s46 offen offset:2048  lds
  v_mfma_f32_16x16x32_bf16 v[32:35], a[172:175], v[140:143], v[32:35]
  v_exp_f32 v1, v1
  v_mfma_f32_16x16x32_bf16 v[36:39], a[172:175], v[156:159], v[196:199]
  v_cvt_pk_bf16_f32 v64, v0, v1
  v_mfma_f32_16x16x32_bf16 v[36:39], a[168:171], v[152:155], v[36:39]
  v_exp_f32 v2, v2
  v_mfma_f32_16x16x32_bf16 v[36:39], a[164:167], v[148:151], v[36:39]
  ds_read_b64_tr_b16 a[196:197], v212 offset:51200
  v_mfma_f32_16x16x32_bf16 v[36:39], a[160:163], v[144:147], v[36:39]
  v_exp_f32 v3, v3
  v_smfmac_f32_16x16x64_bf16 a[232:235], v[252:255], v[68:75], v224
  v_cvt_pk_bf16_f32 v65, v2, v3
  v_mfma_f32_16x16x32_bf16 v[40:43], a[160:163], v[160:163], v[200:203]
  v_exp_f32 v4, v4
  v_mfma_f32_16x16x32_bf16 v[40:43], a[164:167], v[164:167], v[40:43]
  ds_read_b64_tr_b16 a[198:199], v212 offset:52224
  ds_read_b64_tr_b16 a[200:201], v213 offset:49152
  v_mfma_f32_16x16x32_bf16 v[40:43], a[168:171], v[168:171], v[40:43]
  buffer_load_dwordx4 v220, s[24:27], s46 offen offset:3072  lds
  v_mfma_f32_16x16x32_bf16 v[40:43], a[172:175], v[172:175], v[40:43]
  s_add_u32 s46, s46, 16384
  v_exp_f32 v5, v5
  v_mfma_f32_16x16x32_bf16 v[44:47], a[172:175], v[188:191], v[204:207]
  v_cvt_pk_bf16_f32 v76, v4, v5
  v_mfma_f32_16x16x32_bf16 v[44:47], a[168:171], v[184:187], v[44:47]
  v_exp_f32 v6, v6
  v_mfma_f32_16x16x32_bf16 v[44:47], a[164:167], v[180:183], v[44:47]
  ds_read_b64_tr_b16 a[202:203], v213 offset:50176
  v_mfma_f32_16x16x32_bf16 v[44:47], a[160:163], v[176:179], v[44:47]
  v_exp_f32 v7, v7
  v_smfmac_f32_16x16x64_bf16 a[236:239], v[252:255], v[80:87], v224
  v_cvt_pk_bf16_f32 v77, v6, v7
  v_mfma_f32_16x16x32_bf16 v[60:63], a[176:179], v[176:179], v[204:207]
  v_exp_f32 v8, v8
  v_mfma_f32_16x16x32_bf16 v[60:63], a[180:183], v[180:183], v[60:63]
  s_add_u32 m0, s44, 98304
  ds_read_b64_tr_b16 a[204:205], v213 offset:51200
  ds_read_b64_tr_b16 a[206:207], v213 offset:52224
  v_mfma_f32_16x16x32_bf16 v[60:63], a[184:187], v[184:187], v[60:63]
  buffer_load_dwordx4 v221, s[28:31], s47 offen offset:0  lds
  v_mfma_f32_16x16x32_bf16 v[60:63], a[188:191], v[188:191], v[60:63]
  v_exp_f32 v9, v9
  v_mfma_f32_16x16x32_bf16 v[56:59], a[188:191], v[172:175], v[200:203]
  v_cvt_pk_bf16_f32 v88, v8, v9
  v_mfma_f32_16x16x32_bf16 v[56:59], a[184:187], v[168:171], v[56:59]
  v_exp_f32 v10, v10
  v_mfma_f32_16x16x32_bf16 v[56:59], a[180:183], v[164:167], v[56:59]
  ds_read_b64_tr_b16 a[208:209], v214 offset:49152
  v_mfma_f32_16x16x32_bf16 v[56:59], a[176:179], v[160:163], v[56:59]
  v_exp_f32 v11, v11
  v_smfmac_f32_16x16x64_bf16 a[240:243], v[252:255], v[92:99], v224
  v_cvt_pk_bf16_f32 v89, v10, v11
  v_mfma_f32_16x16x32_bf16 v[52:55], a[176:179], v[144:147], v[196:199]
  v_exp_f32 v12, v12
  v_mfma_f32_16x16x32_bf16 v[52:55], a[180:183], v[148:151], v[52:55]
  ds_read_b64_tr_b16 a[210:211], v214 offset:50176
  ds_read_b64_tr_b16 a[212:213], v214 offset:51200
  v_mfma_f32_16x16x32_bf16 v[52:55], a[184:187], v[152:155], v[52:55]
  buffer_load_dwordx4 v221, s[28:31], s47 offen offset:1024  lds
  v_mfma_f32_16x16x32_bf16 v[52:55], a[188:191], v[156:159], v[52:55]
K1_st8:
  s_cbranch_execz K1_st12
  v_exp_f32 v13, v13
  v_mfma_f32_16x16x32_bf16 v[48:51], a[188:191], v[140:143], v[192:195]
  v_cvt_pk_bf16_f32 v100, v12, v13
  v_mfma_f32_16x16x32_bf16 v[48:51], a[184:187], v[136:139], v[48:51]
  v_exp_f32 v14, v14
  v_mfma_f32_16x16x32_bf16 v[48:51], a[180:183], v[132:135], v[48:51]
  ds_read_b64_tr_b16 a[214:215], v214 offset:52224
  v_mfma_f32_16x16x32_bf16 v[48:51], a[176:179], v[128:131], v[48:51]
  v_exp_f32 v15, v15
  v_smfmac_f32_16x16x64_bf16 a[244:247], v[252:255], v[104:111], v224
  s_waitcnt lgkmcnt(1)
  v_cvt_pk_bf16_f32 v101, v14, v15
  v_mfma_f32_16x16x32_bf16 a[0:3], a[192:195], v[72:75], a[0:3]
  v_exp_f32 v16, v16
  v_mfma_f32_16x16x32_bf16 a[0:3], a[196:199], v[68:71], a[0:3]
  v_exp_f32 v17, v17
  v_mfma_f32_16x16x32_bf16 a[4:7], a[196:199], v[80:83], a[4:7]
  v_cvt_pk_bf16_f32 v66, v16, v17
  v_mfma_f32_16x16x32_bf16 a[4:7], a[192:195], v[84:87], a[4:7]
  v_exp_f32 v18, v18
  v_mfma_f32_16x16x32_bf16 a[8:11], a[192:195], v[96:99], a[8:11]
  v_mfma_f32_16x16x32_bf16 a[8:11], a[196:199], v[92:95], a[8:11]
  buffer_load_dwordx4 v221, s[28:31], s47 offen offset:2048  lds
  v_mfma_f32_16x16x32_bf16 a[12:15], a[196:199], v[104:107], a[12:15]
  v_exp_f32 v19, v19
  v_mfma_f32_16x16x32_bf16 a[12:15], a[192:195], v[108:111], a[12:15]
  v_cvt_pk_bf16_f32 v67, v18, v19
  v_mfma_f32_16x16x32_bf16 a[28:31], a[200:203], v[108:111], a[28:31]
  v_exp_f32 v20, v20
  v_mfma_f32_16x16x32_bf16 a[28:31], a[204:207], v[104:107], a[28:31]
  ds_read_b64_tr_b16 a[192:193], v217 offset:49152
  ds_read_b64_tr_b16 a[194:195], v217 offset:50176
  v_mfma_f32_16x16x32_bf16 a[24:27], a[204:207], v[92:95], a[24:27]
  v_exp_f32 v21, v21
  v_mfma_f32_16x16x32_bf16 a[24:27], a[200:203], v[96:99], a[24:27]
  ds_read_b64_tr_b16 a[196:197], v217 offset:51200
  v_cvt_pk_bf16_f32 v78, v20, v21
  v_mfma_f32_16x16x32_bf16 a[20:23], a[200:203], v[84:87], a[20:23]
  v_exp_f32 v22, v22
  v_mfma_f32_16x16x32_bf16 a[20:23], a[204:207], v[80:83], a[20:23]
  ds_read_b64_tr_b16 a[198:199], v217 offset:52224
  v_mfma_f32_16x16x32_bf16 a[16:19], a[204:207], v[68:71], a[16:19]
  v_exp_f32 v23, v23
  v_mfma_f32_16x16x32_bf16 a[16:19], a[200:203], v[72:75], a[16:19]
  v_cvt_pk_bf16_f32 v79, v22, v23
  v_mfma_f32_16x16x32_bf16 a[32:35], a[208:211], v[72:75], a[32:35]
  s_waitcnt lgkmcnt(2)
  v_exp_f32 v24, v24
  v_mfma_f32_16x16x32_bf16 a[32:35], a[212:215], v[68:71], a[32:35]
  ds_read_b64_tr_b16 a[200:201], v218 offset:49152
  ds_read_b64_tr_b16 a[202:203], v218 offset:50176
  v_mfma_f32_16x16x32_bf16 a[36:39], a[212:215], v[80:83], a[36:39]
  v_exp_f32 v25, v25
  v_mfma_f32_16x16x32_bf16 a[36:39], a[208:211], v[84:87], a[36:39]
  ds_read_b64_tr_b16 a[204:205], v218 offset:51200
  ds_read_b64_tr_b16 a[206:207], v218 offset:52224
  v_mfma_f32_16x16x32_bf16 a[40:43], a[208:211], v[96:99], a[40:43]
  buffer_load_dwordx4 v221, s[28:31], s47 offen offset:3072  lds
  v_mfma_f32_16x16x32_bf16 a[40:43], a[212:215], v[92:95], a[40:43]
  s_add_u32 s47, s47, 16384
  v_exp_f32 v26, v26
  v_mfma_f32_16x16x32_bf16 a[44:47], a[212:215], v[104:107], a[44:47]
  v_exp_f32 v27, v27
  v_mfma_f32_16x16x32_bf16 a[44:47], a[208:211], v[108:111], a[44:47]
  v_cvt_pk_bf16_f32 v90, v24, v25
  v_cvt_pk_bf16_f32 v91, v26, v27
  v_mfma_f32_16x16x32_bf16 a[60:63], a[216:219], v[108:111], a[60:63]
  v_exp_f32 v28, v28
  v_mfma_f32_16x16x32_bf16 a[60:63], a[220:223], v[104:107], a[60:63]
  ds_read_b64_tr_b16 a[208:209], v219 offset:49152
  ds_read_b64_tr_b16 a[210:211], v219 offset:50176
  v_mfma_f32_16x16x32_bf16 a[56:59], a[220:223], v[92:95], a[56:59]
  v_exp_f32 v29, v29
  v_mfma_f32_16x16x32_bf16 a[56:59], a[216:219], v[96:99], a[56:59]
  ds_read_b64_tr_b16 a[212:213], v219 offset:51200
  ds_read_b64_tr_b16 a[214:215], v219 offset:52224
  v_mfma_f32_16x16x32_bf16 a[52:55], a[216:219], v[84:87], a[52:55]
  v_exp_f32 v30, v30
  v_mfma_f32_16x16x32_bf16 a[52:55], a[220:223], v[80:83], a[52:55]
  v_exp_f32 v31, v31
  v_mfma_f32_16x16x32_bf16 a[48:51], a[220:223], v[68:71], a[48:51]
  v_cvt_pk_bf16_f32 v102, v28, v29
  v_cvt_pk_bf16_f32 v103, v30, v31
  v_mfma_f32_16x16x32_bf16 a[48:51], a[216:219], v[72:75], a[48:51]
  v_and_b32 v226, 31, v222
  v_lshlrev_b32 v226, 2, v226
  v_mfma_f32_16x16x32_bf16 a[64:67], a[224:227], v[72:75], a[64:67]
  s_waitcnt vmcnt(18) lgkmcnt(0)
  s_barrier
  v_exp_f32 v32, v32
  v_mfma_f32_16x16x32_bf16 a[64:67], a[228:231], v[68:71], a[64:67]
  ds_read_b128 a[128:131], v208 offset:16384
  v_mfma_f32_16x16x32_bf16 a[68:71], a[228:231], v[80:83], a[68:71]
  v_exp_f32 v33, v33
  v_mfma_f32_16x16x32_bf16 a[68:71], a[224:227], v[84:87], a[68:71]
  ds_read_b128 a[132:135], v209 offset:16384
  v_mfma_f32_16x16x32_bf16 a[72:75], a[224:227], v[96:99], a[72:75]
  v_exp_f32 v34, v34
  v_mfma_f32_16x16x32_bf16 a[72:75], a[228:231], v[92:95], a[72:75]
  s_add_u32 m0, s85, s57
  ds_read_b128 a[136:139], v210 offset:16384
  ds_read_b128 a[140:143], v211 offset:16384
  v_mfma_f32_16x16x32_bf16 a[76:79], a[228:231], v[104:107], a[76:79]
  buffer_load_dwordx4 v228, s[16:19], s58 offen offset:0 lds
  v_mfma_f32_16x16x32_bf16 a[76:79], a[224:227], v[108:111], a[76:79]
  v_exp_f32 v35, v35
  v_mfma_f32_16x16x32_bf16 a[92:95], a[192:195], v[108:111], a[92:95]
  ds_read_b128 a[144:147], v208 offset:17408
  v_mfma_f32_16x16x32_bf16 a[92:95], a[196:199], v[104:107], a[92:95]
  v_exp_f32 v36, v36
  v_mfma_f32_16x16x32_bf16 a[88:91], a[196:199], v[92:95], a[88:91]
  ds_read_b128 a[148:151], v209 offset:17408
  ds_read_b128 a[152:155], v210 offset:17408
  v_mfma_f32_16x16x32_bf16 a[88:91], a[192:195], v[96:99], a[88:91]
  v_exp_f32 v37, v37
  v_mfma_f32_16x16x32_bf16 a[84:87], a[192:195], v[84:87], a[84:87]
  v_exp_f32 v38, v38
  v_mfma_f32_16x16x32_bf16 a[84:87], a[196:199], v[80:83], a[84:87]
  ds_read_b128 a[156:159], v211 offset:17408
  v_mfma_f32_16x16x32_bf16 a[80:83], a[196:199], v[68:71], a[80:83]
  v_exp_f32 v39, v39
  v_mfma_f32_16x16x32_bf16 a[80:83], a[192:195], v[72:75], a[80:83]
  ds_read_b64_tr_b16 a[216:217], v215 offset:0
  v_mfma_f32_16x16x32_bf16 a[96:99], a[200:203], v[72:75], a[96:99]
  buffer_load_dwordx4 v229, s[16:19], s58 offen offset:1024 lds
  v_mfma_f32_16x16x32_bf16 a[96:99], a[204:207], v[68:71], a[96:99]
  v_exp_f32 v40, v40
  v_mfma_f32_16x16x32_bf16 a[100:103], a[204:207], v[80:83], a[100:103]
  ds_read_b64_tr_b16 a[218:219], v215 offset:1024
  ds_read_b64_tr_b16 a[220:221], v215 offset:2048
  v_mfma_f32_16x16x32_bf16 a[100:103], a[200:203], v[84:87], a[100:103]
  v_exp_f32 v41, v41
  v_mfma_f32_16x16x32_bf16 a[104:107], a[200:203], v[96:99], a[104:107]
  v_exp_f32 v42, v42
  v_mfma_f32_16x16x32_bf16 a[104:107], a[204:207], v[92:95], a[104:107]
  ds_read_b64_tr_b16 a[222:223], v215 offset:3072
  ds_read_b64_tr_b16 a[224:225], v216 offset:0
  v_mfma_f32_16x16x32_bf16 a[108:111], a[204:207], v[104:107], a[108:111]
  v_exp_f32 v43, v43
  v_mfma_f32_16x16x32_bf16 a[108:111], a[200:203], v[108:111], a[108:111]
  ds_read_b64_tr_b16 a[226:227], v216 offset:1024
  v_mfma_f32_16x16x32_bf16 a[124:127], a[208:211], v[108:111], a[124:127]
  v_exp_f32 v44, v44
  v_mfma_f32_16x16x32_bf16 a[124:127], a[212:215], v[104:107], a[124:127]
  ds_read_b64_tr_b16 a[228:229], v216 offset:2048
  v_mfma_f32_16x16x32_bf16 a[120:123], a[212:215], v[92:95], a[120:123]
  v_exp_f32 v45, v45
  v_mfma_f32_16x16x32_bf16 a[120:123], a[208:211], v[96:99], a[120:123]
  buffer_load_dwordx4 v230, s[16:19], s58 offen offset:2048 lds
  v_mfma_f32_16x16x32_bf16 a[116:119], a[208:211], v[84:87], a[116:119]
  s_add_u32 s58, s58, 81920
  ds_read_b64_tr_b16 a[230:231], v216 offset:3072
  v_mfma_f32_16x16x32_bf16 a[116:119], a[212:215], v[80:83], a[116:119]
  v_exp_f32 v46, v46
  v_mfma_f32_16x16x32_bf16 a[112:115], a[212:215], v[68:71], a[112:115]
  v_exp_f32 v47, v47
  v_mfma_f32_16x16x32_bf16 a[112:115], a[208:211], v[72:75], a[112:115]
  s_waitcnt lgkmcnt(1)
  s_mov_b32 s57, s56
  s_add_u32 s56, s56, 10752
  s_cmp_eq_u32 s56, 32256
  s_cselect_b32 s56, 0, s56
  s_sub_u32 s49, s56, s57
  v_add_u32 v227, s49, v227
  s_waitcnt vmcnt(16)
  v_mov_b32 v225, 1
  s_mov_b64 exec, 1
  buffer_store_dword v225, v223, s[20:23], s97 offen sc1
  s_mov_b64 exec, -1
  v_mfma_f32_16x16x32_bf16 v[0:3], a[128:131], v[128:131], v[192:195]
  v_exp_f32 v48, v48
  v_mfma_f32_16x16x32_bf16 v[0:3], a[132:135], v[132:135], v[0:3]
  ds_read_b128 a[160:163], v208 offset:18432
  ds_read_b128 a[164:167], v209 offset:18432
  v_mfma_f32_16x16x32_bf16 v[0:3], a[136:139], v[136:139], v[0:3]
  buffer_load_dwordx4 v[120:123], v223, s[8:11], s59 offen sc1
  v_mfma_f32_16x16x32_bf16 v[0:3], a[140:143], v[140:143], v[0:3]
  s_add_u32 s59, s59, 4096
  v_exp_f32 v49, v49
  v_mfma_f32_16x16x32_bf16 v[4:7], a[140:143], v[156:159], v[196:199]
  v_cvt_pk_bf16_f32 v68, v32, v33
  v_cvt_pk_bf16_f32 v69, v34, v35
  v_mfma_f32_16x16x32_bf16 v[4:7], a[136:139], v[152:155], v[4:7]
  v_exp_f32 v50, v50
  v_mfma_f32_16x16x32_bf16 v[4:7], a[132:135], v[148:151], v[4:7]
  v_exp_f32 v51, v51
  v_mfma_f32_16x16x32_bf16 v[4:7], a[128:131], v[144:147], v[4:7]
  v_cvt_pk_bf16_f32 v80, v36, v37
  v_cvt_pk_bf16_f32 v81, v38, v39
  v_mfma_f32_16x16x32_bf16 v[8:11], a[128:131], v[160:163], v[200:203]
  v_exp_f32 v52, v52
  v_mfma_f32_16x16x32_bf16 v[8:11], a[132:135], v[164:167], v[8:11]
  ds_read_b128 a[168:171], v210 offset:18432
  ds_read_b128 a[172:175], v211 offset:18432
  v_mfma_f32_16x16x32_bf16 v[8:11], a[136:139], v[168:171], v[8:11]
  buffer_load_dwordx4 v[124:127], v223, s[8:11], s59 offen sc1
  v_mfma_f32_16x16x32_bf16 v[8:11], a[140:143], v[172:175], v[8:11]
  s_add_u32 s59, s59, 4096
  v_exp_f32 v53, v53
  v_mfma_f32_16x16x32_bf16 v[12:15], a[140:143], v[188:191], v[204:207]
  v_cvt_pk_bf16_f32 v92, v40, v41
  v_cvt_pk_bf16_f32 v93, v42, v43
  v_mfma_f32_16x16x32_bf16 v[12:15], a[136:139], v[184:187], v[12:15]
  v_exp_f32 v54, v54
  v_mfma_f32_16x16x32_bf16 v[12:15], a[132:135], v[180:183], v[12:15]
  v_exp_f32 v55, v55
  v_mfma_f32_16x16x32_bf16 v[12:15], a[128:131], v[176:179], v[12:15]
  v_cvt_pk_bf16_f32 v104, v44, v45
  v_cvt_pk_bf16_f32 v105, v46, v47
  v_mfma_f32_16x16x32_bf16 v[28:31], a[144:147], v[176:179], v[204:207]
  v_exp_f32 v56, v56
  v_mfma_f32_16x16x32_bf16 v[28:31], a[148:151], v[180:183], v[28:31]
  s_add_u32 m0, s44, 0
  ds_read_b128 a[176:179], v208 offset:19456
  ds_read_b128 a[180:183], v209 offset:19456
  v_mfma_f32_16x16x32_bf16 v[28:31], a[152:155], v[184:187], v[28:31]
  buffer_load_dwordx4 v220, s[24:27], s46 offen offset:0  lds
  v_mfma_f32_16x16x32_bf16 v[28:31], a[156:159], v[188:191], v[28:31]
  v_exp_f32 v57, v57
  v_mfma_f32_16x16x32_bf16 v[24:27], a[156:159], v[172:175], v[200:203]
  v_cvt_pk_bf16_f32 v70, v48, v49
  v_cvt_pk_bf16_f32 v71, v50, v51
  v_mfma_f32_16x16x32_bf16 v[24:27], a[152:155], v[168:171], v[24:27]
  v_exp_f32 v58, v58
  v_mfma_f32_16x16x32_bf16 v[24:27], a[148:151], v[164:167], v[24:27]
  v_exp_f32 v59, v59
  v_mfma_f32_16x16x32_bf16 v[24:27], a[144:147], v[160:163], v[24:27]
  v_cvt_pk_bf16_f32 v82, v52, v53
  v_cvt_pk_bf16_f32 v83, v54, v55
  v_mfma_f32_16x16x32_bf16 v[20:23], a[144:147], v[144:147], v[196:199]
  v_exp_f32 v60, v60
  v_mfma_f32_16x16x32_bf16 v[20:23], a[148:151], v[148:151], v[20:23]
  ds_read_b128 a[184:187], v210 offset:19456
  ds_read_b128 a[188:191], v211 offset:19456
  v_mfma_f32_16x16x32_bf16 v[20:23], a[152:155], v[152:155], v[20:23]
  buffer_load_dwordx4 v220, s[24:27], s46 offen offset:1024  lds
  v_mfma_f32_16x16x32_bf16 v[20:23], a[156:159], v[156:159], v[20:23]
  v_exp_f32 v61, v61
  v_mfma_f32_16x16x32_bf16 v[16:19], a[156:159], v[140:143], v[192:195]
  v_cvt_pk_bf16_f32 v94, v56, v57
  v_cvt_pk_bf16_f32 v95, v58, v59
  v_mfma_f32_16x16x32_bf16 v[16:19], a[152:155], v[136:139], v[16:19]
  v_exp_f32 v62, v62
  v_mfma_f32_16x16x32_bf16 v[16:19], a[148:151], v[132:135], v[16:19]
  v_exp_f32 v63, v63
  v_mfma_f32_16x16x32_bf16 v[16:19], a[144:147], v[128:131], v[16:19]
  s_waitcnt lgkmcnt(0)
  v_cvt_pk_bf16_f32 v106, v60, v61
  v_cvt_pk_bf16_f32 v107, v62, v63
  v_mfma_f32_16x16x32_bf16 v[32:35], a[160:163], v[128:131], v[192:195]
  v_exp_f32 v0, v0
  v_mfma_f32_16x16x32_bf16 v[32:35], a[164:167], v[132:135], v[32:35]
  ds_read_b64_tr_b16 a[192:193], v212 offset:0
  ds_read_b64_tr_b16 a[194:195], v212 offset:1024
  v_mfma_f32_16x16x32_bf16 v[32:35], a[168:171], v[136:139], v[32:35]
  buffer_load_dwordx4 v220, s[24:27], s46 offen offset:2048  lds
  v_mfma_f32_16x16x32_bf16 v[32:35], a[172:175], v[140:143], v[32:35]
  v_exp_f32 v1, v1
  v_mfma_f32_16x16x32_bf16 v[36:39], a[172:175], v[156:159], v[196:199]
  v_cvt_pk_bf16_f32 v72, v0, v1
  v_mfma_f32_16x16x32_bf16 v[36:39], a[168:171], v[152:155], v[36:39]
  v_exp_f32 v2, v2
  v_mfma_f32_16x16x32_bf16 v[36:39], a[164:167], v[148:151], v[36:39]
  ds_read_b64_tr_b16 a[196:197], v212 offset:2048
  v_mfma_f32_16x16x32_bf16 v[36:39], a[160:163], v[144:147], v[36:39]
  v_exp_f32 v3, v3
  v_smfmac_f32_16x16x64_bf16 a[232:235], v[252:255], v[64:71], v224
  v_cvt_pk_bf16_f32 v73, v2, v3
  v_mfma_f32_16x16x32_bf16 v[40:43], a[160:163], v[160:163], v[200:203]
  v_exp_f32 v4, v4
  v_mfma_f32_16x16x32_bf16 v[40:43], a[164:167], v[164:167], v[40:43]
  ds_read_b64_tr_b16 a[198:199], v212 offset:3072
  ds_read_b64_tr_b16 a[200:201], v213 offset:0
  v_mfma_f32_16x16x32_bf16 v[40:43], a[168:171], v[168:171], v[40:43]
  buffer_load_dwordx4 v220, s[24:27], s46 offen offset:3072  lds
  v_mfma_f32_16x16x32_bf16 v[40:43], a[172:175], v[172:175], v[40:43]
  s_add_u32 s46, s46, 16384
  v_exp_f32 v5, v5
  v_mfma_f32_16x16x32_bf16 v[44:47], a[172:175], v[188:191], v[204:207]
  v_cvt_pk_bf16_f32 v84, v4, v5
  v_mfma_f32_16x16x32_bf16 v[44:47], a[168:171], v[184:187], v[44:47]
  v_exp_f32 v6, v6
  v_mfma_f32_16x16x32_bf16 v[44:47], a[164:167], v[180:183], v[44:47]
  ds_read_b64_tr_b16 a[202:203], v213 offset:1024
  v_mfma_f32_16x16x32_bf16 v[44:47], a[160:163], v[176:179], v[44:47]
  v_exp_f32 v7, v7
  v_smfmac_f32_16x16x64_bf16 a[236:239], v[252:255], v[76:83], v224
  v_cvt_pk_bf16_f32 v85, v6, v7
  v_mfma_f32_16x16x32_bf16 v[60:63], a[176:179], v[176:179], v[204:207]
  v_exp_f32 v8, v8
  v_mfma_f32_16x16x32_bf16 v[60:63], a[180:183], v[180:183], v[60:63]
  s_add_u32 m0, s44, 114688
  ds_read_b64_tr_b16 a[204:205], v213 offset:2048
  ds_read_b64_tr_b16 a[206:207], v213 offset:3072
  v_mfma_f32_16x16x32_bf16 v[60:63], a[184:187], v[184:187], v[60:63]
  buffer_load_dwordx4 v221, s[28:31], s47 offen offset:0  lds
  v_mfma_f32_16x16x32_bf16 v[60:63], a[188:191], v[188:191], v[60:63]
  v_exp_f32 v9, v9
  v_mfma_f32_16x16x32_bf16 v[56:59], a[188:191], v[172:175], v[200:203]
  v_cvt_pk_bf16_f32 v96, v8, v9
  v_mfma_f32_16x16x32_bf16 v[56:59], a[184:187], v[168:171], v[56:59]
  v_exp_f32 v10, v10
  v_mfma_f32_16x16x32_bf16 v[56:59], a[180:183], v[164:167], v[56:59]
  ds_read_b64_tr_b16 a[208:209], v214 offset:0
  v_mfma_f32_16x16x32_bf16 v[56:59], a[176:179], v[160:163], v[56:59]
  v_exp_f32 v11, v11
  v_smfmac_f32_16x16x64_bf16 a[240:243], v[252:255], v[88:95], v224
  v_cvt_pk_bf16_f32 v97, v10, v11
  v_mfma_f32_16x16x32_bf16 v[52:55], a[176:179], v[144:147], v[196:199]
  v_exp_f32 v12, v12
  v_mfma_f32_16x16x32_bf16 v[52:55], a[180:183], v[148:151], v[52:55]
  ds_read_b64_tr_b16 a[210:211], v214 offset:1024
  ds_read_b64_tr_b16 a[212:213], v214 offset:2048
  v_mfma_f32_16x16x32_bf16 v[52:55], a[184:187], v[152:155], v[52:55]
  buffer_load_dwordx4 v221, s[28:31], s47 offen offset:1024  lds
  v_mfma_f32_16x16x32_bf16 v[52:55], a[188:191], v[156:159], v[52:55]
  v_exp_f32 v13, v13
  v_mfma_f32_16x16x32_bf16 v[48:51], a[188:191], v[140:143], v[192:195]
  v_cvt_pk_bf16_f32 v108, v12, v13
  v_mfma_f32_16x16x32_bf16 v[48:51], a[184:187], v[136:139], v[48:51]
  v_exp_f32 v14, v14
  v_mfma_f32_16x16x32_bf16 v[48:51], a[180:183], v[132:135], v[48:51]
  ds_read_b64_tr_b16 a[214:215], v214 offset:3072
  v_mfma_f32_16x16x32_bf16 v[48:51], a[176:179], v[128:131], v[48:51]
  v_exp_f32 v15, v15
  v_smfmac_f32_16x16x64_bf16 a[244:247], v[252:255], v[100:107], v224
  s_waitcnt lgkmcnt(1)
  v_cvt_pk_bf16_f32 v109, v14, v15
  v_mfma_f32_16x16x32_bf16 a[0:3], a[192:195], v[64:67], a[0:3]
  v_exp_f32 v16, v16
  v_mfma_f32_16x16x32_bf16 a[0:3], a[196:199], v[68:71], a[0:3]
  v_exp_f32 v17, v17
  v_mfma_f32_16x16x32_bf16 a[4:7], a[196:199], v[80:83], a[4:7]
  v_cvt_pk_bf16_f32 v74, v16, v17
  v_mfma_f32_16x16x32_bf16 a[4:7], a[192:195], v[76:79], a[4:7]
  v_exp_f32 v18, v18
  v_mfma_f32_16x16x32_bf16 a[8:11], a[192:195], v[88:91], a[8:11]
  v_mfma_f32_16x16x32_bf16 a[8:11], a[196:199], v[92:95], a[8:11]
  buffer_load_dwordx4 v221, s[28:31], s47 offen offset:2048  lds
  v_mfma_f32_16x16x32_bf16 a[12:15], a[196:199], v[104:107], a[12:15]
  v_exp_f32 v19, v19
  v_mfma_f32_16x16x32_bf16 a[12:15], a[192:195], v[100:103], a[12:15]
  v_cvt_pk_bf16_f32 v75, v18, v19
  v_mfma_f32_16x16x32_bf16 a[28:31], a[200:203], v[100:103], a[28:31]
  v_exp_f32 v20, v20
  v_mfma_f32_16x16x32_bf16 a[28:31], a[204:207], v[104:107], a[28:31]
  ds_read_b64_tr_b16 a[192:193], v217 offset:0
  ds_read_b64_tr_b16 a[194:195], v217 offset:1024
  v_mfma_f32_16x16x32_bf16 a[24:27], a[204:207], v[92:95], a[24:27]
  v_exp_f32 v21, v21
  v_mfma_f32_16x16x32_bf16 a[24:27], a[200:203], v[88:91], a[24:27]
  ds_read_b64_tr_b16 a[196:197], v217 offset:2048
  v_cvt_pk_bf16_f32 v86, v20, v21
  v_mfma_f32_16x16x32_bf16 a[20:23], a[200:203], v[76:79], a[20:23]
  v_exp_f32 v22, v22
  v_mfma_f32_16x16x32_bf16 a[20:23], a[204:207], v[80:83], a[20:23]
  ds_read_b64_tr_b16 a[198:199], v217 offset:3072
  v_mfma_f32_16x16x32_bf16 a[16:19], a[204:207], v[68:71], a[16:19]
  v_exp_f32 v23, v23
  v_mfma_f32_16x16x32_bf16 a[16:19], a[200:203], v[64:67], a[16:19]
  v_cvt_pk_bf16_f32 v87, v22, v23
  v_mfma_f32_16x16x32_bf16 a[32:35], a[208:211], v[64:67], a[32:35]
  s_waitcnt lgkmcnt(2)
  v_exp_f32 v24, v24
  v_mfma_f32_16x16x32_bf16 a[32:35], a[212:215], v[68:71], a[32:35]
  ds_read_b64_tr_b16 a[200:201], v218 offset:0
  ds_read_b64_tr_b16 a[202:203], v218 offset:1024
  v_mfma_f32_16x16x32_bf16 a[36:39], a[212:215], v[80:83], a[36:39]
  v_exp_f32 v25, v25
  v_mfma_f32_16x16x32_bf16 a[36:39], a[208:211], v[76:79], a[36:39]
  ds_read_b64_tr_b16 a[204:205], v218 offset:2048
  ds_read_b64_tr_b16 a[206:207], v218 offset:3072
  v_mfma_f32_16x16x32_bf16 a[40:43], a[208:211], v[88:91], a[40:43]
  buffer_load_dwordx4 v221, s[28:31], s47 offen offset:3072  lds
  v_mfma_f32_16x16x32_bf16 a[40:43], a[212:215], v[92:95], a[40:43]
  s_add_u32 s47, s47, 16384
  v_exp_f32 v26, v26
  v_mfma_f32_16x16x32_bf16 a[44:47], a[212:215], v[104:107], a[44:47]
  v_exp_f32 v27, v27
  v_mfma_f32_16x16x32_bf16 a[44:47], a[208:211], v[100:103], a[44:47]
  v_cvt_pk_bf16_f32 v98, v24, v25
  v_cvt_pk_bf16_f32 v99, v26, v27
  v_mfma_f32_16x16x32_bf16 a[60:63], a[216:219], v[100:103], a[60:63]
  v_exp_f32 v28, v28
  v_mfma_f32_16x16x32_bf16 a[60:63], a[220:223], v[104:107], a[60:63]
  ds_read_b64_tr_b16 a[208:209], v219 offset:0
  ds_read_b64_tr_b16 a[210:211], v219 offset:1024
  v_mfma_f32_16x16x32_bf16 a[56:59], a[220:223], v[92:95], a[56:59]
  v_exp_f32 v29, v29
  v_mfma_f32_16x16x32_bf16 a[56:59], a[216:219], v[88:91], a[56:59]
  ds_read_b64_tr_b16 a[212:213], v219 offset:2048
  ds_read_b64_tr_b16 a[214:215], v219 offset:3072
  v_mfma_f32_16x16x32_bf16 a[52:55], a[216:219], v[76:79], a[52:55]
  v_exp_f32 v30, v30
  v_mfma_f32_16x16x32_bf16 a[52:55], a[220:223], v[80:83], a[52:55]
  v_exp_f32 v31, v31
  v_mfma_f32_16x16x32_bf16 a[48:51], a[220:223], v[68:71], a[48:51]
  v_cvt_pk_bf16_f32 v110, v28, v29
  v_cvt_pk_bf16_f32 v111, v30, v31
  v_mfma_f32_16x16x32_bf16 a[48:51], a[216:219], v[64:67], a[48:51]
  s_mul_i32 s51, s70, 81920
  s_mul_i32 s52, s71, 160
  s_add_u32 s51, s51, s52
  s_add_u32 s72, s92, s51
  s_addc_u32 s73, s93, 0
  s_mov_b32 s74, 80800
  s_mov_b32 s75, 0x20000
  s_add_u32 s76, s94, s51
  s_addc_u32 s77, s95, 0
  s_mov_b32 s78, 80800
  s_mov_b32 s79, 0x20000
  s_mov_b32 s50, 6
.p2align 6
K1_att:
  v_mfma_f32_16x16x32_bf16 a[64:67], a[224:227], v[64:67], a[64:67]
  s_waitcnt vmcnt(21) lgkmcnt(0)
  s_barrier
  v_exp_f32 v32, v32
  v_mfma_f32_16x16x32_bf16 a[64:67], a[228:231], v[68:71], a[64:67]
  ds_read_b64_tr_b16 a[160:161], v227 offset:0
  ds_read_b64_tr_b16 a[162:163], v227 offset:2560
  v_mfma_f32_16x16x32_bf16 a[68:71], a[228:231], v[80:83], a[68:71]
  v_exp_f32 v33, v33
  v_mfma_f32_16x16x32_bf16 a[68:71], a[224:227], v[76:79], a[68:71]
  ds_read_b64_tr_b16 a[164:165], v227 offset:5120
  ds_read_b64_tr_b16 a[166:167], v227 offset:7680
  v_mfma_f32_16x16x32_bf16 a[72:75], a[224:227], v[88:91], a[72:75]
  v_exp_f32 v34, v34
  v_mfma_f32_16x16x32_bf16 a[72:75], a[228:231], v[92:95], a[72:75]
  s_add_u32 m0, s85, s57
  ds_read_b64_tr_b16 a[168:169], v227 offset:8
  ds_read_b64_tr_b16 a[170:171], v227 offset:2568
  v_mfma_f32_16x16x32_bf16 a[76:79], a[228:231], v[104:107], a[76:79]
  buffer_load_dwordx4 v228, s[16:19], s58 offen offset:0 lds
  v_mfma_f32_16x16x32_bf16 a[76:79], a[224:227], v[100:103], a[76:79]
  v_exp_f32 v35, v35
  v_mfma_f32_16x16x32_bf16 a[92:95], a[192:195], v[100:103], a[92:95]
  ds_read_b64_tr_b16 a[172:173], v227 offset:5128
  ds_read_b64_tr_b16 a[174:175], v227 offset:7688
  v_mfma_f32_16x16x32_bf16 a[92:95], a[196:199], v[104:107], a[92:95]
  v_exp_f32 v36, v36
  v_mfma_f32_16x16x32_bf16 a[88:91], a[196:199], v[92:95], a[88:91]
  ds_read_b64_tr_b16 a[176:177], v227 offset:16
  ds_read_b64_tr_b16 a[178:179], v227 offset:2576
  v_mfma_f32_16x16x32_bf16 a[88:91], a[192:195], v[88:91], a[88:91]
  ds_read_b64_tr_b16 a[180:181], v227 offset:5136
  v_mfma_f32_16x16x32_bf16 a[84:87], a[192:195], v[76:79], a[84:87]
  v_exp_f32 v37, v37
  v_mfma_f32_16x16x32_bf16 a[84:87], a[196:199], v[80:83], a[84:87]
  ds_read_b64_tr_b16 a[182:183], v227 offset:7696
  ds_read_b64_tr_b16 a[184:185], v227 offset:24
  v_mfma_f32_16x16x32_bf16 a[80:83], a[196:199], v[68:71], a[80:83]
  v_exp_f32 v38, v38
  v_mfma_f32_16x16x32_bf16 a[80:83], a[192:195], v[64:67], a[80:83]
  ds_read_b64_tr_b16 a[186:187], v227 offset:2584
  ds_read_b64_tr_b16 a[188:189], v227 offset:5144
  v_mfma_f32_16x16x32_bf16 a[96:99], a[200:203], v[64:67], a[96:99]
  buffer_load_dwordx4 v229, s[16:19], s58 offen offset:1024 lds
  v_mfma_f32_16x16x32_bf16 a[96:99], a[204:207], v[68:71], a[96:99]
  v_exp_f32 v39, v39
  v_mfma_f32_16x16x32_bf16 a[100:103], a[204:207], v[80:83], a[100:103]
  ds_read_b64_tr_b16 a[190:191], v227 offset:7704
  ds_read_b64_tr_b16 a[248:249], v227 offset:32
  v_mfma_f32_16x16x32_bf16 a[100:103], a[200:203], v[76:79], a[100:103]
  ds_read_b64_tr_b16 a[250:251], v227 offset:2592
  v_mfma_f32_16x16x32_bf16 a[104:107], a[200:203], v[88:91], a[104:107]
  v_exp_f32 v40, v40
  v_mfma_f32_16x16x32_bf16 a[104:107], a[204:207], v[92:95], a[104:107]
  ds_read_b64_tr_b16 a[252:253], v227 offset:5152
  ds_read_b64_tr_b16 a[254:255], v227 offset:7712
  v_mfma_f32_16x16x32_bf16 a[108:111], a[204:207], v[104:107], a[108:111]
  v_exp_f32 v41, v41
  v_mfma_f32_16x16x32_bf16 a[108:111], a[200:203], v[100:103], a[108:111]
  ds_read_b128 a[128:131], v208 offset:32768
  ds_read_b128 a[132:135], v209 offset:32768
  v_mfma_f32_16x16x32_bf16 a[124:127], a[208:211], v[100:103], a[124:127]
  buffer_load_dwordx4 v230, s[16:19], s58 offen offset:2048 lds
  v_mfma_f32_16x16x32_bf16 a[124:127], a[212:215], v[104:107], a[124:127]
  s_add_u32 s58, s58, 81920
  v_exp_f32 v42, v42
  v_mfma_f32_16x16x32_bf16 a[120:123], a[212:215], v[92:95], a[120:123]
  ds_read_b128 a[136:139], v210 offset:32768
  ds_read_b128 a[140:143], v211 offset:32768
  v_mfma_f32_16x16x32_bf16 a[120:123], a[208:211], v[88:91], a[120:123]
  ds_read_b128 a[144:147], v208 offset:33792
  v_mfma_f32_16x16x32_bf16 a[116:119], a[208:211], v[76:79], a[116:119]
  v_exp_f32 v43, v43
  v_mfma_f32_16x16x32_bf16 a[116:119], a[212:215], v[80:83], a[116:119]
  ds_read_b128 a[148:151], v209 offset:33792
  ds_read_b128 a[152:155], v210 offset:33792
  v_mfma_f32_16x16x32_bf16 a[112:115], a[212:215], v[68:71], a[112:115]
  ds_read_b128 a[156:159], v211 offset:33792
  v_mfma_f32_16x16x32_bf16 a[112:115], a[208:211], v[64:67], a[112:115]
  s_waitcnt lgkmcnt(6)
  v_exp_f32 v44, v44
  v_mfma_f32_16x16x32_bf16 v[232:235], a[160:163], v[112:115], v[232:235]
  ds_read_b64_tr_b16 a[216:217], v215 offset:16384
  ds_read_b64_tr_b16 a[218:219], v215 offset:17408
  v_mfma_f32_16x16x32_bf16 v[232:235], a[164:167], v[116:119], v[232:235]
  ds_read_b64_tr_b16 a[220:221], v215 offset:18432
  v_mfma_f32_16x16x32_bf16 v[236:239], a[172:175], v[116:119], v[236:239]
  v_exp_f32 v45, v45
  v_mfma_f32_16x16x32_bf16 v[236:239], a[168:171], v[112:115], v[236:239]
  s_mov_b32 s57, s56
  ds_read_b64_tr_b16 a[222:223], v215 offset:19456
  v_mfma_f32_16x16x32_bf16 v[240:243], a[176:179], v[112:115], v[240:243]
  s_add_u32 s56, s56, 10752
  ds_read_b64_tr_b16 a[224:225], v216 offset:16384
  v_mfma_f32_16x16x32_bf16 v[240:243], a[180:183], v[116:119], v[240:243]
  s_cmp_eq_u32 s56, 32256
  v_exp_f32 v46, v46
  v_mfma_f32_16x16x32_bf16 v[244:247], a[188:191], v[116:119], v[244:247]
  s_cselect_b32 s56, 0, s56
  ds_read_b64_tr_b16 a[226:227], v216 offset:17408
  v_mfma_f32_16x16x32_bf16 v[244:247], a[184:187], v[112:115], v[244:247]
  s_sub_u32 s49, s56, s57
  ds_read_b64_tr_b16 a[228:229], v216 offset:18432
  v_mfma_f32_16x16x32_bf16 v[248:251], a[248:251], v[112:115], v[248:251]
  v_exp_f32 v47, v47
  v_mfma_f32_16x16x32_bf16 v[248:251], a[252:255], v[116:119], v[248:251]
  ds_read_b64_tr_b16 a[230:231], v216 offset:19456
  v_add_u32 v227, s49, v227
  v_mfma_f32_16x16x32_bf16 v[0:3], a[128:131], v[128:131], v[192:195]
  v_exp_f32 v48, v48
  v_mfma_f32_16x16x32_bf16 v[0:3], a[132:135], v[132:135], v[0:3]
  s_waitcnt lgkmcnt(3)
  ds_read_b128 a[160:163], v208 offset:34816
  ds_read_b128 a[164:167], v209 offset:34816
  v_mfma_f32_16x16x32_bf16 v[0:3], a[136:139], v[136:139], v[0:3]
  buffer_load_dwordx4 v[112:115], v223, s[8:11], s59 offen sc1
  v_mfma_f32_16x16x32_bf16 v[0:3], a[140:143], v[140:143], v[0:3]
  s_add_u32 s59, s59, 4096
  v_exp_f32 v49, v49
  v_mfma_f32_16x16x32_bf16 v[4:7], a[140:143], v[156:159], v[196:199]
  v_cvt_pk_bf16_f32 v68, v32, v33
  v_cvt_pk_bf16_f32 v69, v34, v35
  v_mfma_f32_16x16x32_bf16 v[4:7], a[136:139], v[152:155], v[4:7]
  v_exp_f32 v50, v50
  v_mfma_f32_16x16x32_bf16 v[4:7], a[132:135], v[148:151], v[4:7]
  v_exp_f32 v51, v51
  v_mfma_f32_16x16x32_bf16 v[4:7], a[128:131], v[144:147], v[4:7]
  v_cvt_pk_bf16_f32 v80, v36, v37
  v_cvt_pk_bf16_f32 v81, v38, v39
  v_mfma_f32_16x16x32_bf16 v[8:11], a[128:131], v[160:163], v[200:203]
  v_exp_f32 v52, v52
  v_mfma_f32_16x16x32_bf16 v[8:11], a[132:135], v[164:167], v[8:11]
  ds_read_b128 a[168:171], v210 offset:34816
  ds_read_b128 a[172:175], v211 offset:34816
  v_mfma_f32_16x16x32_bf16 v[8:11], a[136:139], v[168:171], v[8:11]
  buffer_load_dwordx4 v[116:119], v223, s[8:11], s59 offen sc1
  v_mfma_f32_16x16x32_bf16 v[8:11], a[140:143], v[172:175], v[8:11]
  s_add_u32 s59, s59, 4096
  v_exp_f32 v53, v53
  v_mfma_f32_16x16x32_bf16 v[12:15], a[140:143], v[188:191], v[204:207]
  v_cvt_pk_bf16_f32 v92, v40, v41
  v_cvt_pk_bf16_f32 v93, v42, v43
  v_mfma_f32_16x16x32_bf16 v[12:15], a[136:139], v[184:187], v[12:15]
  v_exp_f32 v54, v54
  v_mfma_f32_16x16x32_bf16 v[12:15], a[132:135], v[180:183], v[12:15]
  v_exp_f32 v55, v55
  v_mfma_f32_16x16x32_bf16 v[12:15], a[128:131], v[176:179], v[12:15]
  v_cvt_pk_bf16_f32 v104, v44, v45
  v_cvt_pk_bf16_f32 v105, v46, v47
  v_mfma_f32_16x16x32_bf16 v[28:31], a[144:147], v[176:179], v[204:207]
  v_exp_f32 v56, v56
  v_mfma_f32_16x16x32_bf16 v[28:31], a[148:151], v[180:183], v[28:31]
  s_add_u32 m0, s44, 16384
  ds_read_b128 a[176:179], v208 offset:35840
  ds_read_b128 a[180:183], v209 offset:35840
  v_mfma_f32_16x16x32_bf16 v[28:31], a[152:155], v[184:187], v[28:31]
  buffer_load_dwordx4 v220, s[24:27], s46 offen offset:0  lds
  v_mfma_f32_16x16x32_bf16 v[28:31], a[156:159], v[188:191], v[28:31]
  v_exp_f32 v57, v57
  v_mfma_f32_16x16x32_bf16 v[24:27], a[156:159], v[172:175], v[200:203]
  v_cvt_pk_bf16_f32 v70, v48, v49
  v_cvt_pk_bf16_f32 v71, v50, v51
  v_mfma_f32_16x16x32_bf16 v[24:27], a[152:155], v[168:171], v[24:27]
K1_st9:
  s_cbranch_execz K1_st13
  v_exp_f32 v58, v58
  v_mfma_f32_16x16x32_bf16 v[24:27], a[148:151], v[164:167], v[24:27]
  v_exp_f32 v59, v59
  v_mfma_f32_16x16x32_bf16 v[24:27], a[144:147], v[160:163], v[24:27]
  v_cvt_pk_bf16_f32 v82, v52, v53
  v_cvt_pk_bf16_f32 v83, v54, v55
  v_mfma_f32_16x16x32_bf16 v[20:23], a[144:147], v[144:147], v[196:199]
  v_exp_f32 v60, v60
  v_mfma_f32_16x16x32_bf16 v[20:23], a[148:151], v[148:151], v[20:23]
  ds_read_b128 a[184:187], v210 offset:35840
  ds_read_b128 a[188:191], v211 offset:35840
  v_mfma_f32_16x16x32_bf16 v[20:23], a[152:155], v[152:155], v[20:23]
  buffer_load_dwordx4 v220, s[24:27], s46 offen offset:1024  lds
  v_mfma_f32_16x16x32_bf16 v[20:23], a[156:159], v[156:159], v[20:23]
  v_exp_f32 v61, v61
  v_mfma_f32_16x16x32_bf16 v[16:19], a[156:159], v[140:143], v[192:195]
  v_cvt_pk_bf16_f32 v94, v56, v57
  v_cvt_pk_bf16_f32 v95, v58, v59
  v_mfma_f32_16x16x32_bf16 v[16:19], a[152:155], v[136:139], v[16:19]
  v_exp_f32 v62, v62
  v_mfma_f32_16x16x32_bf16 v[16:19], a[148:151], v[132:135], v[16:19]
  v_exp_f32 v63, v63
  v_mfma_f32_16x16x32_bf16 v[16:19], a[144:147], v[128:131], v[16:19]
  s_waitcnt lgkmcnt(0)
  v_cvt_pk_bf16_f32 v106, v60, v61
  v_cvt_pk_bf16_f32 v107, v62, v63
  v_mfma_f32_16x16x32_bf16 v[32:35], a[160:163], v[128:131], v[192:195]
  v_exp_f32 v0, v0
  v_mfma_f32_16x16x32_bf16 v[32:35], a[164:167], v[132:135], v[32:35]
  ds_read_b64_tr_b16 a[192:193], v212 offset:16384
  ds_read_b64_tr_b16 a[194:195], v212 offset:17408
  v_mfma_f32_16x16x32_bf16 v[32:35], a[168:171], v[136:139], v[32:35]
  buffer_load_dwordx4 v220, s[24:27], s46 offen offset:2048  lds
  v_mfma_f32_16x16x32_bf16 v[32:35], a[172:175], v[140:143], v[32:35]
  v_exp_f32 v1, v1
  v_mfma_f32_16x16x32_bf16 v[36:39], a[172:175], v[156:159], v[196:199]
  v_cvt_pk_bf16_f32 v64, v0, v1
  v_mfma_f32_16x16x32_bf16 v[36:39], a[168:171], v[152:155], v[36:39]
  v_exp_f32 v2, v2
  v_mfma_f32_16x16x32_bf16 v[36:39], a[164:167], v[148:151], v[36:39]
  ds_read_b64_tr_b16 a[196:197], v212 offset:18432
  v_mfma_f32_16x16x32_bf16 v[36:39], a[160:163], v[144:147], v[36:39]
  v_exp_f32 v3, v3
  v_smfmac_f32_16x16x64_bf16 a[232:235], v[252:255], v[68:75], v224
  v_cvt_pk_bf16_f32 v65, v2, v3
  v_mfma_f32_16x16x32_bf16 v[40:43], a[160:163], v[160:163], v[200:203]
  v_exp_f32 v4, v4
  v_mfma_f32_16x16x32_bf16 v[40:43], a[164:167], v[164:167], v[40:43]
  ds_read_b64_tr_b16 a[198:199], v212 offset:19456
  ds_read_b64_tr_b16 a[200:201], v213 offset:16384
  v_mfma_f32_16x16x32_bf16 v[40:43], a[168:171], v[168:171], v[40:43]
  buffer_load_dwordx4 v220, s[24:27], s46 offen offset:3072  lds
  v_mfma_f32_16x16x32_bf16 v[40:43], a[172:175], v[172:175], v[40:43]
  s_add_u32 s46, s46, 16384
  v_exp_f32 v5, v5
  v_mfma_f32_16x16x32_bf16 v[44:47], a[172:175], v[188:191], v[204:207]
  v_cvt_pk_bf16_f32 v76, v4, v5
  v_mfma_f32_16x16x32_bf16 v[44:47], a[168:171], v[184:187], v[44:47]
  v_exp_f32 v6, v6
  v_mfma_f32_16x16x32_bf16 v[44:47], a[164:167], v[180:183], v[44:47]
  ds_read_b64_tr_b16 a[202:203], v213 offset:17408
  v_mfma_f32_16x16x32_bf16 v[44:47], a[160:163], v[176:179], v[44:47]
  v_exp_f32 v7, v7
  v_smfmac_f32_16x16x64_bf16 a[236:239], v[252:255], v[80:87], v224
  v_cvt_pk_bf16_f32 v77, v6, v7
  v_mfma_f32_16x16x32_bf16 v[60:63], a[176:179], v[176:179], v[204:207]
  v_exp_f32 v8, v8
  v_mfma_f32_16x16x32_bf16 v[60:63], a[180:183], v[180:183], v[60:63]
  s_add_u32 m0, s44, 65536
  ds_read_b64_tr_b16 a[204:205], v213 offset:18432
  ds_read_b64_tr_b16 a[206:207], v213 offset:19456
  v_mfma_f32_16x16x32_bf16 v[60:63], a[184:187], v[184:187], v[60:63]
  buffer_load_dwordx4 v221, s[28:31], s47 offen offset:0  lds
  v_mfma_f32_16x16x32_bf16 v[60:63], a[188:191], v[188:191], v[60:63]
  v_exp_f32 v9, v9
  v_mfma_f32_16x16x32_bf16 v[56:59], a[188:191], v[172:175], v[200:203]
  v_cvt_pk_bf16_f32 v88, v8, v9
  v_mfma_f32_16x16x32_bf16 v[56:59], a[184:187], v[168:171], v[56:59]
  v_exp_f32 v10, v10
  v_mfma_f32_16x16x32_bf16 v[56:59], a[180:183], v[164:167], v[56:59]
  ds_read_b64_tr_b16 a[208:209], v214 offset:16384
  v_mfma_f32_16x16x32_bf16 v[56:59], a[176:179], v[160:163], v[56:59]
  v_exp_f32 v11, v11
  v_smfmac_f32_16x16x64_bf16 a[240:243], v[252:255], v[92:99], v224
  v_cvt_pk_bf16_f32 v89, v10, v11
  v_mfma_f32_16x16x32_bf16 v[52:55], a[176:179], v[144:147], v[196:199]
  v_exp_f32 v12, v12
  v_mfma_f32_16x16x32_bf16 v[52:55], a[180:183], v[148:151], v[52:55]
  ds_read_b64_tr_b16 a[210:211], v214 offset:17408
  ds_read_b64_tr_b16 a[212:213], v214 offset:18432
  v_mfma_f32_16x16x32_bf16 v[52:55], a[184:187], v[152:155], v[52:55]
  buffer_load_dwordx4 v221, s[28:31], s47 offen offset:1024  lds
  v_mfma_f32_16x16x32_bf16 v[52:55], a[188:191], v[156:159], v[52:55]
  v_exp_f32 v13, v13
  v_mfma_f32_16x16x32_bf16 v[48:51], a[188:191], v[140:143], v[192:195]
  v_cvt_pk_bf16_f32 v100, v12, v13
  v_mfma_f32_16x16x32_bf16 v[48:51], a[184:187], v[136:139], v[48:51]
  v_exp_f32 v14, v14
  v_mfma_f32_16x16x32_bf16 v[48:51], a[180:183], v[132:135], v[48:51]
  ds_read_b64_tr_b16 a[214:215], v214 offset:19456
  v_mfma_f32_16x16x32_bf16 v[48:51], a[176:179], v[128:131], v[48:51]
  v_exp_f32 v15, v15
  v_smfmac_f32_16x16x64_bf16 a[244:247], v[252:255], v[104:111], v224
  s_waitcnt lgkmcnt(1)
  v_cvt_pk_bf16_f32 v101, v14, v15
  v_mfma_f32_16x16x32_bf16 a[0:3], a[192:195], v[72:75], a[0:3]
  v_exp_f32 v16, v16
  v_mfma_f32_16x16x32_bf16 a[0:3], a[196:199], v[68:71], a[0:3]
  v_exp_f32 v17, v17
  v_mfma_f32_16x16x32_bf16 a[4:7], a[196:199], v[80:83], a[4:7]
  v_cvt_pk_bf16_f32 v66, v16, v17
  v_mfma_f32_16x16x32_bf16 a[4:7], a[192:195], v[84:87], a[4:7]
  v_exp_f32 v18, v18
  v_mfma_f32_16x16x32_bf16 a[8:11], a[192:195], v[96:99], a[8:11]
  v_mfma_f32_16x16x32_bf16 a[8:11], a[196:199], v[92:95], a[8:11]
  buffer_load_dwordx4 v221, s[28:31], s47 offen offset:2048  lds
  v_mfma_f32_16x16x32_bf16 a[12:15], a[196:199], v[104:107], a[12:15]
  v_exp_f32 v19, v19
  v_mfma_f32_16x16x32_bf16 a[12:15], a[192:195], v[108:111], a[12:15]
  v_cvt_pk_bf16_f32 v67, v18, v19
  v_mfma_f32_16x16x32_bf16 a[28:31], a[200:203], v[108:111], a[28:31]
  v_exp_f32 v20, v20
  v_mfma_f32_16x16x32_bf16 a[28:31], a[204:207], v[104:107], a[28:31]
  ds_read_b64_tr_b16 a[192:193], v217 offset:16384
  ds_read_b64_tr_b16 a[194:195], v217 offset:17408
  v_mfma_f32_16x16x32_bf16 a[24:27], a[204:207], v[92:95], a[24:27]
  v_exp_f32 v21, v21
  v_mfma_f32_16x16x32_bf16 a[24:27], a[200:203], v[96:99], a[24:27]
  ds_read_b64_tr_b16 a[196:197], v217 offset:18432
  v_cvt_pk_bf16_f32 v78, v20, v21
  v_mfma_f32_16x16x32_bf16 a[20:23], a[200:203], v[84:87], a[20:23]
  v_exp_f32 v22, v22
  v_mfma_f32_16x16x32_bf16 a[20:23], a[204:207], v[80:83], a[20:23]
  ds_read_b64_tr_b16 a[198:199], v217 offset:19456
  v_mfma_f32_16x16x32_bf16 a[16:19], a[204:207], v[68:71], a[16:19]
  v_exp_f32 v23, v23
  v_mfma_f32_16x16x32_bf16 a[16:19], a[200:203], v[72:75], a[16:19]
  v_cvt_pk_bf16_f32 v79, v22, v23
  v_mfma_f32_16x16x32_bf16 a[32:35], a[208:211], v[72:75], a[32:35]
  s_waitcnt lgkmcnt(2)
  v_exp_f32 v24, v24
  v_mfma_f32_16x16x32_bf16 a[32:35], a[212:215], v[68:71], a[32:35]
  ds_read_b64_tr_b16 a[200:201], v218 offset:16384
  ds_read_b64_tr_b16 a[202:203], v218 offset:17408
  v_mfma_f32_16x16x32_bf16 a[36:39], a[212:215], v[80:83], a[36:39]
  v_exp_f32 v25, v25
  v_mfma_f32_16x16x32_bf16 a[36:39], a[208:211], v[84:87], a[36:39]
  ds_read_b64_tr_b16 a[204:205], v218 offset:18432
  ds_read_b64_tr_b16 a[206:207], v218 offset:19456
  v_mfma_f32_16x16x32_bf16 a[40:43], a[208:211], v[96:99], a[40:43]
  buffer_load_dwordx4 v221, s[28:31], s47 offen offset:3072  lds
  v_mfma_f32_16x16x32_bf16 a[40:43], a[212:215], v[92:95], a[40:43]
  s_add_u32 s47, s47, 16384
  v_exp_f32 v26, v26
  v_mfma_f32_16x16x32_bf16 a[44:47], a[212:215], v[104:107], a[44:47]
  v_exp_f32 v27, v27
  v_mfma_f32_16x16x32_bf16 a[44:47], a[208:211], v[108:111], a[44:47]
  v_cvt_pk_bf16_f32 v90, v24, v25
  v_cvt_pk_bf16_f32 v91, v26, v27
  v_mfma_f32_16x16x32_bf16 a[60:63], a[216:219], v[108:111], a[60:63]
  v_exp_f32 v28, v28
  v_mfma_f32_16x16x32_bf16 a[60:63], a[220:223], v[104:107], a[60:63]
  ds_read_b64_tr_b16 a[208:209], v219 offset:16384
  ds_read_b64_tr_b16 a[210:211], v219 offset:17408
  v_mfma_f32_16x16x32_bf16 a[56:59], a[220:223], v[92:95], a[56:59]
  v_exp_f32 v29, v29
  v_mfma_f32_16x16x32_bf16 a[56:59], a[216:219], v[96:99], a[56:59]
  ds_read_b64_tr_b16 a[212:213], v219 offset:18432
  ds_read_b64_tr_b16 a[214:215], v219 offset:19456
  v_mfma_f32_16x16x32_bf16 a[52:55], a[216:219], v[84:87], a[52:55]
  v_exp_f32 v30, v30
  v_mfma_f32_16x16x32_bf16 a[52:55], a[220:223], v[80:83], a[52:55]
  v_exp_f32 v31, v31
  v_mfma_f32_16x16x32_bf16 a[48:51], a[220:223], v[68:71], a[48:51]
  v_cvt_pk_bf16_f32 v102, v28, v29
  v_cvt_pk_bf16_f32 v103, v30, v31
  v_mfma_f32_16x16x32_bf16 a[48:51], a[216:219], v[72:75], a[48:51]
  v_mfma_f32_16x16x32_bf16 a[64:67], a[224:227], v[72:75], a[64:67]
  s_waitcnt vmcnt(21) lgkmcnt(0)
  s_barrier
  v_exp_f32 v32, v32
  v_mfma_f32_16x16x32_bf16 a[64:67], a[228:231], v[68:71], a[64:67]
  ds_read_b64_tr_b16 a[160:161], v227 offset:0
  ds_read_b64_tr_b16 a[162:163], v227 offset:2560
  v_mfma_f32_16x16x32_bf16 a[68:71], a[228:231], v[80:83], a[68:71]
  v_exp_f32 v33, v33
  v_mfma_f32_16x16x32_bf16 a[68:71], a[224:227], v[84:87], a[68:71]
  ds_read_b64_tr_b16 a[164:165], v227 offset:5120
  ds_read_b64_tr_b16 a[166:167], v227 offset:7680
  v_mfma_f32_16x16x32_bf16 a[72:75], a[224:227], v[96:99], a[72:75]
  v_exp_f32 v34, v34
  v_mfma_f32_16x16x32_bf16 a[72:75], a[228:231], v[92:95], a[72:75]
  s_add_u32 m0, s85, s57
  ds_read_b64_tr_b16 a[168:169], v227 offset:8
  ds_read_b64_tr_b16 a[170:171], v227 offset:2568
  v_mfma_f32_16x16x32_bf16 a[76:79], a[228:231], v[104:107], a[76:79]
  buffer_load_dwordx4 v228, s[16:19], s58 offen offset:0 lds
  v_mfma_f32_16x16x32_bf16 a[76:79], a[224:227], v[108:111], a[76:79]
  v_exp_f32 v35, v35
  v_mfma_f32_16x16x32_bf16 a[92:95], a[192:195], v[108:111], a[92:95]
  ds_read_b64_tr_b16 a[172:173], v227 offset:5128
  ds_read_b64_tr_b16 a[174:175], v227 offset:7688
  v_mfma_f32_16x16x32_bf16 a[92:95], a[196:199], v[104:107], a[92:95]
  v_exp_f32 v36, v36
  v_mfma_f32_16x16x32_bf16 a[88:91], a[196:199], v[92:95], a[88:91]
  ds_read_b64_tr_b16 a[176:177], v227 offset:16
  ds_read_b64_tr_b16 a[178:179], v227 offset:2576
  v_mfma_f32_16x16x32_bf16 a[88:91], a[192:195], v[96:99], a[88:91]
  ds_read_b64_tr_b16 a[180:181], v227 offset:5136
  v_mfma_f32_16x16x32_bf16 a[84:87], a[192:195], v[84:87], a[84:87]
  v_exp_f32 v37, v37
  v_mfma_f32_16x16x32_bf16 a[84:87], a[196:199], v[80:83], a[84:87]
  ds_read_b64_tr_b16 a[182:183], v227 offset:7696
  ds_read_b64_tr_b16 a[184:185], v227 offset:24
  v_mfma_f32_16x16x32_bf16 a[80:83], a[196:199], v[68:71], a[80:83]
  v_exp_f32 v38, v38
  v_mfma_f32_16x16x32_bf16 a[80:83], a[192:195], v[72:75], a[80:83]
  ds_read_b64_tr_b16 a[186:187], v227 offset:2584
  ds_read_b64_tr_b16 a[188:189], v227 offset:5144
  v_mfma_f32_16x16x32_bf16 a[96:99], a[200:203], v[72:75], a[96:99]
  buffer_load_dwordx4 v229, s[16:19], s58 offen offset:1024 lds
  v_mfma_f32_16x16x32_bf16 a[96:99], a[204:207], v[68:71], a[96:99]
  v_exp_f32 v39, v39
  v_mfma_f32_16x16x32_bf16 a[100:103], a[204:207], v[80:83], a[100:103]
  ds_read_b64_tr_b16 a[190:191], v227 offset:7704
  ds_read_b64_tr_b16 a[248:249], v227 offset:32
  v_mfma_f32_16x16x32_bf16 a[100:103], a[200:203], v[84:87], a[100:103]
  ds_read_b64_tr_b16 a[250:251], v227 offset:2592
  v_mfma_f32_16x16x32_bf16 a[104:107], a[200:203], v[96:99], a[104:107]
  v_exp_f32 v40, v40
  v_mfma_f32_16x16x32_bf16 a[104:107], a[204:207], v[92:95], a[104:107]
  ds_read_b64_tr_b16 a[252:253], v227 offset:5152
  ds_read_b64_tr_b16 a[254:255], v227 offset:7712
  v_mfma_f32_16x16x32_bf16 a[108:111], a[204:207], v[104:107], a[108:111]
  v_exp_f32 v41, v41
  v_mfma_f32_16x16x32_bf16 a[108:111], a[200:203], v[108:111], a[108:111]
  ds_read_b128 a[128:131], v208 offset:49152
  ds_read_b128 a[132:135], v209 offset:49152
  v_mfma_f32_16x16x32_bf16 a[124:127], a[208:211], v[108:111], a[124:127]
  buffer_load_dwordx4 v230, s[16:19], s58 offen offset:2048 lds
  v_mfma_f32_16x16x32_bf16 a[124:127], a[212:215], v[104:107], a[124:127]
  s_add_u32 s58, s58, 81920
  v_exp_f32 v42, v42
  v_mfma_f32_16x16x32_bf16 a[120:123], a[212:215], v[92:95], a[120:123]
  ds_read_b128 a[136:139], v210 offset:49152
  ds_read_b128 a[140:143], v211 offset:49152
  v_mfma_f32_16x16x32_bf16 a[120:123], a[208:211], v[96:99], a[120:123]
  ds_read_b128 a[144:147], v208 offset:50176
  v_mfma_f32_16x16x32_bf16 a[116:119], a[208:211], v[84:87], a[116:119]
  v_exp_f32 v43, v43
  v_mfma_f32_16x16x32_bf16 a[116:119], a[212:215], v[80:83], a[116:119]
  ds_read_b128 a[148:151], v209 offset:50176
  ds_read_b128 a[152:155], v210 offset:50176
  v_mfma_f32_16x16x32_bf16 a[112:115], a[212:215], v[68:71], a[112:115]
  ds_read_b128 a[156:159], v211 offset:50176
  v_mfma_f32_16x16x32_bf16 a[112:115], a[208:211], v[72:75], a[112:115]
  s_waitcnt lgkmcnt(6)
  v_exp_f32 v44, v44
  v_mfma_f32_16x16x32_bf16 v[232:235], a[160:163], v[120:123], v[232:235]
  ds_read_b64_tr_b16 a[216:217], v215 offset:32768
  ds_read_b64_tr_b16 a[218:219], v215 offset:33792
  v_mfma_f32_16x16x32_bf16 v[232:235], a[164:167], v[124:127], v[232:235]
  ds_read_b64_tr_b16 a[220:221], v215 offset:34816
  v_mfma_f32_16x16x32_bf16 v[236:239], a[172:175], v[124:127], v[236:239]
  v_exp_f32 v45, v45
  v_mfma_f32_16x16x32_bf16 v[236:239], a[168:171], v[120:123], v[236:239]
  s_mov_b32 s57, s56
  ds_read_b64_tr_b16 a[222:223], v215 offset:35840
  v_mfma_f32_16x16x32_bf16 v[240:243], a[176:179], v[120:123], v[240:243]
  s_add_u32 s56, s56, 10752
  ds_read_b64_tr_b16 a[224:225], v216 offset:32768
  v_mfma_f32_16x16x32_bf16 v[240:243], a[180:183], v[124:127], v[240:243]
  s_cmp_eq_u32 s56, 32256
  v_exp_f32 v46, v46
  v_mfma_f32_16x16x32_bf16 v[244:247], a[188:191], v[124:127], v[244:247]
  s_cselect_b32 s56, 0, s56
  ds_read_b64_tr_b16 a[226:227], v216 offset:33792
  v_mfma_f32_16x16x32_bf16 v[244:247], a[184:187], v[120:123], v[244:247]
  s_sub_u32 s49, s56, s57
  ds_read_b64_tr_b16 a[228:229], v216 offset:34816
  v_mfma_f32_16x16x32_bf16 v[248:251], a[248:251], v[120:123], v[248:251]
  v_exp_f32 v47, v47
  v_mfma_f32_16x16x32_bf16 v[248:251], a[252:255], v[124:127], v[248:251]
  ds_read_b64_tr_b16 a[230:231], v216 offset:35840
  v_add_u32 v227, s49, v227
  v_mfma_f32_16x16x32_bf16 v[0:3], a[128:131], v[128:131], v[192:195]
  v_exp_f32 v48, v48
  v_mfma_f32_16x16x32_bf16 v[0:3], a[132:135], v[132:135], v[0:3]
  s_waitcnt lgkmcnt(3)
  ds_read_b128 a[160:163], v208 offset:51200
  ds_read_b128 a[164:167], v209 offset:51200
  v_mfma_f32_16x16x32_bf16 v[0:3], a[136:139], v[136:139], v[0:3]
  buffer_load_dwordx4 v[120:123], v223, s[8:11], s59 offen sc1
  v_mfma_f32_16x16x32_bf16 v[0:3], a[140:143], v[140:143], v[0:3]
  s_add_u32 s59, s59, 4096
  v_exp_f32 v49, v49
  v_mfma_f32_16x16x32_bf16 v[4:7], a[140:143], v[156:159], v[196:199]
  v_cvt_pk_bf16_f32 v68, v32, v33
  v_cvt_pk_bf16_f32 v69, v34, v35
  v_mfma_f32_16x16x32_bf16 v[4:7], a[136:139], v[152:155], v[4:7]
  v_exp_f32 v50, v50
  v_mfma_f32_16x16x32_bf16 v[4:7], a[132:135], v[148:151], v[4:7]
  v_exp_f32 v51, v51
  v_mfma_f32_16x16x32_bf16 v[4:7], a[128:131], v[144:147], v[4:7]
  v_cvt_pk_bf16_f32 v80, v36, v37
  v_cvt_pk_bf16_f32 v81, v38, v39
  v_mfma_f32_16x16x32_bf16 v[8:11], a[128:131], v[160:163], v[200:203]
  v_exp_f32 v52, v52
  v_mfma_f32_16x16x32_bf16 v[8:11], a[132:135], v[164:167], v[8:11]
  ds_read_b128 a[168:171], v210 offset:51200
  ds_read_b128 a[172:175], v211 offset:51200
  v_mfma_f32_16x16x32_bf16 v[8:11], a[136:139], v[168:171], v[8:11]
  buffer_load_dwordx4 v[124:127], v223, s[8:11], s59 offen sc1
  v_mfma_f32_16x16x32_bf16 v[8:11], a[140:143], v[172:175], v[8:11]
  s_add_u32 s59, s59, 4096
  v_exp_f32 v53, v53
  v_mfma_f32_16x16x32_bf16 v[12:15], a[140:143], v[188:191], v[204:207]
  v_cvt_pk_bf16_f32 v92, v40, v41
  v_cvt_pk_bf16_f32 v93, v42, v43
  v_mfma_f32_16x16x32_bf16 v[12:15], a[136:139], v[184:187], v[12:15]
  v_exp_f32 v54, v54
  v_mfma_f32_16x16x32_bf16 v[12:15], a[132:135], v[180:183], v[12:15]
  v_exp_f32 v55, v55
  v_mfma_f32_16x16x32_bf16 v[12:15], a[128:131], v[176:179], v[12:15]
  v_cvt_pk_bf16_f32 v104, v44, v45
  v_cvt_pk_bf16_f32 v105, v46, v47
  v_mfma_f32_16x16x32_bf16 v[28:31], a[144:147], v[176:179], v[204:207]
  v_exp_f32 v56, v56
  v_mfma_f32_16x16x32_bf16 v[28:31], a[148:151], v[180:183], v[28:31]
  s_add_u32 m0, s44, 32768
  ds_read_b128 a[176:179], v208 offset:52224
  ds_read_b128 a[180:183], v209 offset:52224
  v_mfma_f32_16x16x32_bf16 v[28:31], a[152:155], v[184:187], v[28:31]
  buffer_load_dwordx4 v220, s[24:27], s46 offen offset:0  lds
  v_mfma_f32_16x16x32_bf16 v[28:31], a[156:159], v[188:191], v[28:31]
  v_exp_f32 v57, v57
  v_mfma_f32_16x16x32_bf16 v[24:27], a[156:159], v[172:175], v[200:203]
  v_cvt_pk_bf16_f32 v70, v48, v49
  v_cvt_pk_bf16_f32 v71, v50, v51
  v_mfma_f32_16x16x32_bf16 v[24:27], a[152:155], v[168:171], v[24:27]
  v_exp_f32 v58, v58
  v_mfma_f32_16x16x32_bf16 v[24:27], a[148:151], v[164:167], v[24:27]
  v_exp_f32 v59, v59
  v_mfma_f32_16x16x32_bf16 v[24:27], a[144:147], v[160:163], v[24:27]
  v_cvt_pk_bf16_f32 v82, v52, v53
  v_cvt_pk_bf16_f32 v83, v54, v55
  v_mfma_f32_16x16x32_bf16 v[20:23], a[144:147], v[144:147], v[196:199]
  v_exp_f32 v60, v60
  v_mfma_f32_16x16x32_bf16 v[20:23], a[148:151], v[148:151], v[20:23]
  ds_read_b128 a[184:187], v210 offset:52224
  ds_read_b128 a[188:191], v211 offset:52224
  v_mfma_f32_16x16x32_bf16 v[20:23], a[152:155], v[152:155], v[20:23]
  buffer_load_dwordx4 v220, s[24:27], s46 offen offset:1024  lds
  v_mfma_f32_16x16x32_bf16 v[20:23], a[156:159], v[156:159], v[20:23]
  v_exp_f32 v61, v61
  v_mfma_f32_16x16x32_bf16 v[16:19], a[156:159], v[140:143], v[192:195]
  v_cvt_pk_bf16_f32 v94, v56, v57
  v_cvt_pk_bf16_f32 v95, v58, v59
  v_mfma_f32_16x16x32_bf16 v[16:19], a[152:155], v[136:139], v[16:19]
  v_exp_f32 v62, v62
  v_mfma_f32_16x16x32_bf16 v[16:19], a[148:151], v[132:135], v[16:19]
  v_exp_f32 v63, v63
  v_mfma_f32_16x16x32_bf16 v[16:19], a[144:147], v[128:131], v[16:19]
  s_waitcnt lgkmcnt(0)
  v_cvt_pk_bf16_f32 v106, v60, v61
  v_cvt_pk_bf16_f32 v107, v62, v63
  v_mfma_f32_16x16x32_bf16 v[32:35], a[160:163], v[128:131], v[192:195]
  v_exp_f32 v0, v0
  v_mfma_f32_16x16x32_bf16 v[32:35], a[164:167], v[132:135], v[32:35]
  ds_read_b64_tr_b16 a[192:193], v212 offset:32768
  ds_read_b64_tr_b16 a[194:195], v212 offset:33792
  v_mfma_f32_16x16x32_bf16 v[32:35], a[168:171], v[136:139], v[32:35]
  buffer_load_dwordx4 v220, s[24:27], s46 offen offset:2048  lds
  v_mfma_f32_16x16x32_bf16 v[32:35], a[172:175], v[140:143], v[32:35]
  v_exp_f32 v1, v1
  v_mfma_f32_16x16x32_bf16 v[36:39], a[172:175], v[156:159], v[196:199]
  v_cvt_pk_bf16_f32 v72, v0, v1
  v_mfma_f32_16x16x32_bf16 v[36:39], a[168:171], v[152:155], v[36:39]
  v_exp_f32 v2, v2
  v_mfma_f32_16x16x32_bf16 v[36:39], a[164:167], v[148:151], v[36:39]
  ds_read_b64_tr_b16 a[196:197], v212 offset:34816
  v_mfma_f32_16x16x32_bf16 v[36:39], a[160:163], v[144:147], v[36:39]
  v_exp_f32 v3, v3
  v_smfmac_f32_16x16x64_bf16 a[232:235], v[252:255], v[64:71], v224
  v_cvt_pk_bf16_f32 v73, v2, v3
  v_mfma_f32_16x16x32_bf16 v[40:43], a[160:163], v[160:163], v[200:203]
  v_exp_f32 v4, v4
  v_mfma_f32_16x16x32_bf16 v[40:43], a[164:167], v[164:167], v[40:43]
  ds_read_b64_tr_b16 a[198:199], v212 offset:35840
  ds_read_b64_tr_b16 a[200:201], v213 offset:32768
  v_mfma_f32_16x16x32_bf16 v[40:43], a[168:171], v[168:171], v[40:43]
  buffer_load_dwordx4 v220, s[24:27], s46 offen offset:3072  lds
  v_mfma_f32_16x16x32_bf16 v[40:43], a[172:175], v[172:175], v[40:43]
  s_add_u32 s46, s46, 16384
  v_exp_f32 v5, v5
  v_mfma_f32_16x16x32_bf16 v[44:47], a[172:175], v[188:191], v[204:207]
  v_cvt_pk_bf16_f32 v84, v4, v5
  v_mfma_f32_16x16x32_bf16 v[44:47], a[168:171], v[184:187], v[44:47]
  v_exp_f32 v6, v6
  v_mfma_f32_16x16x32_bf16 v[44:47], a[164:167], v[180:183], v[44:47]
  ds_read_b64_tr_b16 a[202:203], v213 offset:33792
  v_mfma_f32_16x16x32_bf16 v[44:47], a[160:163], v[176:179], v[44:47]
  v_exp_f32 v7, v7
  v_smfmac_f32_16x16x64_bf16 a[236:239], v[252:255], v[76:83], v224
  v_cvt_pk_bf16_f32 v85, v6, v7
  v_mfma_f32_16x16x32_bf16 v[60:63], a[176:179], v[176:179], v[204:207]
  v_exp_f32 v8, v8
  v_mfma_f32_16x16x32_bf16 v[60:63], a[180:183], v[180:183], v[60:63]
  s_add_u32 m0, s44, 81920
  ds_read_b64_tr_b16 a[204:205], v213 offset:34816
  ds_read_b64_tr_b16 a[206:207], v213 offset:35840
  v_mfma_f32_16x16x32_bf16 v[60:63], a[184:187], v[184:187], v[60:63]
  buffer_load_dwordx4 v221, s[28:31], s47 offen offset:0  lds
  v_mfma_f32_16x16x32_bf16 v[60:63], a[188:191], v[188:191], v[60:63]
  v_exp_f32 v9, v9
  v_mfma_f32_16x16x32_bf16 v[56:59], a[188:191], v[172:175], v[200:203]
  v_cvt_pk_bf16_f32 v96, v8, v9
  v_mfma_f32_16x16x32_bf16 v[56:59], a[184:187], v[168:171], v[56:59]
  v_exp_f32 v10, v10
  v_mfma_f32_16x16x32_bf16 v[56:59], a[180:183], v[164:167], v[56:59]
  ds_read_b64_tr_b16 a[208:209], v214 offset:32768
  v_mfma_f32_16x16x32_bf16 v[56:59], a[176:179], v[160:163], v[56:59]
  v_exp_f32 v11, v11
  v_smfmac_f32_16x16x64_bf16 a[240:243], v[252:255], v[88:95], v224
  v_cvt_pk_bf16_f32 v97, v10, v11
  v_mfma_f32_16x16x32_bf16 v[52:55], a[176:179], v[144:147], v[196:199]
  v_exp_f32 v12, v12
  v_mfma_f32_16x16x32_bf16 v[52:55], a[180:183], v[148:151], v[52:55]
  ds_read_b64_tr_b16 a[210:211], v214 offset:33792
  ds_read_b64_tr_b16 a[212:213], v214 offset:34816
  v_mfma_f32_16x16x32_bf16 v[52:55], a[184:187], v[152:155], v[52:55]
  buffer_load_dwordx4 v221, s[28:31], s47 offen offset:1024  lds
  v_mfma_f32_16x16x32_bf16 v[52:55], a[188:191], v[156:159], v[52:55]
  v_exp_f32 v13, v13
  v_mfma_f32_16x16x32_bf16 v[48:51], a[188:191], v[140:143], v[192:195]
  v_cvt_pk_bf16_f32 v108, v12, v13
  v_mfma_f32_16x16x32_bf16 v[48:51], a[184:187], v[136:139], v[48:51]
  v_exp_f32 v14, v14
  v_mfma_f32_16x16x32_bf16 v[48:51], a[180:183], v[132:135], v[48:51]
  ds_read_b64_tr_b16 a[214:215], v214 offset:35840
  v_mfma_f32_16x16x32_bf16 v[48:51], a[176:179], v[128:131], v[48:51]
  v_exp_f32 v15, v15
  v_smfmac_f32_16x16x64_bf16 a[244:247], v[252:255], v[100:107], v224
  s_waitcnt lgkmcnt(1)
  v_cvt_pk_bf16_f32 v109, v14, v15
  v_mfma_f32_16x16x32_bf16 a[0:3], a[192:195], v[64:67], a[0:3]
  v_exp_f32 v16, v16
  v_mfma_f32_16x16x32_bf16 a[0:3], a[196:199], v[68:71], a[0:3]
  v_exp_f32 v17, v17
  v_mfma_f32_16x16x32_bf16 a[4:7], a[196:199], v[80:83], a[4:7]
  v_cvt_pk_bf16_f32 v74, v16, v17
  v_mfma_f32_16x16x32_bf16 a[4:7], a[192:195], v[76:79], a[4:7]
  v_exp_f32 v18, v18
  v_mfma_f32_16x16x32_bf16 a[8:11], a[192:195], v[88:91], a[8:11]
  v_mfma_f32_16x16x32_bf16 a[8:11], a[196:199], v[92:95], a[8:11]
  buffer_load_dwordx4 v221, s[28:31], s47 offen offset:2048  lds
  v_mfma_f32_16x16x32_bf16 a[12:15], a[196:199], v[104:107], a[12:15]
  v_exp_f32 v19, v19
  v_mfma_f32_16x16x32_bf16 a[12:15], a[192:195], v[100:103], a[12:15]
  v_cvt_pk_bf16_f32 v75, v18, v19
  v_mfma_f32_16x16x32_bf16 a[28:31], a[200:203], v[100:103], a[28:31]
  v_exp_f32 v20, v20
  v_mfma_f32_16x16x32_bf16 a[28:31], a[204:207], v[104:107], a[28:31]
  ds_read_b64_tr_b16 a[192:193], v217 offset:32768
  ds_read_b64_tr_b16 a[194:195], v217 offset:33792
  v_mfma_f32_16x16x32_bf16 a[24:27], a[204:207], v[92:95], a[24:27]
  v_exp_f32 v21, v21
  v_mfma_f32_16x16x32_bf16 a[24:27], a[200:203], v[88:91], a[24:27]
  ds_read_b64_tr_b16 a[196:197], v217 offset:34816
  v_cvt_pk_bf16_f32 v86, v20, v21
  v_mfma_f32_16x16x32_bf16 a[20:23], a[200:203], v[76:79], a[20:23]
  v_exp_f32 v22, v22
  v_mfma_f32_16x16x32_bf16 a[20:23], a[204:207], v[80:83], a[20:23]
  ds_read_b64_tr_b16 a[198:199], v217 offset:35840
  v_mfma_f32_16x16x32_bf16 a[16:19], a[204:207], v[68:71], a[16:19]
  v_exp_f32 v23, v23
  v_mfma_f32_16x16x32_bf16 a[16:19], a[200:203], v[64:67], a[16:19]
  v_cvt_pk_bf16_f32 v87, v22, v23
  v_mfma_f32_16x16x32_bf16 a[32:35], a[208:211], v[64:67], a[32:35]
  s_waitcnt lgkmcnt(2)
  v_exp_f32 v24, v24
  v_mfma_f32_16x16x32_bf16 a[32:35], a[212:215], v[68:71], a[32:35]
  ds_read_b64_tr_b16 a[200:201], v218 offset:32768
  ds_read_b64_tr_b16 a[202:203], v218 offset:33792
  v_mfma_f32_16x16x32_bf16 a[36:39], a[212:215], v[80:83], a[36:39]
  v_exp_f32 v25, v25
  v_mfma_f32_16x16x32_bf16 a[36:39], a[208:211], v[76:79], a[36:39]
  ds_read_b64_tr_b16 a[204:205], v218 offset:34816
  ds_read_b64_tr_b16 a[206:207], v218 offset:35840
  v_mfma_f32_16x16x32_bf16 a[40:43], a[208:211], v[88:91], a[40:43]
  buffer_load_dwordx4 v221, s[28:31], s47 offen offset:3072  lds
  v_mfma_f32_16x16x32_bf16 a[40:43], a[212:215], v[92:95], a[40:43]
  s_add_u32 s47, s47, 16384
  v_exp_f32 v26, v26
  v_mfma_f32_16x16x32_bf16 a[44:47], a[212:215], v[104:107], a[44:47]
  v_exp_f32 v27, v27
  v_mfma_f32_16x16x32_bf16 a[44:47], a[208:211], v[100:103], a[44:47]
  v_cvt_pk_bf16_f32 v98, v24, v25
  v_cvt_pk_bf16_f32 v99, v26, v27
  v_mfma_f32_16x16x32_bf16 a[60:63], a[216:219], v[100:103], a[60:63]
  v_exp_f32 v28, v28
  v_mfma_f32_16x16x32_bf16 a[60:63], a[220:223], v[104:107], a[60:63]
  ds_read_b64_tr_b16 a[208:209], v219 offset:32768
  ds_read_b64_tr_b16 a[210:211], v219 offset:33792
  v_mfma_f32_16x16x32_bf16 a[56:59], a[220:223], v[92:95], a[56:59]
  v_exp_f32 v29, v29
  v_mfma_f32_16x16x32_bf16 a[56:59], a[216:219], v[88:91], a[56:59]
  ds_read_b64_tr_b16 a[212:213], v219 offset:34816
  ds_read_b64_tr_b16 a[214:215], v219 offset:35840
  v_mfma_f32_16x16x32_bf16 a[52:55], a[216:219], v[76:79], a[52:55]
  v_exp_f32 v30, v30
  v_mfma_f32_16x16x32_bf16 a[52:55], a[220:223], v[80:83], a[52:55]
  v_exp_f32 v31, v31
  v_mfma_f32_16x16x32_bf16 a[48:51], a[220:223], v[68:71], a[48:51]
  v_cvt_pk_bf16_f32 v110, v28, v29
  v_cvt_pk_bf16_f32 v111, v30, v31
  v_mfma_f32_16x16x32_bf16 a[48:51], a[216:219], v[64:67], a[48:51]
  v_mfma_f32_16x16x32_bf16 a[64:67], a[224:227], v[64:67], a[64:67]
  s_waitcnt vmcnt(21) lgkmcnt(0)
  s_barrier
  v_exp_f32 v32, v32
  v_mfma_f32_16x16x32_bf16 a[64:67], a[228:231], v[68:71], a[64:67]
  ds_read_b64_tr_b16 a[160:161], v227 offset:0
  ds_read_b64_tr_b16 a[162:163], v227 offset:2560
  v_mfma_f32_16x16x32_bf16 a[68:71], a[228:231], v[80:83], a[68:71]
  v_exp_f32 v33, v33
  v_mfma_f32_16x16x32_bf16 a[68:71], a[224:227], v[76:79], a[68:71]
  ds_read_b64_tr_b16 a[164:165], v227 offset:5120
  ds_read_b64_tr_b16 a[166:167], v227 offset:7680
  v_mfma_f32_16x16x32_bf16 a[72:75], a[224:227], v[88:91], a[72:75]
  v_exp_f32 v34, v34
  v_mfma_f32_16x16x32_bf16 a[72:75], a[228:231], v[92:95], a[72:75]
  s_add_u32 m0, s85, s57
  ds_read_b64_tr_b16 a[168:169], v227 offset:8
  ds_read_b64_tr_b16 a[170:171], v227 offset:2568
  v_mfma_f32_16x16x32_bf16 a[76:79], a[228:231], v[104:107], a[76:79]
  buffer_load_dwordx4 v228, s[16:19], s58 offen offset:0 lds
  v_mfma_f32_16x16x32_bf16 a[76:79], a[224:227], v[100:103], a[76:79]
  v_exp_f32 v35, v35
  v_mfma_f32_16x16x32_bf16 a[92:95], a[192:195], v[100:103], a[92:95]
  ds_read_b64_tr_b16 a[172:173], v227 offset:5128
  ds_read_b64_tr_b16 a[174:175], v227 offset:7688
  v_mfma_f32_16x16x32_bf16 a[92:95], a[196:199], v[104:107], a[92:95]
  v_exp_f32 v36, v36
  v_mfma_f32_16x16x32_bf16 a[88:91], a[196:199], v[92:95], a[88:91]
  ds_read_b64_tr_b16 a[176:177], v227 offset:16
  ds_read_b64_tr_b16 a[178:179], v227 offset:2576
  v_mfma_f32_16x16x32_bf16 a[88:91], a[192:195], v[88:91], a[88:91]
  ds_read_b64_tr_b16 a[180:181], v227 offset:5136
  v_mfma_f32_16x16x32_bf16 a[84:87], a[192:195], v[76:79], a[84:87]
  v_exp_f32 v37, v37
  v_mfma_f32_16x16x32_bf16 a[84:87], a[196:199], v[80:83], a[84:87]
  ds_read_b64_tr_b16 a[182:183], v227 offset:7696
  ds_read_b64_tr_b16 a[184:185], v227 offset:24
  v_mfma_f32_16x16x32_bf16 a[80:83], a[196:199], v[68:71], a[80:83]
  v_exp_f32 v38, v38
  v_mfma_f32_16x16x32_bf16 a[80:83], a[192:195], v[64:67], a[80:83]
  ds_read_b64_tr_b16 a[186:187], v227 offset:2584
  ds_read_b64_tr_b16 a[188:189], v227 offset:5144
  v_mfma_f32_16x16x32_bf16 a[96:99], a[200:203], v[64:67], a[96:99]
  buffer_load_dwordx4 v229, s[16:19], s58 offen offset:1024 lds
  v_mfma_f32_16x16x32_bf16 a[96:99], a[204:207], v[68:71], a[96:99]
  v_exp_f32 v39, v39
  v_mfma_f32_16x16x32_bf16 a[100:103], a[204:207], v[80:83], a[100:103]
  ds_read_b64_tr_b16 a[190:191], v227 offset:7704
  ds_read_b64_tr_b16 a[248:249], v227 offset:32
  v_mfma_f32_16x16x32_bf16 a[100:103], a[200:203], v[76:79], a[100:103]
  ds_read_b64_tr_b16 a[250:251], v227 offset:2592
  v_mfma_f32_16x16x32_bf16 a[104:107], a[200:203], v[88:91], a[104:107]
  v_exp_f32 v40, v40
  v_mfma_f32_16x16x32_bf16 a[104:107], a[204:207], v[92:95], a[104:107]
  ds_read_b64_tr_b16 a[252:253], v227 offset:5152
  ds_read_b64_tr_b16 a[254:255], v227 offset:7712
  v_mfma_f32_16x16x32_bf16 a[108:111], a[204:207], v[104:107], a[108:111]
  v_exp_f32 v41, v41
  v_mfma_f32_16x16x32_bf16 a[108:111], a[200:203], v[100:103], a[108:111]
K1_st10:
  s_cbranch_execz K1_back
  ds_read_b128 a[128:131], v208 offset:0
  ds_read_b128 a[132:135], v209 offset:0
  v_mfma_f32_16x16x32_bf16 a[124:127], a[208:211], v[100:103], a[124:127]
  buffer_load_dwordx4 v230, s[16:19], s58 offen offset:2048 lds
  v_mfma_f32_16x16x32_bf16 a[124:127], a[212:215], v[104:107], a[124:127]
  s_add_u32 s58, s58, 81920
  v_exp_f32 v42, v42
  v_mfma_f32_16x16x32_bf16 a[120:123], a[212:215], v[92:95], a[120:123]
  ds_read_b128 a[136:139], v210 offset:0
  ds_read_b128 a[140:143], v211 offset:0
  v_mfma_f32_16x16x32_bf16 a[120:123], a[208:211], v[88:91], a[120:123]
  ds_read_b128 a[144:147], v208 offset:1024
  v_mfma_f32_16x16x32_bf16 a[116:119], a[208:211], v[76:79], a[116:119]
  v_exp_f32 v43, v43
  v_mfma_f32_16x16x32_bf16 a[116:119], a[212:215], v[80:83], a[116:119]
  ds_read_b128 a[148:151], v209 offset:1024
  ds_read_b128 a[152:155], v210 offset:1024
  v_mfma_f32_16x16x32_bf16 a[112:115], a[212:215], v[68:71], a[112:115]
  ds_read_b128 a[156:159], v211 offset:1024
  v_mfma_f32_16x16x32_bf16 a[112:115], a[208:211], v[64:67], a[112:115]
  s_waitcnt lgkmcnt(6)
  v_exp_f32 v44, v44
  v_mfma_f32_16x16x32_bf16 v[232:235], a[160:163], v[112:115], v[232:235]
  ds_read_b64_tr_b16 a[216:217], v215 offset:49152
  ds_read_b64_tr_b16 a[218:219], v215 offset:50176
  v_mfma_f32_16x16x32_bf16 v[232:235], a[164:167], v[116:119], v[232:235]
  ds_read_b64_tr_b16 a[220:221], v215 offset:51200
  v_mfma_f32_16x16x32_bf16 v[236:239], a[172:175], v[116:119], v[236:239]
  v_exp_f32 v45, v45
  v_mfma_f32_16x16x32_bf16 v[236:239], a[168:171], v[112:115], v[236:239]
  s_mov_b32 s57, s56
  ds_read_b64_tr_b16 a[222:223], v215 offset:52224
  v_mfma_f32_16x16x32_bf16 v[240:243], a[176:179], v[112:115], v[240:243]
  s_add_u32 s56, s56, 10752
  ds_read_b64_tr_b16 a[224:225], v216 offset:49152
  v_mfma_f32_16x16x32_bf16 v[240:243], a[180:183], v[116:119], v[240:243]
  s_cmp_eq_u32 s56, 32256
  v_exp_f32 v46, v46
  v_mfma_f32_16x16x32_bf16 v[244:247], a[188:191], v[116:119], v[244:247]
  s_cselect_b32 s56, 0, s56
  ds_read_b64_tr_b16 a[226:227], v216 offset:50176
  v_mfma_f32_16x16x32_bf16 v[244:247], a[184:187], v[112:115], v[244:247]
  s_sub_u32 s49, s56, s57
  ds_read_b64_tr_b16 a[228:229], v216 offset:51200
  v_mfma_f32_16x16x32_bf16 v[248:251], a[248:251], v[112:115], v[248:251]
  v_exp_f32 v47, v47
  v_mfma_f32_16x16x32_bf16 v[248:251], a[252:255], v[116:119], v[248:251]
  ds_read_b64_tr_b16 a[230:231], v216 offset:52224
  v_add_u32 v227, s49, v227
  v_mfma_f32_16x16x32_bf16 v[0:3], a[128:131], v[128:131], v[192:195]
  v_exp_f32 v48, v48
  v_mfma_f32_16x16x32_bf16 v[0:3], a[132:135], v[132:135], v[0:3]
  s_waitcnt lgkmcnt(3)
  ds_read_b128 a[160:163], v208 offset:2048
  ds_read_b128 a[164:167], v209 offset:2048
  v_mfma_f32_16x16x32_bf16 v[0:3], a[136:139], v[136:139], v[0:3]
  buffer_load_dwordx4 v[112:115], v223, s[8:11], s59 offen sc1
  v_mfma_f32_16x16x32_bf16 v[0:3], a[140:143], v[140:143], v[0:3]
  s_add_u32 s59, s59, 4096
  v_exp_f32 v49, v49
  v_mfma_f32_16x16x32_bf16 v[4:7], a[140:143], v[156:159], v[196:199]
  v_cvt_pk_bf16_f32 v68, v32, v33
  v_cvt_pk_bf16_f32 v69, v34, v35
  v_mfma_f32_16x16x32_bf16 v[4:7], a[136:139], v[152:155], v[4:7]
  v_exp_f32 v50, v50
  v_mfma_f32_16x16x32_bf16 v[4:7], a[132:135], v[148:151], v[4:7]
  v_exp_f32 v51, v51
  v_mfma_f32_16x16x32_bf16 v[4:7], a[128:131], v[144:147], v[4:7]
  v_cvt_pk_bf16_f32 v80, v36, v37
  v_cvt_pk_bf16_f32 v81, v38, v39
  v_mfma_f32_16x16x32_bf16 v[8:11], a[128:131], v[160:163], v[200:203]
  v_exp_f32 v52, v52
  v_mfma_f32_16x16x32_bf16 v[8:11], a[132:135], v[164:167], v[8:11]
  ds_read_b128 a[168:171], v210 offset:2048
  ds_read_b128 a[172:175], v211 offset:2048
  v_mfma_f32_16x16x32_bf16 v[8:11], a[136:139], v[168:171], v[8:11]
  buffer_load_dwordx4 v[116:119], v223, s[8:11], s59 offen sc1
  v_mfma_f32_16x16x32_bf16 v[8:11], a[140:143], v[172:175], v[8:11]
  s_add_u32 s59, s59, 4096
  v_exp_f32 v53, v53
  v_mfma_f32_16x16x32_bf16 v[12:15], a[140:143], v[188:191], v[204:207]
  v_cvt_pk_bf16_f32 v92, v40, v41
  v_cvt_pk_bf16_f32 v93, v42, v43
  v_mfma_f32_16x16x32_bf16 v[12:15], a[136:139], v[184:187], v[12:15]
  v_exp_f32 v54, v54
  v_mfma_f32_16x16x32_bf16 v[12:15], a[132:135], v[180:183], v[12:15]
  v_exp_f32 v55, v55
  v_mfma_f32_16x16x32_bf16 v[12:15], a[128:131], v[176:179], v[12:15]
  v_cvt_pk_bf16_f32 v104, v44, v45
  v_cvt_pk_bf16_f32 v105, v46, v47
  v_mfma_f32_16x16x32_bf16 v[28:31], a[144:147], v[176:179], v[204:207]
  v_exp_f32 v56, v56
  v_mfma_f32_16x16x32_bf16 v[28:31], a[148:151], v[180:183], v[28:31]
  s_add_u32 m0, s44, 49152
  ds_read_b128 a[176:179], v208 offset:3072
  ds_read_b128 a[180:183], v209 offset:3072
  v_mfma_f32_16x16x32_bf16 v[28:31], a[152:155], v[184:187], v[28:31]
  buffer_load_dwordx4 v220, s[24:27], s46 offen offset:0  lds
  v_mfma_f32_16x16x32_bf16 v[28:31], a[156:159], v[188:191], v[28:31]
  v_exp_f32 v57, v57
  v_mfma_f32_16x16x32_bf16 v[24:27], a[156:159], v[172:175], v[200:203]
  v_cvt_pk_bf16_f32 v70, v48, v49
  v_cvt_pk_bf16_f32 v71, v50, v51
  v_mfma_f32_16x16x32_bf16 v[24:27], a[152:155], v[168:171], v[24:27]
  v_exp_f32 v58, v58
  v_mfma_f32_16x16x32_bf16 v[24:27], a[148:151], v[164:167], v[24:27]
  v_exp_f32 v59, v59
  v_mfma_f32_16x16x32_bf16 v[24:27], a[144:147], v[160:163], v[24:27]
  v_cvt_pk_bf16_f32 v82, v52, v53
  v_cvt_pk_bf16_f32 v83, v54, v55
  v_mfma_f32_16x16x32_bf16 v[20:23], a[144:147], v[144:147], v[196:199]
  v_exp_f32 v60, v60
  v_mfma_f32_16x16x32_bf16 v[20:23], a[148:151], v[148:151], v[20:23]
  ds_read_b128 a[184:187], v210 offset:3072
  ds_read_b128 a[188:191], v211 offset:3072
  v_mfma_f32_16x16x32_bf16 v[20:23], a[152:155], v[152:155], v[20:23]
  buffer_load_dwordx4 v220, s[24:27], s46 offen offset:1024  lds
  v_mfma_f32_16x16x32_bf16 v[20:23], a[156:159], v[156:159], v[20:23]
  v_exp_f32 v61, v61
  v_mfma_f32_16x16x32_bf16 v[16:19], a[156:159], v[140:143], v[192:195]
  v_cvt_pk_bf16_f32 v94, v56, v57
  v_cvt_pk_bf16_f32 v95, v58, v59
  v_mfma_f32_16x16x32_bf16 v[16:19], a[152:155], v[136:139], v[16:19]
  v_exp_f32 v62, v62
  v_mfma_f32_16x16x32_bf16 v[16:19], a[148:151], v[132:135], v[16:19]
  v_exp_f32 v63, v63
  v_mfma_f32_16x16x32_bf16 v[16:19], a[144:147], v[128:131], v[16:19]
  s_waitcnt lgkmcnt(0)
  v_cvt_pk_bf16_f32 v106, v60, v61
  v_cvt_pk_bf16_f32 v107, v62, v63
  v_mfma_f32_16x16x32_bf16 v[32:35], a[160:163], v[128:131], v[192:195]
  v_exp_f32 v0, v0
  v_mfma_f32_16x16x32_bf16 v[32:35], a[164:167], v[132:135], v[32:35]
  ds_read_b64_tr_b16 a[192:193], v212 offset:49152
  ds_read_b64_tr_b16 a[194:195], v212 offset:50176
  v_mfma_f32_16x16x32_bf16 v[32:35], a[168:171], v[136:139], v[32:35]
  buffer_load_dwordx4 v220, s[24:27], s46 offen offset:2048  lds
  v_mfma_f32_16x16x32_bf16 v[32:35], a[172:175], v[140:143], v[32:35]
  v_exp_f32 v1, v1
  v_mfma_f32_16x16x32_bf16 v[36:39], a[172:175], v[156:159], v[196:199]
  v_cvt_pk_bf16_f32 v64, v0, v1
  v_mfma_f32_16x16x32_bf16 v[36:39], a[168:171], v[152:155], v[36:39]
  v_exp_f32 v2, v2
  v_mfma_f32_16x16x32_bf16 v[36:39], a[164:167], v[148:151], v[36:39]
  ds_read_b64_tr_b16 a[196:197], v212 offset:51200
  v_mfma_f32_16x16x32_bf16 v[36:39], a[160:163], v[144:147], v[36:39]
  v_exp_f32 v3, v3
  v_smfmac_f32_16x16x64_bf16 a[232:235], v[252:255], v[68:75], v224
  v_cvt_pk_bf16_f32 v65, v2, v3
  v_mfma_f32_16x16x32_bf16 v[40:43], a[160:163], v[160:163], v[200:203]
  v_exp_f32 v4, v4
  v_mfma_f32_16x16x32_bf16 v[40:43], a[164:167], v[164:167], v[40:43]
  ds_read_b64_tr_b16 a[198:199], v212 offset:52224
  ds_read_b64_tr_b16 a[200:201], v213 offset:49152
  v_mfma_f32_16x16x32_bf16 v[40:43], a[168:171], v[168:171], v[40:43]
  buffer_load_dwordx4 v220, s[24:27], s46 offen offset:3072  lds
  v_mfma_f32_16x16x32_bf16 v[40:43], a[172:175], v[172:175], v[40:43]
  s_add_u32 s46, s46, 16384
  v_exp_f32 v5, v5
  v_mfma_f32_16x16x32_bf16 v[44:47], a[172:175], v[188:191], v[204:207]
  v_cvt_pk_bf16_f32 v76, v4, v5
  v_mfma_f32_16x16x32_bf16 v[44:47], a[168:171], v[184:187], v[44:47]
  v_exp_f32 v6, v6
  v_mfma_f32_16x16x32_bf16 v[44:47], a[164:167], v[180:183], v[44:47]
  ds_read_b64_tr_b16 a[202:203], v213 offset:50176
  v_mfma_f32_16x16x32_bf16 v[44:47], a[160:163], v[176:179], v[44:47]
  v_exp_f32 v7, v7
  v_smfmac_f32_16x16x64_bf16 a[236:239], v[252:255], v[80:87], v224
  v_cvt_pk_bf16_f32 v77, v6, v7
  v_mfma_f32_16x16x32_bf16 v[60:63], a[176:179], v[176:179], v[204:207]
  v_exp_f32 v8, v8
  v_mfma_f32_16x16x32_bf16 v[60:63], a[180:183], v[180:183], v[60:63]
  s_add_u32 m0, s44, 98304
  ds_read_b64_tr_b16 a[204:205], v213 offset:51200
  ds_read_b64_tr_b16 a[206:207], v213 offset:52224
  v_mfma_f32_16x16x32_bf16 v[60:63], a[184:187], v[184:187], v[60:63]
  buffer_load_dwordx4 v221, s[28:31], s47 offen offset:0  lds
  v_mfma_f32_16x16x32_bf16 v[60:63], a[188:191], v[188:191], v[60:63]
  v_exp_f32 v9, v9
  v_mfma_f32_16x16x32_bf16 v[56:59], a[188:191], v[172:175], v[200:203]
  v_cvt_pk_bf16_f32 v88, v8, v9
  v_mfma_f32_16x16x32_bf16 v[56:59], a[184:187], v[168:171], v[56:59]
  v_exp_f32 v10, v10
  v_mfma_f32_16x16x32_bf16 v[56:59], a[180:183], v[164:167], v[56:59]
  ds_read_b64_tr_b16 a[208:209], v214 offset:49152
  v_mfma_f32_16x16x32_bf16 v[56:59], a[176:179], v[160:163], v[56:59]
  v_exp_f32 v11, v11
  v_smfmac_f32_16x16x64_bf16 a[240:243], v[252:255], v[92:99], v224
  v_cvt_pk_bf16_f32 v89, v10, v11
  v_mfma_f32_16x16x32_bf16 v[52:55], a[176:179], v[144:147], v[196:199]
  v_exp_f32 v12, v12
  v_mfma_f32_16x16x32_bf16 v[52:55], a[180:183], v[148:151], v[52:55]
  ds_read_b64_tr_b16 a[210:211], v214 offset:50176
  ds_read_b64_tr_b16 a[212:213], v214 offset:51200
  v_mfma_f32_16x16x32_bf16 v[52:55], a[184:187], v[152:155], v[52:55]
  buffer_load_dwordx4 v221, s[28:31], s47 offen offset:1024  lds
  v_mfma_f32_16x16x32_bf16 v[52:55], a[188:191], v[156:159], v[52:55]
  v_exp_f32 v13, v13
  v_mfma_f32_16x16x32_bf16 v[48:51], a[188:191], v[140:143], v[192:195]
  v_cvt_pk_bf16_f32 v100, v12, v13
  v_mfma_f32_16x16x32_bf16 v[48:51], a[184:187], v[136:139], v[48:51]
  v_exp_f32 v14, v14
  v_mfma_f32_16x16x32_bf16 v[48:51], a[180:183], v[132:135], v[48:51]
  ds_read_b64_tr_b16 a[214:215], v214 offset:52224
  v_mfma_f32_16x16x32_bf16 v[48:51], a[176:179], v[128:131], v[48:51]
  v_exp_f32 v15, v15
  v_smfmac_f32_16x16x64_bf16 a[244:247], v[252:255], v[104:111], v224
  s_waitcnt lgkmcnt(1)
  v_cvt_pk_bf16_f32 v101, v14, v15
  v_mfma_f32_16x16x32_bf16 a[0:3], a[192:195], v[72:75], a[0:3]
  v_exp_f32 v16, v16
  v_mfma_f32_16x16x32_bf16 a[0:3], a[196:199], v[68:71], a[0:3]
  v_exp_f32 v17, v17
  v_mfma_f32_16x16x32_bf16 a[4:7], a[196:199], v[80:83], a[4:7]
  v_cvt_pk_bf16_f32 v66, v16, v17
  v_mfma_f32_16x16x32_bf16 a[4:7], a[192:195], v[84:87], a[4:7]
  v_exp_f32 v18, v18
  v_mfma_f32_16x16x32_bf16 a[8:11], a[192:195], v[96:99], a[8:11]
  v_mfma_f32_16x16x32_bf16 a[8:11], a[196:199], v[92:95], a[8:11]
  buffer_load_dwordx4 v221, s[28:31], s47 offen offset:2048  lds
  v_mfma_f32_16x16x32_bf16 a[12:15], a[196:199], v[104:107], a[12:15]
  v_exp_f32 v19, v19
  v_mfma_f32_16x16x32_bf16 a[12:15], a[192:195], v[108:111], a[12:15]
  v_cvt_pk_bf16_f32 v67, v18, v19
  v_mfma_f32_16x16x32_bf16 a[28:31], a[200:203], v[108:111], a[28:31]
  v_exp_f32 v20, v20
  v_mfma_f32_16x16x32_bf16 a[28:31], a[204:207], v[104:107], a[28:31]
  ds_read_b64_tr_b16 a[192:193], v217 offset:49152
  ds_read_b64_tr_b16 a[194:195], v217 offset:50176
  v_mfma_f32_16x16x32_bf16 a[24:27], a[204:207], v[92:95], a[24:27]
  v_exp_f32 v21, v21
  v_mfma_f32_16x16x32_bf16 a[24:27], a[200:203], v[96:99], a[24:27]
  ds_read_b64_tr_b16 a[196:197], v217 offset:51200
  v_cvt_pk_bf16_f32 v78, v20, v21
  v_mfma_f32_16x16x32_bf16 a[20:23], a[200:203], v[84:87], a[20:23]
  v_exp_f32 v22, v22
  v_mfma_f32_16x16x32_bf16 a[20:23], a[204:207], v[80:83], a[20:23]
  ds_read_b64_tr_b16 a[198:199], v217 offset:52224
  v_mfma_f32_16x16x32_bf16 a[16:19], a[204:207], v[68:71], a[16:19]
  v_exp_f32 v23, v23
  v_mfma_f32_16x16x32_bf16 a[16:19], a[200:203], v[72:75], a[16:19]
  v_cvt_pk_bf16_f32 v79, v22, v23
  v_mfma_f32_16x16x32_bf16 a[32:35], a[208:211], v[72:75], a[32:35]
  s_waitcnt lgkmcnt(2)
  v_exp_f32 v24, v24
  v_mfma_f32_16x16x32_bf16 a[32:35], a[212:215], v[68:71], a[32:35]
  ds_read_b64_tr_b16 a[200:201], v218 offset:49152
  ds_read_b64_tr_b16 a[202:203], v218 offset:50176
  v_mfma_f32_16x16x32_bf16 a[36:39], a[212:215], v[80:83], a[36:39]
  v_exp_f32 v25, v25
  v_mfma_f32_16x16x32_bf16 a[36:39], a[208:211], v[84:87], a[36:39]
  ds_read_b64_tr_b16 a[204:205], v218 offset:51200
  ds_read_b64_tr_b16 a[206:207], v218 offset:52224
  v_mfma_f32_16x16x32_bf16 a[40:43], a[208:211], v[96:99], a[40:43]
  buffer_load_dwordx4 v221, s[28:31], s47 offen offset:3072  lds
  v_mfma_f32_16x16x32_bf16 a[40:43], a[212:215], v[92:95], a[40:43]
  s_add_u32 s47, s47, 16384
  v_exp_f32 v26, v26
  v_mfma_f32_16x16x32_bf16 a[44:47], a[212:215], v[104:107], a[44:47]
  v_exp_f32 v27, v27
  v_mfma_f32_16x16x32_bf16 a[44:47], a[208:211], v[108:111], a[44:47]
  v_cvt_pk_bf16_f32 v90, v24, v25
  v_cvt_pk_bf16_f32 v91, v26, v27
  v_mfma_f32_16x16x32_bf16 a[60:63], a[216:219], v[108:111], a[60:63]
  v_exp_f32 v28, v28
  v_mfma_f32_16x16x32_bf16 a[60:63], a[220:223], v[104:107], a[60:63]
  ds_read_b64_tr_b16 a[208:209], v219 offset:49152
  ds_read_b64_tr_b16 a[210:211], v219 offset:50176
  v_mfma_f32_16x16x32_bf16 a[56:59], a[220:223], v[92:95], a[56:59]
  v_exp_f32 v29, v29
  v_mfma_f32_16x16x32_bf16 a[56:59], a[216:219], v[96:99], a[56:59]
  ds_read_b64_tr_b16 a[212:213], v219 offset:51200
  ds_read_b64_tr_b16 a[214:215], v219 offset:52224
  v_mfma_f32_16x16x32_bf16 a[52:55], a[216:219], v[84:87], a[52:55]
  v_exp_f32 v30, v30
  v_mfma_f32_16x16x32_bf16 a[52:55], a[220:223], v[80:83], a[52:55]
  v_exp_f32 v31, v31
  v_mfma_f32_16x16x32_bf16 a[48:51], a[220:223], v[68:71], a[48:51]
  v_cvt_pk_bf16_f32 v102, v28, v29
  v_cvt_pk_bf16_f32 v103, v30, v31
  v_mfma_f32_16x16x32_bf16 a[48:51], a[216:219], v[72:75], a[48:51]
  v_mfma_f32_16x16x32_bf16 a[64:67], a[224:227], v[72:75], a[64:67]
  s_waitcnt vmcnt(21) lgkmcnt(0)
  s_barrier
  v_exp_f32 v32, v32
  v_mfma_f32_16x16x32_bf16 a[64:67], a[228:231], v[68:71], a[64:67]
  ds_read_b64_tr_b16 a[160:161], v227 offset:0
  ds_read_b64_tr_b16 a[162:163], v227 offset:2560
  v_mfma_f32_16x16x32_bf16 a[68:71], a[228:231], v[80:83], a[68:71]
  v_exp_f32 v33, v33
  v_mfma_f32_16x16x32_bf16 a[68:71], a[224:227], v[84:87], a[68:71]
  ds_read_b64_tr_b16 a[164:165], v227 offset:5120
  ds_read_b64_tr_b16 a[166:167], v227 offset:7680
  v_mfma_f32_16x16x32_bf16 a[72:75], a[224:227], v[96:99], a[72:75]
  v_exp_f32 v34, v34
  v_mfma_f32_16x16x32_bf16 a[72:75], a[228:231], v[92:95], a[72:75]
  s_add_u32 m0, s85, s57
  ds_read_b64_tr_b16 a[168:169], v227 offset:8
  ds_read_b64_tr_b16 a[170:171], v227 offset:2568
  v_mfma_f32_16x16x32_bf16 a[76:79], a[228:231], v[104:107], a[76:79]
  buffer_load_dwordx4 v228, s[16:19], s58 offen offset:0 lds
  v_mfma_f32_16x16x32_bf16 a[76:79], a[224:227], v[108:111], a[76:79]
  v_exp_f32 v35, v35
  v_mfma_f32_16x16x32_bf16 a[92:95], a[192:195], v[108:111], a[92:95]
  ds_read_b64_tr_b16 a[172:173], v227 offset:5128
  ds_read_b64_tr_b16 a[174:175], v227 offset:7688
  v_mfma_f32_16x16x32_bf16 a[92:95], a[196:199], v[104:107], a[92:95]
  v_exp_f32 v36, v36
  v_mfma_f32_16x16x32_bf16 a[88:91], a[196:199], v[92:95], a[88:91]
  ds_read_b64_tr_b16 a[176:177], v227 offset:16
  ds_read_b64_tr_b16 a[178:179], v227 offset:2576
  v_mfma_f32_16x16x32_bf16 a[88:91], a[192:195], v[96:99], a[88:91]
  ds_read_b64_tr_b16 a[180:181], v227 offset:5136
  v_mfma_f32_16x16x32_bf16 a[84:87], a[192:195], v[84:87], a[84:87]
  v_exp_f32 v37, v37
  v_mfma_f32_16x16x32_bf16 a[84:87], a[196:199], v[80:83], a[84:87]
  ds_read_b64_tr_b16 a[182:183], v227 offset:7696
  ds_read_b64_tr_b16 a[184:185], v227 offset:24
  v_mfma_f32_16x16x32_bf16 a[80:83], a[196:199], v[68:71], a[80:83]
  v_exp_f32 v38, v38
  v_mfma_f32_16x16x32_bf16 a[80:83], a[192:195], v[72:75], a[80:83]
  ds_read_b64_tr_b16 a[186:187], v227 offset:2584
  ds_read_b64_tr_b16 a[188:189], v227 offset:5144
  v_mfma_f32_16x16x32_bf16 a[96:99], a[200:203], v[72:75], a[96:99]
  buffer_load_dwordx4 v229, s[16:19], s58 offen offset:1024 lds
  v_mfma_f32_16x16x32_bf16 a[96:99], a[204:207], v[68:71], a[96:99]
  v_exp_f32 v39, v39
  v_mfma_f32_16x16x32_bf16 a[100:103], a[204:207], v[80:83], a[100:103]
  ds_read_b64_tr_b16 a[190:191], v227 offset:7704
  ds_read_b64_tr_b16 a[248:249], v227 offset:32
  v_mfma_f32_16x16x32_bf16 a[100:103], a[200:203], v[84:87], a[100:103]
  ds_read_b64_tr_b16 a[250:251], v227 offset:2592
  v_mfma_f32_16x16x32_bf16 a[104:107], a[200:203], v[96:99], a[104:107]
  v_exp_f32 v40, v40
  v_mfma_f32_16x16x32_bf16 a[104:107], a[204:207], v[92:95], a[104:107]
  ds_read_b64_tr_b16 a[252:253], v227 offset:5152
  ds_read_b64_tr_b16 a[254:255], v227 offset:7712
  v_mfma_f32_16x16x32_bf16 a[108:111], a[204:207], v[104:107], a[108:111]
  v_exp_f32 v41, v41
  v_mfma_f32_16x16x32_bf16 a[108:111], a[200:203], v[108:111], a[108:111]
  ds_read_b128 a[128:131], v208 offset:16384
  ds_read_b128 a[132:135], v209 offset:16384
  v_mfma_f32_16x16x32_bf16 a[124:127], a[208:211], v[108:111], a[124:127]
  buffer_load_dwordx4 v230, s[16:19], s58 offen offset:2048 lds
  v_mfma_f32_16x16x32_bf16 a[124:127], a[212:215], v[104:107], a[124:127]
  s_add_u32 s58, s58, 81920
  v_exp_f32 v42, v42
  v_mfma_f32_16x16x32_bf16 a[120:123], a[212:215], v[92:95], a[120:123]
  ds_read_b128 a[136:139], v210 offset:16384
  ds_read_b128 a[140:143], v211 offset:16384
  v_mfma_f32_16x16x32_bf16 a[120:123], a[208:211], v[96:99], a[120:123]
  ds_read_b128 a[144:147], v208 offset:17408
  v_mfma_f32_16x16x32_bf16 a[116:119], a[208:211], v[84:87], a[116:119]
  v_exp_f32 v43, v43
  v_mfma_f32_16x16x32_bf16 a[116:119], a[212:215], v[80:83], a[116:119]
  ds_read_b128 a[148:151], v209 offset:17408
  ds_read_b128 a[152:155], v210 offset:17408
  v_mfma_f32_16x16x32_bf16 a[112:115], a[212:215], v[68:71], a[112:115]
  ds_read_b128 a[156:159], v211 offset:17408
  v_mfma_f32_16x16x32_bf16 a[112:115], a[208:211], v[72:75], a[112:115]
  s_waitcnt lgkmcnt(6)
  v_exp_f32 v44, v44
  v_mfma_f32_16x16x32_bf16 v[232:235], a[160:163], v[120:123], v[232:235]
  ds_read_b64_tr_b16 a[216:217], v215 offset:0
  ds_read_b64_tr_b16 a[218:219], v215 offset:1024
  v_mfma_f32_16x16x32_bf16 v[232:235], a[164:167], v[124:127], v[232:235]
  ds_read_b64_tr_b16 a[220:221], v215 offset:2048
  v_mfma_f32_16x16x32_bf16 v[236:239], a[172:175], v[124:127], v[236:239]
  v_exp_f32 v45, v45
  v_mfma_f32_16x16x32_bf16 v[236:239], a[168:171], v[120:123], v[236:239]
  s_mov_b32 s57, s56
  ds_read_b64_tr_b16 a[222:223], v215 offset:3072
  v_mfma_f32_16x16x32_bf16 v[240:243], a[176:179], v[120:123], v[240:243]
  s_add_u32 s56, s56, 10752
  ds_read_b64_tr_b16 a[224:225], v216 offset:0
  v_mfma_f32_16x16x32_bf16 v[240:243], a[180:183], v[124:127], v[240:243]
  s_cmp_eq_u32 s56, 32256
  v_exp_f32 v46, v46
  v_mfma_f32_16x16x32_bf16 v[244:247], a[188:191], v[124:127], v[244:247]
  s_cselect_b32 s56, 0, s56
  ds_read_b64_tr_b16 a[226:227], v216 offset:1024
  v_mfma_f32_16x16x32_bf16 v[244:247], a[184:187], v[120:123], v[244:247]
  s_sub_u32 s49, s56, s57
  ds_read_b64_tr_b16 a[228:229], v216 offset:2048
  v_mfma_f32_16x16x32_bf16 v[248:251], a[248:251], v[120:123], v[248:251]
  v_exp_f32 v47, v47
  v_mfma_f32_16x16x32_bf16 v[248:251], a[252:255], v[124:127], v[248:251]
  ds_read_b64_tr_b16 a[230:231], v216 offset:3072
  v_add_u32 v227, s49, v227
  v_mfma_f32_16x16x32_bf16 v[0:3], a[128:131], v[128:131], v[192:195]
  v_exp_f32 v48, v48
  v_mfma_f32_16x16x32_bf16 v[0:3], a[132:135], v[132:135], v[0:3]
  s_waitcnt lgkmcnt(3)
  ds_read_b128 a[160:163], v208 offset:18432
  ds_read_b128 a[164:167], v209 offset:18432
  v_mfma_f32_16x16x32_bf16 v[0:3], a[136:139], v[136:139], v[0:3]
  buffer_load_dwordx4 v[120:123], v223, s[8:11], s59 offen sc1
  v_mfma_f32_16x16x32_bf16 v[0:3], a[140:143], v[140:143], v[0:3]
  s_add_u32 s59, s59, 4096
  v_exp_f32 v49, v49
  v_mfma_f32_16x16x32_bf16 v[4:7], a[140:143], v[156:159], v[196:199]
  v_cvt_pk_bf16_f32 v68, v32, v33
  v_cvt_pk_bf16_f32 v69, v34, v35
  v_mfma_f32_16x16x32_bf16 v[4:7], a[136:139], v[152:155], v[4:7]
  v_exp_f32 v50, v50
  v_mfma_f32_16x16x32_bf16 v[4:7], a[132:135], v[148:151], v[4:7]
  v_exp_f32 v51, v51
  v_mfma_f32_16x16x32_bf16 v[4:7], a[128:131], v[144:147], v[4:7]
  v_cvt_pk_bf16_f32 v80, v36, v37
  v_cvt_pk_bf16_f32 v81, v38, v39
  v_mfma_f32_16x16x32_bf16 v[8:11], a[128:131], v[160:163], v[200:203]
  v_exp_f32 v52, v52
  v_mfma_f32_16x16x32_bf16 v[8:11], a[132:135], v[164:167], v[8:11]
  ds_read_b128 a[168:171], v210 offset:18432
  ds_read_b128 a[172:175], v211 offset:18432
  v_mfma_f32_16x16x32_bf16 v[8:11], a[136:139], v[168:171], v[8:11]
  buffer_load_dwordx4 v[124:127], v223, s[8:11], s59 offen sc1
  v_mfma_f32_16x16x32_bf16 v[8:11], a[140:143], v[172:175], v[8:11]
  s_add_u32 s59, s59, 4096
  v_exp_f32 v53, v53
  v_mfma_f32_16x16x32_bf16 v[12:15], a[140:143], v[188:191], v[204:207]
  v_cvt_pk_bf16_f32 v92, v40, v41
  v_cvt_pk_bf16_f32 v93, v42, v43
  v_mfma_f32_16x16x32_bf16 v[12:15], a[136:139], v[184:187], v[12:15]
  v_exp_f32 v54, v54
  v_mfma_f32_16x16x32_bf16 v[12:15], a[132:135], v[180:183], v[12:15]
  v_exp_f32 v55, v55
  v_mfma_f32_16x16x32_bf16 v[12:15], a[128:131], v[176:179], v[12:15]
  v_cvt_pk_bf16_f32 v104, v44, v45
  v_cvt_pk_bf16_f32 v105, v46, v47
  v_mfma_f32_16x16x32_bf16 v[28:31], a[144:147], v[176:179], v[204:207]
  v_exp_f32 v56, v56
  v_mfma_f32_16x16x32_bf16 v[28:31], a[148:151], v[180:183], v[28:31]
  s_add_u32 m0, s44, 0
  ds_read_b128 a[176:179], v208 offset:19456
  ds_read_b128 a[180:183], v209 offset:19456
  v_mfma_f32_16x16x32_bf16 v[28:31], a[152:155], v[184:187], v[28:31]
  buffer_load_dwordx4 v220, s[24:27], s46 offen offset:0  lds
  v_mfma_f32_16x16x32_bf16 v[28:31], a[156:159], v[188:191], v[28:31]
  v_exp_f32 v57, v57
  v_mfma_f32_16x16x32_bf16 v[24:27], a[156:159], v[172:175], v[200:203]
  v_cvt_pk_bf16_f32 v70, v48, v49
  v_cvt_pk_bf16_f32 v71, v50, v51
  v_mfma_f32_16x16x32_bf16 v[24:27], a[152:155], v[168:171], v[24:27]
  v_exp_f32 v58, v58
  v_mfma_f32_16x16x32_bf16 v[24:27], a[148:151], v[164:167], v[24:27]
  v_exp_f32 v59, v59
  v_mfma_f32_16x16x32_bf16 v[24:27], a[144:147], v[160:163], v[24:27]
  v_cvt_pk_bf16_f32 v82, v52, v53
  v_cvt_pk_bf16_f32 v83, v54, v55
  v_mfma_f32_16x16x32_bf16 v[20:23], a[144:147], v[144:147], v[196:199]
  v_exp_f32 v60, v60
  v_mfma_f32_16x16x32_bf16 v[20:23], a[148:151], v[148:151], v[20:23]
  ds_read_b128 a[184:187], v210 offset:19456
  ds_read_b128 a[188:191], v211 offset:19456
  v_mfma_f32_16x16x32_bf16 v[20:23], a[152:155], v[152:155], v[20:23]
  buffer_load_dwordx4 v220, s[24:27], s46 offen offset:1024  lds
  v_mfma_f32_16x16x32_bf16 v[20:23], a[156:159], v[156:159], v[20:23]
  v_exp_f32 v61, v61
  v_mfma_f32_16x16x32_bf16 v[16:19], a[156:159], v[140:143], v[192:195]
  v_cvt_pk_bf16_f32 v94, v56, v57
  v_cvt_pk_bf16_f32 v95, v58, v59
  v_mfma_f32_16x16x32_bf16 v[16:19], a[152:155], v[136:139], v[16:19]
  v_exp_f32 v62, v62
  v_mfma_f32_16x16x32_bf16 v[16:19], a[148:151], v[132:135], v[16:19]
  v_exp_f32 v63, v63
  v_mfma_f32_16x16x32_bf16 v[16:19], a[144:147], v[128:131], v[16:19]
  s_waitcnt lgkmcnt(0)
  v_cvt_pk_bf16_f32 v106, v60, v61
  v_cvt_pk_bf16_f32 v107, v62, v63
  v_mfma_f32_16x16x32_bf16 v[32:35], a[160:163], v[128:131], v[192:195]
  v_exp_f32 v0, v0
  v_mfma_f32_16x16x32_bf16 v[32:35], a[164:167], v[132:135], v[32:35]
  ds_read_b64_tr_b16 a[192:193], v212 offset:0
  ds_read_b64_tr_b16 a[194:195], v212 offset:1024
  v_mfma_f32_16x16x32_bf16 v[32:35], a[168:171], v[136:139], v[32:35]
  buffer_load_dwordx4 v220, s[24:27], s46 offen offset:2048  lds
  v_mfma_f32_16x16x32_bf16 v[32:35], a[172:175], v[140:143], v[32:35]
  v_exp_f32 v1, v1
  v_mfma_f32_16x16x32_bf16 v[36:39], a[172:175], v[156:159], v[196:199]
  v_cvt_pk_bf16_f32 v72, v0, v1
  v_mfma_f32_16x16x32_bf16 v[36:39], a[168:171], v[152:155], v[36:39]
  v_exp_f32 v2, v2
  v_mfma_f32_16x16x32_bf16 v[36:39], a[164:167], v[148:151], v[36:39]
  ds_read_b64_tr_b16 a[196:197], v212 offset:2048
  v_mfma_f32_16x16x32_bf16 v[36:39], a[160:163], v[144:147], v[36:39]
  v_exp_f32 v3, v3
  v_smfmac_f32_16x16x64_bf16 a[232:235], v[252:255], v[64:71], v224
  v_cvt_pk_bf16_f32 v73, v2, v3
  v_mfma_f32_16x16x32_bf16 v[40:43], a[160:163], v[160:163], v[200:203]
  v_exp_f32 v4, v4
  v_mfma_f32_16x16x32_bf16 v[40:43], a[164:167], v[164:167], v[40:43]
  ds_read_b64_tr_b16 a[198:199], v212 offset:3072
  ds_read_b64_tr_b16 a[200:201], v213 offset:0
  v_mfma_f32_16x16x32_bf16 v[40:43], a[168:171], v[168:171], v[40:43]
  buffer_load_dwordx4 v220, s[24:27], s46 offen offset:3072  lds
  v_mfma_f32_16x16x32_bf16 v[40:43], a[172:175], v[172:175], v[40:43]
  s_add_u32 s46, s46, 16384
  v_exp_f32 v5, v5
  v_mfma_f32_16x16x32_bf16 v[44:47], a[172:175], v[188:191], v[204:207]
  v_cvt_pk_bf16_f32 v84, v4, v5
  v_mfma_f32_16x16x32_bf16 v[44:47], a[168:171], v[184:187], v[44:47]
  v_exp_f32 v6, v6
  v_mfma_f32_16x16x32_bf16 v[44:47], a[164:167], v[180:183], v[44:47]
  ds_read_b64_tr_b16 a[202:203], v213 offset:1024
  v_mfma_f32_16x16x32_bf16 v[44:47], a[160:163], v[176:179], v[44:47]
  v_exp_f32 v7, v7
  v_smfmac_f32_16x16x64_bf16 a[236:239], v[252:255], v[76:83], v224
  v_cvt_pk_bf16_f32 v85, v6, v7
  v_mfma_f32_16x16x32_bf16 v[60:63], a[176:179], v[176:179], v[204:207]
  v_exp_f32 v8, v8
  v_mfma_f32_16x16x32_bf16 v[60:63], a[180:183], v[180:183], v[60:63]
  s_add_u32 m0, s44, 114688
  ds_read_b64_tr_b16 a[204:205], v213 offset:2048
  ds_read_b64_tr_b16 a[206:207], v213 offset:3072
  v_mfma_f32_16x16x32_bf16 v[60:63], a[184:187], v[184:187], v[60:63]
  buffer_load_dwordx4 v221, s[28:31], s47 offen offset:0  lds
  v_mfma_f32_16x16x32_bf16 v[60:63], a[188:191], v[188:191], v[60:63]
  v_exp_f32 v9, v9
  v_mfma_f32_16x16x32_bf16 v[56:59], a[188:191], v[172:175], v[200:203]
  v_cvt_pk_bf16_f32 v96, v8, v9
  v_mfma_f32_16x16x32_bf16 v[56:59], a[184:187], v[168:171], v[56:59]
  v_exp_f32 v10, v10
  v_mfma_f32_16x16x32_bf16 v[56:59], a[180:183], v[164:167], v[56:59]
  ds_read_b64_tr_b16 a[208:209], v214 offset:0
  v_mfma_f32_16x16x32_bf16 v[56:59], a[176:179], v[160:163], v[56:59]
  v_exp_f32 v11, v11
  v_smfmac_f32_16x16x64_bf16 a[240:243], v[252:255], v[88:95], v224
  v_cvt_pk_bf16_f32 v97, v10, v11
  v_mfma_f32_16x16x32_bf16 v[52:55], a[176:179], v[144:147], v[196:199]
  v_exp_f32 v12, v12
  v_mfma_f32_16x16x32_bf16 v[52:55], a[180:183], v[148:151], v[52:55]
  ds_read_b64_tr_b16 a[210:211], v214 offset:1024
  ds_read_b64_tr_b16 a[212:213], v214 offset:2048
  v_mfma_f32_16x16x32_bf16 v[52:55], a[184:187], v[152:155], v[52:55]
  buffer_load_dwordx4 v221, s[28:31], s47 offen offset:1024  lds
  v_mfma_f32_16x16x32_bf16 v[52:55], a[188:191], v[156:159], v[52:55]
  v_exp_f32 v13, v13
  v_mfma_f32_16x16x32_bf16 v[48:51], a[188:191], v[140:143], v[192:195]
  v_cvt_pk_bf16_f32 v108, v12, v13
  v_mfma_f32_16x16x32_bf16 v[48:51], a[184:187], v[136:139], v[48:51]
  v_exp_f32 v14, v14
  v_mfma_f32_16x16x32_bf16 v[48:51], a[180:183], v[132:135], v[48:51]
  ds_read_b64_tr_b16 a[214:215], v214 offset:3072
  v_mfma_f32_16x16x32_bf16 v[48:51], a[176:179], v[128:131], v[48:51]
  v_exp_f32 v15, v15
  v_smfmac_f32_16x16x64_bf16 a[244:247], v[252:255], v[100:107], v224
  s_waitcnt lgkmcnt(1)
  v_cvt_pk_bf16_f32 v109, v14, v15
  v_mfma_f32_16x16x32_bf16 a[0:3], a[192:195], v[64:67], a[0:3]
  v_exp_f32 v16, v16
  v_mfma_f32_16x16x32_bf16 a[0:3], a[196:199], v[68:71], a[0:3]
  v_exp_f32 v17, v17
  v_mfma_f32_16x16x32_bf16 a[4:7], a[196:199], v[80:83], a[4:7]
  v_cvt_pk_bf16_f32 v74, v16, v17
  v_mfma_f32_16x16x32_bf16 a[4:7], a[192:195], v[76:79], a[4:7]
  v_exp_f32 v18, v18
  v_mfma_f32_16x16x32_bf16 a[8:11], a[192:195], v[88:91], a[8:11]
  v_mfma_f32_16x16x32_bf16 a[8:11], a[196:199], v[92:95], a[8:11]
  buffer_load_dwordx4 v221, s[28:31], s47 offen offset:2048  lds
  v_mfma_f32_16x16x32_bf16 a[12:15], a[196:199], v[104:107], a[12:15]
  v_exp_f32 v19, v19
  v_mfma_f32_16x16x32_bf16 a[12:15], a[192:195], v[100:103], a[12:15]
  v_cvt_pk_bf16_f32 v75, v18, v19
  v_mfma_f32_16x16x32_bf16 a[28:31], a[200:203], v[100:103], a[28:31]
  v_exp_f32 v20, v20
  v_mfma_f32_16x16x32_bf16 a[28:31], a[204:207], v[104:107], a[28:31]
  ds_read_b64_tr_b16 a[192:193], v217 offset:0
  ds_read_b64_tr_b16 a[194:195], v217 offset:1024
  v_mfma_f32_16x16x32_bf16 a[24:27], a[204:207], v[92:95], a[24:27]
  v_exp_f32 v21, v21
  v_mfma_f32_16x16x32_bf16 a[24:27], a[200:203], v[88:91], a[24:27]
  ds_read_b64_tr_b16 a[196:197], v217 offset:2048
  v_cvt_pk_bf16_f32 v86, v20, v21
  v_mfma_f32_16x16x32_bf16 a[20:23], a[200:203], v[76:79], a[20:23]
  v_exp_f32 v22, v22
  v_mfma_f32_16x16x32_bf16 a[20:23], a[204:207], v[80:83], a[20:23]
K1_st11:
  s_cbranch_execz K1_back
  ds_read_b64_tr_b16 a[198:199], v217 offset:3072
  v_mfma_f32_16x16x32_bf16 a[16:19], a[204:207], v[68:71], a[16:19]
  v_exp_f32 v23, v23
  v_mfma_f32_16x16x32_bf16 a[16:19], a[200:203], v[64:67], a[16:19]
  v_cvt_pk_bf16_f32 v87, v22, v23
  v_mfma_f32_16x16x32_bf16 a[32:35], a[208:211], v[64:67], a[32:35]
  s_waitcnt lgkmcnt(2)
  v_exp_f32 v24, v24
  v_mfma_f32_16x16x32_bf16 a[32:35], a[212:215], v[68:71], a[32:35]
  ds_read_b64_tr_b16 a[200:201], v218 offset:0
  ds_read_b64_tr_b16 a[202:203], v218 offset:1024
  v_mfma_f32_16x16x32_bf16 a[36:39], a[212:215], v[80:83], a[36:39]
  v_exp_f32 v25, v25
  v_mfma_f32_16x16x32_bf16 a[36:39], a[208:211], v[76:79], a[36:39]
  ds_read_b64_tr_b16 a[204:205], v218 offset:2048
  ds_read_b64_tr_b16 a[206:207], v218 offset:3072
  v_mfma_f32_16x16x32_bf16 a[40:43], a[208:211], v[88:91], a[40:43]
  buffer_load_dwordx4 v221, s[28:31], s47 offen offset:3072  lds
  v_mfma_f32_16x16x32_bf16 a[40:43], a[212:215], v[92:95], a[40:43]
  s_add_u32 s47, s47, 16384
  v_exp_f32 v26, v26
  v_mfma_f32_16x16x32_bf16 a[44:47], a[212:215], v[104:107], a[44:47]
  v_exp_f32 v27, v27
  v_mfma_f32_16x16x32_bf16 a[44:47], a[208:211], v[100:103], a[44:47]
  v_cvt_pk_bf16_f32 v98, v24, v25
  v_cvt_pk_bf16_f32 v99, v26, v27
  v_mfma_f32_16x16x32_bf16 a[60:63], a[216:219], v[100:103], a[60:63]
  v_exp_f32 v28, v28
  v_mfma_f32_16x16x32_bf16 a[60:63], a[220:223], v[104:107], a[60:63]
  ds_read_b64_tr_b16 a[208:209], v219 offset:0
  ds_read_b64_tr_b16 a[210:211], v219 offset:1024
  v_mfma_f32_16x16x32_bf16 a[56:59], a[220:223], v[92:95], a[56:59]
  v_exp_f32 v29, v29
  v_mfma_f32_16x16x32_bf16 a[56:59], a[216:219], v[88:91], a[56:59]
  ds_read_b64_tr_b16 a[212:213], v219 offset:2048
  ds_read_b64_tr_b16 a[214:215], v219 offset:3072
  v_mfma_f32_16x16x32_bf16 a[52:55], a[216:219], v[76:79], a[52:55]
  v_exp_f32 v30, v30
  v_mfma_f32_16x16x32_bf16 a[52:55], a[220:223], v[80:83], a[52:55]
  v_exp_f32 v31, v31
  v_mfma_f32_16x16x32_bf16 a[48:51], a[220:223], v[68:71], a[48:51]
  s_sub_u32 s50, s50, 1
  v_cvt_pk_bf16_f32 v110, v28, v29
  v_cvt_pk_bf16_f32 v111, v30, v31
  v_mfma_f32_16x16x32_bf16 a[48:51], a[216:219], v[64:67], a[48:51]
  s_cmp_lg_u32 s50, 0
  s_cbranch_scc1 K1_att
  v_mfma_f32_16x16x32_bf16 a[64:67], a[224:227], v[64:67], a[64:67]
  s_waitcnt vmcnt(21) lgkmcnt(0)
  s_barrier
  ds_read_b64_tr_b16 a[160:161], v227 offset:0
  v_mfma_f32_16x16x32_bf16 a[64:67], a[228:231], v[68:71], a[64:67]
  v_exp_f32 v32, v32
  v_mfma_f32_16x16x32_bf16 a[68:71], a[228:231], v[80:83], a[68:71]
  ds_read_b64_tr_b16 a[162:163], v227 offset:2560
  ds_read_b64_tr_b16 a[164:165], v227 offset:5120
  v_mfma_f32_16x16x32_bf16 a[68:71], a[224:227], v[76:79], a[68:71]
  v_exp_f32 v33, v33
  v_mfma_f32_16x16x32_bf16 a[72:75], a[224:227], v[88:91], a[72:75]
  s_lshl_b32 s52, s71, 2
  s_add_u32 s52, s52, s36
  s_lshl_b32 s52, s52, 7
  s_add_u32 s52, s52, 262144
  ds_read_b64_tr_b16 a[166:167], v227 offset:7680
  ds_read_b64_tr_b16 a[168:169], v227 offset:8
  v_mfma_f32_16x16x32_bf16 a[72:75], a[228:231], v[92:95], a[72:75]
  buffer_load_dword v225, v226, s[20:23], s52 offen sc1
  v_mfma_f32_16x16x32_bf16 a[76:79], a[228:231], v[104:107], a[76:79]
  v_exp_f32 v34, v34
  v_mfma_f32_16x16x32_bf16 a[76:79], a[224:227], v[100:103], a[76:79]
  ds_read_b64_tr_b16 a[170:171], v227 offset:2568
  ds_read_b64_tr_b16 a[172:173], v227 offset:5128
  v_mfma_f32_16x16x32_bf16 a[92:95], a[192:195], v[100:103], a[92:95]
  v_exp_f32 v35, v35
  v_mfma_f32_16x16x32_bf16 a[92:95], a[196:199], v[104:107], a[92:95]
  ds_read_b64_tr_b16 a[174:175], v227 offset:7688
  ds_read_b64_tr_b16 a[176:177], v227 offset:16
  v_mfma_f32_16x16x32_bf16 a[88:91], a[196:199], v[92:95], a[88:91]
  v_exp_f32 v36, v36
  v_mfma_f32_16x16x32_bf16 a[88:91], a[192:195], v[88:91], a[88:91]
  ds_read_b64_tr_b16 a[178:179], v227 offset:2576
  v_mfma_f32_16x16x32_bf16 a[84:87], a[192:195], v[76:79], a[84:87]
  ds_read_b64_tr_b16 a[180:181], v227 offset:5136
  v_mfma_f32_16x16x32_bf16 a[84:87], a[196:199], v[80:83], a[84:87]
  v_exp_f32 v37, v37
  v_mfma_f32_16x16x32_bf16 a[80:83], a[196:199], v[68:71], a[80:83]
  s_add_u32 m0, s85, s57
  ds_read_b64_tr_b16 a[182:183], v227 offset:7696
  ds_read_b64_tr_b16 a[184:185], v227 offset:24
  v_mfma_f32_16x16x32_bf16 a[80:83], a[192:195], v[64:67], a[80:83]
  buffer_load_dwordx4 v228, s[16:19], s58 offen offset:0 lds
  v_mfma_f32_16x16x32_bf16 a[96:99], a[200:203], v[64:67], a[96:99]
  v_exp_f32 v38, v38
  v_mfma_f32_16x16x32_bf16 a[96:99], a[204:207], v[68:71], a[96:99]
  ds_read_b64_tr_b16 a[186:187], v227 offset:2584
  ds_read_b64_tr_b16 a[188:189], v227 offset:5144
  v_mfma_f32_16x16x32_bf16 a[100:103], a[204:207], v[80:83], a[100:103]
  v_exp_f32 v39, v39
  v_mfma_f32_16x16x32_bf16 a[100:103], a[200:203], v[76:79], a[100:103]
  ds_read_b64_tr_b16 a[190:191], v227 offset:7704
  ds_read_b64_tr_b16 a[248:249], v227 offset:32
  v_mfma_f32_16x16x32_bf16 a[104:107], a[200:203], v[88:91], a[104:107]
  ds_read_b64_tr_b16 a[250:251], v227 offset:2592
  v_mfma_f32_16x16x32_bf16 a[104:107], a[204:207], v[92:95], a[104:107]
  v_exp_f32 v40, v40
  v_mfma_f32_16x16x32_bf16 a[108:111], a[204:207], v[104:107], a[108:111]
  ds_read_b64_tr_b16 a[252:253], v227 offset:5152
  ds_read_b64_tr_b16 a[254:255], v227 offset:7712
  v_mfma_f32_16x16x32_bf16 a[108:111], a[200:203], v[100:103], a[108:111]
  v_exp_f32 v41, v41
  v_mfma_f32_16x16x32_bf16 a[124:127], a[208:211], v[100:103], a[124:127]
  ds_read_b128 a[128:131], v208 offset:32768
  v_mfma_f32_16x16x32_bf16 a[124:127], a[212:215], v[104:107], a[124:127]
  ds_read_b128 a[132:135], v209 offset:32768
  v_mfma_f32_16x16x32_bf16 a[120:123], a[212:215], v[92:95], a[120:123]
  buffer_load_dwordx4 v229, s[16:19], s58 offen offset:1024 lds
  v_mfma_f32_16x16x32_bf16 a[120:123], a[208:211], v[88:91], a[120:123]
  v_exp_f32 v42, v42
  v_mfma_f32_16x16x32_bf16 a[116:119], a[208:211], v[76:79], a[116:119]
  ds_read_b128 a[136:139], v210 offset:32768
  ds_read_b128 a[140:143], v211 offset:32768
  v_mfma_f32_16x16x32_bf16 a[116:119], a[212:215], v[80:83], a[116:119]
  ds_read_b128 a[144:147], v208 offset:33792
  ds_read_b128 a[148:151], v209 offset:33792
  v_mfma_f32_16x16x32_bf16 a[112:115], a[212:215], v[68:71], a[112:115]
  v_exp_f32 v43, v43
  v_mfma_f32_16x16x32_bf16 a[112:115], a[208:211], v[64:67], a[112:115]
  s_waitcnt lgkmcnt(4)
  ds_read_b128 a[152:155], v210 offset:33792
  ds_read_b128 a[156:159], v211 offset:33792
  v_mfma_f32_16x16x32_bf16 v[232:235], a[160:163], v[112:115], v[232:235]
  v_exp_f32 v44, v44
  v_mfma_f32_16x16x32_bf16 v[232:235], a[164:167], v[116:119], v[232:235]
  ds_read_b64_tr_b16 a[216:217], v215 offset:16384
  ds_read_b64_tr_b16 a[218:219], v215 offset:17408
  v_mfma_f32_16x16x32_bf16 v[236:239], a[172:175], v[116:119], v[236:239]
  ds_read_b64_tr_b16 a[220:221], v215 offset:18432
  ds_read_b64_tr_b16 a[222:223], v215 offset:19456
  v_mfma_f32_16x16x32_bf16 v[236:239], a[168:171], v[112:115], v[236:239]
  s_mov_b32 s57, s56
  v_exp_f32 v45, v45
  v_mfma_f32_16x16x32_bf16 v[240:243], a[176:179], v[112:115], v[240:243]
  s_add_u32 s56, s56, 10752
  ds_read_b64_tr_b16 a[224:225], v216 offset:16384
  ds_read_b64_tr_b16 a[226:227], v216 offset:17408
  v_mfma_f32_16x16x32_bf16 v[240:243], a[180:183], v[116:119], v[240:243]
  s_cmp_eq_u32 s56, 32256
  ds_read_b64_tr_b16 a[228:229], v216 offset:18432
  ds_read_b64_tr_b16 a[230:231], v216 offset:19456
  v_mfma_f32_16x16x32_bf16 v[244:247], a[188:191], v[116:119], v[244:247]
  s_cselect_b32 s56, 0, s56
  buffer_load_dwordx4 v230, s[16:19], s58 offen offset:2048 lds
  v_mfma_f32_16x16x32_bf16 v[244:247], a[184:187], v[112:115], v[244:247]
  s_add_u32 s58, s58, 81920
  s_sub_u32 s49, s56, s57
  v_exp_f32 v46, v46
  v_mfma_f32_16x16x32_bf16 v[248:251], a[248:251], v[112:115], v[248:251]
  v_exp_f32 v47, v47
  v_mfma_f32_16x16x32_bf16 v[248:251], a[252:255], v[116:119], v[248:251]
  v_add_u32 v227, s49, v227
  s_mov_b32 s54, 0x100000
  s_waitcnt vmcnt(3)
  v_mov_b32 v225, v225
K1_spinW:
  v_cmp_gt_u32 vcc, 1, v225
  s_nop 4
  s_cbranch_vccz K1_spinW_ok
  s_sleep 2
  buffer_load_dword v225, v226, s[20:23], s52 offen sc1
  s_sub_u32 s54, s54, 1
  s_cmp_lg_u32 s54, 0
  s_waitcnt vmcnt(0)
  s_cbranch_scc1 K1_spinW
K1_spinW_ok:
  v_mfma_f32_16x16x32_bf16 v[0:3], a[128:131], v[128:131], v[192:195]
  v_exp_f32 v48, v48
  v_mfma_f32_16x16x32_bf16 v[0:3], a[132:135], v[132:135], v[0:3]
  s_waitcnt lgkmcnt(0)
  ds_read_b128 a[160:163], v208 offset:34816
  ds_read_b128 a[164:167], v209 offset:34816
  v_mfma_f32_16x16x32_bf16 v[0:3], a[136:139], v[136:139], v[0:3]
  buffer_load_dwordx4 v[112:115], v223, s[8:11], s59 offen sc1
  v_mfma_f32_16x16x32_bf16 v[0:3], a[140:143], v[140:143], v[0:3]
  s_add_u32 s59, s59, 4096
  v_exp_f32 v49, v49
  v_mfma_f32_16x16x32_bf16 v[4:7], a[140:143], v[156:159], v[196:199]
  v_cvt_pk_bf16_f32 v68, v32, v33
  v_cvt_pk_bf16_f32 v69, v34, v35
  v_mfma_f32_16x16x32_bf16 v[4:7], a[136:139], v[152:155], v[4:7]
  v_exp_f32 v50, v50
  v_mfma_f32_16x16x32_bf16 v[4:7], a[132:135], v[148:151], v[4:7]
  v_exp_f32 v51, v51
  v_mfma_f32_16x16x32_bf16 v[4:7], a[128:131], v[144:147], v[4:7]
  v_cvt_pk_bf16_f32 v80, v36, v37
  v_cvt_pk_bf16_f32 v81, v38, v39
  v_mfma_f32_16x16x32_bf16 v[8:11], a[128:131], v[160:163], v[200:203]
  v_exp_f32 v52, v52
  v_mfma_f32_16x16x32_bf16 v[8:11], a[132:135], v[164:167], v[8:11]
  ds_read_b128 a[168:171], v210 offset:34816
  ds_read_b128 a[172:175], v211 offset:34816
  v_mfma_f32_16x16x32_bf16 v[8:11], a[136:139], v[168:171], v[8:11]
  buffer_load_dwordx4 v[116:119], v223, s[8:11], s59 offen sc1
  v_mfma_f32_16x16x32_bf16 v[8:11], a[140:143], v[172:175], v[8:11]
  s_add_u32 s59, s59, 4096
  v_exp_f32 v53, v53
  v_mfma_f32_16x16x32_bf16 v[12:15], a[140:143], v[188:191], v[204:207]
  v_cvt_pk_bf16_f32 v92, v40, v41
  v_cvt_pk_bf16_f32 v93, v42, v43
  v_mfma_f32_16x16x32_bf16 v[12:15], a[136:139], v[184:187], v[12:15]
  v_exp_f32 v54, v54
  v_mfma_f32_16x16x32_bf16 v[12:15], a[132:135], v[180:183], v[12:15]
  v_exp_f32 v55, v55
  v_mfma_f32_16x16x32_bf16 v[12:15], a[128:131], v[176:179], v[12:15]
  v_cvt_pk_bf16_f32 v104, v44, v45
  v_cvt_pk_bf16_f32 v105, v46, v47
  v_mfma_f32_16x16x32_bf16 v[28:31], a[144:147], v[176:179], v[204:207]
  v_exp_f32 v56, v56
  v_mfma_f32_16x16x32_bf16 v[28:31], a[148:151], v[180:183], v[28:31]
  s_add_u32 m0, s44, 16384
  s_add_u32 s55, s41, 36864
  ds_read_b128 a[176:179], v208 offset:35840
  ds_read_b128 a[180:183], v209 offset:35840
  v_mfma_f32_16x16x32_bf16 v[28:31], a[152:155], v[184:187], v[28:31]
  buffer_load_dwordx4 v223, s[12:15], s55 offen offset:0 sc1 lds
  v_mfma_f32_16x16x32_bf16 v[28:31], a[156:159], v[188:191], v[28:31]
  v_exp_f32 v57, v57
  v_mfma_f32_16x16x32_bf16 v[24:27], a[156:159], v[172:175], v[200:203]
  v_cvt_pk_bf16_f32 v70, v48, v49
  v_cvt_pk_bf16_f32 v71, v50, v51
  v_mfma_f32_16x16x32_bf16 v[24:27], a[152:155], v[168:171], v[24:27]
  v_exp_f32 v58, v58
  v_mfma_f32_16x16x32_bf16 v[24:27], a[148:151], v[164:167], v[24:27]
  v_exp_f32 v59, v59
  v_mfma_f32_16x16x32_bf16 v[24:27], a[144:147], v[160:163], v[24:27]
  v_cvt_pk_bf16_f32 v82, v52, v53
  v_cvt_pk_bf16_f32 v83, v54, v55
  v_mfma_f32_16x16x32_bf16 v[20:23], a[144:147], v[144:147], v[196:199]
  v_exp_f32 v60, v60
  v_mfma_f32_16x16x32_bf16 v[20:23], a[148:151], v[148:151], v[20:23]
  ds_read_b128 a[184:187], v210 offset:35840
  ds_read_b128 a[188:191], v211 offset:35840
  v_mfma_f32_16x16x32_bf16 v[20:23], a[152:155], v[152:155], v[20:23]
  buffer_load_dwordx4 v223, s[12:15], s55 offen offset:1024 sc1 lds
  v_mfma_f32_16x16x32_bf16 v[20:23], a[156:159], v[156:159], v[20:23]
  v_exp_f32 v61, v61
  v_mfma_f32_16x16x32_bf16 v[16:19], a[156:159], v[140:143], v[192:195]
  v_cvt_pk_bf16_f32 v94, v56, v57
  v_cvt_pk_bf16_f32 v95, v58, v59
  v_mfma_f32_16x16x32_bf16 v[16:19], a[152:155], v[136:139], v[16:19]
  v_exp_f32 v62, v62
  v_mfma_f32_16x16x32_bf16 v[16:19], a[148:151], v[132:135], v[16:19]
  v_exp_f32 v63, v63
  v_mfma_f32_16x16x32_bf16 v[16:19], a[144:147], v[128:131], v[16:19]
  s_waitcnt lgkmcnt(0)
  v_cvt_pk_bf16_f32 v106, v60, v61
  v_cvt_pk_bf16_f32 v107, v62, v63
  v_mfma_f32_16x16x32_bf16 v[32:35], a[160:163], v[128:131], v[192:195]
  v_exp_f32 v0, v0
  v_mfma_f32_16x16x32_bf16 v[32:35], a[164:167], v[132:135], v[32:35]
  ds_read_b64_tr_b16 a[192:193], v212 offset:16384
  v_mfma_f32_16x16x32_bf16 v[32:35], a[168:171], v[136:139], v[32:35]
  v_exp_f32 v1, v1
  v_mfma_f32_16x16x32_bf16 v[32:35], a[172:175], v[140:143], v[32:35]
  ds_read_b64_tr_b16 a[194:195], v212 offset:17408
  v_cvt_pk_bf16_f32 v64, v0, v1
  v_mfma_f32_16x16x32_bf16 v[36:39], a[172:175], v[156:159], v[196:199]
  buffer_load_dwordx4 v223, s[12:15], s55 offen offset:2048 sc1 lds
  v_mfma_f32_16x16x32_bf16 v[36:39], a[168:171], v[152:155], v[36:39]
  v_exp_f32 v2, v2
  v_mfma_f32_16x16x32_bf16 v[36:39], a[164:167], v[148:151], v[36:39]
  ds_read_b64_tr_b16 a[196:197], v212 offset:18432
  v_mfma_f32_16x16x32_bf16 v[36:39], a[160:163], v[144:147], v[36:39]
  v_exp_f32 v3, v3
  v_smfmac_f32_16x16x64_bf16 a[232:235], v[252:255], v[68:75], v224
  v_cvt_pk_bf16_f32 v65, v2, v3
  v_mfma_f32_16x16x32_bf16 v[40:43], a[160:163], v[160:163], v[200:203]
  v_exp_f32 v4, v4
  v_mfma_f32_16x16x32_bf16 v[40:43], a[164:167], v[164:167], v[40:43]
  ds_read_b64_tr_b16 a[198:199], v212 offset:19456
  v_mfma_f32_16x16x32_bf16 v[40:43], a[168:171], v[168:171], v[40:43]
  buffer_load_dwordx4 v223, s[12:15], s55 offen offset:3072 sc1 lds
  v_mfma_f32_16x16x32_bf16 v[40:43], a[172:175], v[172:175], v[40:43]
  v_exp_f32 v5, v5
  v_mfma_f32_16x16x32_bf16 v[44:47], a[172:175], v[188:191], v[204:207]
  ds_read_b64_tr_b16 a[200:201], v213 offset:16384
  v_cvt_pk_bf16_f32 v76, v4, v5
  v_mfma_f32_16x16x32_bf16 v[44:47], a[168:171], v[184:187], v[44:47]
  v_exp_f32 v6, v6
  v_mfma_f32_16x16x32_bf16 v[44:47], a[164:167], v[180:183], v[44:47]
  ds_read_b64_tr_b16 a[202:203], v213 offset:17408
  v_mfma_f32_16x16x32_bf16 v[44:47], a[160:163], v[176:179], v[44:47]
  v_exp_f32 v7, v7
  v_smfmac_f32_16x16x64_bf16 a[236:239], v[252:255], v[80:87], v224
  s_add_u32 m0, s44, 65536
  s_add_u32 s55, s41, 40960
  ds_read_b64_tr_b16 a[204:205], v213 offset:18432
  v_cvt_pk_bf16_f32 v77, v6, v7
  v_mfma_f32_16x16x32_bf16 v[60:63], a[176:179], v[176:179], v[204:207]
  buffer_load_dwordx4 v223, s[12:15], s55 offen offset:0 sc1 lds
  v_mfma_f32_16x16x32_bf16 v[60:63], a[180:183], v[180:183], v[60:63]
  v_exp_f32 v8, v8
  v_mfma_f32_16x16x32_bf16 v[60:63], a[184:187], v[184:187], v[60:63]
  ds_read_b64_tr_b16 a[206:207], v213 offset:19456
  v_mfma_f32_16x16x32_bf16 v[60:63], a[188:191], v[188:191], v[60:63]
  v_exp_f32 v9, v9
  v_mfma_f32_16x16x32_bf16 v[56:59], a[188:191], v[172:175], v[200:203]
  ds_read_b64_tr_b16 a[208:209], v214 offset:16384
  v_cvt_pk_bf16_f32 v88, v8, v9
  v_mfma_f32_16x16x32_bf16 v[56:59], a[184:187], v[168:171], v[56:59]
  v_exp_f32 v10, v10
  v_mfma_f32_16x16x32_bf16 v[56:59], a[180:183], v[164:167], v[56:59]
  v_exp_f32 v11, v11
  v_mfma_f32_16x16x32_bf16 v[56:59], a[176:179], v[160:163], v[56:59]
  buffer_load_dwordx4 v223, s[12:15], s55 offen offset:1024 sc1 lds
  v_smfmac_f32_16x16x64_bf16 a[240:243], v[252:255], v[92:99], v224
  ds_read_b64_tr_b16 a[210:211], v214 offset:17408
  v_cvt_pk_bf16_f32 v89, v10, v11
  v_mfma_f32_16x16x32_bf16 v[52:55], a[176:179], v[144:147], v[196:199]
  v_exp_f32 v12, v12
  v_mfma_f32_16x16x32_bf16 v[52:55], a[180:183], v[148:151], v[52:55]
  ds_read_b64_tr_b16 a[212:213], v214 offset:18432
  v_mfma_f32_16x16x32_bf16 v[52:55], a[184:187], v[152:155], v[52:55]
  v_exp_f32 v13, v13
  v_mfma_f32_16x16x32_bf16 v[52:55], a[188:191], v[156:159], v[52:55]
  ds_read_b64_tr_b16 a[214:215], v214 offset:19456
  v_cvt_pk_bf16_f32 v100, v12, v13
  v_mfma_f32_16x16x32_bf16 v[48:51], a[188:191], v[140:143], v[192:195]
  v_exp_f32 v14, v14
  v_mfma_f32_16x16x32_bf16 v[48:51], a[184:187], v[136:139], v[48:51]
  buffer_load_dwordx4 v223, s[12:15], s55 offen offset:2048 sc1 lds
  v_mfma_f32_16x16x32_bf16 v[48:51], a[180:183], v[132:135], v[48:51]
  v_exp_f32 v15, v15
  v_mfma_f32_16x16x32_bf16 v[48:51], a[176:179], v[128:131], v[48:51]
  v_cvt_pk_bf16_f32 v101, v14, v15
  v_smfmac_f32_16x16x64_bf16 a[244:247], v[252:255], v[104:111], v224
  s_waitcnt lgkmcnt(1)
  v_mfma_f32_16x16x32_bf16 a[0:3], a[192:195], v[72:75], a[0:3]
  v_exp_f32 v16, v16
  v_mfma_f32_16x16x32_bf16 a[0:3], a[196:199], v[68:71], a[0:3]
  v_exp_f32 v17, v17
  v_mfma_f32_16x16x32_bf16 a[4:7], a[196:199], v[80:83], a[4:7]
  v_cvt_pk_bf16_f32 v66, v16, v17
  v_mfma_f32_16x16x32_bf16 a[4:7], a[192:195], v[84:87], a[4:7]
  buffer_load_dwordx4 v223, s[12:15], s55 offen offset:3072 sc1 lds
  v_mfma_f32_16x16x32_bf16 a[8:11], a[192:195], v[96:99], a[8:11]
  v_exp_f32 v18, v18
  v_mfma_f32_16x16x32_bf16 a[8:11], a[196:199], v[92:95], a[8:11]
  v_exp_f32 v19, v19
  v_mfma_f32_16x16x32_bf16 a[12:15], a[196:199], v[104:107], a[12:15]
  v_cvt_pk_bf16_f32 v67, v18, v19
  v_mfma_f32_16x16x32_bf16 a[12:15], a[192:195], v[108:111], a[12:15]
  v_exp_f32 v20, v20
  v_mfma_f32_16x16x32_bf16 a[28:31], a[200:203], v[108:111], a[28:31]
  ds_read_b64_tr_b16 a[192:193], v217 offset:16384
  ds_read_b64_tr_b16 a[194:195], v217 offset:17408
  v_mfma_f32_16x16x32_bf16 a[28:31], a[204:207], v[104:107], a[28:31]
  s_add_u32 m0, s44, 0
  s_add_u32 s55, s41, 53248
  ds_read_b64_tr_b16 a[196:197], v217 offset:18432
  ds_read_b64_tr_b16 a[198:199], v217 offset:19456
  v_mfma_f32_16x16x32_bf16 a[24:27], a[204:207], v[92:95], a[24:27]
  buffer_load_dwordx4 v223, s[12:15], s55 offen offset:0 sc1 lds
  v_mfma_f32_16x16x32_bf16 a[24:27], a[200:203], v[96:99], a[24:27]
  v_exp_f32 v21, v21
  v_mfma_f32_16x16x32_bf16 a[20:23], a[200:203], v[84:87], a[20:23]
  v_cvt_pk_bf16_f32 v78, v20, v21
  v_mfma_f32_16x16x32_bf16 a[20:23], a[204:207], v[80:83], a[20:23]
  v_exp_f32 v22, v22
  v_mfma_f32_16x16x32_bf16 a[16:19], a[204:207], v[68:71], a[16:19]
  v_exp_f32 v23, v23
  v_mfma_f32_16x16x32_bf16 a[16:19], a[200:203], v[72:75], a[16:19]
  v_cvt_pk_bf16_f32 v79, v22, v23
  v_mfma_f32_16x16x32_bf16 a[32:35], a[208:211], v[72:75], a[32:35]
  s_waitcnt lgkmcnt(0)
  buffer_load_dwordx4 v223, s[12:15], s55 offen offset:1024 sc1 lds
  v_mfma_f32_16x16x32_bf16 a[32:35], a[212:215], v[68:71], a[32:35]
  v_exp_f32 v24, v24
  v_mfma_f32_16x16x32_bf16 a[36:39], a[212:215], v[80:83], a[36:39]
  ds_read_b64_tr_b16 a[200:201], v218 offset:16384
  ds_read_b64_tr_b16 a[202:203], v218 offset:17408
  v_mfma_f32_16x16x32_bf16 a[36:39], a[208:211], v[84:87], a[36:39]
  ds_read_b64_tr_b16 a[204:205], v218 offset:18432
  ds_read_b64_tr_b16 a[206:207], v218 offset:19456
  v_mfma_f32_16x16x32_bf16 a[40:43], a[208:211], v[96:99], a[40:43]
  v_exp_f32 v25, v25
  v_mfma_f32_16x16x32_bf16 a[40:43], a[212:215], v[92:95], a[40:43]
  v_cvt_pk_bf16_f32 v90, v24, v25
  v_mfma_f32_16x16x32_bf16 a[44:47], a[212:215], v[104:107], a[44:47]
  v_exp_f32 v26, v26
  v_mfma_f32_16x16x32_bf16 a[44:47], a[208:211], v[108:111], a[44:47]
  v_exp_f32 v27, v27
  v_mfma_f32_16x16x32_bf16 a[60:63], a[216:219], v[108:111], a[60:63]
  buffer_load_dwordx4 v223, s[12:15], s55 offen offset:2048 sc1 lds
  v_mfma_f32_16x16x32_bf16 a[60:63], a[220:223], v[104:107], a[60:63]
  ds_read_b64_tr_b16 a[208:209], v219 offset:16384
  v_cvt_pk_bf16_f32 v91, v26, v27
  v_mfma_f32_16x16x32_bf16 a[56:59], a[220:223], v[92:95], a[56:59]
  v_exp_f32 v28, v28
  v_mfma_f32_16x16x32_bf16 a[56:59], a[216:219], v[96:99], a[56:59]
  ds_read_b64_tr_b16 a[210:211], v219 offset:17408
  ds_read_b64_tr_b16 a[212:213], v219 offset:18432
  ds_read_b64_tr_b16 a[214:215], v219 offset:19456
  v_mfma_f32_16x16x32_bf16 a[52:55], a[216:219], v[84:87], a[52:55]
  v_exp_f32 v29, v29
  v_mfma_f32_16x16x32_bf16 a[52:55], a[220:223], v[80:83], a[52:55]
  v_cvt_pk_bf16_f32 v102, v28, v29
  v_mfma_f32_16x16x32_bf16 a[48:51], a[220:223], v[68:71], a[48:51]
  v_exp_f32 v30, v30
  v_mfma_f32_16x16x32_bf16 a[48:51], a[216:219], v[72:75], a[48:51]
  buffer_load_dwordx4 v223, s[12:15], s55 offen offset:3072 sc1 lds
  v_exp_f32 v31, v31
  s_nop 0
  v_cvt_pk_bf16_f32 v103, v30, v31
  v_mfma_f32_16x16x32_bf16 a[64:67], a[224:227], v[72:75], a[64:67]
  s_waitcnt vmcnt(17) lgkmcnt(0)
  s_barrier
  v_exp_f32 v32, v32
  v_mfma_f32_16x16x32_bf16 a[64:67], a[228:231], v[68:71], a[64:67]
  ds_read_b128 a[128:131], v208 offset:49152
  v_mfma_f32_16x16x32_bf16 a[68:71], a[228:231], v[80:83], a[68:71]
  v_exp_f32 v33, v33
  v_mfma_f32_16x16x32_bf16 a[68:71], a[224:227], v[84:87], a[68:71]
  s_mov_b32 m0, s85
  s_mul_i32 s58, s36, 20480
  ds_read_b128 a[132:135], v209 offset:49152
  v_mfma_f32_16x16x32_bf16 a[72:75], a[224:227], v[96:99], a[72:75]
  buffer_load_dwordx4 v228, s[72:75], s58 offen offset:0 lds
  v_mfma_f32_16x16x32_bf16 a[72:75], a[228:231], v[92:95], a[72:75]
  v_exp_f32 v34, v34
  v_mfma_f32_16x16x32_bf16 a[76:79], a[228:231], v[104:107], a[76:79]
  ds_read_b128 a[136:139], v210 offset:49152
  ds_read_b128 a[140:143], v211 offset:49152
  v_mfma_f32_16x16x32_bf16 a[76:79], a[224:227], v[108:111], a[76:79]
  v_exp_f32 v35, v35
  v_mfma_f32_16x16x32_bf16 a[92:95], a[192:195], v[108:111], a[92:95]
  ds_read_b128 a[144:147], v208 offset:50176
  v_mfma_f32_16x16x32_bf16 a[92:95], a[196:199], v[104:107], a[92:95]
  buffer_load_dwordx4 v229, s[72:75], s58 offen offset:1024 lds
  v_mfma_f32_16x16x32_bf16 a[88:91], a[196:199], v[92:95], a[88:91]
  v_exp_f32 v36, v36
  v_mfma_f32_16x16x32_bf16 a[88:91], a[192:195], v[96:99], a[88:91]
  ds_read_b128 a[148:151], v209 offset:50176
  ds_read_b128 a[152:155], v210 offset:50176
  v_mfma_f32_16x16x32_bf16 a[84:87], a[192:195], v[84:87], a[84:87]
  v_exp_f32 v37, v37
  v_mfma_f32_16x16x32_bf16 a[84:87], a[196:199], v[80:83], a[84:87]
  v_exp_f32 v38, v38
  v_mfma_f32_16x16x32_bf16 a[80:83], a[196:199], v[68:71], a[80:83]
  ds_read_b128 a[156:159], v211 offset:50176
  ds_read_b64_tr_b16 a[216:217], v215 offset:32768
  v_mfma_f32_16x16x32_bf16 a[80:83], a[192:195], v[72:75], a[80:83]
  buffer_load_dwordx4 v230, s[72:75], s58 offen offset:2048 lds
  v_mfma_f32_16x16x32_bf16 a[96:99], a[200:203], v[72:75], a[96:99]
  v_exp_f32 v39, v39
  v_mfma_f32_16x16x32_bf16 a[96:99], a[204:207], v[68:71], a[96:99]
  v_exp_f32 v40, v40
  v_mfma_f32_16x16x32_bf16 a[100:103], a[204:207], v[80:83], a[100:103]
  ds_read_b64_tr_b16 a[218:219], v215 offset:33792
  ds_read_b64_tr_b16 a[220:221], v215 offset:34816
  v_mfma_f32_16x16x32_bf16 a[100:103], a[200:203], v[84:87], a[100:103]
  s_add_u32 m0, s44, 32768
  s_add_u32 s55, s41, 45056
  v_exp_f32 v41, v41
  v_mfma_f32_16x16x32_bf16 a[104:107], a[200:203], v[96:99], a[104:107]
  buffer_load_dwordx4 v223, s[12:15], s55 offen offset:0 sc1 lds
  v_mfma_f32_16x16x32_bf16 a[104:107], a[204:207], v[92:95], a[104:107]
  v_exp_f32 v42, v42
  v_mfma_f32_16x16x32_bf16 a[108:111], a[204:207], v[104:107], a[108:111]
  ds_read_b64_tr_b16 a[222:223], v215 offset:35840
  ds_read_b64_tr_b16 a[224:225], v216 offset:32768
  v_mfma_f32_16x16x32_bf16 a[108:111], a[200:203], v[108:111], a[108:111]
  v_exp_f32 v43, v43
  v_mfma_f32_16x16x32_bf16 a[124:127], a[208:211], v[108:111], a[124:127]
  ds_read_b64_tr_b16 a[226:227], v216 offset:33792
  ds_read_b64_tr_b16 a[228:229], v216 offset:34816
  v_mfma_f32_16x16x32_bf16 a[124:127], a[212:215], v[104:107], a[124:127]
  buffer_load_dwordx4 v223, s[12:15], s55 offen offset:1024 sc1 lds
  v_mfma_f32_16x16x32_bf16 a[120:123], a[212:215], v[92:95], a[120:123]
  v_exp_f32 v44, v44
  v_mfma_f32_16x16x32_bf16 a[120:123], a[208:211], v[96:99], a[120:123]
  v_exp_f32 v45, v45
  v_mfma_f32_16x16x32_bf16 a[116:119], a[208:211], v[84:87], a[116:119]
  ds_read_b64_tr_b16 a[230:231], v216 offset:35840
  v_mfma_f32_16x16x32_bf16 a[116:119], a[212:215], v[80:83], a[116:119]
  v_exp_f32 v46, v46
  v_mfma_f32_16x16x32_bf16 a[112:115], a[212:215], v[68:71], a[112:115]
  buffer_load_dwordx4 v223, s[12:15], s55 offen offset:2048 sc1 lds
  v_mfma_f32_16x16x32_bf16 a[112:115], a[208:211], v[72:75], a[112:115]
  s_waitcnt lgkmcnt(1)
  v_exp_f32 v47, v47
  v_mfma_f32_16x16x32_bf16 v[0:3], a[128:131], v[128:131], v[192:195]
  v_exp_f32 v48, v48
  v_mfma_f32_16x16x32_bf16 v[0:3], a[132:135], v[132:135], v[0:3]
  ds_read_b128 a[160:163], v208 offset:51200
  v_cvt_pk_bf16_f32 v68, v32, v33
  v_mfma_f32_16x16x32_bf16 v[0:3], a[136:139], v[136:139], v[0:3]
  v_exp_f32 v49, v49
  v_mfma_f32_16x16x32_bf16 v[0:3], a[140:143], v[140:143], v[0:3]
  buffer_load_dwordx4 v223, s[12:15], s55 offen offset:3072 sc1 lds
  v_mfma_f32_16x16x32_bf16 v[4:7], a[140:143], v[156:159], v[196:199]
  v_cvt_pk_bf16_f32 v69, v34, v35
  v_mfma_f32_16x16x32_bf16 v[4:7], a[136:139], v[152:155], v[4:7]
  v_exp_f32 v50, v50
  v_mfma_f32_16x16x32_bf16 v[4:7], a[132:135], v[148:151], v[4:7]
  ds_read_b128 a[164:167], v209 offset:51200
  v_cvt_pk_bf16_f32 v80, v36, v37
  v_mfma_f32_16x16x32_bf16 v[4:7], a[128:131], v[144:147], v[4:7]
  s_add_u32 m0, s44, 81920
  s_add_u32 s55, s41, 49152
  v_exp_f32 v51, v51
  v_mfma_f32_16x16x32_bf16 v[8:11], a[128:131], v[160:163], v[200:203]
  buffer_load_dwordx4 v223, s[12:15], s55 offen offset:0 sc1 lds
  v_mfma_f32_16x16x32_bf16 v[8:11], a[132:135], v[164:167], v[8:11]
  ds_read_b128 a[168:171], v210 offset:51200
  v_cvt_pk_bf16_f32 v81, v38, v39
  v_mfma_f32_16x16x32_bf16 v[8:11], a[136:139], v[168:171], v[8:11]
  v_exp_f32 v52, v52
  v_mfma_f32_16x16x32_bf16 v[8:11], a[140:143], v[172:175], v[8:11]
  v_cvt_pk_bf16_f32 v92, v40, v41
  v_cvt_pk_bf16_f32 v93, v42, v43
  v_mfma_f32_16x16x32_bf16 v[12:15], a[140:143], v[188:191], v[204:207]
  v_exp_f32 v53, v53
  v_mfma_f32_16x16x32_bf16 v[12:15], a[136:139], v[184:187], v[12:15]
  buffer_load_dwordx4 v223, s[12:15], s55 offen offset:1024 sc1 lds
  v_mfma_f32_16x16x32_bf16 v[12:15], a[132:135], v[180:183], v[12:15]
  v_exp_f32 v54, v54
  v_mfma_f32_16x16x32_bf16 v[12:15], a[128:131], v[176:179], v[12:15]
  ds_read_b128 a[172:175], v211 offset:51200
  v_cvt_pk_bf16_f32 v104, v44, v45
  v_mfma_f32_16x16x32_bf16 v[28:31], a[144:147], v[176:179], v[204:207]
  v_exp_f32 v55, v55
  v_mfma_f32_16x16x32_bf16 v[28:31], a[148:151], v[180:183], v[28:31]
  v_cvt_pk_bf16_f32 v105, v46, v47
  v_cvt_pk_bf16_f32 v70, v48, v49
  v_mfma_f32_16x16x32_bf16 v[28:31], a[152:155], v[184:187], v[28:31]
  ds_read_b128 a[176:179], v208 offset:52224
  v_cvt_pk_bf16_f32 v71, v50, v51
  v_cvt_pk_bf16_f32 v82, v52, v53
  v_cvt_pk_bf16_f32 v83, v54, v55
  v_mfma_f32_16x16x32_bf16 v[28:31], a[156:159], v[188:191], v[28:31]
  buffer_load_dwordx4 v223, s[12:15], s55 offen offset:2048 sc1 lds
  v_exp_f32 v56, v56
  v_mfma_f32_16x16x32_bf16 v[24:27], a[156:159], v[172:175], v[200:203]
  v_exp_f32 v57, v57
  v_mfma_f32_16x16x32_bf16 v[24:27], a[152:155], v[168:171], v[24:27]
  ds_read_b128 a[180:183], v209 offset:52224
  v_cvt_pk_bf16_f32 v94, v56, v57
  v_mfma_f32_16x16x32_bf16 v[24:27], a[148:151], v[164:167], v[24:27]
  v_exp_f32 v58, v58
  v_mfma_f32_16x16x32_bf16 v[24:27], a[144:147], v[160:163], v[24:27]
  buffer_load_dwordx4 v223, s[12:15], s55 offen offset:3072 sc1 lds
  v_mfma_f32_16x16x32_bf16 v[20:23], a[144:147], v[144:147], v[196:199]
  v_exp_f32 v59, v59
  v_mfma_f32_16x16x32_bf16 v[20:23], a[148:151], v[148:151], v[20:23]
  ds_read_b128 a[184:187], v210 offset:52224
  v_cvt_pk_bf16_f32 v95, v58, v59
  v_mfma_f32_16x16x32_bf16 v[20:23], a[152:155], v[152:155], v[20:23]
  s_add_u32 s55, s41, 16384
  v_exp_f32 v60, v60
  v_mfma_f32_16x16x32_bf16 v[20:23], a[156:159], v[156:159], v[20:23]
  buffer_load_dwordx4 a[248:251], v223, s[12:15], s55 offen offset:0 sc1
  v_mfma_f32_16x16x32_bf16 v[16:19], a[156:159], v[140:143], v[192:195]
  ds_read_b128 a[188:191], v211 offset:52224
  v_exp_f32 v61, v61
  v_mfma_f32_16x16x32_bf16 v[16:19], a[152:155], v[136:139], v[16:19]
  v_cvt_pk_bf16_f32 v106, v60, v61
  v_mfma_f32_16x16x32_bf16 v[16:19], a[148:151], v[132:135], v[16:19]
  s_add_u32 s55, s41, 16384
  v_exp_f32 v62, v62
  v_mfma_f32_16x16x32_bf16 v[16:19], a[144:147], v[128:131], v[16:19]
  s_waitcnt lgkmcnt(1)
  buffer_load_dwordx4 a[252:255], v223, s[12:15], s55 offen offset:1024 sc1
  v_exp_f32 v63, v63
  s_nop 0
  v_cvt_pk_bf16_f32 v107, v62, v63
  v_mfma_f32_16x16x32_bf16 v[32:35], a[160:163], v[128:131], v[192:195]
  v_exp_f32 v0, v0
  v_mfma_f32_16x16x32_bf16 v[32:35], a[164:167], v[132:135], v[32:35]
  ds_read_b64_tr_b16 a[192:193], v212 offset:32768
  v_mfma_f32_16x16x32_bf16 v[32:35], a[168:171], v[136:139], v[32:35]
  s_add_u32 s55, s41, 0
  v_exp_f32 v1, v1
  v_mfma_f32_16x16x32_bf16 v[32:35], a[172:175], v[140:143], v[32:35]
  buffer_load_dwordx4 a[128:131], v223, s[12:15], s55 offen offset:0 sc1
  v_mfma_f32_16x16x32_bf16 v[36:39], a[172:175], v[156:159], v[196:199]
  ds_read_b64_tr_b16 a[194:195], v212 offset:33792
  v_cvt_pk_bf16_f32 v72, v0, v1
  v_mfma_f32_16x16x32_bf16 v[36:39], a[168:171], v[152:155], v[36:39]
K1_st12:
  s_cbranch_execz K1_back
  v_exp_f32 v2, v2
  v_mfma_f32_16x16x32_bf16 v[36:39], a[164:167], v[148:151], v[36:39]
  ds_read_b64_tr_b16 a[196:197], v212 offset:34816
  v_mfma_f32_16x16x32_bf16 v[36:39], a[160:163], v[144:147], v[36:39]
  s_add_u32 s55, s41, 0
  v_exp_f32 v3, v3
  v_smfmac_f32_16x16x64_bf16 a[232:235], v[252:255], v[64:71], v224
  buffer_load_dwordx4 a[132:135], v223, s[12:15], s55 offen offset:1024 sc1
  v_mfma_f32_16x16x32_bf16 v[40:43], a[160:163], v[160:163], v[200:203]
  ds_read_b64_tr_b16 a[198:199], v212 offset:35840
  v_cvt_pk_bf16_f32 v73, v2, v3
  v_mfma_f32_16x16x32_bf16 v[40:43], a[164:167], v[164:167], v[40:43]
  v_exp_f32 v4, v4
  v_mfma_f32_16x16x32_bf16 v[40:43], a[168:171], v[168:171], v[40:43]
  v_exp_f32 v5, v5
  v_mfma_f32_16x16x32_bf16 v[40:43], a[172:175], v[172:175], v[40:43]
  s_add_u32 s55, s41, 0
  ds_read_b64_tr_b16 a[200:201], v213 offset:32768
  v_cvt_pk_bf16_f32 v84, v4, v5
  v_mfma_f32_16x16x32_bf16 v[44:47], a[172:175], v[188:191], v[204:207]
  buffer_load_dwordx4 a[136:139], v223, s[12:15], s55 offen offset:2048 sc1
  v_mfma_f32_16x16x32_bf16 v[44:47], a[168:171], v[184:187], v[44:47]
  v_exp_f32 v6, v6
  v_mfma_f32_16x16x32_bf16 v[44:47], a[164:167], v[180:183], v[44:47]
  ds_read_b64_tr_b16 a[202:203], v213 offset:33792
  v_mfma_f32_16x16x32_bf16 v[44:47], a[160:163], v[176:179], v[44:47]
  v_exp_f32 v7, v7
  v_smfmac_f32_16x16x64_bf16 a[236:239], v[252:255], v[76:83], v224
  s_add_u32 s55, s41, 0
  ds_read_b64_tr_b16 a[204:205], v213 offset:34816
  v_cvt_pk_bf16_f32 v85, v6, v7
  v_mfma_f32_16x16x32_bf16 v[60:63], a[176:179], v[176:179], v[204:207]
  buffer_load_dwordx4 a[140:143], v223, s[12:15], s55 offen offset:3072 sc1
  v_mfma_f32_16x16x32_bf16 v[60:63], a[180:183], v[180:183], v[60:63]
  v_exp_f32 v8, v8
  v_mfma_f32_16x16x32_bf16 v[60:63], a[184:187], v[184:187], v[60:63]
  s_waitcnt lgkmcnt(2)
  ds_read_b64_tr_b16 a[206:207], v213 offset:35840
  v_mfma_f32_16x16x32_bf16 v[60:63], a[188:191], v[188:191], v[60:63]
  v_exp_f32 v9, v9
  v_mfma_f32_16x16x32_bf16 v[56:59], a[188:191], v[172:175], v[200:203]
  ds_read_b64_tr_b16 a[208:209], v214 offset:32768
  v_cvt_pk_bf16_f32 v96, v8, v9
  v_mfma_f32_16x16x32_bf16 v[56:59], a[184:187], v[168:171], v[56:59]
  s_add_u32 s55, s41, 4096
  v_exp_f32 v10, v10
  v_mfma_f32_16x16x32_bf16 v[56:59], a[180:183], v[164:167], v[56:59]
  buffer_load_dwordx4 a[144:147], v223, s[12:15], s55 offen offset:0 sc1
  v_mfma_f32_16x16x32_bf16 v[56:59], a[176:179], v[160:163], v[56:59]
  v_exp_f32 v11, v11
  v_smfmac_f32_16x16x64_bf16 a[240:243], v[252:255], v[88:95], v224
  ds_read_b64_tr_b16 a[210:211], v214 offset:33792
  v_cvt_pk_bf16_f32 v97, v10, v11
  v_mfma_f32_16x16x32_bf16 v[52:55], a[176:179], v[144:147], v[196:199]
  v_exp_f32 v12, v12
  v_mfma_f32_16x16x32_bf16 v[52:55], a[180:183], v[148:151], v[52:55]
  s_add_u32 s55, s41, 4096
  ds_read_b64_tr_b16 a[212:213], v214 offset:34816
  v_mfma_f32_16x16x32_bf16 v[52:55], a[184:187], v[152:155], v[52:55]
  buffer_load_dwordx4 a[148:151], v223, s[12:15], s55 offen offset:1024 sc1
  v_mfma_f32_16x16x32_bf16 v[52:55], a[188:191], v[156:159], v[52:55]
  v_exp_f32 v13, v13
  v_mfma_f32_16x16x32_bf16 v[48:51], a[188:191], v[140:143], v[192:195]
  ds_read_b64_tr_b16 a[214:215], v214 offset:35840
  v_cvt_pk_bf16_f32 v108, v12, v13
  v_mfma_f32_16x16x32_bf16 v[48:51], a[184:187], v[136:139], v[48:51]
  s_add_u32 s55, s41, 4096
  v_exp_f32 v14, v14
  v_mfma_f32_16x16x32_bf16 v[48:51], a[180:183], v[132:135], v[48:51]
  buffer_load_dwordx4 a[152:155], v223, s[12:15], s55 offen offset:2048 sc1
  v_mfma_f32_16x16x32_bf16 v[48:51], a[176:179], v[128:131], v[48:51]
  v_exp_f32 v15, v15
  v_smfmac_f32_16x16x64_bf16 a[244:247], v[252:255], v[100:107], v224
  v_cvt_pk_bf16_f32 v109, v14, v15
  v_mfma_f32_16x16x32_bf16 a[0:3], a[192:195], v[64:67], a[0:3]
  v_exp_f32 v16, v16
  v_mfma_f32_16x16x32_bf16 a[0:3], a[196:199], v[68:71], a[0:3]
  s_add_u32 s55, s41, 4096
  v_exp_f32 v17, v17
  v_mfma_f32_16x16x32_bf16 a[4:7], a[196:199], v[80:83], a[4:7]
  buffer_load_dwordx4 a[156:159], v223, s[12:15], s55 offen offset:3072 sc1
  v_mfma_f32_16x16x32_bf16 a[4:7], a[192:195], v[76:79], a[4:7]
  v_cvt_pk_bf16_f32 v74, v16, v17
  v_mfma_f32_16x16x32_bf16 a[8:11], a[192:195], v[88:91], a[8:11]
  v_exp_f32 v18, v18
  v_mfma_f32_16x16x32_bf16 a[8:11], a[196:199], v[92:95], a[8:11]
  v_exp_f32 v19, v19
  v_mfma_f32_16x16x32_bf16 a[12:15], a[196:199], v[104:107], a[12:15]
  s_nop 0
  s_add_u32 s55, s41, 16384
  v_cvt_pk_bf16_f32 v75, v18, v19
  v_mfma_f32_16x16x32_bf16 a[12:15], a[192:195], v[100:103], a[12:15]
  s_waitcnt lgkmcnt(0)
  buffer_load_dwordx4 a[160:163], v223, s[12:15], s55 offen offset:2048 sc1
  v_mfma_f32_16x16x32_bf16 a[28:31], a[200:203], v[100:103], a[28:31]
  v_exp_f32 v20, v20
  v_mfma_f32_16x16x32_bf16 a[28:31], a[204:207], v[104:107], a[28:31]
  ds_read_b64_tr_b16 a[192:193], v217 offset:32768
  ds_read_b64_tr_b16 a[194:195], v217 offset:33792
  v_mfma_f32_16x16x32_bf16 a[24:27], a[204:207], v[92:95], a[24:27]
  ds_read_b64_tr_b16 a[196:197], v217 offset:34816
  ds_read_b64_tr_b16 a[198:199], v217 offset:35840
  v_mfma_f32_16x16x32_bf16 a[24:27], a[200:203], v[88:91], a[24:27]
  v_exp_f32 v21, v21
  v_mfma_f32_16x16x32_bf16 a[20:23], a[200:203], v[76:79], a[20:23]
  v_cvt_pk_bf16_f32 v86, v20, v21
  v_mfma_f32_16x16x32_bf16 a[20:23], a[204:207], v[80:83], a[20:23]
  s_add_u32 s55, s41, 16384
  v_exp_f32 v22, v22
  v_mfma_f32_16x16x32_bf16 a[16:19], a[204:207], v[68:71], a[16:19]
  buffer_load_dwordx4 a[164:167], v223, s[12:15], s55 offen offset:3072 sc1
  v_mfma_f32_16x16x32_bf16 a[16:19], a[200:203], v[64:67], a[16:19]
  v_exp_f32 v23, v23
  v_mfma_f32_16x16x32_bf16 a[32:35], a[208:211], v[64:67], a[32:35]
  ds_read_b64_tr_b16 a[200:201], v218 offset:32768
  v_cvt_pk_bf16_f32 v87, v22, v23
  v_mfma_f32_16x16x32_bf16 a[32:35], a[212:215], v[68:71], a[32:35]
  v_exp_f32 v24, v24
  v_mfma_f32_16x16x32_bf16 a[36:39], a[212:215], v[80:83], a[36:39]
  ds_read_b64_tr_b16 a[202:203], v218 offset:33792
  ds_read_b64_tr_b16 a[204:205], v218 offset:34816
  v_mfma_f32_16x16x32_bf16 a[36:39], a[208:211], v[76:79], a[36:39]
  ds_read_b64_tr_b16 a[206:207], v218 offset:35840
  v_mfma_f32_16x16x32_bf16 a[40:43], a[208:211], v[88:91], a[40:43]
  s_add_u32 s55, s41, 20480
  v_exp_f32 v25, v25
  v_mfma_f32_16x16x32_bf16 a[40:43], a[212:215], v[92:95], a[40:43]
  buffer_load_dwordx4 a[168:171], v223, s[12:15], s55 offen offset:0 sc1
  v_cvt_pk_bf16_f32 v98, v24, v25
  v_mfma_f32_16x16x32_bf16 a[44:47], a[212:215], v[104:107], a[44:47]
  v_exp_f32 v26, v26
  v_mfma_f32_16x16x32_bf16 a[44:47], a[208:211], v[100:103], a[44:47]
  v_exp_f32 v27, v27
  v_mfma_f32_16x16x32_bf16 a[60:63], a[216:219], v[100:103], a[60:63]
  s_add_u32 s55, s41, 20480
  ds_read_b64_tr_b16 a[208:209], v219 offset:32768
  v_cvt_pk_bf16_f32 v99, v26, v27
  v_mfma_f32_16x16x32_bf16 a[60:63], a[220:223], v[104:107], a[60:63]
  buffer_load_dwordx4 a[172:175], v223, s[12:15], s55 offen offset:1024 sc1
  v_mfma_f32_16x16x32_bf16 a[56:59], a[220:223], v[92:95], a[56:59]
  v_exp_f32 v28, v28
  v_mfma_f32_16x16x32_bf16 a[56:59], a[216:219], v[88:91], a[56:59]
  ds_read_b64_tr_b16 a[210:211], v219 offset:33792
  ds_read_b64_tr_b16 a[212:213], v219 offset:34816
  ds_read_b64_tr_b16 a[214:215], v219 offset:35840
  v_mfma_f32_16x16x32_bf16 a[52:55], a[216:219], v[76:79], a[52:55]
  v_exp_f32 v29, v29
  v_mfma_f32_16x16x32_bf16 a[52:55], a[220:223], v[80:83], a[52:55]
  v_cvt_pk_bf16_f32 v110, v28, v29
  v_mfma_f32_16x16x32_bf16 a[48:51], a[220:223], v[68:71], a[48:51]
  s_add_u32 s55, s41, 20480
  v_exp_f32 v30, v30
  v_mfma_f32_16x16x32_bf16 a[48:51], a[216:219], v[64:67], a[48:51]
  buffer_load_dwordx4 a[176:179], v223, s[12:15], s55 offen offset:2048 sc1
  v_exp_f32 v31, v31
  s_nop 0
  v_cvt_pk_bf16_f32 v111, v30, v31
  v_mfma_f32_16x16x32_bf16 a[64:67], a[224:227], v[64:67], a[64:67]
  s_waitcnt vmcnt(38) lgkmcnt(0)
  s_barrier
  s_add_u32 m0, s44, 49152
  s_add_u32 s55, s41, 28672
  v_exp_f32 v32, v32
  v_mfma_f32_16x16x32_bf16 a[64:67], a[228:231], v[68:71], a[64:67]
  buffer_load_dwordx4 v223, s[12:15], s55 offen offset:0 sc1 lds
  v_mfma_f32_16x16x32_bf16 a[68:71], a[228:231], v[80:83], a[68:71]
  ds_read_b64_tr_b16 a[216:217], v215 offset:49152
  v_mfma_f32_16x16x32_bf16 a[68:71], a[224:227], v[76:79], a[68:71]
  v_exp_f32 v33, v33
  v_mfma_f32_16x16x32_bf16 a[72:75], a[224:227], v[88:91], a[72:75]
  v_exp_f32 v34, v34
  v_mfma_f32_16x16x32_bf16 a[72:75], a[228:231], v[92:95], a[72:75]
  buffer_load_dwordx4 v223, s[12:15], s55 offen offset:1024 sc1 lds
  v_mfma_f32_16x16x32_bf16 a[76:79], a[228:231], v[104:107], a[76:79]
  ds_read_b64_tr_b16 a[218:219], v215 offset:50176
  v_mfma_f32_16x16x32_bf16 a[76:79], a[224:227], v[100:103], a[76:79]
  v_exp_f32 v35, v35
  v_mfma_f32_16x16x32_bf16 a[92:95], a[192:195], v[100:103], a[92:95]
  buffer_load_dwordx4 v223, s[12:15], s55 offen offset:2048 sc1 lds
  v_mfma_f32_16x16x32_bf16 a[92:95], a[196:199], v[104:107], a[92:95]
  v_exp_f32 v36, v36
  v_mfma_f32_16x16x32_bf16 a[88:91], a[196:199], v[92:95], a[88:91]
  ds_read_b64_tr_b16 a[220:221], v215 offset:51200
  v_mfma_f32_16x16x32_bf16 a[88:91], a[192:195], v[88:91], a[88:91]
  v_exp_f32 v37, v37
  v_mfma_f32_16x16x32_bf16 a[84:87], a[192:195], v[76:79], a[84:87]
  buffer_load_dwordx4 v223, s[12:15], s55 offen offset:3072 sc1 lds
  v_mfma_f32_16x16x32_bf16 a[84:87], a[196:199], v[80:83], a[84:87]
  v_exp_f32 v38, v38
  v_mfma_f32_16x16x32_bf16 a[80:83], a[196:199], v[68:71], a[80:83]
  ds_read_b64_tr_b16 a[222:223], v215 offset:52224
  v_mfma_f32_16x16x32_bf16 a[80:83], a[192:195], v[64:67], a[80:83]
  s_add_u32 m0, s44, 98304
  s_add_u32 s55, s41, 32768
  v_exp_f32 v39, v39
  v_mfma_f32_16x16x32_bf16 a[96:99], a[200:203], v[64:67], a[96:99]
  buffer_load_dwordx4 v223, s[12:15], s55 offen offset:0 sc1 lds
  v_mfma_f32_16x16x32_bf16 a[96:99], a[204:207], v[68:71], a[96:99]
  ds_read_b64_tr_b16 a[224:225], v216 offset:49152
  v_mfma_f32_16x16x32_bf16 a[100:103], a[204:207], v[80:83], a[100:103]
  v_exp_f32 v40, v40
  v_mfma_f32_16x16x32_bf16 a[100:103], a[200:203], v[76:79], a[100:103]
  buffer_load_dwordx4 v223, s[12:15], s55 offen offset:1024 sc1 lds
  v_mfma_f32_16x16x32_bf16 a[104:107], a[200:203], v[88:91], a[104:107]
  v_exp_f32 v41, v41
  v_mfma_f32_16x16x32_bf16 a[104:107], a[204:207], v[92:95], a[104:107]
  ds_read_b64_tr_b16 a[226:227], v216 offset:50176
  ds_read_b64_tr_b16 a[228:229], v216 offset:51200
  v_mfma_f32_16x16x32_bf16 a[108:111], a[204:207], v[104:107], a[108:111]
  v_exp_f32 v42, v42
  v_mfma_f32_16x16x32_bf16 a[108:111], a[200:203], v[100:103], a[108:111]
  buffer_load_dwordx4 v223, s[12:15], s55 offen offset:2048 sc1 lds
  v_mfma_f32_16x16x32_bf16 a[124:127], a[208:211], v[100:103], a[124:127]
  v_exp_f32 v43, v43
  v_mfma_f32_16x16x32_bf16 a[124:127], a[212:215], v[104:107], a[124:127]
  buffer_load_dwordx4 v223, s[12:15], s55 offen offset:3072 sc1 lds
  v_mfma_f32_16x16x32_bf16 a[120:123], a[212:215], v[92:95], a[120:123]
  v_exp_f32 v44, v44
  v_mfma_f32_16x16x32_bf16 a[120:123], a[208:211], v[88:91], a[120:123]
  v_exp_f32 v45, v45
  v_mfma_f32_16x16x32_bf16 a[116:119], a[208:211], v[76:79], a[116:119]
  s_add_u32 s55, s41, 8192
  ds_read_b64_tr_b16 a[230:231], v216 offset:52224
  v_mfma_f32_16x16x32_bf16 a[116:119], a[212:215], v[80:83], a[116:119]
  buffer_load_dwordx4 v[0:3], v223, s[12:15], s55 offen offset:0 sc1
  v_mfma_f32_16x16x32_bf16 a[112:115], a[212:215], v[68:71], a[112:115]
  s_add_u32 s55, s41, 8192
  v_exp_f32 v46, v46
  v_mfma_f32_16x16x32_bf16 a[112:115], a[208:211], v[64:67], a[112:115]
  s_waitcnt lgkmcnt(1)
  buffer_load_dwordx4 v[4:7], v223, s[12:15], s55 offen offset:1024 sc1
  v_exp_f32 v47, v47
  ds_read_b64_tr_b16 a[192:193], v212 offset:49152
  ds_read_b64_tr_b16 a[194:195], v212 offset:50176
  ds_read_b64_tr_b16 a[200:201], v213 offset:49152
  ds_read_b64_tr_b16 a[202:203], v213 offset:50176
  ds_read_b64_tr_b16 a[208:209], v214 offset:49152
  ds_read_b64_tr_b16 a[210:211], v214 offset:50176
  v_cvt_pk_bf16_f32 v68, v32, v33
  v_cvt_pk_bf16_f32 v69, v34, v35
  v_cvt_pk_bf16_f32 v80, v36, v37
  v_cvt_pk_bf16_f32 v81, v38, v39
  v_cvt_pk_bf16_f32 v92, v40, v41
  v_cvt_pk_bf16_f32 v93, v42, v43
  v_cvt_pk_bf16_f32 v104, v44, v45
  v_cvt_pk_bf16_f32 v105, v46, v47
  v_mfma_f32_16x16x32_bf16 a[64:67], a[224:227], v[72:75], a[64:67]
  ds_read_b64_tr_b16 a[196:197], v212 offset:51200
  v_exp_f32 v48, v48
  v_mfma_f32_16x16x32_bf16 a[68:71], a[224:227], v[84:87], a[68:71]
  ds_read_b64_tr_b16 a[198:199], v212 offset:52224
  v_exp_f32 v49, v49
  v_mfma_f32_16x16x32_bf16 a[72:75], a[224:227], v[96:99], a[72:75]
  ds_read_b64_tr_b16 a[204:205], v213 offset:51200
  v_exp_f32 v50, v50
  v_cvt_pk_bf16_f32 v70, v48, v49
  v_mfma_f32_16x16x32_bf16 a[76:79], a[224:227], v[108:111], a[76:79]
  s_add_u32 s55, s41, 8192
  buffer_load_dwordx4 v[8:11], v223, s[12:15], s55 offen offset:2048 sc1
  v_mfma_f32_16x16x32_bf16 a[60:63], a[216:219], v[108:111], a[60:63]
  ds_read_b64_tr_b16 a[206:207], v213 offset:52224
  v_exp_f32 v51, v51
  v_mfma_f32_16x16x32_bf16 a[56:59], a[216:219], v[96:99], a[56:59]
  ds_read_b64_tr_b16 a[212:213], v214 offset:51200
  v_exp_f32 v52, v52
  v_cvt_pk_bf16_f32 v71, v50, v51
  v_mfma_f32_16x16x32_bf16 a[52:55], a[216:219], v[84:87], a[52:55]
  ds_read_b64_tr_b16 a[214:215], v214 offset:52224
  v_exp_f32 v53, v53
  v_mfma_f32_16x16x32_bf16 a[48:51], a[216:219], v[72:75], a[48:51]
  s_waitcnt lgkmcnt(4)
  s_add_u32 s55, s41, 8192
  buffer_load_dwordx4 v[12:15], v223, s[12:15], s55 offen offset:3072 sc1
  v_mfma_f32_16x16x32_bf16 a[0:3], a[192:195], v[72:75], a[0:3]
  v_exp_f32 v54, v54
  v_cvt_pk_bf16_f32 v82, v52, v53
  v_mfma_f32_16x16x32_bf16 a[4:7], a[192:195], v[84:87], a[4:7]
  v_exp_f32 v55, v55
  v_exp_f32 v56, v56
  v_mfma_f32_16x16x32_bf16 a[8:11], a[192:195], v[96:99], a[8:11]
  s_add_u32 s55, s41, 12288
  buffer_load_dwordx4 v[16:19], v223, s[12:15], s55 offen offset:0 sc1
  v_mfma_f32_16x16x32_bf16 a[12:15], a[192:195], v[108:111], a[12:15]
  v_cvt_pk_bf16_f32 v83, v54, v55
  v_exp_f32 v57, v57
  v_mfma_f32_16x16x32_bf16 a[28:31], a[200:203], v[108:111], a[28:31]
  v_exp_f32 v58, v58
  v_cvt_pk_bf16_f32 v94, v56, v57
  v_mfma_f32_16x16x32_bf16 a[24:27], a[200:203], v[96:99], a[24:27]
  s_add_u32 s55, s41, 12288
  buffer_load_dwordx4 v[20:23], v223, s[12:15], s55 offen offset:1024 sc1
  v_mfma_f32_16x16x32_bf16 a[20:23], a[200:203], v[84:87], a[20:23]
  v_exp_f32 v59, v59
  v_mfma_f32_16x16x32_bf16 a[16:19], a[200:203], v[72:75], a[16:19]
  v_exp_f32 v60, v60
  v_cvt_pk_bf16_f32 v95, v58, v59
  v_mfma_f32_16x16x32_bf16 a[32:35], a[208:211], v[72:75], a[32:35]
  s_add_u32 s55, s41, 12288
  buffer_load_dwordx4 v[24:27], v223, s[12:15], s55 offen offset:2048 sc1
  v_mfma_f32_16x16x32_bf16 a[36:39], a[208:211], v[84:87], a[36:39]
  v_exp_f32 v61, v61
  v_exp_f32 v62, v62
  v_mfma_f32_16x16x32_bf16 a[40:43], a[208:211], v[96:99], a[40:43]
  v_cvt_pk_bf16_f32 v106, v60, v61
  v_exp_f32 v63, v63
  s_nop 0
  v_cvt_pk_bf16_f32 v107, v62, v63
  v_mfma_f32_16x16x32_bf16 a[44:47], a[208:211], v[108:111], a[44:47]
  s_add_u32 s55, s41, 12288
  buffer_load_dwordx4 v[28:31], v223, s[12:15], s55 offen offset:3072 sc1
  v_smfmac_f32_16x16x64_bf16 a[232:235], v[252:255], v[68:75], v224
  v_smfmac_f32_16x16x64_bf16 a[236:239], v[252:255], v[80:87], v224
  v_smfmac_f32_16x16x64_bf16 a[240:243], v[252:255], v[92:99], v224
  v_smfmac_f32_16x16x64_bf16 a[244:247], v[252:255], v[104:111], v224
  v_mfma_f32_16x16x32_bf16 a[0:3], a[196:199], v[68:71], a[0:3]
  v_mfma_f32_16x16x32_bf16 a[4:7], a[196:199], v[80:83], a[4:7]
  v_mfma_f32_16x16x32_bf16 a[8:11], a[196:199], v[92:95], a[8:11]
  v_mfma_f32_16x16x32_bf16 a[12:15], a[196:199], v[104:107], a[12:15]
  s_waitcnt lgkmcnt(0)
  v_mfma_f32_16x16x32_bf16 a[28:31], a[204:207], v[104:107], a[28:31]
  ds_read_b64_tr_b16 a[192:193], v217 offset:49152
  ds_read_b64_tr_b16 a[194:195], v217 offset:50176
  ds_read_b64_tr_b16 a[196:197], v217 offset:51200
  v_mfma_f32_16x16x32_bf16 a[24:27], a[204:207], v[92:95], a[24:27]
  v_and_b32 v221, 15, v222
  v_lshlrev_b32 v221, 3, v221
  v_accvgpr_read_b32 v196, a232
  v_mfma_f32_16x16x32_bf16 a[20:23], a[204:207], v[80:83], a[20:23]
  ds_read_b64_tr_b16 a[198:199], v217 offset:52224
  v_accvgpr_read_b32 v200, a233
  v_accvgpr_read_b32 v197, a236
  v_mfma_f32_16x16x32_bf16 a[16:19], a[204:207], v[68:71], a[16:19]
  v_accvgpr_read_b32 v201, a237
  v_accvgpr_read_b32 v198, a240
  v_accvgpr_read_b32 v202, a241
  v_mfma_f32_16x16x32_bf16 a[32:35], a[212:215], v[68:71], a[32:35]
  ds_read_b64_tr_b16 a[200:201], v218 offset:49152
  v_accvgpr_read_b32 v199, a244
  v_accvgpr_read_b32 v203, a245
  v_mfma_f32_16x16x32_bf16 a[36:39], a[212:215], v[80:83], a[36:39]
  ds_read_b64_tr_b16 a[202:203], v218 offset:50176
  v_add_f32 v196, v196, v200
  v_add_f32 v197, v197, v201
  v_mfma_f32_16x16x32_bf16 a[40:43], a[212:215], v[92:95], a[40:43]
  ds_read_b64_tr_b16 a[204:205], v218 offset:51200
  v_add_f32 v198, v198, v202
  v_add_f32 v199, v199, v203
  v_mfma_f32_16x16x32_bf16 a[44:47], a[212:215], v[104:107], a[44:47]
  ds_read_b64_tr_b16 a[206:207], v218 offset:52224
  s_mov_b32 s51, 0x4e800000
  v_add_f32 v204, v196, v197
  v_add_f32 v205, v198, v199
  v_mfma_f32_16x16x32_bf16 a[60:63], a[220:223], v[104:107], a[60:63]
  v_rcp_f32 v192, v196
  v_rcp_f32 v193, v197
  v_mfma_f32_16x16x32_bf16 a[56:59], a[220:223], v[92:95], a[56:59]
  ds_read_b64_tr_b16 a[208:209], v219 offset:49152
  v_rcp_f32 v194, v198
  v_rcp_f32 v195, v199
  v_mfma_f32_16x16x32_bf16 a[52:55], a[220:223], v[80:83], a[52:55]
  ds_read_b64_tr_b16 a[210:211], v219 offset:50176
  v_add_f32 v204, v204, v205
  v_mfma_f32_16x16x32_bf16 a[48:51], a[220:223], v[68:71], a[48:51]
  ds_read_b64_tr_b16 a[212:213], v219 offset:51200
  ds_read_b64_tr_b16 a[214:215], v219 offset:52224
  v_cmp_ngt_f32 vcc, s51, v204
  s_nop 4
  s_cbranch_vccnz K1_fb
  v_accvgpr_read_b32 v200, a0
  v_accvgpr_read_b32 v201, a1
  v_accvgpr_read_b32 v202, a2
  v_accvgpr_read_b32 v203, a3
  v_accvgpr_read_b32 v204, a16
  v_accvgpr_read_b32 v205, a17
  v_accvgpr_read_b32 v206, a18
  v_accvgpr_read_b32 v207, a19
  v_pk_mul_f32 v[200:201], v[200:201], v[192:193] op_sel:[0,0] op_sel_hi:[1,0]
  v_pk_mul_f32 v[202:203], v[202:203], v[192:193] op_sel:[0,0] op_sel_hi:[1,0]
  v_pk_mul_f32 v[204:205], v[204:205], v[192:193] op_sel:[0,0] op_sel_hi:[1,0]
  v_pk_mul_f32 v[206:207], v[206:207], v[192:193] op_sel:[0,0] op_sel_hi:[1,0]
  v_cvt_pk_bf16_f32 v208, v200, v201
  v_cvt_pk_bf16_f32 v209, v202, v203
  v_cvt_pk_bf16_f32 v210, v204, v205
  v_cvt_pk_bf16_f32 v211, v206, v207
  s_lshl_b32 s51, s37, 14
  s_add_u32 s51, s51, 0
  buffer_store_dwordx4 v[208:211], v223, s[32:35], s51 offen offset:0 sc1
  v_accvgpr_read_b32 v200, a4
  v_accvgpr_read_b32 v201, a5
  v_accvgpr_read_b32 v202, a6
  v_accvgpr_read_b32 v203, a7
  v_accvgpr_read_b32 v204, a20
  v_accvgpr_read_b32 v205, a21
  v_accvgpr_read_b32 v206, a22
  v_accvgpr_read_b32 v207, a23
  v_pk_mul_f32 v[200:201], v[200:201], v[192:193] op_sel:[0,1] op_sel_hi:[1,1]
  v_pk_mul_f32 v[202:203], v[202:203], v[192:193] op_sel:[0,1] op_sel_hi:[1,1]
  v_pk_mul_f32 v[204:205], v[204:205], v[192:193] op_sel:[0,1] op_sel_hi:[1,1]
  v_pk_mul_f32 v[206:207], v[206:207], v[192:193] op_sel:[0,1] op_sel_hi:[1,1]
  v_cvt_pk_bf16_f32 v212, v200, v201
  v_cvt_pk_bf16_f32 v213, v202, v203
  v_cvt_pk_bf16_f32 v214, v204, v205
  v_cvt_pk_bf16_f32 v215, v206, v207
  s_lshl_b32 s51, s37, 14
  s_add_u32 s51, s51, 0
  buffer_store_dwordx4 v[212:215], v223, s[32:35], s51 offen offset:1024 sc1
  v_accvgpr_read_b32 v200, a8
  v_accvgpr_read_b32 v201, a9
  v_accvgpr_read_b32 v202, a10
  v_accvgpr_read_b32 v203, a11
  v_accvgpr_read_b32 v204, a24
  v_accvgpr_read_b32 v205, a25
  v_accvgpr_read_b32 v206, a26
  v_accvgpr_read_b32 v207, a27
  v_pk_mul_f32 v[200:201], v[200:201], v[194:195] op_sel:[0,0] op_sel_hi:[1,0]
  v_pk_mul_f32 v[202:203], v[202:203], v[194:195] op_sel:[0,0] op_sel_hi:[1,0]
  v_pk_mul_f32 v[204:205], v[204:205], v[194:195] op_sel:[0,0] op_sel_hi:[1,0]
  v_pk_mul_f32 v[206:207], v[206:207], v[194:195] op_sel:[0,0] op_sel_hi:[1,0]
  v_cvt_pk_bf16_f32 v208, v200, v201
  v_cvt_pk_bf16_f32 v209, v202, v203
  v_cvt_pk_bf16_f32 v210, v204, v205
  v_cvt_pk_bf16_f32 v211, v206, v207
  s_lshl_b32 s51, s37, 14
  s_add_u32 s51, s51, 0
  buffer_store_dwordx4 v[208:211], v223, s[32:35], s51 offen offset:2048 sc1
  v_accvgpr_read_b32 v200, a12
  v_accvgpr_read_b32 v201, a13
  v_accvgpr_read_b32 v202, a14
  v_accvgpr_read_b32 v203, a15
  v_accvgpr_read_b32 v204, a28
  v_accvgpr_read_b32 v205, a29
  v_accvgpr_read_b32 v206, a30
  v_accvgpr_read_b32 v207, a31
  v_pk_mul_f32 v[200:201], v[200:201], v[194:195] op_sel:[0,1] op_sel_hi:[1,1]
  v_pk_mul_f32 v[202:203], v[202:203], v[194:195] op_sel:[0,1] op_sel_hi:[1,1]
  v_pk_mul_f32 v[204:205], v[204:205], v[194:195] op_sel:[0,1] op_sel_hi:[1,1]
  v_pk_mul_f32 v[206:207], v[206:207], v[194:195] op_sel:[0,1] op_sel_hi:[1,1]
  v_cvt_pk_bf16_f32 v212, v200, v201
  v_cvt_pk_bf16_f32 v213, v202, v203
  v_cvt_pk_bf16_f32 v214, v204, v205
  v_cvt_pk_bf16_f32 v215, v206, v207
  s_lshl_b32 s51, s37, 14
  s_add_u32 s51, s51, 0
  buffer_store_dwordx4 v[212:215], v223, s[32:35], s51 offen offset:3072 sc1
  v_accvgpr_read_b32 v200, a32
  v_accvgpr_read_b32 v201, a33
  v_accvgpr_read_b32 v202, a34
  v_accvgpr_read_b32 v203, a35
  v_accvgpr_read_b32 v204, a48
  v_accvgpr_read_b32 v205, a49
  v_accvgpr_read_b32 v206, a50
  v_accvgpr_read_b32 v207, a51
  v_pk_mul_f32 v[200:201], v[200:201], v[192:193] op_sel:[0,0] op_sel_hi:[1,0]
  v_pk_mul_f32 v[202:203], v[202:203], v[192:193] op_sel:[0,0] op_sel_hi:[1,0]
  v_pk_mul_f32 v[204:205], v[204:205], v[192:193] op_sel:[0,0] op_sel_hi:[1,0]
  v_pk_mul_f32 v[206:207], v[206:207], v[192:193] op_sel:[0,0] op_sel_hi:[1,0]
  v_cvt_pk_bf16_f32 v208, v200, v201
  v_cvt_pk_bf16_f32 v209, v202, v203
  v_cvt_pk_bf16_f32 v210, v204, v205
  v_cvt_pk_bf16_f32 v211, v206, v207
  s_lshl_b32 s51, s37, 14
  s_add_u32 s51, s51, 4096
  buffer_store_dwordx4 v[208:211], v223, s[32:35], s51 offen offset:0 sc1
  v_accvgpr_read_b32 v200, a36
  v_accvgpr_read_b32 v201, a37
  v_accvgpr_read_b32 v202, a38
  v_accvgpr_read_b32 v203, a39
  v_accvgpr_read_b32 v204, a52
  v_accvgpr_read_b32 v205, a53
  v_accvgpr_read_b32 v206, a54
  v_accvgpr_read_b32 v207, a55
  v_pk_mul_f32 v[200:201], v[200:201], v[192:193] op_sel:[0,1] op_sel_hi:[1,1]
  v_pk_mul_f32 v[202:203], v[202:203], v[192:193] op_sel:[0,1] op_sel_hi:[1,1]
  v_pk_mul_f32 v[204:205], v[204:205], v[192:193] op_sel:[0,1] op_sel_hi:[1,1]
  v_pk_mul_f32 v[206:207], v[206:207], v[192:193] op_sel:[0,1] op_sel_hi:[1,1]
  v_cvt_pk_bf16_f32 v212, v200, v201
  v_cvt_pk_bf16_f32 v213, v202, v203
  v_cvt_pk_bf16_f32 v214, v204, v205
  v_cvt_pk_bf16_f32 v215, v206, v207
  s_lshl_b32 s51, s37, 14
  s_add_u32 s51, s51, 4096
  buffer_store_dwordx4 v[212:215], v223, s[32:35], s51 offen offset:1024 sc1
  v_accvgpr_read_b32 v200, a40
  v_accvgpr_read_b32 v201, a41
  v_accvgpr_read_b32 v202, a42
  v_accvgpr_read_b32 v203, a43
  v_accvgpr_read_b32 v204, a56
  v_accvgpr_read_b32 v205, a57
  v_accvgpr_read_b32 v206, a58
  v_accvgpr_read_b32 v207, a59
  v_pk_mul_f32 v[200:201], v[200:201], v[194:195] op_sel:[0,0] op_sel_hi:[1,0]
  v_pk_mul_f32 v[202:203], v[202:203], v[194:195] op_sel:[0,0] op_sel_hi:[1,0]
  v_pk_mul_f32 v[204:205], v[204:205], v[194:195] op_sel:[0,0] op_sel_hi:[1,0]
  v_pk_mul_f32 v[206:207], v[206:207], v[194:195] op_sel:[0,0] op_sel_hi:[1,0]
  v_cvt_pk_bf16_f32 v208, v200, v201
  v_cvt_pk_bf16_f32 v209, v202, v203
  v_cvt_pk_bf16_f32 v210, v204, v205
  v_cvt_pk_bf16_f32 v211, v206, v207
  s_lshl_b32 s51, s37, 14
  s_add_u32 s51, s51, 4096
  buffer_store_dwordx4 v[208:211], v223, s[32:35], s51 offen offset:2048 sc1
  v_accvgpr_read_b32 v200, a44
  v_accvgpr_read_b32 v201, a45
  v_accvgpr_read_b32 v202, a46
  v_accvgpr_read_b32 v203, a47
  v_accvgpr_read_b32 v204, a60
  v_accvgpr_read_b32 v205, a61
  v_accvgpr_read_b32 v206, a62
  v_accvgpr_read_b32 v207, a63
  v_pk_mul_f32 v[200:201], v[200:201], v[194:195] op_sel:[0,1] op_sel_hi:[1,1]
  v_pk_mul_f32 v[202:203], v[202:203], v[194:195] op_sel:[0,1] op_sel_hi:[1,1]
  v_pk_mul_f32 v[204:205], v[204:205], v[194:195] op_sel:[0,1] op_sel_hi:[1,1]
  v_pk_mul_f32 v[206:207], v[206:207], v[194:195] op_sel:[0,1] op_sel_hi:[1,1]
  v_cvt_pk_bf16_f32 v212, v200, v201
  v_cvt_pk_bf16_f32 v213, v202, v203
  v_cvt_pk_bf16_f32 v214, v204, v205
  v_cvt_pk_bf16_f32 v215, v206, v207
  s_lshl_b32 s51, s37, 14
  s_add_u32 s51, s51, 4096
  buffer_store_dwordx4 v[212:215], v223, s[32:35], s51 offen offset:3072 sc1
  v_mfma_f32_16x16x32_bf16 a[64:67], a[228:231], v[68:71], a[64:67]
  s_lshl_b32 s49, s70, 2
  s_add_u32 s49, s49, s36
  s_lshl_b32 s49, s49, 7
  s_add_u32 s49, s49, 327684
  v_mfma_f32_16x16x32_bf16 a[68:71], a[228:231], v[80:83], a[68:71]
  buffer_load_dword v220, v221, s[20:23], s49 offen sc1
  v_mfma_f32_16x16x32_bf16 a[72:75], a[228:231], v[92:95], a[72:75]
  v_mfma_f32_16x16x32_bf16 a[76:79], a[228:231], v[104:107], a[76:79]
  s_waitcnt lgkmcnt(3)
  v_mfma_f32_16x16x32_bf16 a[92:95], a[192:195], v[108:111], a[92:95]
  s_add_u32 s55, s41, 20480
  v_mfma_f32_16x16x32_bf16 a[92:95], a[196:199], v[104:107], a[92:95]
  buffer_load_dwordx4 v[128:131], v223, s[12:15], s55 offen offset:3072 sc1
  v_mfma_f32_16x16x32_bf16 a[88:91], a[196:199], v[92:95], a[88:91]
  v_mfma_f32_16x16x32_bf16 a[88:91], a[192:195], v[96:99], a[88:91]
  v_mfma_f32_16x16x32_bf16 a[84:87], a[192:195], v[84:87], a[84:87]
  s_add_u32 s55, s41, 24576
  v_mfma_f32_16x16x32_bf16 a[84:87], a[196:199], v[80:83], a[84:87]
  buffer_load_dwordx4 v[132:135], v223, s[12:15], s55 offen offset:0 sc1
  v_mfma_f32_16x16x32_bf16 a[80:83], a[196:199], v[68:71], a[80:83]
  v_mfma_f32_16x16x32_bf16 a[80:83], a[192:195], v[72:75], a[80:83]
  v_mfma_f32_16x16x32_bf16 a[96:99], a[200:203], v[72:75], a[96:99]
  v_mfma_f32_16x16x32_bf16 a[96:99], a[204:207], v[68:71], a[96:99]
  buffer_load_dwordx4 v[136:139], v223, s[12:15], s55 offen offset:1024 sc1
  v_mfma_f32_16x16x32_bf16 a[100:103], a[204:207], v[80:83], a[100:103]
  v_mfma_f32_16x16x32_bf16 a[100:103], a[200:203], v[84:87], a[100:103]
  v_mfma_f32_16x16x32_bf16 a[104:107], a[200:203], v[96:99], a[104:107]
  v_mfma_f32_16x16x32_bf16 a[104:107], a[204:207], v[92:95], a[104:107]
  buffer_load_dwordx4 v[140:143], v223, s[12:15], s55 offen offset:2048 sc1
  v_mfma_f32_16x16x32_bf16 a[108:111], a[204:207], v[104:107], a[108:111]
  v_mfma_f32_16x16x32_bf16 a[108:111], a[200:203], v[108:111], a[108:111]
  s_waitcnt lgkmcnt(0)
  v_mfma_f32_16x16x32_bf16 a[124:127], a[208:211], v[108:111], a[124:127]
  v_mfma_f32_16x16x32_bf16 a[124:127], a[212:215], v[104:107], a[124:127]
  buffer_load_dwordx4 v[144:147], v223, s[12:15], s55 offen offset:3072 sc1
  v_mfma_f32_16x16x32_bf16 a[120:123], a[212:215], v[92:95], a[120:123]
  v_mfma_f32_16x16x32_bf16 a[120:123], a[208:211], v[96:99], a[120:123]
  v_mfma_f32_16x16x32_bf16 a[116:119], a[208:211], v[84:87], a[116:119]
  s_add_u32 s55, s41, 57344
  v_mfma_f32_16x16x32_bf16 a[116:119], a[212:215], v[80:83], a[116:119]
  buffer_load_dwordx4 v[148:151], v223, s[12:15], s55 offen offset:0 sc1
  v_mfma_f32_16x16x32_bf16 a[112:115], a[212:215], v[68:71], a[112:115]
K1_st13:
  s_cbranch_execz K1_back
  v_mfma_f32_16x16x32_bf16 a[112:115], a[208:211], v[72:75], a[112:115]
K1_T0:
  v_add_u32 v224, 4096, v223
  v_and_b32 v226, 3, v222
  v_lshlrev_b32 v226, 4, v226
  v_bfe_u32 v196, v222, 2, 1
  v_lshl_add_u32 v226, v196, 9, v226
  s_andn2_b32 s52, s70, 1
  s_lshl_b32 s52, s52, 9
  s_lshl_b32 s51, s36, 7
  s_add_u32 s52, s52, s51
  s_and_b32 s51, s70, 1
  s_lshl_b32 s51, s51, 6
  s_add_u32 s52, s52, s51
  s_lshl_b32 s51, s36, 10
  v_xor_b32 v216, s51, v223
  v_xor_b32 v217, 1024, v216
  v_xor_b32 v218, 2048, v216
  v_xor_b32 v219, 3072, v216
  s_waitcnt vmcnt(7)
  v_mov_b32 v196, 2
  s_mov_b64 exec, 1
  buffer_store_dword v196, v223, s[20:23], s53 offen sc1
  s_mov_b64 exec, -1
  v_accvgpr_read_b32 v200, a64
  v_accvgpr_read_b32 v201, a65
  v_accvgpr_read_b32 v202, a66
  v_accvgpr_read_b32 v203, a67
  v_accvgpr_read_b32 v204, a80
  v_accvgpr_read_b32 v205, a81
  v_accvgpr_read_b32 v206, a82
  v_accvgpr_read_b32 v207, a83
  v_pk_mul_f32 v[200:201], v[200:201], v[192:193] op_sel:[0,0] op_sel_hi:[1,0]
  v_pk_mul_f32 v[202:203], v[202:203], v[192:193] op_sel:[0,0] op_sel_hi:[1,0]
  v_pk_mul_f32 v[204:205], v[204:205], v[192:193] op_sel:[0,0] op_sel_hi:[1,0]
  v_pk_mul_f32 v[206:207], v[206:207], v[192:193] op_sel:[0,0] op_sel_hi:[1,0]
  v_cvt_pk_bf16_f32 v208, v200, v201
  v_cvt_pk_bf16_f32 v209, v202, v203
  v_cvt_pk_bf16_f32 v210, v204, v205
  v_cvt_pk_bf16_f32 v211, v206, v207
  s_lshl_b32 s51, s37, 14
  s_add_u32 s51, s51, 8192
  buffer_store_dwordx4 v[208:211], v223, s[32:35], s51 offen offset:0 sc1
  v_accvgpr_read_b32 v200, a68
  v_accvgpr_read_b32 v201, a69
  v_accvgpr_read_b32 v202, a70
  v_accvgpr_read_b32 v203, a71
  v_accvgpr_read_b32 v204, a84
  v_accvgpr_read_b32 v205, a85
  v_accvgpr_read_b32 v206, a86
  v_accvgpr_read_b32 v207, a87
  v_pk_mul_f32 v[200:201], v[200:201], v[192:193] op_sel:[0,1] op_sel_hi:[1,1]
  v_pk_mul_f32 v[202:203], v[202:203], v[192:193] op_sel:[0,1] op_sel_hi:[1,1]
  v_pk_mul_f32 v[204:205], v[204:205], v[192:193] op_sel:[0,1] op_sel_hi:[1,1]
  v_pk_mul_f32 v[206:207], v[206:207], v[192:193] op_sel:[0,1] op_sel_hi:[1,1]
  v_cvt_pk_bf16_f32 v212, v200, v201
  v_cvt_pk_bf16_f32 v213, v202, v203
  v_cvt_pk_bf16_f32 v214, v204, v205
  v_cvt_pk_bf16_f32 v215, v206, v207
  s_lshl_b32 s51, s37, 14
  s_add_u32 s51, s51, 8192
  buffer_store_dwordx4 v[212:215], v223, s[32:35], s51 offen offset:1024 sc1
  v_accvgpr_read_b32 v200, a72
  v_accvgpr_read_b32 v201, a73
  v_accvgpr_read_b32 v202, a74
  v_accvgpr_read_b32 v203, a75
  v_accvgpr_read_b32 v204, a88
  v_accvgpr_read_b32 v205, a89
  v_accvgpr_read_b32 v206, a90
  v_accvgpr_read_b32 v207, a91
  v_pk_mul_f32 v[200:201], v[200:201], v[194:195] op_sel:[0,0] op_sel_hi:[1,0]
  v_pk_mul_f32 v[202:203], v[202:203], v[194:195] op_sel:[0,0] op_sel_hi:[1,0]
  v_pk_mul_f32 v[204:205], v[204:205], v[194:195] op_sel:[0,0] op_sel_hi:[1,0]
  v_pk_mul_f32 v[206:207], v[206:207], v[194:195] op_sel:[0,0] op_sel_hi:[1,0]
  v_cvt_pk_bf16_f32 v208, v200, v201
  v_cvt_pk_bf16_f32 v209, v202, v203
  v_cvt_pk_bf16_f32 v210, v204, v205
  v_cvt_pk_bf16_f32 v211, v206, v207
  s_lshl_b32 s51, s37, 14
  s_add_u32 s51, s51, 8192
  buffer_store_dwordx4 v[208:211], v223, s[32:35], s51 offen offset:2048 sc1
  v_accvgpr_read_b32 v200, a76
  v_accvgpr_read_b32 v201, a77
  v_accvgpr_read_b32 v202, a78
  v_accvgpr_read_b32 v203, a79
  v_accvgpr_read_b32 v204, a92
  v_accvgpr_read_b32 v205, a93
  v_accvgpr_read_b32 v206, a94
  v_accvgpr_read_b32 v207, a95
  v_pk_mul_f32 v[200:201], v[200:201], v[194:195] op_sel:[0,1] op_sel_hi:[1,1]
  v_pk_mul_f32 v[202:203], v[202:203], v[194:195] op_sel:[0,1] op_sel_hi:[1,1]
  v_pk_mul_f32 v[204:205], v[204:205], v[194:195] op_sel:[0,1] op_sel_hi:[1,1]
  v_pk_mul_f32 v[206:207], v[206:207], v[194:195] op_sel:[0,1] op_sel_hi:[1,1]
  v_cvt_pk_bf16_f32 v212, v200, v201
  v_cvt_pk_bf16_f32 v213, v202, v203
  v_cvt_pk_bf16_f32 v214, v204, v205
  v_cvt_pk_bf16_f32 v215, v206, v207
  s_lshl_b32 s51, s37, 14
  s_add_u32 s51, s51, 8192
  buffer_store_dwordx4 v[212:215], v223, s[32:35], s51 offen offset:3072 sc1
  v_accvgpr_read_b32 v200, a96
  v_accvgpr_read_b32 v201, a97
  v_accvgpr_read_b32 v202, a98
  v_accvgpr_read_b32 v203, a99
  v_accvgpr_read_b32 v204, a112
  v_accvgpr_read_b32 v205, a113
  v_accvgpr_read_b32 v206, a114
  v_accvgpr_read_b32 v207, a115
  v_pk_mul_f32 v[200:201], v[200:201], v[192:193] op_sel:[0,0] op_sel_hi:[1,0]
  v_pk_mul_f32 v[202:203], v[202:203], v[192:193] op_sel:[0,0] op_sel_hi:[1,0]
  v_pk_mul_f32 v[204:205], v[204:205], v[192:193] op_sel:[0,0] op_sel_hi:[1,0]
  v_pk_mul_f32 v[206:207], v[206:207], v[192:193] op_sel:[0,0] op_sel_hi:[1,0]
  v_cvt_pk_bf16_f32 v208, v200, v201
  v_cvt_pk_bf16_f32 v209, v202, v203
  v_cvt_pk_bf16_f32 v210, v204, v205
  v_cvt_pk_bf16_f32 v211, v206, v207
  s_lshl_b32 s51, s37, 14
  s_add_u32 s51, s51, 12288
  buffer_store_dwordx4 v[208:211], v223, s[32:35], s51 offen offset:0 sc1
  v_accvgpr_read_b32 v200, a100
  v_accvgpr_read_b32 v201, a101
  v_accvgpr_read_b32 v202, a102
  v_accvgpr_read_b32 v203, a103
  v_accvgpr_read_b32 v204, a116
  v_accvgpr_read_b32 v205, a117
  v_accvgpr_read_b32 v206, a118
  v_accvgpr_read_b32 v207, a119
  v_pk_mul_f32 v[200:201], v[200:201], v[192:193] op_sel:[0,1] op_sel_hi:[1,1]
  v_pk_mul_f32 v[202:203], v[202:203], v[192:193] op_sel:[0,1] op_sel_hi:[1,1]
  v_pk_mul_f32 v[204:205], v[204:205], v[192:193] op_sel:[0,1] op_sel_hi:[1,1]
  v_pk_mul_f32 v[206:207], v[206:207], v[192:193] op_sel:[0,1] op_sel_hi:[1,1]
  v_cvt_pk_bf16_f32 v212, v200, v201
  v_cvt_pk_bf16_f32 v213, v202, v203
  v_cvt_pk_bf16_f32 v214, v204, v205
  v_cvt_pk_bf16_f32 v215, v206, v207
  s_lshl_b32 s51, s37, 14
  s_add_u32 s51, s51, 12288
  buffer_store_dwordx4 v[212:215], v223, s[32:35], s51 offen offset:1024 sc1
  v_accvgpr_read_b32 v200, a104
  v_accvgpr_read_b32 v201, a105
  v_accvgpr_read_b32 v202, a106
  v_accvgpr_read_b32 v203, a107
  v_accvgpr_read_b32 v204, a120
  v_accvgpr_read_b32 v205, a121
  v_accvgpr_read_b32 v206, a122
  v_accvgpr_read_b32 v207, a123
  v_pk_mul_f32 v[200:201], v[200:201], v[194:195] op_sel:[0,0] op_sel_hi:[1,0]
  v_pk_mul_f32 v[202:203], v[202:203], v[194:195] op_sel:[0,0] op_sel_hi:[1,0]
  v_pk_mul_f32 v[204:205], v[204:205], v[194:195] op_sel:[0,0] op_sel_hi:[1,0]
  v_pk_mul_f32 v[206:207], v[206:207], v[194:195] op_sel:[0,0] op_sel_hi:[1,0]
  v_cvt_pk_bf16_f32 v208, v200, v201
  v_cvt_pk_bf16_f32 v209, v202, v203
  v_cvt_pk_bf16_f32 v210, v204, v205
  v_cvt_pk_bf16_f32 v211, v206, v207
  s_lshl_b32 s51, s37, 14
  s_add_u32 s51, s51, 12288
  buffer_store_dwordx4 v[208:211], v223, s[32:35], s51 offen offset:2048 sc1
  v_accvgpr_read_b32 v200, a108
  v_accvgpr_read_b32 v201, a109
  v_accvgpr_read_b32 v202, a110
  v_accvgpr_read_b32 v203, a111
  v_accvgpr_read_b32 v204, a124
  v_accvgpr_read_b32 v205, a125
  v_accvgpr_read_b32 v206, a126
  v_accvgpr_read_b32 v207, a127
  v_pk_mul_f32 v[200:201], v[200:201], v[194:195] op_sel:[0,1] op_sel_hi:[1,1]
  v_pk_mul_f32 v[202:203], v[202:203], v[194:195] op_sel:[0,1] op_sel_hi:[1,1]
  v_pk_mul_f32 v[204:205], v[204:205], v[194:195] op_sel:[0,1] op_sel_hi:[1,1]
  v_pk_mul_f32 v[206:207], v[206:207], v[194:195] op_sel:[0,1] op_sel_hi:[1,1]
  v_cvt_pk_bf16_f32 v212, v200, v201
  v_cvt_pk_bf16_f32 v213, v202, v203
  v_cvt_pk_bf16_f32 v214, v204, v205
  v_cvt_pk_bf16_f32 v215, v206, v207
  s_lshl_b32 s51, s37, 14
  s_add_u32 s51, s51, 12288
  buffer_store_dwordx4 v[212:215], v223, s[32:35], s51 offen offset:3072 sc1
  buffer_load_dword v225, v226, s[20:23], s52 offen sc1
  ds_read_b64_tr_b16 a[180:181], v227 offset:0
  ds_read_b64_tr_b16 a[182:183], v227 offset:2560
  ds_read_b64_tr_b16 a[184:185], v227 offset:5120
  ds_read_b64_tr_b16 a[186:187], v227 offset:7680
  ds_read_b64_tr_b16 a[188:189], v227 offset:8
  ds_read_b64_tr_b16 a[190:191], v227 offset:2568
  ds_read_b64_tr_b16 a[192:193], v227 offset:5128
  ds_read_b64_tr_b16 a[194:195], v227 offset:7688
  ds_read_b64_tr_b16 a[196:197], v227 offset:16
  ds_read_b64_tr_b16 a[198:199], v227 offset:2576
  ds_read_b64_tr_b16 a[200:201], v227 offset:5136
  ds_read_b64_tr_b16 a[202:203], v227 offset:7696
  ds_read_b64_tr_b16 a[204:205], v227 offset:24
  ds_read_b64_tr_b16 a[206:207], v227 offset:2584
  ds_read_b64_tr_b16 a[208:209], v227 offset:5144
  ds_read_b64_tr_b16 a[210:211], v227 offset:7704
  ds_read_b64_tr_b16 a[212:213], v227 offset:32
  ds_read_b64_tr_b16 a[214:215], v227 offset:2592
  ds_read_b64_tr_b16 a[216:217], v227 offset:5152
  ds_read_b64_tr_b16 a[218:219], v227 offset:7712
  s_waitcnt lgkmcnt(15)
  v_mfma_f32_16x16x32_bf16 v[232:235], a[180:183], v[120:123], v[232:235]
  ds_read_b64_tr_b16 a[220:221], v227 offset:10752
  ds_read_b64_tr_b16 a[222:223], v227 offset:13312
  v_mfma_f32_16x16x32_bf16 v[232:235], a[184:187], v[124:127], v[232:235]
  s_waitcnt lgkmcnt(14)
  ds_read_b64_tr_b16 a[224:225], v227 offset:15872
  ds_read_b64_tr_b16 a[226:227], v227 offset:18432
  v_mfma_f32_16x16x32_bf16 v[236:239], a[192:195], v[124:127], v[236:239]
  ds_read_b64_tr_b16 a[228:229], v227 offset:10760
  ds_read_b64_tr_b16 a[230:231], v227 offset:13320
  v_mfma_f32_16x16x32_bf16 v[236:239], a[188:191], v[120:123], v[236:239]
  s_waitcnt lgkmcnt(15)
  ds_read_b64_tr_b16 a[84:85], v227 offset:15880
  ds_read_b64_tr_b16 a[86:87], v227 offset:18440
  v_mfma_f32_16x16x32_bf16 v[240:243], a[196:199], v[120:123], v[240:243]
  s_waitcnt lgkmcnt(15)
  ds_read_b64_tr_b16 a[88:89], v227 offset:10768
  ds_read_b64_tr_b16 a[90:91], v227 offset:13328
  v_mfma_f32_16x16x32_bf16 v[240:243], a[200:203], v[124:127], v[240:243]
  s_waitcnt lgkmcnt(10)
  ds_read_b64_tr_b16 a[92:93], v227 offset:15888
  ds_read_b64_tr_b16 a[94:95], v227 offset:18448
  v_mfma_f32_16x16x32_bf16 v[244:247], a[208:211], v[124:127], v[244:247]
  ds_read_b64_tr_b16 a[96:97], v227 offset:10776
  ds_read_b64_tr_b16 a[98:99], v227 offset:13336
  v_mfma_f32_16x16x32_bf16 v[244:247], a[204:207], v[120:123], v[244:247]
  ds_read_b64_tr_b16 a[100:101], v227 offset:15896
  ds_read_b64_tr_b16 a[102:103], v227 offset:18456
  v_mfma_f32_16x16x32_bf16 v[248:251], a[212:215], v[120:123], v[248:251]
  ds_read_b64_tr_b16 a[104:105], v227 offset:10784
  ds_read_b64_tr_b16 a[106:107], v227 offset:13344
  v_mfma_f32_16x16x32_bf16 v[248:251], a[216:219], v[124:127], v[248:251]
  s_waitcnt lgkmcnt(10)
  ds_read_b64_tr_b16 a[108:109], v227 offset:15904
  ds_read_b64_tr_b16 a[110:111], v227 offset:18464
  v_mfma_f32_16x16x32_bf16 v[232:235], a[220:223], v[112:115], v[232:235]
  v_mfma_f32_16x16x32_bf16 v[232:235], a[224:227], v[116:119], v[232:235]
  v_mfma_f32_16x16x32_bf16 v[236:239], a[84:87], v[116:119], v[236:239]
  v_mfma_f32_16x16x32_bf16 v[236:239], a[228:231], v[112:115], v[236:239]
  s_waitcnt lgkmcnt(4)
  v_mfma_f32_16x16x32_bf16 v[240:243], a[88:91], v[112:115], v[240:243]
  v_mfma_f32_16x16x32_bf16 v[240:243], a[92:95], v[116:119], v[240:243]
  v_mfma_f32_16x16x32_bf16 v[244:247], a[100:103], v[116:119], v[244:247]
  v_mfma_f32_16x16x32_bf16 v[244:247], a[96:99], v[112:115], v[244:247]
  s_waitcnt lgkmcnt(0)
  v_mfma_f32_16x16x32_bf16 v[248:251], a[104:107], v[112:115], v[248:251]
  v_mfma_f32_16x16x32_bf16 v[248:251], a[108:111], v[116:119], v[248:251]
  s_waitcnt vmcnt(16)
  v_mul_f32 v220, v220, v220
  v_mul_f32 v232, v232, v220
  v_mul_f32 v233, v233, v220
  v_mul_f32 v234, v234, v220
  v_mul_f32 v235, v235, v220
  v_mul_f32 v236, v236, v220
  v_mul_f32 v237, v237, v220
  v_mul_f32 v238, v238, v220
  v_mul_f32 v239, v239, v220
  v_mul_f32 v240, v240, v220
  v_mul_f32 v241, v241, v220
  v_mul_f32 v242, v242, v220
  v_mul_f32 v243, v243, v220
  v_mul_f32 v244, v244, v220
  v_mul_f32 v245, v245, v220
  v_mul_f32 v246, v246, v220
  v_mul_f32 v247, v247, v220
  v_mul_f32 v248, v248, v220
  v_mul_f32 v249, v249, v220
  v_mul_f32 v250, v250, v220
  v_mul_f32 v251, v251, v220
  v_mul_f32 v196, 0xbfb8aa3b, v232
  v_mul_f32 v197, 0xbfb8aa3b, v233
  v_mul_f32 v198, 0xbfb8aa3b, v234
  v_mul_f32 v199, 0xbfb8aa3b, v235
  v_exp_f32 v196, v196
  v_exp_f32 v197, v197
  v_exp_f32 v198, v198
  v_exp_f32 v199, v199
  v_add_f32 v196, 1.0, v196
  v_add_f32 v197, 1.0, v197
  v_add_f32 v198, 1.0, v198
  v_add_f32 v199, 1.0, v199
  v_rcp_f32 v196, v196
  v_rcp_f32 v197, v197
  v_rcp_f32 v198, v198
  v_rcp_f32 v199, v199
  v_mul_f32 v232, v232, v196
  v_mul_f32 v233, v233, v197
  v_mul_f32 v234, v234, v198
  v_mul_f32 v235, v235, v199
  v_mul_f32 v196, 0xbfb8aa3b, v236
  v_mul_f32 v197, 0xbfb8aa3b, v237
  v_mul_f32 v198, 0xbfb8aa3b, v238
  v_mul_f32 v199, 0xbfb8aa3b, v239
  v_exp_f32 v196, v196
  v_exp_f32 v197, v197
  v_exp_f32 v198, v198
  v_exp_f32 v199, v199
  v_add_f32 v196, 1.0, v196
  v_add_f32 v197, 1.0, v197
  v_add_f32 v198, 1.0, v198
  v_add_f32 v199, 1.0, v199
  v_rcp_f32 v196, v196
  v_rcp_f32 v197, v197
  v_rcp_f32 v198, v198
  v_rcp_f32 v199, v199
  v_mul_f32 v236, v236, v196
  v_mul_f32 v237, v237, v197
  v_mul_f32 v238, v238, v198
  v_mul_f32 v239, v239, v199
  v_mul_f32 v196, 0xbfb8aa3b, v240
  v_mul_f32 v197, 0xbfb8aa3b, v241
  v_mul_f32 v198, 0xbfb8aa3b, v242
  v_mul_f32 v199, 0xbfb8aa3b, v243
  v_exp_f32 v196, v196
  v_exp_f32 v197, v197
  v_exp_f32 v198, v198
  v_exp_f32 v199, v199
  v_add_f32 v196, 1.0, v196
  v_add_f32 v197, 1.0, v197
  v_add_f32 v198, 1.0, v198
  v_add_f32 v199, 1.0, v199
  v_rcp_f32 v196, v196
  v_rcp_f32 v197, v197
  v_rcp_f32 v198, v198
  v_rcp_f32 v199, v199
  v_mul_f32 v240, v240, v196
  v_mul_f32 v241, v241, v197
  v_mul_f32 v242, v242, v198
  v_mul_f32 v243, v243, v199
  v_mul_f32 v196, 0xbfb8aa3b, v244
  v_mul_f32 v197, 0xbfb8aa3b, v245
  v_mul_f32 v198, 0xbfb8aa3b, v246
  v_mul_f32 v199, 0xbfb8aa3b, v247
  v_exp_f32 v196, v196
  v_exp_f32 v197, v197
  v_exp_f32 v198, v198
  v_exp_f32 v199, v199
  v_add_f32 v196, 1.0, v196
  v_add_f32 v197, 1.0, v197
  v_add_f32 v198, 1.0, v198
  v_add_f32 v199, 1.0, v199
  v_rcp_f32 v196, v196
  v_rcp_f32 v197, v197
  v_rcp_f32 v198, v198
  v_rcp_f32 v199, v199
  v_mul_f32 v244, v244, v196
  v_mul_f32 v245, v245, v197
  v_mul_f32 v246, v246, v198
  v_mul_f32 v247, v247, v199
  v_mul_f32 v196, 0xbfb8aa3b, v248
  v_mul_f32 v197, 0xbfb8aa3b, v249
  v_mul_f32 v198, 0xbfb8aa3b, v250
  v_mul_f32 v199, 0xbfb8aa3b, v251
  v_exp_f32 v196, v196
  v_exp_f32 v197, v197
  v_exp_f32 v198, v198
  v_exp_f32 v199, v199
  v_add_f32 v196, 1.0, v196
  v_add_f32 v197, 1.0, v197
  v_add_f32 v198, 1.0, v198
  v_add_f32 v199, 1.0, v199
  v_rcp_f32 v196, v196
  v_rcp_f32 v197, v197
  v_rcp_f32 v198, v198
  v_rcp_f32 v199, v199
  v_mul_f32 v248, v248, v196
  v_mul_f32 v249, v249, v197
  v_mul_f32 v250, v250, v198
  v_mul_f32 v251, v251, v199
  v_add_u32 v220, s44, v223
  v_add_u32 v221, 0x10000, v220
  s_xor_b32 s51, s36, 0
  s_mov_b32 s49, 49152
  s_cmp_eq_u32 s51, 1
  s_cselect_b32 s49, 98304, s49
  s_cmp_eq_u32 s51, 2
  s_cselect_b32 s49, 114688, s49
  s_cmp_eq_u32 s51, 3
  s_cselect_b32 s49, 147456, s49
  s_add_u32 s49, s49, 0
  v_add_u32 v252, s49, v223
  s_xor_b32 s51, s36, 1
  s_mov_b32 s49, 49152
  s_cmp_eq_u32 s51, 1
  s_cselect_b32 s49, 98304, s49
  s_cmp_eq_u32 s51, 2
  s_cselect_b32 s49, 114688, s49
  s_cmp_eq_u32 s51, 3
  s_cselect_b32 s49, 147456, s49
  s_add_u32 s49, s49, 0
  v_add_u32 v253, s49, v223
  s_xor_b32 s51, s36, 2
  s_mov_b32 s49, 49152
  s_cmp_eq_u32 s51, 1
  s_cselect_b32 s49, 98304, s49
  s_cmp_eq_u32 s51, 2
  s_cselect_b32 s49, 114688, s49
  s_cmp_eq_u32 s51, 3
  s_cselect_b32 s49, 147456, s49
  s_add_u32 s49, s49, 5120
  v_add_u32 v254, s49, v223
  s_xor_b32 s51, s36, 3
  s_mov_b32 s49, 49152
  s_cmp_eq_u32 s51, 1
  s_cselect_b32 s49, 98304, s49
  s_cmp_eq_u32 s51, 2
  s_cselect_b32 s49, 114688, s49
  s_cmp_eq_u32 s51, 3
  s_cselect_b32 s49, 147456, s49
  s_add_u32 s49, s49, 10240
  v_add_u32 v255, s49, v223
  s_waitcnt vmcnt(0)
  v_cmp_gt_u32 vcc, 2, v225
  s_nop 4
  s_cbranch_vccz K1_spinO_ok
  buffer_load_dword v225, v226, s[20:23], s52 offen sc1
  s_waitcnt vmcnt(0)
  v_mov_b32 v196, 3
  s_mov_b64 exec, 1
  buffer_store_dword v196, v223, s[20:23], s53 offen sc1
  s_mov_b64 exec, -1
  s_mov_b32 s54, 0x100000
  v_mov_b32 v225, v225
K1_spinO:
  v_cmp_gt_u32 vcc, 2, v225
  s_nop 4
  s_cbranch_vccz K1_spinO_ok
  s_sleep 2
  buffer_load_dword v225, v226, s[20:23], s52 offen sc1
  s_sub_u32 s54, s54, 1
  s_cmp_lg_u32 s54, 0
  s_waitcnt vmcnt(0)
  s_cbranch_scc1 K1_spinO
K1_spinO_ok:
  s_add_u32 s45, s40, 0
  buffer_load_dwordx4 v[152:155], v216, s[8:11], s45 offen sc1
  buffer_load_dwordx4 v[156:159], v217, s[8:11], s45 offen sc1
  buffer_load_dwordx4 v[160:163], v218, s[8:11], s45 offen sc1
  buffer_load_dwordx4 v[164:167], v219, s[8:11], s45 offen sc1
  s_add_u32 s45, s40, 16384
  buffer_load_dwordx4 v[168:171], v216, s[8:11], s45 offen sc1
  buffer_load_dwordx4 v[172:175], v217, s[8:11], s45 offen sc1
  buffer_load_dwordx4 v[176:179], v218, s[8:11], s45 offen sc1
  buffer_load_dwordx4 v[180:183], v219, s[8:11], s45 offen sc1
  s_add_u32 s45, s40, 32768
  buffer_load_dwordx4 v[184:187], v216, s[8:11], s45 offen sc1
  buffer_load_dwordx4 v[188:191], v217, s[8:11], s45 offen sc1
  buffer_load_dwordx4 v[32:35], v218, s[8:11], s45 offen sc1
  buffer_load_dwordx4 v[36:39], v219, s[8:11], s45 offen sc1
  s_add_u32 s55, s41, 57344
  buffer_load_dwordx4 v[40:43], v223, s[12:15], s55 offen offset:1024 sc1
  buffer_load_dwordx4 v[44:47], v223, s[12:15], s55 offen offset:2048 sc1
  buffer_load_dwordx4 v[48:51], v223, s[12:15], s55 offen offset:3072 sc1
  s_add_u32 s55, s41, 61440
  buffer_load_dwordx4 v[52:55], v223, s[12:15], s55 offen offset:0 sc1
  buffer_load_dwordx4 v[56:59], v223, s[12:15], s55 offen offset:1024 sc1
  buffer_load_dwordx4 v[60:63], v223, s[12:15], s55 offen offset:2048 sc1
  s_bitcmp0_b32 s2, 0
  s_cbranch_scc1 K1_ce
K1_c0:
  v_mov_b32 v196, 3
  s_mov_b64 exec, 1
  buffer_store_dword v196, v223, s[20:23], s53 offen sc1
  s_mov_b64 exec, -1
  s_waitcnt vmcnt(18)
  v_mfma_f32_16x16x32_bf16 a[0:3], a[128:131], v[152:155], 0
  s_add_u32 s45, s40, 49152
  s_waitcnt vmcnt(17)
  v_mfma_f32_16x16x32_bf16 a[20:23], a[128:131], v[156:159], 0
  buffer_load_dwordx4 a[180:183], v216, s[8:11], s45 offen sc1
  s_waitcnt vmcnt(17)
  v_mfma_f32_16x16x32_bf16 a[40:43], a[128:131], v[160:163], 0
  s_waitcnt vmcnt(16)
  v_mfma_f32_16x16x32_bf16 a[60:63], a[128:131], v[164:167], 0
  v_mfma_f32_16x16x32_bf16 a[232:235], a[132:135], v[164:167], 0
  v_mfma_f32_16x16x32_bf16 a[44:47], a[132:135], v[160:163], 0
  buffer_load_dwordx4 a[184:187], v217, s[8:11], s45 offen sc1
  v_mfma_f32_16x16x32_bf16 a[24:27], a[132:135], v[156:159], 0
  v_mfma_f32_16x16x32_bf16 a[4:7], a[132:135], v[152:155], 0
  v_mfma_f32_16x16x32_bf16 a[8:11], a[136:139], v[152:155], 0
  v_mfma_f32_16x16x32_bf16 a[28:31], a[136:139], v[156:159], 0
  buffer_load_dwordx4 a[188:191], v218, s[8:11], s45 offen sc1
  v_mfma_f32_16x16x32_bf16 a[48:51], a[136:139], v[160:163], 0
  v_mfma_f32_16x16x32_bf16 a[236:239], a[136:139], v[164:167], 0
  v_mfma_f32_16x16x32_bf16 a[240:243], a[140:143], v[164:167], 0
  v_mfma_f32_16x16x32_bf16 a[52:55], a[140:143], v[160:163], 0
  buffer_load_dwordx4 v[64:67], v219, s[8:11], s45 offen sc1
  v_mfma_f32_16x16x32_bf16 a[32:35], a[140:143], v[156:159], 0
  v_mfma_f32_16x16x32_bf16 a[12:15], a[140:143], v[152:155], 0
  v_mfma_f32_16x16x32_bf16 a[16:19], a[144:147], v[152:155], 0
  s_add_u32 s55, s41, 61440
  v_mfma_f32_16x16x32_bf16 a[36:39], a[144:147], v[156:159], 0
  buffer_load_dwordx4 v[68:71], v223, s[12:15], s55 offen offset:3072 sc1
  v_mfma_f32_16x16x32_bf16 a[56:59], a[144:147], v[160:163], 0
  v_mfma_f32_16x16x32_bf16 a[244:247], a[144:147], v[164:167], 0
  s_waitcnt vmcnt(19)
  v_mfma_f32_16x16x32_bf16 a[0:3], a[148:151], v[168:171], a[0:3]
  s_add_u32 s45, s40, 4096
  s_waitcnt vmcnt(18)
  v_mfma_f32_16x16x32_bf16 a[20:23], a[148:151], v[172:175], a[20:23]
  buffer_load_dwordx4 v[72:75], v216, s[8:11], s45 offen sc1
  s_waitcnt vmcnt(18)
  v_mfma_f32_16x16x32_bf16 a[40:43], a[148:151], v[176:179], a[40:43]
  s_waitcnt vmcnt(17)
  v_mfma_f32_16x16x32_bf16 a[60:63], a[148:151], v[180:183], a[60:63]
  v_mfma_f32_16x16x32_bf16 a[232:235], a[152:155], v[180:183], a[232:235]
  buffer_load_dwordx4 v[76:79], v217, s[8:11], s45 offen sc1
  v_mfma_f32_16x16x32_bf16 a[44:47], a[152:155], v[176:179], a[44:47]
  v_mfma_f32_16x16x32_bf16 a[24:27], a[152:155], v[172:175], a[24:27]
  v_mfma_f32_16x16x32_bf16 a[4:7], a[152:155], v[168:171], a[4:7]
  buffer_load_dwordx4 v[80:83], v218, s[8:11], s45 offen sc1
  v_mfma_f32_16x16x32_bf16 a[8:11], a[156:159], v[168:171], a[8:11]
  v_mfma_f32_16x16x32_bf16 a[28:31], a[156:159], v[172:175], a[28:31]
  v_mfma_f32_16x16x32_bf16 a[48:51], a[156:159], v[176:179], a[48:51]
  v_mfma_f32_16x16x32_bf16 a[236:239], a[156:159], v[180:183], a[236:239]
  buffer_load_dwordx4 v[84:87], v219, s[8:11], s45 offen sc1
  v_mfma_f32_16x16x32_bf16 a[240:243], v[0:3], v[180:183], a[240:243]
  v_mfma_f32_16x16x32_bf16 a[52:55], v[0:3], v[176:179], a[52:55]
  s_add_u32 s55, s41, 65536
  v_mfma_f32_16x16x32_bf16 a[32:35], v[0:3], v[172:175], a[32:35]
  buffer_load_dwordx4 v[88:91], v223, s[12:15], s55 offen offset:0 sc1
  v_mfma_f32_16x16x32_bf16 a[12:15], v[0:3], v[168:171], a[12:15]
  v_mfma_f32_16x16x32_bf16 a[16:19], v[4:7], v[168:171], a[16:19]
  v_mfma_f32_16x16x32_bf16 a[36:39], v[4:7], v[172:175], a[36:39]
  buffer_load_dwordx4 v[92:95], v223, s[12:15], s55 offen offset:1024 sc1
  v_mfma_f32_16x16x32_bf16 a[56:59], v[4:7], v[176:179], a[56:59]
  v_mfma_f32_16x16x32_bf16 a[244:247], v[4:7], v[180:183], a[244:247]
  s_waitcnt vmcnt(21)
  v_mfma_f32_16x16x32_bf16 a[0:3], v[8:11], v[184:187], a[0:3]
  s_add_u32 s45, s40, 20480
  s_waitcnt vmcnt(20)
  v_mfma_f32_16x16x32_bf16 a[20:23], v[8:11], v[188:191], a[20:23]
  buffer_load_dwordx4 v[96:99], v216, s[8:11], s45 offen sc1
  s_waitcnt vmcnt(20)
  v_mfma_f32_16x16x32_bf16 a[40:43], v[8:11], v[32:35], a[40:43]
  s_waitcnt vmcnt(19)
  v_mfma_f32_16x16x32_bf16 a[60:63], v[8:11], v[36:39], a[60:63]
  v_mfma_f32_16x16x32_bf16 a[232:235], v[12:15], v[36:39], a[232:235]
  v_mfma_f32_16x16x32_bf16 a[44:47], v[12:15], v[32:35], a[44:47]
  buffer_load_dwordx4 v[100:103], v217, s[8:11], s45 offen sc1
  v_mfma_f32_16x16x32_bf16 a[24:27], v[12:15], v[188:191], a[24:27]
  v_mfma_f32_16x16x32_bf16 a[4:7], v[12:15], v[184:187], a[4:7]
  v_mfma_f32_16x16x32_bf16 a[8:11], v[16:19], v[184:187], a[8:11]
  v_mfma_f32_16x16x32_bf16 a[28:31], v[16:19], v[188:191], a[28:31]
  buffer_load_dwordx4 v[104:107], v218, s[8:11], s45 offen sc1
  v_mfma_f32_16x16x32_bf16 a[48:51], v[16:19], v[32:35], a[48:51]
  v_mfma_f32_16x16x32_bf16 a[236:239], v[16:19], v[36:39], a[236:239]
  v_mfma_f32_16x16x32_bf16 a[240:243], v[20:23], v[36:39], a[240:243]
  v_mfma_f32_16x16x32_bf16 a[52:55], v[20:23], v[32:35], a[52:55]
  buffer_load_dwordx4 v[108:111], v219, s[8:11], s45 offen sc1
  v_mfma_f32_16x16x32_bf16 a[32:35], v[20:23], v[188:191], a[32:35]
  v_mfma_f32_16x16x32_bf16 a[12:15], v[20:23], v[184:187], a[12:15]
  v_mfma_f32_16x16x32_bf16 a[16:19], v[24:27], v[184:187], a[16:19]
  s_add_u32 s55, s41, 65536
  v_mfma_f32_16x16x32_bf16 a[36:39], v[24:27], v[188:191], a[36:39]
  buffer_load_dwordx4 v[112:115], v223, s[12:15], s55 offen offset:2048 sc1
  v_mfma_f32_16x16x32_bf16 a[56:59], v[24:27], v[32:35], a[56:59]
  v_mfma_f32_16x16x32_bf16 a[244:247], v[24:27], v[36:39], a[244:247]
  s_waitcnt vmcnt(15)
  v_mfma_f32_16x16x32_bf16 a[0:3], v[28:31], a[180:183], a[0:3]
  s_waitcnt vmcnt(14)
  v_mfma_f32_16x16x32_bf16 a[20:23], v[28:31], a[184:187], a[20:23]
  buffer_load_dword v225, v226, s[20:23], s52 offen sc1
  s_waitcnt vmcnt(14)
  v_mfma_f32_16x16x32_bf16 a[40:43], v[28:31], a[188:191], a[40:43]
  s_add_u32 s45, s40, 36864
  s_waitcnt vmcnt(13)
  v_mfma_f32_16x16x32_bf16 a[60:63], v[28:31], v[64:67], a[60:63]
  buffer_load_dwordx4 v[116:119], v216, s[8:11], s45 offen sc1
  v_mfma_f32_16x16x32_bf16 a[232:235], a[248:251], v[64:67], a[232:235]
  v_mfma_f32_16x16x32_bf16 a[44:47], a[248:251], a[188:191], a[44:47]
  v_mfma_f32_16x16x32_bf16 a[24:27], a[248:251], a[184:187], a[24:27]
  buffer_load_dwordx4 v[120:123], v217, s[8:11], s45 offen sc1
  v_mfma_f32_16x16x32_bf16 a[4:7], a[248:251], a[180:183], a[4:7]
  v_mfma_f32_16x16x32_bf16 a[8:11], a[252:255], a[180:183], a[8:11]
  v_mfma_f32_16x16x32_bf16 a[28:31], a[252:255], a[184:187], a[28:31]
  buffer_load_dwordx4 v[124:127], v218, s[8:11], s45 offen sc1
  v_mfma_f32_16x16x32_bf16 a[48:51], a[252:255], a[188:191], a[48:51]
  v_mfma_f32_16x16x32_bf16 a[236:239], a[252:255], v[64:67], a[236:239]
  v_mfma_f32_16x16x32_bf16 a[240:243], a[160:163], v[64:67], a[240:243]
  buffer_load_dwordx4 a[192:195], v219, s[8:11], s45 offen sc1
  v_mfma_f32_16x16x32_bf16 a[52:55], a[160:163], a[188:191], a[52:55]
  v_mfma_f32_16x16x32_bf16 a[32:35], a[160:163], a[184:187], a[32:35]
  s_add_u32 s55, s41, 65536
  v_mfma_f32_16x16x32_bf16 a[12:15], a[160:163], a[180:183], a[12:15]
  buffer_load_dwordx4 a[196:199], v223, s[12:15], s55 offen offset:3072 sc1
  v_mfma_f32_16x16x32_bf16 a[16:19], a[164:167], a[180:183], a[16:19]
  v_mfma_f32_16x16x32_bf16 a[36:39], a[164:167], a[184:187], a[36:39]
  s_add_u32 s55, s41, 69632
  v_mfma_f32_16x16x32_bf16 a[56:59], a[164:167], a[188:191], a[56:59]
  buffer_load_dwordx4 a[200:203], v223, s[12:15], s55 offen offset:0 sc1
  v_mfma_f32_16x16x32_bf16 a[244:247], a[164:167], v[64:67], a[244:247]
  s_waitcnt vmcnt(17)
  v_mfma_f32_16x16x32_bf16 a[0:3], a[168:171], v[72:75], a[0:3]
  s_add_u32 s45, s40, 53248
  s_waitcnt vmcnt(16)
  v_mfma_f32_16x16x32_bf16 a[20:23], a[168:171], v[76:79], a[20:23]
  buffer_load_dwordx4 a[212:215], v216, s[8:11], s45 offen sc1
  s_waitcnt vmcnt(16)
  v_mfma_f32_16x16x32_bf16 a[40:43], a[168:171], v[80:83], a[40:43]
  ds_read_b128 a[204:207], v220 offset:49152
  s_waitcnt vmcnt(15)
  v_mfma_f32_16x16x32_bf16 a[60:63], a[168:171], v[84:87], a[60:63]
  v_mfma_f32_16x16x32_bf16 a[232:235], a[172:175], v[84:87], a[232:235]
  buffer_load_dwordx4 a[216:219], v217, s[8:11], s45 offen sc1
  v_mfma_f32_16x16x32_bf16 a[44:47], a[172:175], v[80:83], a[44:47]
  v_mfma_f32_16x16x32_bf16 a[24:27], a[172:175], v[76:79], a[24:27]
  ds_read_b128 a[208:211], v220 offset:50176
  v_mfma_f32_16x16x32_bf16 a[4:7], a[172:175], v[72:75], a[4:7]
  buffer_load_dwordx4 a[220:223], v218, s[8:11], s45 offen sc1
  v_mfma_f32_16x16x32_bf16 a[8:11], a[176:179], v[72:75], a[8:11]
  v_mfma_f32_16x16x32_bf16 a[28:31], a[176:179], v[76:79], a[28:31]
  v_mfma_f32_16x16x32_bf16 a[48:51], a[176:179], v[80:83], a[48:51]
  v_mfma_f32_16x16x32_bf16 a[236:239], a[176:179], v[84:87], a[236:239]
  buffer_load_dwordx4 a[224:227], v219, s[8:11], s45 offen sc1
  v_mfma_f32_16x16x32_bf16 a[240:243], v[128:131], v[84:87], a[240:243]
  v_mfma_f32_16x16x32_bf16 a[52:55], v[128:131], v[80:83], a[52:55]
K1_st14:
  s_cbranch_execz K1_st3
  s_add_u32 s55, s41, 69632
  v_mfma_f32_16x16x32_bf16 a[32:35], v[128:131], v[76:79], a[32:35]
  buffer_load_dwordx4 a[228:231], v223, s[12:15], s55 offen offset:1024 sc1
  v_mfma_f32_16x16x32_bf16 a[12:15], v[128:131], v[72:75], a[12:15]
  v_mfma_f32_16x16x32_bf16 a[16:19], v[132:135], v[72:75], a[16:19]
  v_mfma_f32_16x16x32_bf16 a[36:39], v[132:135], v[76:79], a[36:39]
  buffer_load_dwordx4 a[84:87], v223, s[12:15], s55 offen offset:2048 sc1
  v_mfma_f32_16x16x32_bf16 a[56:59], v[132:135], v[80:83], a[56:59]
  v_mfma_f32_16x16x32_bf16 a[244:247], v[132:135], v[84:87], a[244:247]
  s_mov_b32 s54, 0x100000
  s_waitcnt vmcnt(12)
  v_mov_b32 v225, v225
K1_spinO2:
  v_cmp_gt_u32 vcc, 3, v225
  s_nop 4
  s_cbranch_vccz K1_spinO2_ok
  s_sleep 2
  buffer_load_dword v225, v226, s[20:23], s52 offen sc1
  s_sub_u32 s54, s54, 1
  s_cmp_lg_u32 s54, 0
  s_waitcnt vmcnt(0)
  s_cbranch_scc1 K1_spinO2
K1_spinO2_ok:
  v_mfma_f32_16x16x32_bf16 a[0:3], v[136:139], v[96:99], a[0:3]
  s_add_u32 s45, s40, 8192
  v_mfma_f32_16x16x32_bf16 a[20:23], v[136:139], v[100:103], a[20:23]
  buffer_load_dwordx4 a[108:111], v216, s[8:11], s45 offen sc1
  v_mfma_f32_16x16x32_bf16 a[40:43], v[136:139], v[104:107], a[40:43]
  ds_read_b128 a[88:91], v220 offset:51200
  v_mfma_f32_16x16x32_bf16 a[60:63], v[136:139], v[108:111], a[60:63]
  v_mfma_f32_16x16x32_bf16 a[232:235], v[140:143], v[108:111], a[232:235]
  v_mfma_f32_16x16x32_bf16 a[44:47], v[140:143], v[104:107], a[44:47]
  buffer_load_dwordx4 a[112:115], v217, s[8:11], s45 offen sc1
  v_mfma_f32_16x16x32_bf16 a[24:27], v[140:143], v[100:103], a[24:27]
  ds_read_b128 a[92:95], v220 offset:52224
  v_mfma_f32_16x16x32_bf16 a[4:7], v[140:143], v[96:99], a[4:7]
  v_mfma_f32_16x16x32_bf16 a[8:11], v[144:147], v[96:99], a[8:11]
  v_mfma_f32_16x16x32_bf16 a[28:31], v[144:147], v[100:103], a[28:31]
  buffer_load_dwordx4 a[116:119], v218, s[8:11], s45 offen sc1
  v_mfma_f32_16x16x32_bf16 a[48:51], v[144:147], v[104:107], a[48:51]
  ds_read_b128 a[96:99], v221 offset:32768
  v_mfma_f32_16x16x32_bf16 a[236:239], v[144:147], v[108:111], a[236:239]
  s_waitcnt lgkmcnt(2)
  v_mfma_f32_16x16x32_bf16 a[240:243], a[204:207], v[108:111], a[240:243]
  v_mfma_f32_16x16x32_bf16 a[52:55], a[204:207], v[104:107], a[52:55]
  buffer_load_dwordx4 a[120:123], v219, s[8:11], s45 offen sc1
  v_mfma_f32_16x16x32_bf16 a[32:35], a[204:207], v[100:103], a[32:35]
  ds_read_b128 a[100:103], v221 offset:33792
  v_mfma_f32_16x16x32_bf16 a[12:15], a[204:207], v[96:99], a[12:15]
  v_mfma_f32_16x16x32_bf16 a[16:19], a[208:211], v[96:99], a[16:19]
  s_add_u32 s55, s41, 69632
  v_mfma_f32_16x16x32_bf16 a[36:39], a[208:211], v[100:103], a[36:39]
  buffer_load_dwordx4 a[124:127], v223, s[12:15], s55 offen offset:3072 sc1
  v_mfma_f32_16x16x32_bf16 a[56:59], a[208:211], v[104:107], a[56:59]
  ds_read_b128 a[104:107], v221 offset:34816
  v_mfma_f32_16x16x32_bf16 a[244:247], a[208:211], v[108:111], a[244:247]
  s_waitcnt vmcnt(16)
  v_mfma_f32_16x16x32_bf16 a[0:3], a[88:91], v[116:119], a[0:3]
  s_add_u32 s45, s40, 24576
  s_waitcnt vmcnt(15)
  v_mfma_f32_16x16x32_bf16 a[20:23], a[88:91], v[120:123], a[20:23]
  buffer_load_dwordx4 v[172:175], v216, s[8:11], s45 offen sc1
  s_waitcnt vmcnt(15)
  v_mfma_f32_16x16x32_bf16 a[40:43], a[88:91], v[124:127], a[40:43]
  ds_read_b128 v[152:155], v221 offset:35840
  s_waitcnt vmcnt(14)
  v_mfma_f32_16x16x32_bf16 a[60:63], a[88:91], a[192:195], a[60:63]
  s_waitcnt lgkmcnt(2)
  v_mfma_f32_16x16x32_bf16 a[232:235], a[92:95], a[192:195], a[232:235]
  buffer_load_dwordx4 v[176:179], v217, s[8:11], s45 offen sc1
  v_mfma_f32_16x16x32_bf16 a[44:47], a[92:95], v[124:127], a[44:47]
  v_mfma_f32_16x16x32_bf16 a[24:27], a[92:95], v[120:123], a[24:27]
  ds_read_b128 v[156:159], v220 offset:16384
  v_mfma_f32_16x16x32_bf16 a[4:7], a[92:95], v[116:119], a[4:7]
  buffer_load_dwordx4 v[180:183], v218, s[8:11], s45 offen sc1
  v_mfma_f32_16x16x32_bf16 a[8:11], a[96:99], v[116:119], a[8:11]
  v_mfma_f32_16x16x32_bf16 a[28:31], a[96:99], v[120:123], a[28:31]
  v_mfma_f32_16x16x32_bf16 a[48:51], a[96:99], v[124:127], a[48:51]
  ds_read_b128 v[160:163], v220 offset:17408
  v_mfma_f32_16x16x32_bf16 a[236:239], a[96:99], a[192:195], a[236:239]
  buffer_load_dwordx4 v[184:187], v219, s[8:11], s45 offen sc1
  v_mfma_f32_16x16x32_bf16 a[240:243], a[100:103], a[192:195], a[240:243]
  v_mfma_f32_16x16x32_bf16 a[52:55], a[100:103], v[124:127], a[52:55]
  s_add_u32 s55, s41, 73728
  v_mfma_f32_16x16x32_bf16 a[32:35], a[100:103], v[120:123], a[32:35]
  buffer_load_dwordx4 v[188:191], v223, s[12:15], s55 offen offset:0 sc1
  ds_read_b128 v[164:167], v220 offset:18432
  v_mfma_f32_16x16x32_bf16 a[12:15], a[100:103], v[116:119], a[12:15]
  s_waitcnt lgkmcnt(2)
  v_mfma_f32_16x16x32_bf16 a[16:19], a[104:107], v[116:119], a[16:19]
  v_mfma_f32_16x16x32_bf16 a[36:39], a[104:107], v[120:123], a[36:39]
  buffer_load_dwordx4 v[32:35], v223, s[12:15], s55 offen offset:1024 sc1
  v_mfma_f32_16x16x32_bf16 a[56:59], a[104:107], v[124:127], a[56:59]
  ds_read_b128 v[168:171], v220 offset:19456
  v_mfma_f32_16x16x32_bf16 a[244:247], a[104:107], a[192:195], a[244:247]
  s_waitcnt vmcnt(16)
  v_mfma_f32_16x16x32_bf16 a[0:3], v[152:155], a[212:215], a[0:3]
  s_add_u32 s45, s40, 40960
  s_waitcnt vmcnt(15)
  v_mfma_f32_16x16x32_bf16 a[20:23], v[152:155], a[216:219], a[20:23]
  buffer_load_dwordx4 v[72:75], v216, s[8:11], s45 offen sc1
  s_waitcnt vmcnt(15)
  v_mfma_f32_16x16x32_bf16 a[40:43], v[152:155], a[220:223], a[40:43]
  ds_read_b128 v[36:39], v221 offset:0
  s_waitcnt vmcnt(14)
  v_mfma_f32_16x16x32_bf16 a[60:63], v[152:155], a[224:227], a[60:63]
  v_mfma_f32_16x16x32_bf16 a[232:235], v[156:159], a[224:227], a[232:235]
  v_mfma_f32_16x16x32_bf16 a[44:47], v[156:159], a[220:223], a[44:47]
  buffer_load_dwordx4 v[76:79], v217, s[8:11], s45 offen sc1
  v_mfma_f32_16x16x32_bf16 a[24:27], v[156:159], a[216:219], a[24:27]
  ds_read_b128 a[180:183], v221 offset:1024
  v_mfma_f32_16x16x32_bf16 a[4:7], v[156:159], a[212:215], a[4:7]
  s_waitcnt lgkmcnt(2)
  v_mfma_f32_16x16x32_bf16 a[8:11], v[160:163], a[212:215], a[8:11]
  v_mfma_f32_16x16x32_bf16 a[28:31], v[160:163], a[216:219], a[28:31]
  buffer_load_dwordx4 v[80:83], v218, s[8:11], s45 offen sc1
  v_mfma_f32_16x16x32_bf16 a[48:51], v[160:163], a[220:223], a[48:51]
  ds_read_b128 a[184:187], v221 offset:2048
  v_mfma_f32_16x16x32_bf16 a[236:239], v[160:163], a[224:227], a[236:239]
  v_mfma_f32_16x16x32_bf16 a[240:243], v[164:167], a[224:227], a[240:243]
  v_mfma_f32_16x16x32_bf16 a[52:55], v[164:167], a[220:223], a[52:55]
  buffer_load_dwordx4 v[84:87], v219, s[8:11], s45 offen sc1
  v_mfma_f32_16x16x32_bf16 a[32:35], v[164:167], a[216:219], a[32:35]
  ds_read_b128 a[188:191], v221 offset:3072
  v_mfma_f32_16x16x32_bf16 a[12:15], v[164:167], a[212:215], a[12:15]
  v_mfma_f32_16x16x32_bf16 a[16:19], v[168:171], a[212:215], a[16:19]
  s_add_u32 s55, s41, 73728
  v_mfma_f32_16x16x32_bf16 a[36:39], v[168:171], a[216:219], a[36:39]
  buffer_load_dwordx4 v[96:99], v223, s[12:15], s55 offen offset:2048 sc1
  v_mfma_f32_16x16x32_bf16 a[56:59], v[168:171], a[220:223], a[56:59]
  ds_read_b128 v[64:67], v220 offset:32768
  v_mfma_f32_16x16x32_bf16 a[244:247], v[168:171], a[224:227], a[244:247]
  s_waitcnt lgkmcnt(2)
  s_waitcnt vmcnt(15)
  v_mfma_f32_16x16x32_bf16 a[0:3], v[36:39], a[108:111], a[0:3]
  s_add_u32 s45, s40, 57344
  s_waitcnt vmcnt(14)
  v_mfma_f32_16x16x32_bf16 a[20:23], v[36:39], a[112:115], a[20:23]
  buffer_load_dwordx4 v[124:127], v216, s[8:11], s45 offen sc1
  s_waitcnt vmcnt(14)
  v_mfma_f32_16x16x32_bf16 a[40:43], v[36:39], a[116:119], a[40:43]
  ds_read_b128 v[100:103], v220 offset:33792
  s_waitcnt vmcnt(13)
  v_mfma_f32_16x16x32_bf16 a[60:63], v[36:39], a[120:123], a[60:63]
  v_mfma_f32_16x16x32_bf16 a[232:235], a[180:183], a[120:123], a[232:235]
  buffer_load_dwordx4 a[192:195], v217, s[8:11], s45 offen sc1
  v_mfma_f32_16x16x32_bf16 a[44:47], a[180:183], a[116:119], a[44:47]
  v_mfma_f32_16x16x32_bf16 a[24:27], a[180:183], a[112:115], a[24:27]
  ds_read_b128 v[104:107], v220 offset:34816
  v_mfma_f32_16x16x32_bf16 a[4:7], a[180:183], a[108:111], a[4:7]
  buffer_load_dwordx4 a[212:215], v218, s[8:11], s45 offen sc1
  v_mfma_f32_16x16x32_bf16 a[8:11], a[184:187], a[108:111], a[8:11]
  v_mfma_f32_16x16x32_bf16 a[28:31], a[184:187], a[112:115], a[28:31]
  v_mfma_f32_16x16x32_bf16 a[48:51], a[184:187], a[116:119], a[48:51]
  ds_read_b128 v[108:111], v220 offset:35840
  v_mfma_f32_16x16x32_bf16 a[236:239], a[184:187], a[120:123], a[236:239]
  s_waitcnt lgkmcnt(2)
  buffer_load_dwordx4 a[216:219], v219, s[8:11], s45 offen sc1
  v_mfma_f32_16x16x32_bf16 a[240:243], a[188:191], a[120:123], a[240:243]
  v_mfma_f32_16x16x32_bf16 a[52:55], a[188:191], a[116:119], a[52:55]
  s_add_u32 s55, s41, 73728
  v_mfma_f32_16x16x32_bf16 a[32:35], a[188:191], a[112:115], a[32:35]
  buffer_load_dwordx4 a[220:223], v223, s[12:15], s55 offen offset:3072 sc1
  ds_read_b128 v[116:119], v221 offset:16384
  v_mfma_f32_16x16x32_bf16 a[12:15], a[188:191], a[108:111], a[12:15]
  v_mfma_f32_16x16x32_bf16 a[16:19], v[64:67], a[108:111], a[16:19]
  s_add_u32 s55, s41, 77824
  v_mfma_f32_16x16x32_bf16 a[36:39], v[64:67], a[112:115], a[36:39]
  buffer_load_dwordx4 a[224:227], v223, s[12:15], s55 offen offset:0 sc1
  v_mfma_f32_16x16x32_bf16 a[56:59], v[64:67], a[116:119], a[56:59]
  ds_read_b128 v[120:123], v221 offset:17408
  v_mfma_f32_16x16x32_bf16 a[244:247], v[64:67], a[120:123], a[244:247]
  s_waitcnt vmcnt(16)
  v_mfma_f32_16x16x32_bf16 a[0:3], v[100:103], v[172:175], a[0:3]
  s_add_u32 s45, s42, 0
  s_waitcnt vmcnt(15)
  v_mfma_f32_16x16x32_bf16 a[20:23], v[100:103], v[176:179], a[20:23]
  buffer_load_dwordx4 a[112:115], v216, s[8:11], s45 offen sc1
  s_waitcnt vmcnt(15)
  v_mfma_f32_16x16x32_bf16 a[40:43], v[100:103], v[180:183], a[40:43]
  ds_read_b128 v[156:159], v221 offset:18432
  s_waitcnt vmcnt(14)
  v_mfma_f32_16x16x32_bf16 a[60:63], v[100:103], v[184:187], a[60:63]
  s_waitcnt lgkmcnt(2)
  v_mfma_f32_16x16x32_bf16 a[232:235], v[104:107], v[184:187], a[232:235]
  v_mfma_f32_16x16x32_bf16 a[44:47], v[104:107], v[180:183], a[44:47]
  buffer_load_dwordx4 a[116:119], v217, s[8:11], s45 offen sc1
  v_mfma_f32_16x16x32_bf16 a[24:27], v[104:107], v[176:179], a[24:27]
  ds_read_b128 v[160:163], v221 offset:19456
  v_mfma_f32_16x16x32_bf16 a[4:7], v[104:107], v[172:175], a[4:7]
  v_mfma_f32_16x16x32_bf16 a[8:11], v[108:111], v[172:175], a[8:11]
  v_mfma_f32_16x16x32_bf16 a[28:31], v[108:111], v[176:179], a[28:31]
  buffer_load_dwordx4 a[120:123], v218, s[8:11], s45 offen sc1
  v_mfma_f32_16x16x32_bf16 a[48:51], v[108:111], v[180:183], a[48:51]
  ds_read_b128 v[164:167], v220 offset:0
  v_mfma_f32_16x16x32_bf16 a[236:239], v[108:111], v[184:187], a[236:239]
  v_mfma_f32_16x16x32_bf16 a[240:243], v[116:119], v[184:187], a[240:243]
  v_mfma_f32_16x16x32_bf16 a[52:55], v[116:119], v[180:183], a[52:55]
  buffer_load_dwordx4 v[36:39], v219, s[8:11], s45 offen sc1
  v_mfma_f32_16x16x32_bf16 a[32:35], v[116:119], v[176:179], a[32:35]
  ds_read_b128 v[168:171], v220 offset:1024
  v_mfma_f32_16x16x32_bf16 a[12:15], v[116:119], v[172:175], a[12:15]
  s_waitcnt lgkmcnt(2)
  v_mfma_f32_16x16x32_bf16 a[16:19], v[120:123], v[172:175], a[16:19]
  s_add_u32 s55, s41, 77824
  v_mfma_f32_16x16x32_bf16 a[36:39], v[120:123], v[176:179], a[36:39]
  buffer_load_dwordx4 a[180:183], v223, s[12:15], s55 offen offset:1024 sc1
  v_mfma_f32_16x16x32_bf16 a[56:59], v[120:123], v[180:183], a[56:59]
  ds_read_b128 a[108:111], v220 offset:2048
  v_mfma_f32_16x16x32_bf16 a[244:247], v[120:123], v[184:187], a[244:247]
  s_waitcnt lgkmcnt(0)
  s_barrier
  s_waitcnt vmcnt(15)
  v_mfma_f32_16x16x32_bf16 a[0:3], v[156:159], v[72:75], a[0:3]
  s_add_u32 s45, s42, 16384
  s_waitcnt vmcnt(14)
  v_mfma_f32_16x16x32_bf16 a[20:23], v[156:159], v[76:79], a[20:23]
  buffer_load_dwordx4 a[188:191], v216, s[8:11], s45 offen sc1
  s_waitcnt vmcnt(14)
  v_mfma_f32_16x16x32_bf16 a[40:43], v[156:159], v[80:83], a[40:43]
  ds_read_b128 a[184:187], v220 offset:3072
  s_waitcnt vmcnt(13)
  v_mfma_f32_16x16x32_bf16 a[60:63], v[156:159], v[84:87], a[60:63]
  v_mfma_f32_16x16x32_bf16 a[232:235], v[160:163], v[84:87], a[232:235]
  v_mfma_f32_16x16x32_bf16 a[44:47], v[160:163], v[80:83], a[44:47]
  buffer_load_dwordx4 v[64:67], v217, s[8:11], s45 offen sc1
  v_mfma_f32_16x16x32_bf16 a[24:27], v[160:163], v[76:79], a[24:27]
  v_mfma_f32_16x16x32_bf16 a[4:7], v[160:163], v[72:75], a[4:7]
  v_mfma_f32_16x16x32_bf16 a[8:11], v[164:167], v[72:75], a[8:11]
  v_mfma_f32_16x16x32_bf16 a[28:31], v[164:167], v[76:79], a[28:31]
  buffer_load_dwordx4 v[172:175], v218, s[8:11], s45 offen sc1
  v_mfma_f32_16x16x32_bf16 a[48:51], v[164:167], v[80:83], a[48:51]
  v_mfma_f32_16x16x32_bf16 a[236:239], v[164:167], v[84:87], a[236:239]
  v_mfma_f32_16x16x32_bf16 a[240:243], v[168:171], v[84:87], a[240:243]
  v_mfma_f32_16x16x32_bf16 a[52:55], v[168:171], v[80:83], a[52:55]
  buffer_load_dwordx4 v[176:179], v219, s[8:11], s45 offen sc1
  v_mfma_f32_16x16x32_bf16 a[32:35], v[168:171], v[76:79], a[32:35]
  v_mfma_f32_16x16x32_bf16 a[12:15], v[168:171], v[72:75], a[12:15]
  v_mfma_f32_16x16x32_bf16 a[16:19], a[108:111], v[72:75], a[16:19]
  s_add_u32 s55, s41, 77824
  v_mfma_f32_16x16x32_bf16 a[36:39], a[108:111], v[76:79], a[36:39]
  buffer_load_dwordx4 v[180:183], v223, s[12:15], s55 offen offset:2048 sc1
  v_mfma_f32_16x16x32_bf16 a[56:59], a[108:111], v[80:83], a[56:59]
  v_mfma_f32_16x16x32_bf16 a[244:247], a[108:111], v[84:87], a[244:247]
  s_waitcnt lgkmcnt(0)
  s_waitcnt vmcnt(14)
  v_mfma_f32_16x16x32_bf16 a[20:23], a[184:187], a[192:195], a[20:23]
  s_add_u32 s45, s42, 32768
  v_mfma_f32_16x16x32_bf16 a[24:27], v[148:151], a[192:195], a[24:27]
  buffer_load_dwordx4 v[184:187], v216, s[8:11], s45 offen sc1
  v_mfma_f32_16x16x32_bf16 a[28:31], v[40:43], a[192:195], a[28:31]
  v_mfma_f32_16x16x32_bf16 a[32:35], v[44:47], a[192:195], a[32:35]
  v_mfma_f32_16x16x32_bf16 a[36:39], v[48:51], a[192:195], a[36:39]
  s_waitcnt vmcnt(14)
  v_mfma_f32_16x16x32_bf16 a[40:43], a[184:187], a[212:215], a[40:43]
  buffer_load_dwordx4 v[100:103], v217, s[8:11], s45 offen sc1
  v_mfma_f32_16x16x32_bf16 a[44:47], v[148:151], a[212:215], a[44:47]
  v_mfma_f32_16x16x32_bf16 a[48:51], v[40:43], a[212:215], a[48:51]
  v_mfma_f32_16x16x32_bf16 a[52:55], v[44:47], a[212:215], a[52:55]
  ds_write_b128 v253, a[20:23] offset:0
  v_mfma_f32_16x16x32_bf16 a[56:59], v[48:51], a[212:215], a[56:59]
  buffer_load_dwordx4 v[104:107], v218, s[8:11], s45 offen sc1
  s_waitcnt vmcnt(15)
  v_mfma_f32_16x16x32_bf16 a[60:63], a[184:187], a[216:219], a[60:63]
  ds_write_b128 v253, a[24:27] offset:1024
  v_mfma_f32_16x16x32_bf16 a[232:235], v[148:151], a[216:219], a[232:235]
  v_mfma_f32_16x16x32_bf16 a[236:239], v[40:43], a[216:219], a[236:239]
  ds_write_b128 v253, a[28:31] offset:2048
  v_mfma_f32_16x16x32_bf16 a[240:243], v[44:47], a[216:219], a[240:243]
  buffer_load_dwordx4 v[108:111], v219, s[8:11], s45 offen sc1
  v_mfma_f32_16x16x32_bf16 a[244:247], v[48:51], a[216:219], a[244:247]
  ds_write_b128 v253, a[32:35] offset:3072
  v_mfma_f32_16x16x32_bf16 a[0:3], a[184:187], v[124:127], a[0:3]
  v_mfma_f32_16x16x32_bf16 a[4:7], v[148:151], v[124:127], a[4:7]
  s_add_u32 s55, s41, 77824
  ds_write_b128 v253, a[36:39] offset:4096
  v_mfma_f32_16x16x32_bf16 a[8:11], v[40:43], v[124:127], a[8:11]
  buffer_load_dwordx4 v[116:119], v223, s[12:15], s55 offen offset:3072 sc1
  v_mfma_f32_16x16x32_bf16 a[12:15], v[44:47], v[124:127], a[12:15]
  ds_write_b128 v254, a[40:43] offset:0
  v_mfma_f32_16x16x32_bf16 a[16:19], v[48:51], v[124:127], a[16:19]
  s_waitcnt vmcnt(14)
  v_mfma_f32_16x16x32_bf16 a[64:67], a[128:131], a[112:115], 0
  s_add_u32 s45, s42, 49152
  ds_write_b128 v254, a[44:47] offset:1024
  v_mfma_f32_16x16x32_bf16 a[68:71], a[132:135], a[112:115], 0
  buffer_load_dwordx4 v[120:123], v216, s[8:11], s45 offen sc1
  v_mfma_f32_16x16x32_bf16 a[72:75], a[136:139], a[112:115], 0
  ds_write_b128 v254, a[48:51] offset:2048
  v_mfma_f32_16x16x32_bf16 a[76:79], a[140:143], a[112:115], 0
  v_mfma_f32_16x16x32_bf16 a[80:83], a[144:147], a[112:115], 0
  ds_write_b128 v254, a[52:55] offset:3072
  s_waitcnt vmcnt(14)
  v_mfma_f32_16x16x32_bf16 a[20:23], a[128:131], a[116:119], 0
  v_mfma_f32_16x16x32_bf16 a[24:27], a[132:135], a[116:119], 0
  buffer_load_dwordx4 v[72:75], v217, s[8:11], s45 offen sc1
  ds_write_b128 v254, a[56:59] offset:4096
  v_mfma_f32_16x16x32_bf16 a[28:31], a[136:139], a[116:119], 0
  v_mfma_f32_16x16x32_bf16 a[32:35], a[140:143], a[116:119], 0
  ds_write_b128 v255, a[60:63] offset:0
  v_mfma_f32_16x16x32_bf16 a[36:39], a[144:147], a[116:119], 0
  s_waitcnt vmcnt(14)
  v_mfma_f32_16x16x32_bf16 a[40:43], a[128:131], a[120:123], 0
  ds_write_b128 v255, a[232:235] offset:1024
  v_mfma_f32_16x16x32_bf16 a[44:47], a[132:135], a[120:123], 0
  buffer_load_dwordx4 v[76:79], v218, s[8:11], s45 offen sc1
  v_mfma_f32_16x16x32_bf16 a[48:51], a[136:139], a[120:123], 0
  ds_write_b128 v255, a[236:239] offset:2048
  v_mfma_f32_16x16x32_bf16 a[52:55], a[140:143], a[120:123], 0
  v_mfma_f32_16x16x32_bf16 a[56:59], a[144:147], a[120:123], 0
  ds_write_b128 v255, a[240:243] offset:3072
  s_waitcnt vmcnt(14)
  v_mfma_f32_16x16x32_bf16 a[60:63], a[128:131], v[36:39], 0
  v_mfma_f32_16x16x32_bf16 a[232:235], a[132:135], v[36:39], 0
  buffer_load_dwordx4 v[80:83], v219, s[8:11], s45 offen sc1
  ds_write_b128 v255, a[244:247] offset:4096
  v_mfma_f32_16x16x32_bf16 a[236:239], a[136:139], v[36:39], 0
  v_mfma_f32_16x16x32_bf16 a[240:243], a[140:143], v[36:39], 0
  v_mfma_f32_16x16x32_bf16 a[244:247], a[144:147], v[36:39], 0
  s_waitcnt vmcnt(13)
  v_mfma_f32_16x16x32_bf16 a[64:67], a[148:151], a[188:191], a[64:67]
  s_add_u32 s45, s42, 4096
  s_waitcnt vmcnt(12)
  v_mfma_f32_16x16x32_bf16 a[20:23], a[148:151], v[64:67], a[20:23]
  buffer_load_dwordx4 v[164:167], v216, s[8:11], s45 offen sc1
  s_waitcnt vmcnt(12)
  v_mfma_f32_16x16x32_bf16 a[40:43], a[148:151], v[172:175], a[40:43]
  s_waitcnt vmcnt(11)
  v_mfma_f32_16x16x32_bf16 a[60:63], a[148:151], v[176:179], a[60:63]
  v_mfma_f32_16x16x32_bf16 a[232:235], a[152:155], v[176:179], a[232:235]
  s_waitcnt lgkmcnt(0)
  s_barrier
  v_mfma_f32_16x16x32_bf16 a[44:47], a[152:155], v[172:175], a[44:47]
  v_mfma_f32_16x16x32_bf16 a[24:27], a[152:155], v[64:67], a[24:27]
  buffer_load_dwordx4 v[168:171], v217, s[8:11], s45 offen sc1
  v_mfma_f32_16x16x32_bf16 a[68:71], a[152:155], a[188:191], a[68:71]
  ds_read_b128 v[84:87], v252 offset:0
  ds_read_b128 v[156:159], v252 offset:5120
  v_mfma_f32_16x16x32_bf16 a[72:75], a[156:159], a[188:191], a[72:75]
  ds_read_b128 v[160:163], v252 offset:10240
  ds_read_b128 v[192:195], v252 offset:1024
  v_mfma_f32_16x16x32_bf16 a[28:31], a[156:159], v[64:67], a[28:31]
  ds_read_b128 v[196:199], v252 offset:6144
  ds_read_b128 v[200:203], v252 offset:11264
  v_mfma_f32_16x16x32_bf16 a[48:51], a[156:159], v[172:175], a[48:51]
  v_accvgpr_read_b32 v208, a0
  v_accvgpr_read_b32 v209, a1
  v_mfma_f32_16x16x32_bf16 a[236:239], a[156:159], v[176:179], a[236:239]
  buffer_load_dwordx4 a[108:111], v218, s[8:11], s45 offen sc1
  v_mfma_f32_16x16x32_bf16 a[240:243], v[0:3], v[176:179], a[240:243]
  v_accvgpr_read_b32 v210, a2
  v_accvgpr_read_b32 v211, a3
  v_mfma_f32_16x16x32_bf16 a[52:55], v[0:3], v[172:175], a[52:55]
  s_waitcnt lgkmcnt(4)
  v_add_f32 v84, v84, v156
  v_add_f32 v85, v85, v157
  v_mfma_f32_16x16x32_bf16 a[32:35], v[0:3], v[64:67], a[32:35]
  v_add_f32 v86, v86, v158
  v_add_f32 v87, v87, v159
  v_mfma_f32_16x16x32_bf16 a[76:79], v[0:3], a[188:191], a[76:79]
  s_waitcnt lgkmcnt(3)
  v_add_f32 v208, v208, v160
  v_add_f32 v209, v209, v161
  v_mfma_f32_16x16x32_bf16 a[80:83], v[4:7], a[188:191], a[80:83]
  buffer_load_dwordx4 v[124:127], v219, s[8:11], s45 offen sc1
  v_mfma_f32_16x16x32_bf16 a[36:39], v[4:7], v[64:67], a[36:39]
  v_add_f32 v210, v210, v162
  v_add_f32 v211, v211, v163
  v_mfma_f32_16x16x32_bf16 a[56:59], v[4:7], v[172:175], a[56:59]
  v_add_f32 v208, v208, v84
  v_add_f32 v209, v209, v85
  v_mfma_f32_16x16x32_bf16 a[244:247], v[4:7], v[176:179], a[244:247]
  v_add_f32 v210, v210, v86
  v_add_f32 v211, v211, v87
  s_waitcnt vmcnt(12)
  v_mfma_f32_16x16x32_bf16 a[64:67], v[8:11], v[184:187], a[64:67]
  s_add_u32 s45, s42, 20480
  buffer_store_dwordx4 v[208:211], v223, s[80:83], s64 offen offset:0 sc1
  s_waitcnt vmcnt(12)
  v_mfma_f32_16x16x32_bf16 a[20:23], v[8:11], v[100:103], a[20:23]
  buffer_load_dwordx4 a[192:195], v216, s[8:11], s45 offen sc1
  s_waitcnt vmcnt(12)
  v_mfma_f32_16x16x32_bf16 a[40:43], v[8:11], v[104:107], a[40:43]
  ds_read_b128 v[84:87], v252 offset:2048
  ds_read_b128 v[156:159], v252 offset:7168
  s_waitcnt vmcnt(11)
  v_mfma_f32_16x16x32_bf16 a[60:63], v[8:11], v[108:111], a[60:63]
  ds_read_b128 v[160:163], v252 offset:12288
  v_mfma_f32_16x16x32_bf16 a[232:235], v[12:15], v[108:111], a[232:235]
  v_accvgpr_read_b32 v212, a4
  v_accvgpr_read_b32 v213, a5
  v_mfma_f32_16x16x32_bf16 a[44:47], v[12:15], v[104:107], a[44:47]
  v_accvgpr_read_b32 v214, a6
  v_accvgpr_read_b32 v215, a7
  v_mfma_f32_16x16x32_bf16 a[24:27], v[12:15], v[100:103], a[24:27]
  buffer_load_dwordx4 a[212:215], v217, s[8:11], s45 offen sc1
  v_mfma_f32_16x16x32_bf16 a[68:71], v[12:15], v[184:187], a[68:71]
  s_waitcnt lgkmcnt(4)
  v_add_f32 v192, v192, v196
  v_add_f32 v193, v193, v197
  v_mfma_f32_16x16x32_bf16 a[72:75], v[16:19], v[184:187], a[72:75]
  v_add_f32 v194, v194, v198
  v_add_f32 v195, v195, v199
  v_mfma_f32_16x16x32_bf16 a[28:31], v[16:19], v[100:103], a[28:31]
  s_waitcnt lgkmcnt(3)
  v_add_f32 v212, v212, v200
  v_add_f32 v213, v213, v201
  v_mfma_f32_16x16x32_bf16 a[48:51], v[16:19], v[104:107], a[48:51]
  v_add_f32 v214, v214, v202
  v_add_f32 v215, v215, v203
  v_mfma_f32_16x16x32_bf16 a[236:239], v[16:19], v[108:111], a[236:239]
  buffer_load_dwordx4 a[216:219], v218, s[8:11], s45 offen sc1
  v_mfma_f32_16x16x32_bf16 a[240:243], v[20:23], v[108:111], a[240:243]
  v_add_f32 v212, v212, v192
  v_add_f32 v213, v213, v193
  v_mfma_f32_16x16x32_bf16 a[52:55], v[20:23], v[104:107], a[52:55]
  v_add_f32 v214, v214, v194
  v_add_f32 v215, v215, v195
  v_mfma_f32_16x16x32_bf16 a[32:35], v[20:23], v[100:103], a[32:35]
  buffer_store_dwordx4 v[212:215], v223, s[80:83], s64 offen offset:1024 sc1
  v_mfma_f32_16x16x32_bf16 a[76:79], v[20:23], v[184:187], a[76:79]
  ds_read_b128 v[192:195], v252 offset:3072
  ds_read_b128 v[196:199], v252 offset:8192
  v_mfma_f32_16x16x32_bf16 a[80:83], v[24:27], v[184:187], a[80:83]
  buffer_load_dwordx4 a[184:187], v219, s[8:11], s45 offen sc1
  v_mfma_f32_16x16x32_bf16 a[36:39], v[24:27], v[100:103], a[36:39]
  ds_read_b128 v[200:203], v252 offset:13312
  v_mfma_f32_16x16x32_bf16 a[56:59], v[24:27], v[104:107], a[56:59]
  v_accvgpr_read_b32 v208, a8
  v_accvgpr_read_b32 v209, a9
  v_mfma_f32_16x16x32_bf16 a[244:247], v[24:27], v[108:111], a[244:247]
  v_accvgpr_read_b32 v210, a10
  v_accvgpr_read_b32 v211, a11
  s_waitcnt vmcnt(13)
  v_mfma_f32_16x16x32_bf16 a[64:67], v[28:31], v[120:123], a[64:67]
  s_add_u32 s45, s42, 36864
  s_waitcnt lgkmcnt(4)
  v_add_f32 v84, v84, v156
  v_add_f32 v85, v85, v157
  s_waitcnt vmcnt(12)
  v_mfma_f32_16x16x32_bf16 a[20:23], v[28:31], v[72:75], a[20:23]
  buffer_load_dwordx4 a[112:115], v216, s[8:11], s45 offen sc1
  s_waitcnt vmcnt(12)
  v_mfma_f32_16x16x32_bf16 a[40:43], v[28:31], v[76:79], a[40:43]
  v_add_f32 v86, v86, v158
  v_add_f32 v87, v87, v159
  s_waitcnt vmcnt(11)
  v_mfma_f32_16x16x32_bf16 a[60:63], v[28:31], v[80:83], a[60:63]
  s_waitcnt lgkmcnt(3)
  v_add_f32 v208, v208, v160
  v_add_f32 v209, v209, v161
  v_mfma_f32_16x16x32_bf16 a[232:235], a[248:251], v[80:83], a[232:235]
  v_add_f32 v210, v210, v162
  v_add_f32 v211, v211, v163
  v_mfma_f32_16x16x32_bf16 a[44:47], a[248:251], v[76:79], a[44:47]
  v_add_f32 v208, v208, v84
  v_add_f32 v209, v209, v85
  v_mfma_f32_16x16x32_bf16 a[24:27], a[248:251], v[72:75], a[24:27]
  buffer_load_dwordx4 a[116:119], v217, s[8:11], s45 offen sc1
  v_mfma_f32_16x16x32_bf16 a[68:71], a[248:251], v[120:123], a[68:71]
  v_add_f32 v210, v210, v86
  v_add_f32 v211, v211, v87
  v_mfma_f32_16x16x32_bf16 a[72:75], a[252:255], v[120:123], a[72:75]
  buffer_store_dwordx4 v[208:211], v223, s[80:83], s64 offen offset:2048 sc1
  v_mfma_f32_16x16x32_bf16 a[28:31], a[252:255], v[72:75], a[28:31]
  ds_read_b128 v[84:87], v252 offset:4096
  ds_read_b128 v[156:159], v252 offset:9216
  v_mfma_f32_16x16x32_bf16 a[48:51], a[252:255], v[76:79], a[48:51]
  ds_read_b128 v[160:163], v252 offset:14336
  v_mfma_f32_16x16x32_bf16 a[236:239], a[252:255], v[80:83], a[236:239]
  buffer_load_dwordx4 a[120:123], v218, s[8:11], s45 offen sc1
  v_mfma_f32_16x16x32_bf16 a[240:243], a[160:163], v[80:83], a[240:243]
  v_accvgpr_read_b32 v212, a12
  v_accvgpr_read_b32 v213, a13
  v_mfma_f32_16x16x32_bf16 a[52:55], a[160:163], v[76:79], a[52:55]
  v_accvgpr_read_b32 v214, a14
  v_accvgpr_read_b32 v215, a15
  v_mfma_f32_16x16x32_bf16 a[32:35], a[160:163], v[72:75], a[32:35]
  s_waitcnt lgkmcnt(4)
  v_add_f32 v192, v192, v196
  v_add_f32 v193, v193, v197
  v_mfma_f32_16x16x32_bf16 a[76:79], a[160:163], v[120:123], a[76:79]
  v_add_f32 v194, v194, v198
  v_add_f32 v195, v195, v199
  v_mfma_f32_16x16x32_bf16 a[80:83], a[164:167], v[120:123], a[80:83]
  buffer_load_dwordx4 v[36:39], v219, s[8:11], s45 offen sc1
  v_mfma_f32_16x16x32_bf16 a[36:39], a[164:167], v[72:75], a[36:39]
  s_waitcnt lgkmcnt(3)
  v_add_f32 v212, v212, v200
  v_add_f32 v213, v213, v201
  v_mfma_f32_16x16x32_bf16 a[56:59], a[164:167], v[76:79], a[56:59]
  v_add_f32 v214, v214, v202
  v_add_f32 v215, v215, v203
  v_mfma_f32_16x16x32_bf16 a[244:247], a[164:167], v[80:83], a[244:247]
  v_add_f32 v212, v212, v192
  v_add_f32 v213, v213, v193
  s_waitcnt vmcnt(14)
  v_mfma_f32_16x16x32_bf16 a[64:67], a[168:171], v[164:167], a[64:67]
  s_add_u32 s45, s42, 53248
  v_add_f32 v214, v214, v194
  v_add_f32 v215, v215, v195
  s_waitcnt vmcnt(13)
  v_mfma_f32_16x16x32_bf16 a[20:23], a[168:171], v[168:171], a[20:23]
  buffer_load_dwordx4 a[128:131], v216, s[8:11], s45 offen sc1
  s_waitcnt vmcnt(13)
  v_mfma_f32_16x16x32_bf16 a[40:43], a[168:171], a[108:111], a[40:43]
  buffer_store_dwordx4 v[212:215], v223, s[80:83], s64 offen offset:3072 sc1
  s_waitcnt vmcnt(13)
  v_mfma_f32_16x16x32_bf16 a[60:63], a[168:171], v[124:127], a[60:63]
  v_accvgpr_read_b32 v208, a16
  v_accvgpr_read_b32 v209, a17
  v_mfma_f32_16x16x32_bf16 a[232:235], a[172:175], v[124:127], a[232:235]
  v_accvgpr_read_b32 v210, a18
  v_accvgpr_read_b32 v211, a19
  v_mfma_f32_16x16x32_bf16 a[44:47], a[172:175], a[108:111], a[44:47]
  s_waitcnt lgkmcnt(1)
  v_add_f32 v84, v84, v156
  v_add_f32 v85, v85, v157
  v_mfma_f32_16x16x32_bf16 a[24:27], a[172:175], v[168:171], a[24:27]
  buffer_load_dwordx4 a[132:135], v217, s[8:11], s45 offen sc1
  v_mfma_f32_16x16x32_bf16 a[68:71], a[172:175], v[164:167], a[68:71]
  v_add_f32 v86, v86, v158
  v_add_f32 v87, v87, v159
  v_mfma_f32_16x16x32_bf16 a[72:75], a[176:179], v[164:167], a[72:75]
  s_waitcnt lgkmcnt(0)
  v_add_f32 v208, v208, v160
  v_add_f32 v209, v209, v161
  v_mfma_f32_16x16x32_bf16 a[28:31], a[176:179], v[168:171], a[28:31]
  v_add_f32 v210, v210, v162
  v_add_f32 v211, v211, v163
  v_mfma_f32_16x16x32_bf16 a[48:51], a[176:179], a[108:111], a[48:51]
  v_add_f32 v208, v208, v84
  v_add_f32 v209, v209, v85
  v_mfma_f32_16x16x32_bf16 a[236:239], a[176:179], v[124:127], a[236:239]
  buffer_load_dwordx4 a[136:139], v218, s[8:11], s45 offen sc1
  v_mfma_f32_16x16x32_bf16 a[240:243], v[128:131], v[124:127], a[240:243]
  v_add_f32 v210, v210, v86
  v_add_f32 v211, v211, v87
  v_mfma_f32_16x16x32_bf16 a[52:55], v[128:131], a[108:111], a[52:55]
  buffer_store_dwordx4 v[208:211], v224, s[80:83], s64 offen offset:0 sc1
  v_mfma_f32_16x16x32_bf16 a[32:35], v[128:131], v[168:171], a[32:35]
  v_mfma_f32_16x16x32_bf16 a[76:79], v[128:131], v[164:167], a[76:79]
  v_mfma_f32_16x16x32_bf16 a[80:83], v[132:135], v[164:167], a[80:83]
  buffer_load_dwordx4 a[140:143], v219, s[8:11], s45 offen sc1
  v_mfma_f32_16x16x32_bf16 a[36:39], v[132:135], v[168:171], a[36:39]
  v_mfma_f32_16x16x32_bf16 a[56:59], v[132:135], a[108:111], a[56:59]
  v_mfma_f32_16x16x32_bf16 a[244:247], v[132:135], v[124:127], a[244:247]
  s_waitcnt vmcnt(15)
  v_mfma_f32_16x16x32_bf16 a[64:67], v[136:139], a[192:195], a[64:67]
  s_add_u32 s45, s42, 8192
  s_waitcnt vmcnt(14)
  v_mfma_f32_16x16x32_bf16 a[20:23], v[136:139], a[212:215], a[20:23]
  buffer_load_dwordx4 a[144:147], v216, s[8:11], s45 offen sc1
  s_waitcnt vmcnt(14)
  v_mfma_f32_16x16x32_bf16 a[40:43], v[136:139], a[216:219], a[40:43]
  s_waitcnt vmcnt(12)
  v_mfma_f32_16x16x32_bf16 a[60:63], v[136:139], a[184:187], a[60:63]
  v_mfma_f32_16x16x32_bf16 a[232:235], v[140:143], a[184:187], a[232:235]
  v_mfma_f32_16x16x32_bf16 a[44:47], v[140:143], a[216:219], a[44:47]
  v_mfma_f32_16x16x32_bf16 a[24:27], v[140:143], a[212:215], a[24:27]
  buffer_load_dwordx4 a[188:191], v217, s[8:11], s45 offen sc1
  v_mfma_f32_16x16x32_bf16 a[68:71], v[140:143], a[192:195], a[68:71]
  v_mfma_f32_16x16x32_bf16 a[72:75], v[144:147], a[192:195], a[72:75]
  v_mfma_f32_16x16x32_bf16 a[28:31], v[144:147], a[212:215], a[28:31]
  v_mfma_f32_16x16x32_bf16 a[48:51], v[144:147], a[216:219], a[48:51]
  v_mfma_f32_16x16x32_bf16 a[236:239], v[144:147], a[184:187], a[236:239]
  buffer_load_dwordx4 v[64:67], v218, s[8:11], s45 offen sc1
  v_mfma_f32_16x16x32_bf16 a[240:243], a[204:207], a[184:187], a[240:243]
  v_mfma_f32_16x16x32_bf16 a[52:55], a[204:207], a[216:219], a[52:55]
  v_mfma_f32_16x16x32_bf16 a[32:35], a[204:207], a[212:215], a[32:35]
  v_mfma_f32_16x16x32_bf16 a[76:79], a[204:207], a[192:195], a[76:79]
  v_mfma_f32_16x16x32_bf16 a[80:83], a[208:211], a[192:195], a[80:83]
  buffer_load_dwordx4 v[172:175], v219, s[8:11], s45 offen sc1
  v_mfma_f32_16x16x32_bf16 a[36:39], a[208:211], a[212:215], a[36:39]
  v_mfma_f32_16x16x32_bf16 a[56:59], a[208:211], a[216:219], a[56:59]
  v_mfma_f32_16x16x32_bf16 a[244:247], a[208:211], a[184:187], a[244:247]
  s_waitcnt vmcnt(5)
  v_mov_b32 v197, 1
  s_mov_b64 exec, 1
  buffer_store_dword v197, v223, s[20:23], s60 offen sc1
  s_mov_b64 exec, -1
  v_mfma_f32_16x16x32_bf16 a[64:67], a[88:91], a[112:115], a[64:67]
  s_add_u32 s45, s42, 24576
  v_mov_b32 v206, 0
  v_and_b32 v202, 15, v222
  v_mfma_f32_16x16x32_bf16 a[20:23], a[88:91], a[116:119], a[20:23]
  buffer_load_dwordx4 v[0:3], v216, s[8:11], s45 offen sc1
K1_st15:
  s_cbranch_execz K1_st2
  v_mfma_f32_16x16x32_bf16 a[40:43], a[88:91], a[120:123], a[40:43]
  ds_read_b128 v[176:179], v220 offset:16384
  v_mul_u32_u24 v202, 160, v202
  v_lshrrev_b32 v203, 4, v222
  v_mfma_f32_16x16x32_bf16 a[60:63], a[88:91], v[36:39], a[60:63]
  v_mul_u32_u24 v203, 40, v203
  v_add3_u32 v202, v202, v203, s85
  v_mfma_f32_16x16x32_bf16 a[232:235], a[92:95], v[36:39], a[232:235]
  v_add_u32 v207, s85, v223
  v_mfma_f32_16x16x32_bf16 a[44:47], a[92:95], a[120:123], a[44:47]
  ds_read_b64 v[192:193], v202 offset:0
  ds_read_b64 v[194:195], v202 offset:8
  v_mfma_f32_16x16x32_bf16 a[24:27], a[92:95], a[116:119], a[24:27]
  buffer_load_dwordx4 v[4:7], v217, s[8:11], s45 offen sc1
  ds_read_b128 a[148:151], v220 offset:17408
  v_mfma_f32_16x16x32_bf16 a[68:71], a[92:95], a[112:115], a[68:71]
  ds_read_b64 v[196:197], v202 offset:16
  ds_read_b64 v[198:199], v202 offset:24
  v_mfma_f32_16x16x32_bf16 a[72:75], a[96:99], a[112:115], a[72:75]
  ds_read_b64 v[200:201], v202 offset:32
  v_mfma_f32_16x16x32_bf16 a[28:31], a[96:99], a[116:119], a[28:31]
  v_mfma_f32_16x16x32_bf16 a[48:51], a[96:99], a[120:123], a[48:51]
  ds_read_b128 a[152:155], v220 offset:18432
  v_mfma_f32_16x16x32_bf16 a[236:239], a[96:99], v[36:39], a[236:239]
  buffer_load_dwordx4 v[184:187], v218, s[8:11], s45 offen sc1
  v_mfma_f32_16x16x32_bf16 a[240:243], a[100:103], v[36:39], a[240:243]
  v_mfma_f32_16x16x32_bf16 a[52:55], a[100:103], a[120:123], a[52:55]
  v_mfma_f32_16x16x32_bf16 a[32:35], a[100:103], a[116:119], a[32:35]
  ds_read_b128 a[156:159], v220 offset:19456
  v_mfma_f32_16x16x32_bf16 a[76:79], a[100:103], a[112:115], a[76:79]
  v_mfma_f32_16x16x32_bf16 a[80:83], a[104:107], a[112:115], a[80:83]
  buffer_load_dwordx4 v[100:103], v219, s[8:11], s45 offen sc1
  v_mfma_f32_16x16x32_bf16 a[36:39], a[104:107], a[116:119], a[36:39]
  v_mfma_f32_16x16x32_bf16 a[56:59], a[104:107], a[120:123], a[56:59]
  v_mfma_f32_16x16x32_bf16 a[244:247], a[104:107], v[36:39], a[244:247]
  v_mfma_f32_16x16x32_bf16 a[64:67], v[152:155], a[128:131], a[64:67]
  s_add_u32 s45, s42, 40960
  v_mfma_f32_16x16x32_bf16 a[20:23], v[152:155], a[132:135], a[20:23]
  buffer_load_dwordx4 v[20:23], v216, s[8:11], s45 offen sc1
  v_mfma_f32_16x16x32_bf16 a[40:43], v[152:155], a[136:139], a[40:43]
  ds_read_b128 v[104:107], v221 offset:0
  s_waitcnt vmcnt(10)
  v_mfma_f32_16x16x32_bf16 a[60:63], v[152:155], a[140:143], a[60:63]
  s_waitcnt lgkmcnt(1)
  v_mfma_f32_16x16x32_bf16 a[232:235], v[176:179], a[140:143], a[232:235]
  v_mfma_f32_16x16x32_bf16 a[44:47], v[176:179], a[136:139], a[44:47]
  v_mfma_f32_16x16x32_bf16 a[24:27], v[176:179], a[132:135], a[24:27]
  buffer_load_dwordx4 v[24:27], v217, s[8:11], s45 offen sc1
  ds_read_b128 v[108:111], v221 offset:1024
  v_mfma_f32_16x16x32_bf16 a[68:71], v[176:179], a[128:131], a[68:71]
  v_mfma_f32_16x16x32_bf16 a[72:75], a[148:151], a[128:131], a[72:75]
  v_mfma_f32_16x16x32_bf16 a[28:31], a[148:151], a[132:135], a[28:31]
  v_mfma_f32_16x16x32_bf16 a[48:51], a[148:151], a[136:139], a[48:51]
  ds_read_b128 v[8:11], v221 offset:2048
  v_mfma_f32_16x16x32_bf16 a[236:239], a[148:151], a[140:143], a[236:239]
  buffer_load_dwordx4 v[120:123], v218, s[8:11], s45 offen sc1
  v_mfma_f32_16x16x32_bf16 a[240:243], a[152:155], a[140:143], a[240:243]
  v_mfma_f32_16x16x32_bf16 a[52:55], a[152:155], a[136:139], a[52:55]
  v_mfma_f32_16x16x32_bf16 a[32:35], a[152:155], a[132:135], a[32:35]
  ds_read_b128 v[12:15], v221 offset:3072
  v_mfma_f32_16x16x32_bf16 a[76:79], a[152:155], a[128:131], a[76:79]
  v_mfma_f32_16x16x32_bf16 a[80:83], a[156:159], a[128:131], a[80:83]
  buffer_load_dwordx4 v[72:75], v219, s[8:11], s45 offen sc1
  v_mfma_f32_16x16x32_bf16 a[36:39], a[156:159], a[132:135], a[36:39]
  v_mfma_f32_16x16x32_bf16 a[56:59], a[156:159], a[136:139], a[56:59]
  ds_read_b128 v[16:19], v220 offset:32768
  v_mfma_f32_16x16x32_bf16 a[244:247], a[156:159], a[140:143], a[244:247]
  s_waitcnt lgkmcnt(2)
  s_waitcnt vmcnt(12)
  v_mfma_f32_16x16x32_bf16 a[64:67], v[104:107], a[144:147], a[64:67]
  s_add_u32 s45, s42, 57344
  s_waitcnt vmcnt(11)
  v_mfma_f32_16x16x32_bf16 a[20:23], v[104:107], a[188:191], a[20:23]
  buffer_load_dwordx4 a[160:163], v216, s[8:11], s45 offen sc1
  s_waitcnt vmcnt(11)
  v_mfma_f32_16x16x32_bf16 a[40:43], v[104:107], v[64:67], a[40:43]
  ds_read_b128 v[76:79], v220 offset:33792
  s_waitcnt vmcnt(10)
  v_mfma_f32_16x16x32_bf16 a[60:63], v[104:107], v[172:175], a[60:63]
  v_mfma_f32_16x16x32_bf16 a[232:235], v[108:111], v[172:175], a[232:235]
  v_mfma_f32_16x16x32_bf16 a[44:47], v[108:111], v[64:67], a[44:47]
  v_mfma_f32_16x16x32_bf16 a[24:27], v[108:111], a[188:191], a[24:27]
  buffer_load_dwordx4 a[164:167], v217, s[8:11], s45 offen sc1
  ds_read_b128 v[80:83], v220 offset:34816
  v_mfma_f32_16x16x32_bf16 a[68:71], v[108:111], a[144:147], a[68:71]
  v_mfma_f32_16x16x32_bf16 a[72:75], v[8:11], a[144:147], a[72:75]
  v_mfma_f32_16x16x32_bf16 a[28:31], v[8:11], a[188:191], a[28:31]
  v_mfma_f32_16x16x32_bf16 a[48:51], v[8:11], v[64:67], a[48:51]
  ds_read_b128 v[28:31], v220 offset:35840
  v_mfma_f32_16x16x32_bf16 a[236:239], v[8:11], v[172:175], a[236:239]
  s_waitcnt lgkmcnt(2)
  buffer_load_dwordx4 v[164:167], v218, s[8:11], s45 offen sc1
  v_mfma_f32_16x16x32_bf16 a[240:243], v[12:15], v[172:175], a[240:243]
  v_mfma_f32_16x16x32_bf16 a[52:55], v[12:15], v[64:67], a[52:55]
  v_mfma_f32_16x16x32_bf16 a[32:35], v[12:15], a[188:191], a[32:35]
  ds_read_b128 a[248:251], v221 offset:16384
  v_mfma_f32_16x16x32_bf16 a[76:79], v[12:15], a[144:147], a[76:79]
  v_mfma_f32_16x16x32_bf16 a[80:83], v[16:19], a[144:147], a[80:83]
  buffer_load_dwordx4 v[168:171], v219, s[8:11], s45 offen sc1
  v_mfma_f32_16x16x32_bf16 a[36:39], v[16:19], a[188:191], a[36:39]
  v_mfma_f32_16x16x32_bf16 a[56:59], v[16:19], v[64:67], a[56:59]
  ds_read_b128 a[252:255], v221 offset:17408
  v_mfma_f32_16x16x32_bf16 a[244:247], v[16:19], v[172:175], a[244:247]
  s_waitcnt vmcnt(11)
  v_mfma_f32_16x16x32_bf16 a[64:67], v[76:79], v[0:3], a[64:67]
  s_add_u32 s45, s42, 12288
  s_waitcnt vmcnt(10)
  v_mfma_f32_16x16x32_bf16 a[20:23], v[76:79], v[4:7], a[20:23]
  buffer_load_dwordx4 v[128:131], v216, s[8:11], s45 offen sc1
  s_waitcnt vmcnt(10)
  v_mfma_f32_16x16x32_bf16 a[40:43], v[76:79], v[184:187], a[40:43]
  ds_read_b128 a[108:111], v221 offset:18432
  s_waitcnt vmcnt(9)
  v_mfma_f32_16x16x32_bf16 a[60:63], v[76:79], v[100:103], a[60:63]
  s_waitcnt lgkmcnt(2)
  v_mfma_f32_16x16x32_bf16 a[232:235], v[80:83], v[100:103], a[232:235]
  v_mfma_f32_16x16x32_bf16 a[44:47], v[80:83], v[184:187], a[44:47]
  v_mfma_f32_16x16x32_bf16 a[24:27], v[80:83], v[4:7], a[24:27]
  buffer_load_dwordx4 v[132:135], v217, s[8:11], s45 offen sc1
  ds_read_b128 v[124:127], v221 offset:19456
  v_mfma_f32_16x16x32_bf16 a[68:71], v[80:83], v[0:3], a[68:71]
  v_mfma_f32_16x16x32_bf16 a[72:75], v[28:31], v[0:3], a[72:75]
  v_mfma_f32_16x16x32_bf16 a[28:31], v[28:31], v[4:7], a[28:31]
  v_mfma_f32_16x16x32_bf16 a[48:51], v[28:31], v[184:187], a[48:51]
  ds_read_b128 a[168:171], v220 offset:0
  v_mfma_f32_16x16x32_bf16 a[236:239], v[28:31], v[100:103], a[236:239]
  buffer_load_dwordx4 a[192:195], v218, s[8:11], s45 offen sc1
  v_mfma_f32_16x16x32_bf16 a[240:243], a[248:251], v[100:103], a[240:243]
  v_mfma_f32_16x16x32_bf16 a[52:55], a[248:251], v[184:187], a[52:55]
  v_mfma_f32_16x16x32_bf16 a[32:35], a[248:251], v[4:7], a[32:35]
  ds_read_b128 a[172:175], v220 offset:1024
  v_mfma_f32_16x16x32_bf16 a[76:79], a[248:251], v[0:3], a[76:79]
  s_waitcnt lgkmcnt(2)
  v_mfma_f32_16x16x32_bf16 a[80:83], a[252:255], v[0:3], a[80:83]
  buffer_load_dwordx4 a[212:215], v219, s[8:11], s45 offen sc1
  v_mfma_f32_16x16x32_bf16 a[36:39], a[252:255], v[4:7], a[36:39]
  v_mfma_f32_16x16x32_bf16 a[56:59], a[252:255], v[184:187], a[56:59]
  ds_read_b128 a[176:179], v220 offset:2048
  v_mfma_f32_16x16x32_bf16 a[244:247], a[252:255], v[100:103], a[244:247]
  s_waitcnt vmcnt(11)
  v_mfma_f32_16x16x32_bf16 a[64:67], a[108:111], v[20:23], a[64:67]
  s_add_u32 s45, s42, 28672
  s_waitcnt vmcnt(10)
  v_mfma_f32_16x16x32_bf16 a[20:23], a[108:111], v[24:27], a[20:23]
  buffer_load_dwordx4 a[184:187], v216, s[8:11], s45 offen sc1
  s_waitcnt vmcnt(10)
  v_mfma_f32_16x16x32_bf16 a[40:43], a[108:111], v[120:123], a[40:43]
  ds_read_b128 a[216:219], v220 offset:3072
  s_waitcnt vmcnt(9)
  v_mfma_f32_16x16x32_bf16 a[60:63], a[108:111], v[72:75], a[60:63]
  v_mfma_f32_16x16x32_bf16 a[232:235], v[124:127], v[72:75], a[232:235]
  v_mfma_f32_16x16x32_bf16 a[44:47], v[124:127], v[120:123], a[44:47]
  v_mfma_f32_16x16x32_bf16 a[24:27], v[124:127], v[24:27], a[24:27]
  buffer_load_dwordx4 v[136:139], v217, s[8:11], s45 offen sc1
  v_mfma_f32_16x16x32_bf16 a[68:71], v[124:127], v[20:23], a[68:71]
  s_waitcnt lgkmcnt(1)
  v_mfma_f32_16x16x32_bf16 a[72:75], a[168:171], v[20:23], a[72:75]
  v_mfma_f32_16x16x32_bf16 a[28:31], a[168:171], v[24:27], a[28:31]
  v_mfma_f32_16x16x32_bf16 a[48:51], a[168:171], v[120:123], a[48:51]
  v_mfma_f32_16x16x32_bf16 a[236:239], a[168:171], v[72:75], a[236:239]
  buffer_load_dwordx4 v[140:143], v218, s[8:11], s45 offen sc1
  v_mfma_f32_16x16x32_bf16 a[240:243], a[172:175], v[72:75], a[240:243]
  v_mfma_f32_16x16x32_bf16 a[52:55], a[172:175], v[120:123], a[52:55]
  v_mfma_f32_16x16x32_bf16 a[32:35], a[172:175], v[24:27], a[32:35]
  v_mfma_f32_16x16x32_bf16 a[76:79], a[172:175], v[20:23], a[76:79]
  v_mfma_f32_16x16x32_bf16 a[80:83], a[176:179], v[20:23], a[80:83]
  buffer_load_dwordx4 v[144:147], v219, s[8:11], s45 offen sc1
  v_mfma_f32_16x16x32_bf16 a[36:39], a[176:179], v[24:27], a[36:39]
  v_mfma_f32_16x16x32_bf16 a[56:59], a[176:179], v[120:123], a[56:59]
  v_mfma_f32_16x16x32_bf16 a[244:247], a[176:179], v[72:75], a[244:247]
  s_waitcnt lgkmcnt(0)
  s_waitcnt vmcnt(11)
  v_mfma_f32_16x16x32_bf16 a[64:67], a[216:219], a[160:163], a[64:67]
  s_waitcnt vmcnt(10)
  v_mfma_f32_16x16x32_bf16 a[20:23], a[216:219], a[164:167], a[20:23]
  buffer_load_dword v225, v206, s[20:23], s61 offen sc1
  s_waitcnt vmcnt(10)
  v_mfma_f32_16x16x32_bf16 a[40:43], a[216:219], v[164:167], a[40:43]
  s_waitcnt vmcnt(9)
  v_mfma_f32_16x16x32_bf16 a[60:63], a[216:219], v[168:171], a[60:63]
  v_mfma_f32_16x16x32_bf16 a[232:235], v[148:151], v[168:171], a[232:235]
  s_add_u32 s45, s42, 45056
  v_mfma_f32_16x16x32_bf16 a[44:47], v[148:151], v[164:167], a[44:47]
  buffer_load_dwordx4 a[204:207], v216, s[8:11], s45 offen sc1
  v_mfma_f32_16x16x32_bf16 a[24:27], v[148:151], a[164:167], a[24:27]
  v_mfma_f32_16x16x32_bf16 a[68:71], v[148:151], a[160:163], a[68:71]
  v_mfma_f32_16x16x32_bf16 a[72:75], v[40:43], a[160:163], a[72:75]
  v_mfma_f32_16x16x32_bf16 a[28:31], v[40:43], a[164:167], a[28:31]
  buffer_load_dwordx4 a[208:211], v217, s[8:11], s45 offen sc1
  v_mfma_f32_16x16x32_bf16 a[48:51], v[40:43], v[164:167], a[48:51]
  v_mfma_f32_16x16x32_bf16 a[236:239], v[40:43], v[168:171], a[236:239]
  v_mfma_f32_16x16x32_bf16 a[240:243], v[44:47], v[168:171], a[240:243]
  v_mfma_f32_16x16x32_bf16 a[52:55], v[44:47], v[164:167], a[52:55]
  buffer_load_dwordx4 v[84:87], v218, s[8:11], s45 offen sc1
  v_mfma_f32_16x16x32_bf16 a[32:35], v[44:47], a[164:167], a[32:35]
  v_mfma_f32_16x16x32_bf16 a[76:79], v[44:47], a[160:163], a[76:79]
  v_mfma_f32_16x16x32_bf16 a[80:83], v[48:51], a[160:163], a[80:83]
  v_mfma_f32_16x16x32_bf16 a[36:39], v[48:51], a[164:167], a[36:39]
  buffer_load_dwordx4 v[156:159], v219, s[8:11], s45 offen sc1
  v_mfma_f32_16x16x32_bf16 a[56:59], v[48:51], v[164:167], a[56:59]
  v_mfma_f32_16x16x32_bf16 a[244:247], v[48:51], v[168:171], a[244:247]
  s_waitcnt vmcnt(12)
  v_mfma_f32_16x16x32_bf16 a[64:67], v[52:55], v[128:131], a[64:67]
  s_add_u32 s45, s42, 61440
  s_waitcnt vmcnt(11)
  v_mfma_f32_16x16x32_bf16 a[20:23], v[52:55], v[132:135], a[20:23]
  buffer_load_dwordx4 v[160:163], v216, s[8:11], s45 offen sc1
  s_waitcnt vmcnt(11)
  v_mfma_f32_16x16x32_bf16 a[40:43], v[52:55], a[192:195], a[40:43]
  s_waitcnt vmcnt(10)
  v_mfma_f32_16x16x32_bf16 a[60:63], v[52:55], a[212:215], a[60:63]
  v_mfma_f32_16x16x32_bf16 a[232:235], v[56:59], a[212:215], a[232:235]
  v_mfma_f32_16x16x32_bf16 a[44:47], v[56:59], a[192:195], a[44:47]
  v_mfma_f32_16x16x32_bf16 a[24:27], v[56:59], v[132:135], a[24:27]
  buffer_load_dwordx4 a[112:115], v217, s[8:11], s45 offen sc1
  v_mfma_f32_16x16x32_bf16 a[68:71], v[56:59], v[128:131], a[68:71]
  v_mfma_f32_16x16x32_bf16 a[72:75], v[60:63], v[128:131], a[72:75]
  v_mfma_f32_16x16x32_bf16 a[28:31], v[60:63], v[132:135], a[28:31]
  v_mfma_f32_16x16x32_bf16 a[48:51], v[60:63], a[192:195], a[48:51]
  v_mfma_f32_16x16x32_bf16 a[236:239], v[60:63], a[212:215], a[236:239]
  buffer_load_dwordx4 a[116:119], v218, s[8:11], s45 offen sc1
  v_mfma_f32_16x16x32_bf16 a[240:243], v[68:71], a[212:215], a[240:243]
  v_mfma_f32_16x16x32_bf16 a[52:55], v[68:71], a[192:195], a[52:55]
  v_mfma_f32_16x16x32_bf16 a[32:35], v[68:71], v[132:135], a[32:35]
  v_mfma_f32_16x16x32_bf16 a[76:79], v[68:71], v[128:131], a[76:79]
  v_mfma_f32_16x16x32_bf16 a[80:83], v[88:91], v[128:131], a[80:83]
  buffer_load_dwordx4 a[120:123], v219, s[8:11], s45 offen sc1
  v_mfma_f32_16x16x32_bf16 a[36:39], v[88:91], v[132:135], a[36:39]
  v_mfma_f32_16x16x32_bf16 a[56:59], v[88:91], a[192:195], a[56:59]
  v_mfma_f32_16x16x32_bf16 a[244:247], v[88:91], a[212:215], a[244:247]
  s_barrier
  s_waitcnt vmcnt(12)
  v_mfma_f32_16x16x32_bf16 a[64:67], v[92:95], a[184:187], a[64:67]
  s_waitcnt vmcnt(11)
  v_mfma_f32_16x16x32_bf16 a[20:23], v[92:95], v[136:139], a[20:23]
  s_waitcnt vmcnt(10)
  v_mfma_f32_16x16x32_bf16 a[40:43], v[92:95], v[140:143], a[40:43]
  s_waitcnt vmcnt(9)
  v_mfma_f32_16x16x32_bf16 a[60:63], v[92:95], v[144:147], a[60:63]
  v_mfma_f32_16x16x32_bf16 a[232:235], v[112:115], v[144:147], a[232:235]
  v_mfma_f32_16x16x32_bf16 a[44:47], v[112:115], v[140:143], a[44:47]
  v_mfma_f32_16x16x32_bf16 a[24:27], v[112:115], v[136:139], a[24:27]
  v_mfma_f32_16x16x32_bf16 a[68:71], v[112:115], a[184:187], a[68:71]
  v_mfma_f32_16x16x32_bf16 a[72:75], a[196:199], a[184:187], a[72:75]
  v_mfma_f32_16x16x32_bf16 a[28:31], a[196:199], v[136:139], a[28:31]
  v_mfma_f32_16x16x32_bf16 a[48:51], a[196:199], v[140:143], a[48:51]
  v_mfma_f32_16x16x32_bf16 a[236:239], a[196:199], v[144:147], a[236:239]
  v_mfma_f32_16x16x32_bf16 a[240:243], a[200:203], v[144:147], a[240:243]
  v_mfma_f32_16x16x32_bf16 a[52:55], a[200:203], v[140:143], a[52:55]
  v_mfma_f32_16x16x32_bf16 a[32:35], a[200:203], v[136:139], a[32:35]
  v_mfma_f32_16x16x32_bf16 a[76:79], a[200:203], a[184:187], a[76:79]
  v_mfma_f32_16x16x32_bf16 a[80:83], a[228:231], a[184:187], a[80:83]
  v_mfma_f32_16x16x32_bf16 a[36:39], a[228:231], v[136:139], a[36:39]
  v_mfma_f32_16x16x32_bf16 a[56:59], a[228:231], v[140:143], a[56:59]
  v_mfma_f32_16x16x32_bf16 a[244:247], a[228:231], v[144:147], a[244:247]
  s_mov_b32 s54, 0x100000
  s_waitcnt vmcnt(8)
  v_mov_b32 v225, v225
K1_spinX:
  v_cmp_gt_u32 vcc, 1, v225
  s_nop 4
  s_cbranch_vccz K1_spinX_ok
  s_sleep 2
  buffer_load_dword v225, v206, s[20:23], s61 offen sc1
  s_sub_u32 s54, s54, 1
  s_cmp_lg_u32 s54, 0
  s_waitcnt vmcnt(0)
  s_cbranch_scc1 K1_spinX
K1_spinX_ok:
  s_waitcnt vmcnt(6)
  v_mfma_f32_16x16x32_bf16 a[20:23], a[84:87], a[208:211], a[20:23]
  s_waitcnt vmcnt(2)
  v_mfma_f32_16x16x32_bf16 a[20:23], a[220:223], a[112:115], a[20:23]
  buffer_load_dwordx4 v[152:155], v223, s[80:83], s65 offen offset:0 sc1
  v_mfma_f32_16x16x32_bf16 a[24:27], a[224:227], a[112:115], a[24:27]
  v_mfma_f32_16x16x32_bf16 a[24:27], a[124:127], a[208:211], a[24:27]
  v_mfma_f32_16x16x32_bf16 a[28:31], v[188:191], a[208:211], a[28:31]
  v_mfma_f32_16x16x32_bf16 a[28:31], a[180:183], a[112:115], a[28:31]
  buffer_load_dwordx4 v[176:179], v223, s[80:83], s65 offen offset:1024 sc1
  v_mfma_f32_16x16x32_bf16 a[32:35], v[180:183], a[112:115], a[32:35]
  v_mfma_f32_16x16x32_bf16 a[32:35], v[32:35], a[208:211], a[32:35]
  v_mfma_f32_16x16x32_bf16 a[36:39], v[96:99], a[208:211], a[36:39]
  v_mfma_f32_16x16x32_bf16 a[36:39], v[116:119], a[112:115], a[36:39]
  buffer_load_dwordx4 v[172:175], v223, s[80:83], s65 offen offset:2048 sc1
  ds_write_b128 v253, a[20:23] offset:0
  s_waitcnt vmcnt(4)
  v_mfma_f32_16x16x32_bf16 a[40:43], a[220:223], a[116:119], a[40:43]
  v_mfma_f32_16x16x32_bf16 a[40:43], a[84:87], v[84:87], a[40:43]
  ds_write_b128 v253, a[24:27] offset:1024
  v_mfma_f32_16x16x32_bf16 a[44:47], a[124:127], v[84:87], a[44:47]
  v_mfma_f32_16x16x32_bf16 a[44:47], a[224:227], a[116:119], a[44:47]
  buffer_load_dwordx4 v[104:107], v223, s[80:83], s65 offen offset:3072 sc1
  ds_write_b128 v253, a[28:31] offset:2048
  v_mfma_f32_16x16x32_bf16 a[48:51], a[180:183], a[116:119], a[48:51]
  v_mfma_f32_16x16x32_bf16 a[48:51], v[188:191], v[84:87], a[48:51]
  ds_write_b128 v253, a[32:35] offset:3072
  v_mfma_f32_16x16x32_bf16 a[52:55], v[32:35], v[84:87], a[52:55]
  v_mfma_f32_16x16x32_bf16 a[52:55], v[180:183], a[116:119], a[52:55]
  buffer_load_dwordx4 v[108:111], v224, s[80:83], s65 offen offset:0 sc1
  ds_write_b128 v253, a[36:39] offset:4096
  v_mfma_f32_16x16x32_bf16 a[56:59], v[116:119], a[116:119], a[56:59]
  v_mfma_f32_16x16x32_bf16 a[56:59], v[96:99], v[84:87], a[56:59]
  ds_write_b128 v254, a[40:43] offset:0
  v_mfma_f32_16x16x32_bf16 a[60:63], a[84:87], v[156:159], a[60:63]
  v_lshlrev_b32 v184, 16, v192
  v_and_b32 v185, 0xffff0000, v192
  s_waitcnt vmcnt(5)
  v_mfma_f32_16x16x32_bf16 a[60:63], a[220:223], a[120:123], a[60:63]
  ds_write_b128 v254, a[44:47] offset:1024
  v_mfma_f32_16x16x32_bf16 a[232:235], a[224:227], a[120:123], a[232:235]
  v_lshlrev_b32 v186, 16, v193
  v_and_b32 v187, 0xffff0000, v193
  v_mfma_f32_16x16x32_bf16 a[232:235], a[124:127], v[156:159], a[232:235]
  ds_write_b128 v254, a[48:51] offset:2048
  v_mfma_f32_16x16x32_bf16 a[236:239], v[188:191], v[156:159], a[236:239]
  v_lshlrev_b32 v100, 16, v194
  v_and_b32 v101, 0xffff0000, v194
  v_mfma_f32_16x16x32_bf16 a[236:239], a[180:183], a[120:123], a[236:239]
  ds_write_b128 v254, a[52:55] offset:3072
  v_mfma_f32_16x16x32_bf16 a[240:243], v[180:183], a[120:123], a[240:243]
  v_lshlrev_b32 v102, 16, v195
  v_and_b32 v103, 0xffff0000, v195
  v_mfma_f32_16x16x32_bf16 a[240:243], v[32:35], v[156:159], a[240:243]
  ds_write_b128 v254, a[56:59] offset:4096
  v_mfma_f32_16x16x32_bf16 a[244:247], v[96:99], v[156:159], a[244:247]
  v_lshlrev_b32 v80, 16, v196
  v_and_b32 v81, 0xffff0000, v196
  v_mfma_f32_16x16x32_bf16 a[244:247], v[116:119], a[120:123], a[244:247]
  ds_write_b128 v255, a[60:63] offset:0
  v_mfma_f32_16x16x32_bf16 a[64:67], a[220:223], v[160:163], a[64:67]
  v_lshlrev_b32 v82, 16, v197
  v_and_b32 v83, 0xffff0000, v197
  v_mfma_f32_16x16x32_bf16 a[64:67], a[84:87], a[204:207], a[64:67]
  ds_write_b128 v255, a[232:235] offset:1024
  v_mfma_f32_16x16x32_bf16 a[68:71], a[124:127], a[204:207], a[68:71]
  v_lshlrev_b32 v164, 16, v198
  v_and_b32 v165, 0xffff0000, v198
  v_mfma_f32_16x16x32_bf16 a[68:71], a[224:227], v[160:163], a[68:71]
  ds_write_b128 v255, a[236:239] offset:2048
  v_mfma_f32_16x16x32_bf16 a[72:75], a[180:183], v[160:163], a[72:75]
  v_lshlrev_b32 v166, 16, v199
  v_and_b32 v167, 0xffff0000, v199
  v_mfma_f32_16x16x32_bf16 a[72:75], v[188:191], a[204:207], a[72:75]
  ds_write_b128 v255, a[240:243] offset:3072
  v_mfma_f32_16x16x32_bf16 a[76:79], v[32:35], a[204:207], a[76:79]
  v_lshlrev_b32 v168, 16, v200
  v_and_b32 v169, 0xffff0000, v200
  v_mfma_f32_16x16x32_bf16 a[76:79], v[180:183], v[160:163], a[76:79]
  ds_write_b128 v255, a[244:247] offset:4096
  v_mfma_f32_16x16x32_bf16 a[80:83], v[116:119], v[160:163], a[80:83]
  v_lshlrev_b32 v170, 16, v201
  v_and_b32 v171, 0xffff0000, v201
  v_mfma_f32_16x16x32_bf16 a[80:83], v[96:99], a[204:207], a[80:83]
  s_waitcnt lgkmcnt(0)
  s_barrier
  ds_read_b128 v[4:7], v252 offset:0
  ds_read_b128 v[8:11], v252 offset:5120
  ds_read_b128 v[12:15], v252 offset:10240
  ds_read_b128 v[20:23], v252 offset:1024
  ds_read_b128 v[24:27], v252 offset:6144
  ds_read_b128 v[28:31], v252 offset:11264
  ds_read_b128 v[36:39], v252 offset:2048
  ds_read_b128 v[40:43], v252 offset:7168
  ds_read_b128 v[44:47], v252 offset:12288
  ds_read_b128 v[52:55], v252 offset:3072
  ds_read_b128 v[56:59], v252 offset:8192
  ds_read_b128 v[60:63], v252 offset:13312
  ds_read_b128 v[68:71], v252 offset:4096
  ds_read_b128 v[72:75], v252 offset:9216
  ds_read_b128 v[76:79], v252 offset:14336
  v_accvgpr_read_b32 v0, a64
  v_accvgpr_read_b32 v1, a65
  v_accvgpr_read_b32 v2, a66
  v_accvgpr_read_b32 v3, a67
  v_accvgpr_read_b32 v16, a68
  v_accvgpr_read_b32 v17, a69
  v_accvgpr_read_b32 v18, a70
  v_accvgpr_read_b32 v19, a71
  v_accvgpr_read_b32 v32, a72
  v_accvgpr_read_b32 v33, a73
  v_accvgpr_read_b32 v34, a74
  v_accvgpr_read_b32 v35, a75
  v_accvgpr_read_b32 v48, a76
  v_accvgpr_read_b32 v49, a77
  v_accvgpr_read_b32 v50, a78
  v_accvgpr_read_b32 v51, a79
  v_accvgpr_read_b32 v64, a80
  v_accvgpr_read_b32 v65, a81
  v_accvgpr_read_b32 v66, a82
  v_accvgpr_read_b32 v67, a83
  s_waitcnt vmcnt(4)
  v_pk_add_f32 v[0:1], v[0:1], v[152:153]
  v_pk_add_f32 v[2:3], v[2:3], v[154:155]
  s_waitcnt vmcnt(3)
  v_pk_add_f32 v[16:17], v[16:17], v[176:177]
  v_pk_add_f32 v[18:19], v[18:19], v[178:179]
  s_waitcnt vmcnt(2)
  v_pk_add_f32 v[32:33], v[32:33], v[172:173]
  v_pk_add_f32 v[34:35], v[34:35], v[174:175]
  s_waitcnt vmcnt(1)
  v_pk_add_f32 v[48:49], v[48:49], v[104:105]
  v_pk_add_f32 v[50:51], v[50:51], v[106:107]
  s_waitcnt vmcnt(0)
  v_pk_add_f32 v[64:65], v[64:65], v[108:109]
  v_pk_add_f32 v[66:67], v[66:67], v[110:111]
  s_waitcnt lgkmcnt(14)
  v_pk_add_f32 v[0:1], v[0:1], v[4:5]
  v_pk_add_f32 v[2:3], v[2:3], v[6:7]
  s_waitcnt lgkmcnt(12)
  v_pk_add_f32 v[8:9], v[8:9], v[12:13]
  v_pk_add_f32 v[10:11], v[10:11], v[14:15]
  v_pk_add_f32 v[0:1], v[0:1], v[8:9]
  v_pk_add_f32 v[2:3], v[2:3], v[10:11]
  v_pk_fma_f32 v[184:185], v[0:1], v[232:233], v[184:185]
  v_pk_fma_f32 v[186:187], v[2:3], v[234:235], v[186:187]
  v_cvt_pk_bf16_f32 v140, v184, v185
  v_cvt_pk_bf16_f32 v141, v186, v187
  ds_write_b64 v202, v[140:141] offset:0
  s_waitcnt lgkmcnt(12)
  v_pk_add_f32 v[16:17], v[16:17], v[20:21]
  v_pk_add_f32 v[18:19], v[18:19], v[22:23]
  s_waitcnt lgkmcnt(10)
  v_pk_add_f32 v[24:25], v[24:25], v[28:29]
  v_pk_add_f32 v[26:27], v[26:27], v[30:31]
  v_pk_add_f32 v[16:17], v[16:17], v[24:25]
  v_pk_add_f32 v[18:19], v[18:19], v[26:27]
  v_pk_fma_f32 v[100:101], v[16:17], v[236:237], v[100:101]
  v_pk_fma_f32 v[102:103], v[18:19], v[238:239], v[102:103]
  v_cvt_pk_bf16_f32 v142, v100, v101
  v_cvt_pk_bf16_f32 v143, v102, v103
  ds_write_b64 v202, v[142:143] offset:8
  s_waitcnt lgkmcnt(10)
  v_pk_add_f32 v[32:33], v[32:33], v[36:37]
  v_pk_add_f32 v[34:35], v[34:35], v[38:39]
  s_waitcnt lgkmcnt(8)
  v_pk_add_f32 v[40:41], v[40:41], v[44:45]
  v_pk_add_f32 v[42:43], v[42:43], v[46:47]
  v_pk_add_f32 v[32:33], v[32:33], v[40:41]
  v_pk_add_f32 v[34:35], v[34:35], v[42:43]
  v_pk_fma_f32 v[80:81], v[32:33], v[240:241], v[80:81]
  v_pk_fma_f32 v[82:83], v[34:35], v[242:243], v[82:83]
  v_cvt_pk_bf16_f32 v144, v80, v81
  v_cvt_pk_bf16_f32 v145, v82, v83
  ds_write_b64 v202, v[144:145] offset:16
  s_waitcnt lgkmcnt(8)
  v_pk_add_f32 v[48:49], v[48:49], v[52:53]
  v_pk_add_f32 v[50:51], v[50:51], v[54:55]
  s_waitcnt lgkmcnt(6)
  v_pk_add_f32 v[56:57], v[56:57], v[60:61]
  v_pk_add_f32 v[58:59], v[58:59], v[62:63]
  v_pk_add_f32 v[48:49], v[48:49], v[56:57]
  v_pk_add_f32 v[50:51], v[50:51], v[58:59]
  v_pk_fma_f32 v[164:165], v[48:49], v[244:245], v[164:165]
  v_pk_fma_f32 v[166:167], v[50:51], v[246:247], v[166:167]
  v_cvt_pk_bf16_f32 v146, v164, v165
  v_cvt_pk_bf16_f32 v147, v166, v167
  ds_write_b64 v202, v[146:147] offset:24
  s_waitcnt lgkmcnt(6)
  v_pk_add_f32 v[64:65], v[64:65], v[68:69]
  v_pk_add_f32 v[66:67], v[66:67], v[70:71]
  s_waitcnt lgkmcnt(4)
  v_pk_add_f32 v[72:73], v[72:73], v[76:77]
  v_pk_add_f32 v[74:75], v[74:75], v[78:79]
  v_pk_add_f32 v[64:65], v[64:65], v[72:73]
  v_pk_add_f32 v[66:67], v[66:67], v[74:75]
  v_pk_fma_f32 v[168:169], v[64:65], v[248:249], v[168:169]
  v_pk_fma_f32 v[170:171], v[66:67], v[250:251], v[170:171]
  v_cvt_pk_bf16_f32 v148, v168, v169
  v_cvt_pk_bf16_f32 v149, v170, v171
  ds_write_b64 v202, v[148:149] offset:32
  ds_read_b128 v[120:123], v207 offset:0
  ds_read_b128 v[124:127], v207 offset:1024
  ds_read_b128 v[128:131], v207 offset:2048
  s_waitcnt lgkmcnt(2)
  buffer_store_dwordx4 v[120:123], v228, s[76:79], s58 offen offset:0 nt
  s_waitcnt lgkmcnt(1)
  buffer_store_dwordx4 v[124:127], v229, s[76:79], s58 offen offset:1024 nt
  s_mov_b32 exec_hi, 0
  s_waitcnt lgkmcnt(0)
  buffer_store_dwordx4 v[128:131], v230, s[76:79], s58 offen offset:2048 nt
  s_mov_b64 exec, -1
K1_c1:
K1_end:
  s_endpgm
K1_ce:
  v_mov_b32 v196, 3
  s_mov_b64 exec, 1
  buffer_store_dword v196, v223, s[20:23], s53 offen sc1
  s_mov_b64 exec, -1
  s_waitcnt vmcnt(18)
  v_mfma_f32_16x16x32_bf16 a[0:3], a[128:131], v[152:155], 0
K1_st16:
  s_cbranch_execz K1_st3
  s_add_u32 s45, s40, 49152
  s_waitcnt vmcnt(17)
  v_mfma_f32_16x16x32_bf16 a[20:23], a[128:131], v[156:159], 0
  buffer_load_dwordx4 a[180:183], v216, s[8:11], s45 offen sc1
  s_waitcnt vmcnt(17)
  v_mfma_f32_16x16x32_bf16 a[40:43], a[128:131], v[160:163], 0
  s_waitcnt vmcnt(16)
  v_mfma_f32_16x16x32_bf16 a[60:63], a[128:131], v[164:167], 0
  v_mfma_f32_16x16x32_bf16 a[232:235], a[132:135], v[164:167], 0
  buffer_load_dwordx4 a[184:187], v217, s[8:11], s45 offen sc1
  v_mfma_f32_16x16x32_bf16 a[44:47], a[132:135], v[160:163], 0
  v_mfma_f32_16x16x32_bf16 a[24:27], a[132:135], v[156:159], 0
  v_mfma_f32_16x16x32_bf16 a[4:7], a[132:135], v[152:155], 0
  buffer_load_dwordx4 a[188:191], v218, s[8:11], s45 offen sc1
  v_mfma_f32_16x16x32_bf16 a[8:11], a[136:139], v[152:155], 0
  v_mfma_f32_16x16x32_bf16 a[28:31], a[136:139], v[156:159], 0
  v_mfma_f32_16x16x32_bf16 a[48:51], a[136:139], v[160:163], 0
  v_mfma_f32_16x16x32_bf16 a[236:239], a[136:139], v[164:167], 0
  buffer_load_dwordx4 v[64:67], v219, s[8:11], s45 offen sc1
  v_mfma_f32_16x16x32_bf16 a[240:243], a[140:143], v[164:167], 0
  v_mfma_f32_16x16x32_bf16 a[52:55], a[140:143], v[160:163], 0
  s_add_u32 s55, s41, 61440
  v_mfma_f32_16x16x32_bf16 a[32:35], a[140:143], v[156:159], 0
  buffer_load_dwordx4 v[68:71], v223, s[12:15], s55 offen offset:3072 sc1
  v_mfma_f32_16x16x32_bf16 a[12:15], a[140:143], v[152:155], 0
  v_mfma_f32_16x16x32_bf16 a[16:19], a[144:147], v[152:155], 0
  s_add_u32 s55, s41, 65536
  v_mfma_f32_16x16x32_bf16 a[36:39], a[144:147], v[156:159], 0
  buffer_load_dwordx4 v[72:75], v223, s[12:15], s55 offen offset:0 sc1
  v_mfma_f32_16x16x32_bf16 a[56:59], a[144:147], v[160:163], 0
  v_mfma_f32_16x16x32_bf16 a[244:247], a[144:147], v[164:167], 0
  s_waitcnt vmcnt(20)
  v_mfma_f32_16x16x32_bf16 a[0:3], a[148:151], v[168:171], a[0:3]
  s_add_u32 s45, s40, 4096
  s_waitcnt vmcnt(19)
  v_mfma_f32_16x16x32_bf16 a[20:23], a[148:151], v[172:175], a[20:23]
  buffer_load_dwordx4 v[76:79], v216, s[8:11], s45 offen sc1
  s_waitcnt vmcnt(19)
  v_mfma_f32_16x16x32_bf16 a[40:43], a[148:151], v[176:179], a[40:43]
  s_waitcnt vmcnt(18)
  v_mfma_f32_16x16x32_bf16 a[60:63], a[148:151], v[180:183], a[60:63]
  buffer_load_dwordx4 v[80:83], v217, s[8:11], s45 offen sc1
  v_mfma_f32_16x16x32_bf16 a[232:235], a[152:155], v[180:183], a[232:235]
  v_mfma_f32_16x16x32_bf16 a[44:47], a[152:155], v[176:179], a[44:47]
  v_mfma_f32_16x16x32_bf16 a[24:27], a[152:155], v[172:175], a[24:27]
  buffer_load_dwordx4 v[84:87], v218, s[8:11], s45 offen sc1
  v_mfma_f32_16x16x32_bf16 a[4:7], a[152:155], v[168:171], a[4:7]
  v_mfma_f32_16x16x32_bf16 a[8:11], a[156:159], v[168:171], a[8:11]
  v_mfma_f32_16x16x32_bf16 a[28:31], a[156:159], v[172:175], a[28:31]
  buffer_load_dwordx4 v[88:91], v219, s[8:11], s45 offen sc1
  v_mfma_f32_16x16x32_bf16 a[48:51], a[156:159], v[176:179], a[48:51]
  v_mfma_f32_16x16x32_bf16 a[236:239], a[156:159], v[180:183], a[236:239]
  s_add_u32 s55, s41, 65536
  v_mfma_f32_16x16x32_bf16 a[240:243], v[0:3], v[180:183], a[240:243]
  buffer_load_dwordx4 v[92:95], v223, s[12:15], s55 offen offset:1024 sc1
  v_mfma_f32_16x16x32_bf16 a[52:55], v[0:3], v[176:179], a[52:55]
  v_mfma_f32_16x16x32_bf16 a[32:35], v[0:3], v[172:175], a[32:35]
  v_mfma_f32_16x16x32_bf16 a[12:15], v[0:3], v[168:171], a[12:15]
  buffer_load_dwordx4 v[96:99], v223, s[12:15], s55 offen offset:2048 sc1
  v_mfma_f32_16x16x32_bf16 a[16:19], v[4:7], v[168:171], a[16:19]
  v_mfma_f32_16x16x32_bf16 a[36:39], v[4:7], v[172:175], a[36:39]
  v_mfma_f32_16x16x32_bf16 a[56:59], v[4:7], v[176:179], a[56:59]
  buffer_load_dwordx4 v[100:103], v223, s[12:15], s55 offen offset:3072 sc1
  v_mfma_f32_16x16x32_bf16 a[244:247], v[4:7], v[180:183], a[244:247]
  s_waitcnt vmcnt(23)
  v_mfma_f32_16x16x32_bf16 a[0:3], v[8:11], v[184:187], a[0:3]
  s_add_u32 s45, s40, 20480
  s_waitcnt vmcnt(22)
  v_mfma_f32_16x16x32_bf16 a[20:23], v[8:11], v[188:191], a[20:23]
  buffer_load_dwordx4 v[104:107], v216, s[8:11], s45 offen sc1
  s_waitcnt vmcnt(22)
  v_mfma_f32_16x16x32_bf16 a[40:43], v[8:11], v[32:35], a[40:43]
  s_waitcnt vmcnt(21)
  v_mfma_f32_16x16x32_bf16 a[60:63], v[8:11], v[36:39], a[60:63]
K1_st17:
  s_cbranch_execz K1_st2
  v_mfma_f32_16x16x32_bf16 a[232:235], v[12:15], v[36:39], a[232:235]
  buffer_load_dwordx4 v[108:111], v217, s[8:11], s45 offen sc1
  v_mfma_f32_16x16x32_bf16 a[44:47], v[12:15], v[32:35], a[44:47]
  v_mfma_f32_16x16x32_bf16 a[24:27], v[12:15], v[188:191], a[24:27]
  v_mfma_f32_16x16x32_bf16 a[4:7], v[12:15], v[184:187], a[4:7]
  buffer_load_dwordx4 v[112:115], v218, s[8:11], s45 offen sc1
  v_mfma_f32_16x16x32_bf16 a[8:11], v[16:19], v[184:187], a[8:11]
  v_mfma_f32_16x16x32_bf16 a[28:31], v[16:19], v[188:191], a[28:31]
  v_mfma_f32_16x16x32_bf16 a[48:51], v[16:19], v[32:35], a[48:51]
  v_mfma_f32_16x16x32_bf16 a[236:239], v[16:19], v[36:39], a[236:239]
  buffer_load_dwordx4 v[116:119], v219, s[8:11], s45 offen sc1
  v_mfma_f32_16x16x32_bf16 a[240:243], v[20:23], v[36:39], a[240:243]
  v_mfma_f32_16x16x32_bf16 a[52:55], v[20:23], v[32:35], a[52:55]
  s_add_u32 s55, s41, 69632
  v_mfma_f32_16x16x32_bf16 a[32:35], v[20:23], v[188:191], a[32:35]
  buffer_load_dwordx4 v[120:123], v223, s[12:15], s55 offen offset:0 sc1
  v_mfma_f32_16x16x32_bf16 a[12:15], v[20:23], v[184:187], a[12:15]
  v_mfma_f32_16x16x32_bf16 a[16:19], v[24:27], v[184:187], a[16:19]
  v_mfma_f32_16x16x32_bf16 a[36:39], v[24:27], v[188:191], a[36:39]
  buffer_load_dwordx4 v[124:127], v223, s[12:15], s55 offen offset:1024 sc1
  v_mfma_f32_16x16x32_bf16 a[56:59], v[24:27], v[32:35], a[56:59]
  v_mfma_f32_16x16x32_bf16 a[244:247], v[24:27], v[36:39], a[244:247]
  s_waitcnt vmcnt(18)
  v_mfma_f32_16x16x32_bf16 a[0:3], v[28:31], a[180:183], a[0:3]
  s_waitcnt vmcnt(17)
  v_mfma_f32_16x16x32_bf16 a[20:23], v[28:31], a[184:187], a[20:23]
  buffer_load_dword v225, v226, s[20:23], s52 offen sc1
  s_waitcnt vmcnt(17)
  v_mfma_f32_16x16x32_bf16 a[40:43], v[28:31], a[188:191], a[40:43]
  s_add_u32 s45, s40, 36864
  s_waitcnt vmcnt(16)
  v_mfma_f32_16x16x32_bf16 a[60:63], v[28:31], v[64:67], a[60:63]
  buffer_load_dwordx4 a[192:195], v216, s[8:11], s45 offen sc1
  v_mfma_f32_16x16x32_bf16 a[232:235], a[248:251], v[64:67], a[232:235]
  v_mfma_f32_16x16x32_bf16 a[44:47], a[248:251], a[188:191], a[44:47]
  v_mfma_f32_16x16x32_bf16 a[24:27], a[248:251], a[184:187], a[24:27]
  buffer_load_dwordx4 a[196:199], v217, s[8:11], s45 offen sc1
  v_mfma_f32_16x16x32_bf16 a[4:7], a[248:251], a[180:183], a[4:7]
  v_mfma_f32_16x16x32_bf16 a[8:11], a[252:255], a[180:183], a[8:11]
  buffer_load_dwordx4 a[200:203], v218, s[8:11], s45 offen sc1
  v_mfma_f32_16x16x32_bf16 a[28:31], a[252:255], a[184:187], a[28:31]
  v_mfma_f32_16x16x32_bf16 a[48:51], a[252:255], a[188:191], a[48:51]
  v_mfma_f32_16x16x32_bf16 a[236:239], a[252:255], v[64:67], a[236:239]
  buffer_load_dwordx4 a[204:207], v219, s[8:11], s45 offen sc1
  v_mfma_f32_16x16x32_bf16 a[240:243], a[160:163], v[64:67], a[240:243]
  s_add_u32 s55, s41, 69632
  v_mfma_f32_16x16x32_bf16 a[52:55], a[160:163], a[188:191], a[52:55]
  buffer_load_dwordx4 a[208:211], v223, s[12:15], s55 offen offset:2048 sc1
  v_mfma_f32_16x16x32_bf16 a[32:35], a[160:163], a[184:187], a[32:35]
  v_mfma_f32_16x16x32_bf16 a[12:15], a[160:163], a[180:183], a[12:15]
  v_mfma_f32_16x16x32_bf16 a[16:19], a[164:167], a[180:183], a[16:19]
  buffer_load_dwordx4 a[212:215], v223, s[12:15], s55 offen offset:3072 sc1
  v_mfma_f32_16x16x32_bf16 a[36:39], a[164:167], a[184:187], a[36:39]
  s_add_u32 s55, s41, 73728
  v_mfma_f32_16x16x32_bf16 a[56:59], a[164:167], a[188:191], a[56:59]
  buffer_load_dwordx4 a[216:219], v223, s[12:15], s55 offen offset:0 sc1
  v_mfma_f32_16x16x32_bf16 a[244:247], a[164:167], v[64:67], a[244:247]
  s_waitcnt vmcnt(20)
  v_mfma_f32_16x16x32_bf16 a[0:3], a[168:171], v[76:79], a[0:3]
  s_add_u32 s45, s40, 53248
  s_waitcnt vmcnt(19)
  v_mfma_f32_16x16x32_bf16 a[20:23], a[168:171], v[80:83], a[20:23]
  buffer_load_dwordx4 a[228:231], v216, s[8:11], s45 offen sc1
  s_waitcnt vmcnt(19)
  v_mfma_f32_16x16x32_bf16 a[40:43], a[168:171], v[84:87], a[40:43]
  ds_read_b128 a[220:223], v220 offset:49152
  s_waitcnt vmcnt(18)
  v_mfma_f32_16x16x32_bf16 a[60:63], a[168:171], v[88:91], a[60:63]
  v_mfma_f32_16x16x32_bf16 a[232:235], a[172:175], v[88:91], a[232:235]
  buffer_load_dwordx4 a[84:87], v217, s[8:11], s45 offen sc1
  v_mfma_f32_16x16x32_bf16 a[44:47], a[172:175], v[84:87], a[44:47]
  v_mfma_f32_16x16x32_bf16 a[24:27], a[172:175], v[80:83], a[24:27]
  ds_read_b128 a[224:227], v220 offset:50176
  v_mfma_f32_16x16x32_bf16 a[4:7], a[172:175], v[76:79], a[4:7]
  buffer_load_dwordx4 a[88:91], v218, s[8:11], s45 offen sc1
  v_mfma_f32_16x16x32_bf16 a[8:11], a[176:179], v[76:79], a[8:11]
  v_mfma_f32_16x16x32_bf16 a[28:31], a[176:179], v[80:83], a[28:31]
  v_mfma_f32_16x16x32_bf16 a[48:51], a[176:179], v[84:87], a[48:51]
  v_mfma_f32_16x16x32_bf16 a[236:239], a[176:179], v[88:91], a[236:239]
  buffer_load_dwordx4 a[92:95], v219, s[8:11], s45 offen sc1
  v_mfma_f32_16x16x32_bf16 a[240:243], v[128:131], v[88:91], a[240:243]
  v_mfma_f32_16x16x32_bf16 a[52:55], v[128:131], v[84:87], a[52:55]
  s_add_u32 s55, s41, 73728
  v_mfma_f32_16x16x32_bf16 a[32:35], v[128:131], v[80:83], a[32:35]
  buffer_load_dwordx4 a[96:99], v223, s[12:15], s55 offen offset:1024 sc1
  v_mfma_f32_16x16x32_bf16 a[12:15], v[128:131], v[76:79], a[12:15]
  v_mfma_f32_16x16x32_bf16 a[16:19], v[132:135], v[76:79], a[16:19]
  v_mfma_f32_16x16x32_bf16 a[36:39], v[132:135], v[80:83], a[36:39]
  buffer_load_dwordx4 a[100:103], v223, s[12:15], s55 offen offset:2048 sc1
  v_mfma_f32_16x16x32_bf16 a[56:59], v[132:135], v[84:87], a[56:59]
  v_mfma_f32_16x16x32_bf16 a[244:247], v[132:135], v[88:91], a[244:247]
  s_mov_b32 s54, 0x100000
  s_waitcnt vmcnt(13)
  v_mov_b32 v225, v225
K1_spinEO2:
  v_cmp_gt_u32 vcc, 3, v225
  s_nop 4
  s_cbranch_vccz K1_spinEO2_ok
  s_sleep 2
  buffer_load_dword v225, v226, s[20:23], s52 offen sc1
  s_sub_u32 s54, s54, 1
  s_cmp_lg_u32 s54, 0
  s_waitcnt vmcnt(0)
  s_cbranch_scc1 K1_spinEO2
K1_spinEO2_ok:
  v_mfma_f32_16x16x32_bf16 a[0:3], v[136:139], v[104:107], a[0:3]
  s_add_u32 s45, s40, 8192
  v_mfma_f32_16x16x32_bf16 a[20:23], v[136:139], v[108:111], a[20:23]
  buffer_load_dwordx4 a[124:127], v216, s[8:11], s45 offen sc1
  v_mfma_f32_16x16x32_bf16 a[40:43], v[136:139], v[112:115], a[40:43]
  ds_read_b128 a[104:107], v220 offset:51200
  v_mfma_f32_16x16x32_bf16 a[60:63], v[136:139], v[116:119], a[60:63]
  buffer_load_dwordx4 v[152:155], v217, s[8:11], s45 offen sc1
  v_mfma_f32_16x16x32_bf16 a[232:235], v[140:143], v[116:119], a[232:235]
  v_mfma_f32_16x16x32_bf16 a[44:47], v[140:143], v[112:115], a[44:47]
  v_mfma_f32_16x16x32_bf16 a[24:27], v[140:143], v[108:111], a[24:27]
  buffer_load_dwordx4 v[156:159], v218, s[8:11], s45 offen sc1
  ds_read_b128 a[108:111], v220 offset:52224
  v_mfma_f32_16x16x32_bf16 a[4:7], v[140:143], v[104:107], a[4:7]
  v_mfma_f32_16x16x32_bf16 a[8:11], v[144:147], v[104:107], a[8:11]
  v_mfma_f32_16x16x32_bf16 a[28:31], v[144:147], v[108:111], a[28:31]
  buffer_load_dwordx4 v[160:163], v219, s[8:11], s45 offen sc1
  v_mfma_f32_16x16x32_bf16 a[48:51], v[144:147], v[112:115], a[48:51]
  ds_read_b128 a[112:115], v221 offset:32768
  v_mfma_f32_16x16x32_bf16 a[236:239], v[144:147], v[116:119], a[236:239]
  s_waitcnt lgkmcnt(2)
  s_add_u32 s55, s41, 73728
  v_mfma_f32_16x16x32_bf16 a[240:243], a[220:223], v[116:119], a[240:243]
  buffer_load_dwordx4 v[164:167], v223, s[12:15], s55 offen offset:3072 sc1
  v_mfma_f32_16x16x32_bf16 a[52:55], a[220:223], v[112:115], a[52:55]
  v_mfma_f32_16x16x32_bf16 a[32:35], a[220:223], v[108:111], a[32:35]
  s_add_u32 s55, s41, 77824
  ds_read_b128 a[116:119], v221 offset:33792
  v_mfma_f32_16x16x32_bf16 a[12:15], a[220:223], v[104:107], a[12:15]
  buffer_load_dwordx4 v[168:171], v223, s[12:15], s55 offen offset:0 sc1
  v_mfma_f32_16x16x32_bf16 a[16:19], a[224:227], v[104:107], a[16:19]
  v_mfma_f32_16x16x32_bf16 a[36:39], a[224:227], v[108:111], a[36:39]
  v_mfma_f32_16x16x32_bf16 a[56:59], a[224:227], v[112:115], a[56:59]
  buffer_load_dwordx4 v[172:175], v223, s[12:15], s55 offen offset:1024 sc1
  ds_read_b128 a[120:123], v221 offset:34816
  v_mfma_f32_16x16x32_bf16 a[244:247], a[224:227], v[116:119], a[244:247]
  s_waitcnt vmcnt(19)
  v_mfma_f32_16x16x32_bf16 a[0:3], a[104:107], a[192:195], a[0:3]
  s_add_u32 s45, s40, 24576
  s_waitcnt vmcnt(18)
  v_mfma_f32_16x16x32_bf16 a[20:23], a[104:107], a[196:199], a[20:23]
  buffer_load_dwordx4 v[36:39], v216, s[8:11], s45 offen sc1
  s_waitcnt vmcnt(18)
  v_mfma_f32_16x16x32_bf16 a[40:43], a[104:107], a[200:203], a[40:43]
  ds_read_b128 v[176:179], v221 offset:35840
  s_waitcnt vmcnt(17)
  v_mfma_f32_16x16x32_bf16 a[60:63], a[104:107], a[204:207], a[60:63]
  s_waitcnt lgkmcnt(2)
  v_mfma_f32_16x16x32_bf16 a[232:235], a[108:111], a[204:207], a[232:235]
  buffer_load_dwordx4 a[180:183], v217, s[8:11], s45 offen sc1
  v_mfma_f32_16x16x32_bf16 a[44:47], a[108:111], a[200:203], a[44:47]
  v_mfma_f32_16x16x32_bf16 a[24:27], a[108:111], a[196:199], a[24:27]
  ds_read_b128 v[180:183], v220 offset:16384
  v_mfma_f32_16x16x32_bf16 a[4:7], a[108:111], a[192:195], a[4:7]
  buffer_load_dwordx4 a[184:187], v218, s[8:11], s45 offen sc1
  v_mfma_f32_16x16x32_bf16 a[8:11], a[112:115], a[192:195], a[8:11]
  v_mfma_f32_16x16x32_bf16 a[28:31], a[112:115], a[196:199], a[28:31]
  v_mfma_f32_16x16x32_bf16 a[48:51], a[112:115], a[200:203], a[48:51]
  ds_read_b128 v[184:187], v220 offset:17408
  v_mfma_f32_16x16x32_bf16 a[236:239], a[112:115], a[204:207], a[236:239]
  buffer_load_dwordx4 a[188:191], v219, s[8:11], s45 offen sc1
  v_mfma_f32_16x16x32_bf16 a[240:243], a[116:119], a[204:207], a[240:243]
  v_mfma_f32_16x16x32_bf16 a[52:55], a[116:119], a[200:203], a[52:55]
  s_add_u32 s55, s41, 77824
  v_mfma_f32_16x16x32_bf16 a[32:35], a[116:119], a[196:199], a[32:35]
  buffer_load_dwordx4 v[64:67], v223, s[12:15], s55 offen offset:2048 sc1
  ds_read_b128 v[188:191], v220 offset:18432
  v_mfma_f32_16x16x32_bf16 a[12:15], a[116:119], a[192:195], a[12:15]
  s_waitcnt lgkmcnt(2)
  v_mfma_f32_16x16x32_bf16 a[16:19], a[120:123], a[192:195], a[16:19]
  v_mfma_f32_16x16x32_bf16 a[36:39], a[120:123], a[196:199], a[36:39]
  buffer_load_dwordx4 v[76:79], v223, s[12:15], s55 offen offset:3072 sc1
  v_mfma_f32_16x16x32_bf16 a[56:59], a[120:123], a[200:203], a[56:59]
  ds_read_b128 v[32:35], v220 offset:19456
  v_mfma_f32_16x16x32_bf16 a[244:247], a[120:123], a[204:207], a[244:247]
  s_waitcnt vmcnt(18)
  v_mfma_f32_16x16x32_bf16 a[0:3], v[176:179], a[228:231], a[0:3]
  s_add_u32 s45, s40, 40960
  s_waitcnt vmcnt(17)
  v_mfma_f32_16x16x32_bf16 a[20:23], v[176:179], a[84:87], a[20:23]
  buffer_load_dwordx4 v[112:115], v216, s[8:11], s45 offen sc1
  s_waitcnt vmcnt(17)
  v_mfma_f32_16x16x32_bf16 a[40:43], v[176:179], a[88:91], a[40:43]
  ds_read_b128 v[80:83], v221 offset:0
  s_waitcnt vmcnt(16)
  v_mfma_f32_16x16x32_bf16 a[60:63], v[176:179], a[92:95], a[60:63]
  v_mfma_f32_16x16x32_bf16 a[232:235], v[180:183], a[92:95], a[232:235]
  v_mfma_f32_16x16x32_bf16 a[44:47], v[180:183], a[88:91], a[44:47]
  v_mfma_f32_16x16x32_bf16 a[24:27], v[180:183], a[84:87], a[24:27]
  buffer_load_dwordx4 v[116:119], v217, s[8:11], s45 offen sc1
  ds_read_b128 v[84:87], v221 offset:1024
  v_mfma_f32_16x16x32_bf16 a[4:7], v[180:183], a[228:231], a[4:7]
  s_waitcnt lgkmcnt(2)
  v_mfma_f32_16x16x32_bf16 a[8:11], v[184:187], a[228:231], a[8:11]
  v_mfma_f32_16x16x32_bf16 a[28:31], v[184:187], a[84:87], a[28:31]
  v_mfma_f32_16x16x32_bf16 a[48:51], v[184:187], a[88:91], a[48:51]
  ds_read_b128 v[88:91], v221 offset:2048
  v_mfma_f32_16x16x32_bf16 a[236:239], v[184:187], a[92:95], a[236:239]
  buffer_load_dwordx4 a[192:195], v218, s[8:11], s45 offen sc1
  v_mfma_f32_16x16x32_bf16 a[240:243], v[188:191], a[92:95], a[240:243]
  v_mfma_f32_16x16x32_bf16 a[52:55], v[188:191], a[88:91], a[52:55]
  v_mfma_f32_16x16x32_bf16 a[32:35], v[188:191], a[84:87], a[32:35]
  ds_read_b128 v[104:107], v221 offset:3072
  v_mfma_f32_16x16x32_bf16 a[12:15], v[188:191], a[228:231], a[12:15]
  v_mfma_f32_16x16x32_bf16 a[16:19], v[32:35], a[228:231], a[16:19]
  buffer_load_dwordx4 a[196:199], v219, s[8:11], s45 offen sc1
  v_mfma_f32_16x16x32_bf16 a[36:39], v[32:35], a[84:87], a[36:39]
  v_mfma_f32_16x16x32_bf16 a[56:59], v[32:35], a[88:91], a[56:59]
  ds_read_b128 v[108:111], v220 offset:32768
  v_mfma_f32_16x16x32_bf16 a[244:247], v[32:35], a[92:95], a[244:247]
  s_waitcnt lgkmcnt(2)
  s_waitcnt vmcnt(16)
  v_mfma_f32_16x16x32_bf16 a[0:3], v[80:83], a[124:127], a[0:3]
  s_add_u32 s45, s40, 57344
  s_waitcnt vmcnt(15)
  v_mfma_f32_16x16x32_bf16 a[20:23], v[80:83], v[152:155], a[20:23]
  buffer_load_dwordx4 a[92:95], v216, s[8:11], s45 offen sc1
  s_waitcnt vmcnt(15)
  v_mfma_f32_16x16x32_bf16 a[40:43], v[80:83], v[156:159], a[40:43]
  ds_read_b128 a[200:203], v220 offset:33792
  s_waitcnt vmcnt(14)
  v_mfma_f32_16x16x32_bf16 a[60:63], v[80:83], v[160:163], a[60:63]
  v_mfma_f32_16x16x32_bf16 a[232:235], v[84:87], v[160:163], a[232:235]
  v_mfma_f32_16x16x32_bf16 a[44:47], v[84:87], v[156:159], a[44:47]
  v_mfma_f32_16x16x32_bf16 a[24:27], v[84:87], v[152:155], a[24:27]
  buffer_load_dwordx4 v[180:183], v217, s[8:11], s45 offen sc1
  ds_read_b128 a[204:207], v220 offset:34816
  v_mfma_f32_16x16x32_bf16 a[4:7], v[84:87], a[124:127], a[4:7]
  v_mfma_f32_16x16x32_bf16 a[8:11], v[88:91], a[124:127], a[8:11]
  v_mfma_f32_16x16x32_bf16 a[28:31], v[88:91], v[152:155], a[28:31]
  v_mfma_f32_16x16x32_bf16 a[48:51], v[88:91], v[156:159], a[48:51]
  ds_read_b128 a[228:231], v220 offset:35840
  v_mfma_f32_16x16x32_bf16 a[236:239], v[88:91], v[160:163], a[236:239]
  s_waitcnt lgkmcnt(2)
  buffer_load_dwordx4 v[184:187], v218, s[8:11], s45 offen sc1
  v_mfma_f32_16x16x32_bf16 a[240:243], v[104:107], v[160:163], a[240:243]
  v_mfma_f32_16x16x32_bf16 a[52:55], v[104:107], v[156:159], a[52:55]
  v_mfma_f32_16x16x32_bf16 a[32:35], v[104:107], v[152:155], a[32:35]
  ds_read_b128 a[84:87], v221 offset:16384
  v_mfma_f32_16x16x32_bf16 a[12:15], v[104:107], a[124:127], a[12:15]
  v_mfma_f32_16x16x32_bf16 a[16:19], v[108:111], a[124:127], a[16:19]
  buffer_load_dwordx4 v[188:191], v219, s[8:11], s45 offen sc1
  v_mfma_f32_16x16x32_bf16 a[36:39], v[108:111], v[152:155], a[36:39]
  v_mfma_f32_16x16x32_bf16 a[56:59], v[108:111], v[156:159], a[56:59]
  ds_read_b128 a[88:91], v221 offset:17408
  v_mfma_f32_16x16x32_bf16 a[244:247], v[108:111], v[160:163], a[244:247]
  s_waitcnt vmcnt(13)
  v_mfma_f32_16x16x32_bf16 a[0:3], a[200:203], v[36:39], a[0:3]
  s_add_u32 s45, s40, 12288
  s_waitcnt vmcnt(12)
  v_mfma_f32_16x16x32_bf16 a[20:23], a[200:203], a[180:183], a[20:23]
  buffer_load_dwordx4 v[80:83], v216, s[8:11], s45 offen sc1
  s_waitcnt vmcnt(12)
  v_mfma_f32_16x16x32_bf16 a[40:43], a[200:203], a[184:187], a[40:43]
  ds_read_b128 v[32:35], v221 offset:18432
  s_waitcnt vmcnt(11)
  v_mfma_f32_16x16x32_bf16 a[60:63], a[200:203], a[188:191], a[60:63]
  s_waitcnt lgkmcnt(2)
  v_mfma_f32_16x16x32_bf16 a[232:235], a[204:207], a[188:191], a[232:235]
  v_mfma_f32_16x16x32_bf16 a[44:47], a[204:207], a[184:187], a[44:47]
  v_mfma_f32_16x16x32_bf16 a[24:27], a[204:207], a[180:183], a[24:27]
  buffer_load_dwordx4 v[84:87], v217, s[8:11], s45 offen sc1
  ds_read_b128 a[124:127], v221 offset:19456
  v_mfma_f32_16x16x32_bf16 a[4:7], a[204:207], v[36:39], a[4:7]
  v_mfma_f32_16x16x32_bf16 a[8:11], a[228:231], v[36:39], a[8:11]
  v_mfma_f32_16x16x32_bf16 a[28:31], a[228:231], a[180:183], a[28:31]
  v_mfma_f32_16x16x32_bf16 a[48:51], a[228:231], a[184:187], a[48:51]
  ds_read_b128 v[152:155], v220 offset:0
  v_mfma_f32_16x16x32_bf16 a[236:239], a[228:231], a[188:191], a[236:239]
  buffer_load_dwordx4 v[88:91], v218, s[8:11], s45 offen sc1
  v_mfma_f32_16x16x32_bf16 a[240:243], a[84:87], a[188:191], a[240:243]
  v_mfma_f32_16x16x32_bf16 a[52:55], a[84:87], a[184:187], a[52:55]
  v_mfma_f32_16x16x32_bf16 a[32:35], a[84:87], a[180:183], a[32:35]
  ds_read_b128 v[156:159], v220 offset:1024
  v_mfma_f32_16x16x32_bf16 a[12:15], a[84:87], v[36:39], a[12:15]
  s_waitcnt lgkmcnt(2)
  v_mfma_f32_16x16x32_bf16 a[16:19], a[88:91], v[36:39], a[16:19]
  buffer_load_dwordx4 v[104:107], v219, s[8:11], s45 offen sc1
  v_mfma_f32_16x16x32_bf16 a[36:39], a[88:91], a[180:183], a[36:39]
  v_mfma_f32_16x16x32_bf16 a[56:59], a[88:91], a[184:187], a[56:59]
  ds_read_b128 v[160:163], v220 offset:2048
  v_mfma_f32_16x16x32_bf16 a[244:247], a[88:91], a[188:191], a[244:247]
  s_waitcnt vmcnt(11)
  v_mfma_f32_16x16x32_bf16 a[0:3], v[32:35], v[112:115], a[0:3]
  s_add_u32 s45, s40, 28672
  s_waitcnt vmcnt(10)
  v_mfma_f32_16x16x32_bf16 a[20:23], v[32:35], v[116:119], a[20:23]
  buffer_load_dwordx4 v[36:39], v216, s[8:11], s45 offen sc1
  s_waitcnt vmcnt(10)
  v_mfma_f32_16x16x32_bf16 a[40:43], v[32:35], a[192:195], a[40:43]
  ds_read_b128 v[108:111], v220 offset:3072
  s_waitcnt vmcnt(9)
  v_mfma_f32_16x16x32_bf16 a[60:63], v[32:35], a[196:199], a[60:63]
  v_mfma_f32_16x16x32_bf16 a[232:235], a[124:127], a[196:199], a[232:235]
  v_mfma_f32_16x16x32_bf16 a[44:47], a[124:127], a[192:195], a[44:47]
  v_mfma_f32_16x16x32_bf16 a[24:27], a[124:127], v[116:119], a[24:27]
  buffer_load_dwordx4 a[180:183], v217, s[8:11], s45 offen sc1
  v_mfma_f32_16x16x32_bf16 a[4:7], a[124:127], v[112:115], a[4:7]
  s_waitcnt lgkmcnt(1)
  v_mfma_f32_16x16x32_bf16 a[8:11], v[152:155], v[112:115], a[8:11]
  v_mfma_f32_16x16x32_bf16 a[28:31], v[152:155], v[116:119], a[28:31]
  v_mfma_f32_16x16x32_bf16 a[48:51], v[152:155], a[192:195], a[48:51]
  v_mfma_f32_16x16x32_bf16 a[236:239], v[152:155], a[196:199], a[236:239]
  buffer_load_dwordx4 a[184:187], v218, s[8:11], s45 offen sc1
  v_mfma_f32_16x16x32_bf16 a[240:243], v[156:159], a[196:199], a[240:243]
  v_mfma_f32_16x16x32_bf16 a[52:55], v[156:159], a[192:195], a[52:55]
  v_mfma_f32_16x16x32_bf16 a[32:35], v[156:159], v[116:119], a[32:35]
  v_mfma_f32_16x16x32_bf16 a[12:15], v[156:159], v[112:115], a[12:15]
  v_mfma_f32_16x16x32_bf16 a[16:19], v[160:163], v[112:115], a[16:19]
  buffer_load_dwordx4 a[188:191], v219, s[8:11], s45 offen sc1
  v_mfma_f32_16x16x32_bf16 a[36:39], v[160:163], v[116:119], a[36:39]
  v_mfma_f32_16x16x32_bf16 a[56:59], v[160:163], a[192:195], a[56:59]
  v_mfma_f32_16x16x32_bf16 a[244:247], v[160:163], a[196:199], a[244:247]
  s_waitcnt lgkmcnt(0)
  s_waitcnt vmcnt(11)
  v_mfma_f32_16x16x32_bf16 a[0:3], v[108:111], a[92:95], a[0:3]
  s_add_u32 s45, s40, 45056
  s_waitcnt vmcnt(10)
  v_mfma_f32_16x16x32_bf16 a[20:23], v[108:111], v[180:183], a[20:23]
  buffer_load_dwordx4 a[200:203], v216, s[8:11], s45 offen sc1
  s_waitcnt vmcnt(10)
  v_mfma_f32_16x16x32_bf16 a[40:43], v[108:111], v[184:187], a[40:43]
  s_waitcnt vmcnt(9)
  v_mfma_f32_16x16x32_bf16 a[60:63], v[108:111], v[188:191], a[60:63]
  v_mfma_f32_16x16x32_bf16 a[232:235], v[148:151], v[188:191], a[232:235]
  v_mfma_f32_16x16x32_bf16 a[44:47], v[148:151], v[184:187], a[44:47]
  v_mfma_f32_16x16x32_bf16 a[24:27], v[148:151], v[180:183], a[24:27]
  buffer_load_dwordx4 a[204:207], v217, s[8:11], s45 offen sc1
  v_mfma_f32_16x16x32_bf16 a[4:7], v[148:151], a[92:95], a[4:7]
  v_mfma_f32_16x16x32_bf16 a[8:11], v[40:43], a[92:95], a[8:11]
  v_mfma_f32_16x16x32_bf16 a[28:31], v[40:43], v[180:183], a[28:31]
  v_mfma_f32_16x16x32_bf16 a[48:51], v[40:43], v[184:187], a[48:51]
  v_mfma_f32_16x16x32_bf16 a[236:239], v[40:43], v[188:191], a[236:239]
  buffer_load_dwordx4 a[228:231], v218, s[8:11], s45 offen sc1
  v_mfma_f32_16x16x32_bf16 a[240:243], v[44:47], v[188:191], a[240:243]
  v_mfma_f32_16x16x32_bf16 a[52:55], v[44:47], v[184:187], a[52:55]
  v_mfma_f32_16x16x32_bf16 a[32:35], v[44:47], v[180:183], a[32:35]
  v_mfma_f32_16x16x32_bf16 a[12:15], v[44:47], a[92:95], a[12:15]
  v_mfma_f32_16x16x32_bf16 a[16:19], v[48:51], a[92:95], a[16:19]
  buffer_load_dwordx4 a[84:87], v219, s[8:11], s45 offen sc1
  v_mfma_f32_16x16x32_bf16 a[36:39], v[48:51], v[180:183], a[36:39]
  v_mfma_f32_16x16x32_bf16 a[56:59], v[48:51], v[184:187], a[56:59]
  v_mfma_f32_16x16x32_bf16 a[244:247], v[48:51], v[188:191], a[244:247]
  s_waitcnt vmcnt(11)
  v_mfma_f32_16x16x32_bf16 a[0:3], v[52:55], v[80:83], a[0:3]
  s_add_u32 s45, s40, 61440
  s_waitcnt vmcnt(10)
  v_mfma_f32_16x16x32_bf16 a[20:23], v[52:55], v[84:87], a[20:23]
  buffer_load_dwordx4 a[88:91], v216, s[8:11], s45 offen sc1
  s_waitcnt vmcnt(10)
  v_mfma_f32_16x16x32_bf16 a[40:43], v[52:55], v[88:91], a[40:43]
  s_waitcnt vmcnt(9)
  v_mfma_f32_16x16x32_bf16 a[60:63], v[52:55], v[104:107], a[60:63]
  v_mfma_f32_16x16x32_bf16 a[232:235], v[56:59], v[104:107], a[232:235]
  v_mfma_f32_16x16x32_bf16 a[44:47], v[56:59], v[88:91], a[44:47]
  v_mfma_f32_16x16x32_bf16 a[24:27], v[56:59], v[84:87], a[24:27]
  buffer_load_dwordx4 v[112:115], v217, s[8:11], s45 offen sc1
  v_mfma_f32_16x16x32_bf16 a[4:7], v[56:59], v[80:83], a[4:7]
  v_mfma_f32_16x16x32_bf16 a[8:11], v[60:63], v[80:83], a[8:11]
  v_mfma_f32_16x16x32_bf16 a[28:31], v[60:63], v[84:87], a[28:31]
  v_mfma_f32_16x16x32_bf16 a[48:51], v[60:63], v[88:91], a[48:51]
  v_mfma_f32_16x16x32_bf16 a[236:239], v[60:63], v[104:107], a[236:239]
  buffer_load_dwordx4 v[116:119], v218, s[8:11], s45 offen sc1
  v_mfma_f32_16x16x32_bf16 a[240:243], v[68:71], v[104:107], a[240:243]
  v_mfma_f32_16x16x32_bf16 a[52:55], v[68:71], v[88:91], a[52:55]
  v_mfma_f32_16x16x32_bf16 a[32:35], v[68:71], v[84:87], a[32:35]
  v_mfma_f32_16x16x32_bf16 a[12:15], v[68:71], v[80:83], a[12:15]
  v_mfma_f32_16x16x32_bf16 a[16:19], v[72:75], v[80:83], a[16:19]
  buffer_load_dwordx4 a[192:195], v219, s[8:11], s45 offen sc1
  v_mfma_f32_16x16x32_bf16 a[36:39], v[72:75], v[84:87], a[36:39]
  v_mfma_f32_16x16x32_bf16 a[56:59], v[72:75], v[88:91], a[56:59]
  v_mfma_f32_16x16x32_bf16 a[244:247], v[72:75], v[104:107], a[244:247]
  s_waitcnt vmcnt(11)
  v_mfma_f32_16x16x32_bf16 a[0:3], v[92:95], v[36:39], a[0:3]
  s_add_u32 s45, s42, 0
  s_waitcnt vmcnt(10)
  v_mfma_f32_16x16x32_bf16 a[20:23], v[92:95], a[180:183], a[20:23]
  buffer_load_dwordx4 a[196:199], v216, s[8:11], s45 offen sc1
  s_waitcnt vmcnt(10)
  v_mfma_f32_16x16x32_bf16 a[40:43], v[92:95], a[184:187], a[40:43]
  s_waitcnt vmcnt(9)
  v_mfma_f32_16x16x32_bf16 a[60:63], v[92:95], a[188:191], a[60:63]
  v_mfma_f32_16x16x32_bf16 a[232:235], v[96:99], a[188:191], a[232:235]
  v_mfma_f32_16x16x32_bf16 a[44:47], v[96:99], a[184:187], a[44:47]
  v_mfma_f32_16x16x32_bf16 a[24:27], v[96:99], a[180:183], a[24:27]
  buffer_load_dwordx4 v[32:35], v217, s[8:11], s45 offen sc1
  v_mfma_f32_16x16x32_bf16 a[4:7], v[96:99], v[36:39], a[4:7]
  v_mfma_f32_16x16x32_bf16 a[8:11], v[100:103], v[36:39], a[8:11]
  v_mfma_f32_16x16x32_bf16 a[28:31], v[100:103], a[180:183], a[28:31]
  v_mfma_f32_16x16x32_bf16 a[48:51], v[100:103], a[184:187], a[48:51]
  v_mfma_f32_16x16x32_bf16 a[236:239], v[100:103], a[188:191], a[236:239]
  buffer_load_dwordx4 a[124:127], v218, s[8:11], s45 offen sc1
  v_mfma_f32_16x16x32_bf16 a[240:243], v[120:123], a[188:191], a[240:243]
  v_mfma_f32_16x16x32_bf16 a[52:55], v[120:123], a[184:187], a[52:55]
  v_mfma_f32_16x16x32_bf16 a[32:35], v[120:123], a[180:183], a[32:35]
  v_mfma_f32_16x16x32_bf16 a[12:15], v[120:123], v[36:39], a[12:15]
  v_mfma_f32_16x16x32_bf16 a[16:19], v[124:127], v[36:39], a[16:19]
  buffer_load_dwordx4 v[152:155], v219, s[8:11], s45 offen sc1
  v_mfma_f32_16x16x32_bf16 a[36:39], v[124:127], a[180:183], a[36:39]
  v_mfma_f32_16x16x32_bf16 a[56:59], v[124:127], a[184:187], a[56:59]
  v_mfma_f32_16x16x32_bf16 a[244:247], v[124:127], a[188:191], a[244:247]
  s_waitcnt lgkmcnt(0)
  s_barrier
  s_waitcnt vmcnt(11)
  v_mfma_f32_16x16x32_bf16 a[0:3], a[208:211], a[200:203], a[0:3]
  s_add_u32 s45, s42, 16384
  s_waitcnt vmcnt(10)
  v_mfma_f32_16x16x32_bf16 a[20:23], a[208:211], a[204:207], a[20:23]
  buffer_load_dwordx4 v[156:159], v216, s[8:11], s45 offen sc1
  s_waitcnt vmcnt(10)
  v_mfma_f32_16x16x32_bf16 a[40:43], a[208:211], a[228:231], a[40:43]
  s_waitcnt vmcnt(9)
  v_mfma_f32_16x16x32_bf16 a[60:63], a[208:211], a[84:87], a[60:63]
  v_mfma_f32_16x16x32_bf16 a[232:235], a[212:215], a[84:87], a[232:235]
  v_mfma_f32_16x16x32_bf16 a[44:47], a[212:215], a[228:231], a[44:47]
  v_mfma_f32_16x16x32_bf16 a[24:27], a[212:215], a[204:207], a[24:27]
  buffer_load_dwordx4 v[160:163], v217, s[8:11], s45 offen sc1
  v_mfma_f32_16x16x32_bf16 a[4:7], a[212:215], a[200:203], a[4:7]
  v_mfma_f32_16x16x32_bf16 a[8:11], a[216:219], a[200:203], a[8:11]
  v_mfma_f32_16x16x32_bf16 a[28:31], a[216:219], a[204:207], a[28:31]
  v_mfma_f32_16x16x32_bf16 a[48:51], a[216:219], a[228:231], a[48:51]
  v_mfma_f32_16x16x32_bf16 a[236:239], a[216:219], a[84:87], a[236:239]
  buffer_load_dwordx4 a[92:95], v218, s[8:11], s45 offen sc1
  v_mfma_f32_16x16x32_bf16 a[240:243], a[96:99], a[84:87], a[240:243]
  v_mfma_f32_16x16x32_bf16 a[52:55], a[96:99], a[228:231], a[52:55]
  v_mfma_f32_16x16x32_bf16 a[32:35], a[96:99], a[204:207], a[32:35]
  v_mfma_f32_16x16x32_bf16 a[12:15], a[96:99], a[200:203], a[12:15]
  v_mfma_f32_16x16x32_bf16 a[16:19], a[100:103], a[200:203], a[16:19]
  buffer_load_dwordx4 v[180:183], v219, s[8:11], s45 offen sc1
  v_mfma_f32_16x16x32_bf16 a[36:39], a[100:103], a[204:207], a[36:39]
  v_mfma_f32_16x16x32_bf16 a[56:59], a[100:103], a[228:231], a[56:59]
  v_mfma_f32_16x16x32_bf16 a[244:247], a[100:103], a[84:87], a[244:247]
  s_waitcnt vmcnt(10)
  v_mfma_f32_16x16x32_bf16 a[20:23], v[164:167], v[112:115], a[20:23]
  s_add_u32 s45, s42, 32768
  v_mfma_f32_16x16x32_bf16 a[24:27], v[168:171], v[112:115], a[24:27]
  buffer_load_dwordx4 v[184:187], v216, s[8:11], s45 offen sc1
  v_mfma_f32_16x16x32_bf16 a[28:31], v[172:175], v[112:115], a[28:31]
  v_mfma_f32_16x16x32_bf16 a[32:35], v[64:67], v[112:115], a[32:35]
  v_mfma_f32_16x16x32_bf16 a[36:39], v[76:79], v[112:115], a[36:39]
  s_waitcnt vmcnt(10)
  v_mfma_f32_16x16x32_bf16 a[40:43], v[164:167], v[116:119], a[40:43]
  v_mfma_f32_16x16x32_bf16 a[44:47], v[168:171], v[116:119], a[44:47]
  buffer_load_dwordx4 v[188:191], v217, s[8:11], s45 offen sc1
  v_mfma_f32_16x16x32_bf16 a[48:51], v[172:175], v[116:119], a[48:51]
  v_mfma_f32_16x16x32_bf16 a[52:55], v[64:67], v[116:119], a[52:55]
  ds_write_b128 v253, a[20:23] offset:0
  v_mfma_f32_16x16x32_bf16 a[56:59], v[76:79], v[116:119], a[56:59]
  s_waitcnt vmcnt(10)
  v_mfma_f32_16x16x32_bf16 a[60:63], v[164:167], a[192:195], a[60:63]
  ds_write_b128 v253, a[24:27] offset:1024
  v_mfma_f32_16x16x32_bf16 a[232:235], v[168:171], a[192:195], a[232:235]
  buffer_load_dwordx4 v[108:111], v218, s[8:11], s45 offen sc1
  v_mfma_f32_16x16x32_bf16 a[236:239], v[172:175], a[192:195], a[236:239]
  ds_write_b128 v253, a[28:31] offset:2048
  v_mfma_f32_16x16x32_bf16 a[240:243], v[64:67], a[192:195], a[240:243]
  v_mfma_f32_16x16x32_bf16 a[244:247], v[76:79], a[192:195], a[244:247]
  ds_write_b128 v253, a[32:35] offset:3072
  v_mfma_f32_16x16x32_bf16 a[0:3], v[164:167], a[88:91], a[0:3]
  v_mfma_f32_16x16x32_bf16 a[4:7], v[168:171], a[88:91], a[4:7]
  buffer_load_dwordx4 v[80:83], v219, s[8:11], s45 offen sc1
  ds_write_b128 v253, a[36:39] offset:4096
  v_mfma_f32_16x16x32_bf16 a[8:11], v[172:175], a[88:91], a[8:11]
  v_mfma_f32_16x16x32_bf16 a[12:15], v[64:67], a[88:91], a[12:15]
  ds_write_b128 v254, a[40:43] offset:0
  v_mfma_f32_16x16x32_bf16 a[16:19], v[76:79], a[88:91], a[16:19]
  s_waitcnt vmcnt(11)
  v_mfma_f32_16x16x32_bf16 a[64:67], a[128:131], a[196:199], 0
  s_add_u32 s45, s42, 49152
  ds_write_b128 v254, a[44:47] offset:1024
  v_mfma_f32_16x16x32_bf16 a[68:71], a[132:135], a[196:199], 0
  buffer_load_dwordx4 v[84:87], v216, s[8:11], s45 offen sc1
  v_mfma_f32_16x16x32_bf16 a[72:75], a[136:139], a[196:199], 0
  ds_write_b128 v254, a[48:51] offset:2048
  v_mfma_f32_16x16x32_bf16 a[76:79], a[140:143], a[196:199], 0
  v_mfma_f32_16x16x32_bf16 a[80:83], a[144:147], a[196:199], 0
  ds_write_b128 v254, a[52:55] offset:3072
  s_waitcnt vmcnt(11)
  v_mfma_f32_16x16x32_bf16 a[20:23], a[128:131], v[32:35], 0
  v_mfma_f32_16x16x32_bf16 a[24:27], a[132:135], v[32:35], 0
  buffer_load_dwordx4 v[88:91], v217, s[8:11], s45 offen sc1
  ds_write_b128 v254, a[56:59] offset:4096
  v_mfma_f32_16x16x32_bf16 a[28:31], a[136:139], v[32:35], 0
  v_mfma_f32_16x16x32_bf16 a[32:35], a[140:143], v[32:35], 0
  ds_write_b128 v255, a[60:63] offset:0
  v_mfma_f32_16x16x32_bf16 a[36:39], a[144:147], v[32:35], 0
  s_waitcnt vmcnt(11)
  v_mfma_f32_16x16x32_bf16 a[40:43], a[128:131], a[124:127], 0
  ds_write_b128 v255, a[232:235] offset:1024
  v_mfma_f32_16x16x32_bf16 a[44:47], a[132:135], a[124:127], 0
  buffer_load_dwordx4 v[104:107], v218, s[8:11], s45 offen sc1
  v_mfma_f32_16x16x32_bf16 a[48:51], a[136:139], a[124:127], 0
  ds_write_b128 v255, a[236:239] offset:2048
  v_mfma_f32_16x16x32_bf16 a[52:55], a[140:143], a[124:127], 0
  v_mfma_f32_16x16x32_bf16 a[56:59], a[144:147], a[124:127], 0
  ds_write_b128 v255, a[240:243] offset:3072
  s_waitcnt vmcnt(11)
  v_mfma_f32_16x16x32_bf16 a[60:63], a[128:131], v[152:155], 0
  v_mfma_f32_16x16x32_bf16 a[232:235], a[132:135], v[152:155], 0
  buffer_load_dwordx4 v[36:39], v219, s[8:11], s45 offen sc1
  ds_write_b128 v255, a[244:247] offset:4096
  v_mfma_f32_16x16x32_bf16 a[236:239], a[136:139], v[152:155], 0
  v_mfma_f32_16x16x32_bf16 a[240:243], a[140:143], v[152:155], 0
  v_mfma_f32_16x16x32_bf16 a[244:247], a[144:147], v[152:155], 0
  s_waitcnt vmcnt(11)
  v_mfma_f32_16x16x32_bf16 a[64:67], a[148:151], v[156:159], a[64:67]
  s_add_u32 s45, s42, 4096
  s_waitcnt vmcnt(10)
  v_mfma_f32_16x16x32_bf16 a[20:23], a[148:151], v[160:163], a[20:23]
  buffer_load_dwordx4 a[180:183], v216, s[8:11], s45 offen sc1
  s_waitcnt vmcnt(10)
  v_mfma_f32_16x16x32_bf16 a[40:43], a[148:151], a[92:95], a[40:43]
  s_waitcnt vmcnt(9)
  v_mfma_f32_16x16x32_bf16 a[60:63], a[148:151], v[180:183], a[60:63]
  v_mfma_f32_16x16x32_bf16 a[232:235], a[152:155], v[180:183], a[232:235]
  s_waitcnt lgkmcnt(0)
  s_barrier
  buffer_load_dwordx4 a[184:187], v217, s[8:11], s45 offen sc1
  v_mfma_f32_16x16x32_bf16 a[44:47], a[152:155], a[92:95], a[44:47]
  v_mfma_f32_16x16x32_bf16 a[24:27], a[152:155], v[160:163], a[24:27]
  v_mfma_f32_16x16x32_bf16 a[68:71], a[152:155], v[156:159], a[68:71]
  buffer_load_dwordx4 a[188:191], v218, s[8:11], s45 offen sc1
  v_mfma_f32_16x16x32_bf16 a[72:75], a[156:159], v[156:159], a[72:75]
  ds_read_b128 v[112:115], v252 offset:0
  ds_read_b128 v[116:119], v252 offset:5120
  v_mfma_f32_16x16x32_bf16 a[28:31], a[156:159], v[160:163], a[28:31]
  ds_read_b128 v[32:35], v252 offset:10240
  ds_read_b128 v[192:195], v252 offset:1024
  v_mfma_f32_16x16x32_bf16 a[48:51], a[156:159], a[92:95], a[48:51]
  ds_read_b128 v[196:199], v252 offset:6144
  ds_read_b128 v[200:203], v252 offset:11264
  v_mfma_f32_16x16x32_bf16 a[236:239], a[156:159], v[180:183], a[236:239]
  buffer_load_dwordx4 a[200:203], v219, s[8:11], s45 offen sc1
  v_mfma_f32_16x16x32_bf16 a[240:243], v[0:3], v[180:183], a[240:243]
  v_accvgpr_read_b32 v208, a0
  v_accvgpr_read_b32 v209, a1
  v_mfma_f32_16x16x32_bf16 a[52:55], v[0:3], a[92:95], a[52:55]
  s_add_u32 s55, s41, 143360
  v_accvgpr_read_b32 v210, a2
  v_accvgpr_read_b32 v211, a3
  v_mfma_f32_16x16x32_bf16 a[32:35], v[0:3], v[160:163], a[32:35]
  buffer_load_dwordx4 a[204:207], v223, s[12:15], s55 offen offset:0 sc1
  v_mfma_f32_16x16x32_bf16 a[76:79], v[0:3], v[156:159], a[76:79]
  s_waitcnt lgkmcnt(4)
  v_add_f32 v112, v112, v116
  v_add_f32 v113, v113, v117
  v_mfma_f32_16x16x32_bf16 a[80:83], v[4:7], v[156:159], a[80:83]
  v_add_f32 v114, v114, v118
  v_add_f32 v115, v115, v119
  v_mfma_f32_16x16x32_bf16 a[36:39], v[4:7], v[160:163], a[36:39]
  buffer_load_dwordx4 a[228:231], v223, s[12:15], s55 offen offset:1024 sc1
K1_st18:
  s_cbranch_execz K1_st1
  v_mfma_f32_16x16x32_bf16 a[56:59], v[4:7], a[92:95], a[56:59]
  s_waitcnt lgkmcnt(3)
  v_add_f32 v208, v208, v32
  v_add_f32 v209, v209, v33
  v_mfma_f32_16x16x32_bf16 a[244:247], v[4:7], v[180:183], a[244:247]
  v_add_f32 v210, v210, v34
  v_add_f32 v211, v211, v35
  s_waitcnt vmcnt(13)
  v_mfma_f32_16x16x32_bf16 a[64:67], v[8:11], v[184:187], a[64:67]
  s_add_u32 s45, s42, 20480
  v_add_f32 v208, v208, v112
  v_add_f32 v209, v209, v113
  s_waitcnt vmcnt(12)
  v_mfma_f32_16x16x32_bf16 a[20:23], v[8:11], v[188:191], a[20:23]
  buffer_load_dwordx4 a[84:87], v216, s[8:11], s45 offen sc1
  s_waitcnt vmcnt(12)
  v_mfma_f32_16x16x32_bf16 a[40:43], v[8:11], v[108:111], a[40:43]
  v_add_f32 v210, v210, v114
  v_add_f32 v211, v211, v115
  s_waitcnt vmcnt(11)
  v_mfma_f32_16x16x32_bf16 a[60:63], v[8:11], v[80:83], a[60:63]
  buffer_store_dwordx4 v[208:211], v223, s[80:83], s64 offen offset:0 sc1
  v_mfma_f32_16x16x32_bf16 a[232:235], v[12:15], v[80:83], a[232:235]
  ds_read_b128 v[112:115], v252 offset:2048
  ds_read_b128 v[116:119], v252 offset:7168
  v_mfma_f32_16x16x32_bf16 a[44:47], v[12:15], v[108:111], a[44:47]
  buffer_load_dwordx4 a[88:91], v217, s[8:11], s45 offen sc1
  v_mfma_f32_16x16x32_bf16 a[24:27], v[12:15], v[188:191], a[24:27]
  ds_read_b128 v[32:35], v252 offset:12288
  v_mfma_f32_16x16x32_bf16 a[68:71], v[12:15], v[184:187], a[68:71]
  v_accvgpr_read_b32 v212, a4
  v_accvgpr_read_b32 v213, a5
  v_mfma_f32_16x16x32_bf16 a[72:75], v[16:19], v[184:187], a[72:75]
  v_accvgpr_read_b32 v214, a6
  v_accvgpr_read_b32 v215, a7
  v_mfma_f32_16x16x32_bf16 a[28:31], v[16:19], v[188:191], a[28:31]
  buffer_load_dwordx4 a[192:195], v218, s[8:11], s45 offen sc1
  v_mfma_f32_16x16x32_bf16 a[48:51], v[16:19], v[108:111], a[48:51]
  s_waitcnt lgkmcnt(4)
  v_add_f32 v192, v192, v196
  v_add_f32 v193, v193, v197
  v_mfma_f32_16x16x32_bf16 a[236:239], v[16:19], v[80:83], a[236:239]
  v_add_f32 v194, v194, v198
  v_add_f32 v195, v195, v199
  v_mfma_f32_16x16x32_bf16 a[240:243], v[20:23], v[80:83], a[240:243]
  s_waitcnt lgkmcnt(3)
  v_add_f32 v212, v212, v200
  v_add_f32 v213, v213, v201
  v_mfma_f32_16x16x32_bf16 a[52:55], v[20:23], v[108:111], a[52:55]
  buffer_load_dwordx4 a[196:199], v219, s[8:11], s45 offen sc1
  v_mfma_f32_16x16x32_bf16 a[32:35], v[20:23], v[188:191], a[32:35]
  v_add_f32 v214, v214, v202
  v_add_f32 v215, v215, v203
  v_mfma_f32_16x16x32_bf16 a[76:79], v[20:23], v[184:187], a[76:79]
  v_add_f32 v212, v212, v192
  v_add_f32 v213, v213, v193
  v_mfma_f32_16x16x32_bf16 a[80:83], v[24:27], v[184:187], a[80:83]
  s_add_u32 s55, s41, 143360
  v_add_f32 v214, v214, v194
  v_add_f32 v215, v215, v195
  v_mfma_f32_16x16x32_bf16 a[36:39], v[24:27], v[188:191], a[36:39]
  buffer_load_dwordx4 a[124:127], v223, s[12:15], s55 offen offset:2048 sc1
  v_mfma_f32_16x16x32_bf16 a[56:59], v[24:27], v[108:111], a[56:59]
  buffer_store_dwordx4 v[212:215], v223, s[80:83], s64 offen offset:1024 sc1
  v_mfma_f32_16x16x32_bf16 a[244:247], v[24:27], v[80:83], a[244:247]
  ds_read_b128 v[192:195], v252 offset:3072
  ds_read_b128 v[196:199], v252 offset:8192
  s_waitcnt vmcnt(16)
  v_mfma_f32_16x16x32_bf16 a[64:67], v[28:31], v[84:87], a[64:67]
  s_add_u32 s45, s42, 36864
  ds_read_b128 v[200:203], v252 offset:13312
  s_waitcnt vmcnt(15)
  v_mfma_f32_16x16x32_bf16 a[20:23], v[28:31], v[88:91], a[20:23]
  buffer_load_dwordx4 v[152:155], v216, s[8:11], s45 offen sc1
  s_waitcnt vmcnt(15)
  v_mfma_f32_16x16x32_bf16 a[40:43], v[28:31], v[104:107], a[40:43]
  v_accvgpr_read_b32 v208, a8
  v_accvgpr_read_b32 v209, a9
  s_waitcnt vmcnt(14)
  v_mfma_f32_16x16x32_bf16 a[60:63], v[28:31], v[36:39], a[60:63]
  v_accvgpr_read_b32 v210, a10
  v_accvgpr_read_b32 v211, a11
  v_mfma_f32_16x16x32_bf16 a[232:235], a[248:251], v[36:39], a[232:235]
  buffer_load_dwordx4 a[128:131], v217, s[8:11], s45 offen sc1
  v_mfma_f32_16x16x32_bf16 a[44:47], a[248:251], v[104:107], a[44:47]
  s_waitcnt lgkmcnt(4)
  v_add_f32 v112, v112, v116
  v_add_f32 v113, v113, v117
  v_mfma_f32_16x16x32_bf16 a[24:27], a[248:251], v[88:91], a[24:27]
  v_add_f32 v114, v114, v118
  v_add_f32 v115, v115, v119
  v_mfma_f32_16x16x32_bf16 a[68:71], a[248:251], v[84:87], a[68:71]
  buffer_load_dwordx4 a[132:135], v218, s[8:11], s45 offen sc1
  v_mfma_f32_16x16x32_bf16 a[72:75], a[252:255], v[84:87], a[72:75]
  s_waitcnt lgkmcnt(3)
  v_add_f32 v208, v208, v32
  v_add_f32 v209, v209, v33
  v_mfma_f32_16x16x32_bf16 a[28:31], a[252:255], v[88:91], a[28:31]
  v_add_f32 v210, v210, v34
  v_add_f32 v211, v211, v35
  v_mfma_f32_16x16x32_bf16 a[48:51], a[252:255], v[104:107], a[48:51]
  v_add_f32 v208, v208, v112
  v_add_f32 v209, v209, v113
  v_mfma_f32_16x16x32_bf16 a[236:239], a[252:255], v[36:39], a[236:239]
  buffer_load_dwordx4 a[136:139], v219, s[8:11], s45 offen sc1
  v_mfma_f32_16x16x32_bf16 a[240:243], a[160:163], v[36:39], a[240:243]
  v_add_f32 v210, v210, v114
  v_add_f32 v211, v211, v115
  v_mfma_f32_16x16x32_bf16 a[52:55], a[160:163], v[104:107], a[52:55]
  s_add_u32 s55, s41, 143360
  buffer_store_dwordx4 v[208:211], v223, s[80:83], s64 offen offset:2048 sc1
  v_mfma_f32_16x16x32_bf16 a[32:35], a[160:163], v[88:91], a[32:35]
  buffer_load_dwordx4 a[140:143], v223, s[12:15], s55 offen offset:3072 sc1
  v_mfma_f32_16x16x32_bf16 a[76:79], a[160:163], v[84:87], a[76:79]
  ds_read_b128 v[112:115], v252 offset:4096
  ds_read_b128 v[116:119], v252 offset:9216
  v_mfma_f32_16x16x32_bf16 a[80:83], a[164:167], v[84:87], a[80:83]
  s_add_u32 s55, s41, 147456
  ds_read_b128 v[32:35], v252 offset:14336
  v_mfma_f32_16x16x32_bf16 a[36:39], a[164:167], v[88:91], a[36:39]
  buffer_load_dwordx4 a[144:147], v223, s[12:15], s55 offen offset:0 sc1
  v_mfma_f32_16x16x32_bf16 a[56:59], a[164:167], v[104:107], a[56:59]
  v_accvgpr_read_b32 v212, a12
  v_accvgpr_read_b32 v213, a13
  v_mfma_f32_16x16x32_bf16 a[244:247], a[164:167], v[36:39], a[244:247]
  v_accvgpr_read_b32 v214, a14
  v_accvgpr_read_b32 v215, a15
  s_waitcnt vmcnt(19)
  v_mfma_f32_16x16x32_bf16 a[64:67], a[168:171], a[180:183], a[64:67]
  s_add_u32 s45, s42, 53248
  s_waitcnt lgkmcnt(4)
  v_add_f32 v192, v192, v196
  v_add_f32 v193, v193, v197
  s_waitcnt vmcnt(18)
  v_mfma_f32_16x16x32_bf16 a[20:23], a[168:171], a[184:187], a[20:23]
  buffer_load_dwordx4 v[156:159], v216, s[8:11], s45 offen sc1
  s_waitcnt vmcnt(18)
  v_mfma_f32_16x16x32_bf16 a[40:43], a[168:171], a[188:191], a[40:43]
  v_add_f32 v194, v194, v198
  v_add_f32 v195, v195, v199
  s_waitcnt vmcnt(17)
  v_mfma_f32_16x16x32_bf16 a[60:63], a[168:171], a[200:203], a[60:63]
  s_waitcnt lgkmcnt(3)
  v_add_f32 v212, v212, v200
  v_add_f32 v213, v213, v201
  v_mfma_f32_16x16x32_bf16 a[232:235], a[172:175], a[200:203], a[232:235]
  v_add_f32 v214, v214, v202
  v_add_f32 v215, v215, v203
  v_mfma_f32_16x16x32_bf16 a[44:47], a[172:175], a[188:191], a[44:47]
  buffer_load_dwordx4 v[160:163], v217, s[8:11], s45 offen sc1
  v_mfma_f32_16x16x32_bf16 a[24:27], a[172:175], a[184:187], a[24:27]
  v_add_f32 v212, v212, v192
  v_add_f32 v213, v213, v193
  v_mfma_f32_16x16x32_bf16 a[68:71], a[172:175], a[180:183], a[68:71]
  v_add_f32 v214, v214, v194
  v_add_f32 v215, v215, v195
  v_mfma_f32_16x16x32_bf16 a[72:75], a[176:179], a[180:183], a[72:75]
  buffer_store_dwordx4 v[212:215], v223, s[80:83], s64 offen offset:3072 sc1
  v_mfma_f32_16x16x32_bf16 a[28:31], a[176:179], a[184:187], a[28:31]
  buffer_load_dwordx4 a[92:95], v218, s[8:11], s45 offen sc1
  v_mfma_f32_16x16x32_bf16 a[48:51], a[176:179], a[188:191], a[48:51]
  v_accvgpr_read_b32 v208, a16
  v_accvgpr_read_b32 v209, a17
  v_mfma_f32_16x16x32_bf16 a[236:239], a[176:179], a[200:203], a[236:239]
  v_accvgpr_read_b32 v210, a18
  v_accvgpr_read_b32 v211, a19
  v_mfma_f32_16x16x32_bf16 a[240:243], v[128:131], a[200:203], a[240:243]
  s_waitcnt lgkmcnt(1)
  v_add_f32 v112, v112, v116
  v_add_f32 v113, v113, v117
  v_mfma_f32_16x16x32_bf16 a[52:55], v[128:131], a[188:191], a[52:55]
  buffer_load_dwordx4 v[180:183], v219, s[8:11], s45 offen sc1
  v_mfma_f32_16x16x32_bf16 a[32:35], v[128:131], a[184:187], a[32:35]
  v_add_f32 v114, v114, v118
  v_add_f32 v115, v115, v119
  v_mfma_f32_16x16x32_bf16 a[76:79], v[128:131], a[180:183], a[76:79]
  s_waitcnt lgkmcnt(0)
  v_add_f32 v208, v208, v32
  v_add_f32 v209, v209, v33
  v_mfma_f32_16x16x32_bf16 a[80:83], v[132:135], a[180:183], a[80:83]
  s_add_u32 s55, s41, 147456
  v_add_f32 v210, v210, v34
  v_add_f32 v211, v211, v35
  v_mfma_f32_16x16x32_bf16 a[36:39], v[132:135], a[184:187], a[36:39]
  buffer_load_dwordx4 a[148:151], v223, s[12:15], s55 offen offset:1024 sc1
  v_mfma_f32_16x16x32_bf16 a[56:59], v[132:135], a[188:191], a[56:59]
  v_add_f32 v208, v208, v112
  v_add_f32 v209, v209, v113
  v_mfma_f32_16x16x32_bf16 a[244:247], v[132:135], a[200:203], a[244:247]
  v_add_f32 v210, v210, v114
  v_add_f32 v211, v211, v115
  s_waitcnt vmcnt(19)
  v_mfma_f32_16x16x32_bf16 a[64:67], v[136:139], a[84:87], a[64:67]
  s_add_u32 s45, s42, 8192
  buffer_store_dwordx4 v[208:211], v224, s[80:83], s64 offen offset:0 sc1
  s_waitcnt vmcnt(18)
  v_mfma_f32_16x16x32_bf16 a[20:23], v[136:139], a[88:91], a[20:23]
  buffer_load_dwordx4 a[152:155], v216, s[8:11], s45 offen sc1
  s_waitcnt vmcnt(18)
  v_mfma_f32_16x16x32_bf16 a[40:43], v[136:139], a[192:195], a[40:43]
  s_waitcnt vmcnt(17)
  v_mfma_f32_16x16x32_bf16 a[60:63], v[136:139], a[196:199], a[60:63]
  v_mfma_f32_16x16x32_bf16 a[232:235], v[140:143], a[196:199], a[232:235]
  buffer_load_dwordx4 a[156:159], v217, s[8:11], s45 offen sc1
  v_mfma_f32_16x16x32_bf16 a[44:47], v[140:143], a[192:195], a[44:47]
  v_mfma_f32_16x16x32_bf16 a[24:27], v[140:143], a[88:91], a[24:27]
  v_mfma_f32_16x16x32_bf16 a[68:71], v[140:143], a[84:87], a[68:71]
  buffer_load_dwordx4 v[0:3], v218, s[8:11], s45 offen sc1
  v_mfma_f32_16x16x32_bf16 a[72:75], v[144:147], a[84:87], a[72:75]
  v_mfma_f32_16x16x32_bf16 a[28:31], v[144:147], a[88:91], a[28:31]
  v_mfma_f32_16x16x32_bf16 a[48:51], v[144:147], a[192:195], a[48:51]
  v_mfma_f32_16x16x32_bf16 a[236:239], v[144:147], a[196:199], a[236:239]
  buffer_load_dwordx4 v[4:7], v219, s[8:11], s45 offen sc1
  v_mfma_f32_16x16x32_bf16 a[240:243], a[220:223], a[196:199], a[240:243]
  v_mfma_f32_16x16x32_bf16 a[52:55], a[220:223], a[192:195], a[52:55]
  s_add_u32 s55, s41, 147456
  v_mfma_f32_16x16x32_bf16 a[32:35], a[220:223], a[88:91], a[32:35]
  buffer_load_dwordx4 v[184:187], v223, s[12:15], s55 offen offset:2048 sc1
  v_mfma_f32_16x16x32_bf16 a[76:79], a[220:223], a[84:87], a[76:79]
  v_mfma_f32_16x16x32_bf16 a[80:83], a[224:227], a[84:87], a[80:83]
  v_mfma_f32_16x16x32_bf16 a[36:39], a[224:227], a[88:91], a[36:39]
  buffer_load_dwordx4 v[188:191], v223, s[12:15], s55 offen offset:3072 sc1
  v_mfma_f32_16x16x32_bf16 a[56:59], a[224:227], a[192:195], a[56:59]
  v_mfma_f32_16x16x32_bf16 a[244:247], a[224:227], a[196:199], a[244:247]
  s_waitcnt vmcnt(6)
  v_mov_b32 v197, 1
  s_mov_b64 exec, 1
  buffer_store_dword v197, v223, s[20:23], s60 offen sc1
  s_mov_b64 exec, -1
  v_mfma_f32_16x16x32_bf16 a[64:67], a[104:107], v[152:155], a[64:67]
  s_add_u32 s45, s42, 24576
  v_mov_b32 v206, 0
  v_and_b32 v202, 15, v222
  v_mfma_f32_16x16x32_bf16 a[20:23], a[104:107], a[128:131], a[20:23]
  buffer_load_dwordx4 v[16:19], v216, s[8:11], s45 offen sc1
  v_mfma_f32_16x16x32_bf16 a[40:43], a[104:107], a[132:135], a[40:43]
  ds_read_b128 v[108:111], v220 offset:16384
  v_mul_u32_u24 v202, 160, v202
  v_lshrrev_b32 v203, 4, v222
  v_mfma_f32_16x16x32_bf16 a[60:63], a[104:107], a[136:139], a[60:63]
  v_mul_u32_u24 v203, 40, v203
  v_add3_u32 v202, v202, v203, s85
  v_mfma_f32_16x16x32_bf16 a[232:235], a[108:111], a[136:139], a[232:235]
  v_add_u32 v207, s85, v223
  v_mfma_f32_16x16x32_bf16 a[44:47], a[108:111], a[132:135], a[44:47]
  buffer_load_dwordx4 v[20:23], v217, s[8:11], s45 offen sc1
  v_mfma_f32_16x16x32_bf16 a[24:27], a[108:111], a[128:131], a[24:27]
  ds_read_b128 v[80:83], v220 offset:17408
  ds_read_b64 v[192:193], v202 offset:0
  ds_read_b64 v[194:195], v202 offset:8
  v_mfma_f32_16x16x32_bf16 a[68:71], a[108:111], v[152:155], a[68:71]
  ds_read_b64 v[196:197], v202 offset:16
  ds_read_b64 v[198:199], v202 offset:24
  v_mfma_f32_16x16x32_bf16 a[72:75], a[112:115], v[152:155], a[72:75]
  ds_read_b64 v[200:201], v202 offset:32
  v_mfma_f32_16x16x32_bf16 a[28:31], a[112:115], a[128:131], a[28:31]
  buffer_load_dwordx4 v[24:27], v218, s[8:11], s45 offen sc1
  v_mfma_f32_16x16x32_bf16 a[48:51], a[112:115], a[132:135], a[48:51]
  ds_read_b128 v[8:11], v220 offset:18432
  v_mfma_f32_16x16x32_bf16 a[236:239], a[112:115], a[136:139], a[236:239]
  v_mfma_f32_16x16x32_bf16 a[240:243], a[116:119], a[136:139], a[240:243]
  v_mfma_f32_16x16x32_bf16 a[52:55], a[116:119], a[132:135], a[52:55]
  buffer_load_dwordx4 v[84:87], v219, s[8:11], s45 offen sc1
  v_mfma_f32_16x16x32_bf16 a[32:35], a[116:119], a[128:131], a[32:35]
  ds_read_b128 v[12:15], v220 offset:19456
  v_mfma_f32_16x16x32_bf16 a[76:79], a[116:119], v[152:155], a[76:79]
  v_mfma_f32_16x16x32_bf16 a[80:83], a[120:123], v[152:155], a[80:83]
  s_add_u32 s55, s41, 151552
  v_mfma_f32_16x16x32_bf16 a[36:39], a[120:123], a[128:131], a[36:39]
  buffer_load_dwordx4 v[88:91], v223, s[12:15], s55 offen offset:0 sc1
  v_mfma_f32_16x16x32_bf16 a[56:59], a[120:123], a[132:135], a[56:59]
  v_mfma_f32_16x16x32_bf16 a[244:247], a[120:123], a[136:139], a[244:247]
  v_mfma_f32_16x16x32_bf16 a[64:67], v[176:179], v[156:159], a[64:67]
  s_add_u32 s45, s42, 40960
  v_mfma_f32_16x16x32_bf16 a[20:23], v[176:179], v[160:163], a[20:23]
  buffer_load_dwordx4 a[160:163], v216, s[8:11], s45 offen sc1
  v_mfma_f32_16x16x32_bf16 a[40:43], v[176:179], a[92:95], a[40:43]
  ds_read_b128 v[104:107], v221 offset:0
  v_mfma_f32_16x16x32_bf16 a[60:63], v[176:179], v[180:183], a[60:63]
  s_waitcnt lgkmcnt(1)
  v_mfma_f32_16x16x32_bf16 a[232:235], v[108:111], v[180:183], a[232:235]
  buffer_load_dwordx4 a[164:167], v217, s[8:11], s45 offen sc1
  v_mfma_f32_16x16x32_bf16 a[44:47], v[108:111], a[92:95], a[44:47]
  v_mfma_f32_16x16x32_bf16 a[24:27], v[108:111], v[160:163], a[24:27]
  ds_read_b128 v[36:39], v221 offset:1024
  v_mfma_f32_16x16x32_bf16 a[68:71], v[108:111], v[156:159], a[68:71]
  buffer_load_dwordx4 a[180:183], v218, s[8:11], s45 offen sc1
  v_mfma_f32_16x16x32_bf16 a[72:75], v[80:83], v[156:159], a[72:75]
  v_mfma_f32_16x16x32_bf16 a[28:31], v[80:83], v[160:163], a[28:31]
  v_mfma_f32_16x16x32_bf16 a[48:51], v[80:83], a[92:95], a[48:51]
  ds_read_b128 v[28:31], v221 offset:2048
  v_mfma_f32_16x16x32_bf16 a[236:239], v[80:83], v[180:183], a[236:239]
  buffer_load_dwordx4 a[184:187], v219, s[8:11], s45 offen sc1
  v_mfma_f32_16x16x32_bf16 a[240:243], v[8:11], v[180:183], a[240:243]
  v_mfma_f32_16x16x32_bf16 a[52:55], v[8:11], a[92:95], a[52:55]
  s_add_u32 s55, s41, 151552
  v_mfma_f32_16x16x32_bf16 a[32:35], v[8:11], v[160:163], a[32:35]
  buffer_load_dwordx4 a[188:191], v223, s[12:15], s55 offen offset:1024 sc1
  ds_read_b128 a[248:251], v221 offset:3072
  v_mfma_f32_16x16x32_bf16 a[76:79], v[8:11], v[156:159], a[76:79]
  v_mfma_f32_16x16x32_bf16 a[80:83], v[12:15], v[156:159], a[80:83]
  v_mfma_f32_16x16x32_bf16 a[36:39], v[12:15], v[160:163], a[36:39]
  buffer_load_dwordx4 a[200:203], v223, s[12:15], s55 offen offset:2048 sc1
  v_mfma_f32_16x16x32_bf16 a[56:59], v[12:15], a[92:95], a[56:59]
  ds_read_b128 a[252:255], v220 offset:32768
  v_mfma_f32_16x16x32_bf16 a[244:247], v[12:15], v[180:183], a[244:247]
  s_waitcnt lgkmcnt(2)
  s_waitcnt vmcnt(17)
  v_mfma_f32_16x16x32_bf16 a[64:67], v[104:107], a[152:155], a[64:67]
  s_add_u32 s45, s42, 57344
  s_waitcnt vmcnt(16)
  v_mfma_f32_16x16x32_bf16 a[20:23], v[104:107], a[156:159], a[20:23]
  buffer_load_dwordx4 a[84:87], v216, s[8:11], s45 offen sc1
  s_waitcnt vmcnt(16)
  v_mfma_f32_16x16x32_bf16 a[40:43], v[104:107], v[0:3], a[40:43]
  ds_read_b128 a[168:171], v220 offset:33792
  s_waitcnt vmcnt(15)
  v_mfma_f32_16x16x32_bf16 a[60:63], v[104:107], v[4:7], a[60:63]
  v_mfma_f32_16x16x32_bf16 a[232:235], v[36:39], v[4:7], a[232:235]
  v_mfma_f32_16x16x32_bf16 a[44:47], v[36:39], v[0:3], a[44:47]
  buffer_load_dwordx4 a[88:91], v217, s[8:11], s45 offen sc1
  v_mfma_f32_16x16x32_bf16 a[24:27], v[36:39], a[156:159], a[24:27]
  ds_read_b128 a[172:175], v220 offset:34816
  v_mfma_f32_16x16x32_bf16 a[68:71], v[36:39], a[152:155], a[68:71]
  v_mfma_f32_16x16x32_bf16 a[72:75], v[28:31], a[152:155], a[72:75]
  v_mfma_f32_16x16x32_bf16 a[28:31], v[28:31], a[156:159], a[28:31]
  buffer_load_dwordx4 a[192:195], v218, s[8:11], s45 offen sc1
  v_mfma_f32_16x16x32_bf16 a[48:51], v[28:31], v[0:3], a[48:51]
  ds_read_b128 a[176:179], v220 offset:35840
  v_mfma_f32_16x16x32_bf16 a[236:239], v[28:31], v[4:7], a[236:239]
  s_waitcnt lgkmcnt(2)
  v_mfma_f32_16x16x32_bf16 a[240:243], a[248:251], v[4:7], a[240:243]
  v_mfma_f32_16x16x32_bf16 a[52:55], a[248:251], v[0:3], a[52:55]
  buffer_load_dwordx4 a[196:199], v219, s[8:11], s45 offen sc1
  v_mfma_f32_16x16x32_bf16 a[32:35], a[248:251], a[156:159], a[32:35]
  ds_read_b128 v[128:131], v221 offset:16384
  v_mfma_f32_16x16x32_bf16 a[76:79], a[248:251], a[152:155], a[76:79]
  v_mfma_f32_16x16x32_bf16 a[80:83], a[252:255], a[152:155], a[80:83]
  s_add_u32 s55, s41, 151552
  v_mfma_f32_16x16x32_bf16 a[36:39], a[252:255], a[156:159], a[36:39]
  buffer_load_dwordx4 v[136:139], v223, s[12:15], s55 offen offset:3072 sc1
  v_mfma_f32_16x16x32_bf16 a[56:59], a[252:255], v[0:3], a[56:59]
  ds_read_b128 v[132:135], v221 offset:17408
  v_mfma_f32_16x16x32_bf16 a[244:247], a[252:255], v[4:7], a[244:247]
  s_waitcnt vmcnt(15)
  v_mfma_f32_16x16x32_bf16 a[64:67], a[168:171], v[16:19], a[64:67]
  s_add_u32 s45, s42, 12288
  s_waitcnt vmcnt(14)
  v_mfma_f32_16x16x32_bf16 a[20:23], a[168:171], v[20:23], a[20:23]
  buffer_load_dwordx4 v[116:119], v216, s[8:11], s45 offen sc1
  s_waitcnt vmcnt(14)
  v_mfma_f32_16x16x32_bf16 a[40:43], a[168:171], v[24:27], a[40:43]
  ds_read_b128 v[140:143], v221 offset:18432
  s_waitcnt vmcnt(13)
  v_mfma_f32_16x16x32_bf16 a[60:63], a[168:171], v[84:87], a[60:63]
  s_waitcnt lgkmcnt(2)
  v_mfma_f32_16x16x32_bf16 a[232:235], a[172:175], v[84:87], a[232:235]
  buffer_load_dwordx4 v[32:35], v217, s[8:11], s45 offen sc1
  v_mfma_f32_16x16x32_bf16 a[44:47], a[172:175], v[24:27], a[44:47]
  v_mfma_f32_16x16x32_bf16 a[24:27], a[172:175], v[20:23], a[24:27]
  ds_read_b128 v[144:147], v221 offset:19456
  v_mfma_f32_16x16x32_bf16 a[68:71], a[172:175], v[16:19], a[68:71]
  buffer_load_dwordx4 v[152:155], v218, s[8:11], s45 offen sc1
  v_mfma_f32_16x16x32_bf16 a[72:75], a[176:179], v[16:19], a[72:75]
  v_mfma_f32_16x16x32_bf16 a[28:31], a[176:179], v[20:23], a[28:31]
  v_mfma_f32_16x16x32_bf16 a[48:51], a[176:179], v[24:27], a[48:51]
  ds_read_b128 a[220:223], v220 offset:0
  v_mfma_f32_16x16x32_bf16 a[236:239], a[176:179], v[84:87], a[236:239]
  buffer_load_dwordx4 a[128:131], v219, s[8:11], s45 offen sc1
  v_mfma_f32_16x16x32_bf16 a[240:243], v[128:131], v[84:87], a[240:243]
  v_mfma_f32_16x16x32_bf16 a[52:55], v[128:131], v[24:27], a[52:55]
  s_add_u32 s55, s41, 155648
  v_mfma_f32_16x16x32_bf16 a[32:35], v[128:131], v[20:23], a[32:35]
  buffer_load_dwordx4 a[132:135], v223, s[12:15], s55 offen offset:0 sc1
  ds_read_b128 a[224:227], v220 offset:1024
  v_mfma_f32_16x16x32_bf16 a[76:79], v[128:131], v[16:19], a[76:79]
  s_waitcnt lgkmcnt(2)
  v_mfma_f32_16x16x32_bf16 a[80:83], v[132:135], v[16:19], a[80:83]
  v_mfma_f32_16x16x32_bf16 a[36:39], v[132:135], v[20:23], a[36:39]
  buffer_load_dwordx4 a[136:139], v223, s[12:15], s55 offen offset:1024 sc1
  v_mfma_f32_16x16x32_bf16 a[56:59], v[132:135], v[24:27], a[56:59]
  ds_read_b128 v[112:115], v220 offset:2048
  v_mfma_f32_16x16x32_bf16 a[244:247], v[132:135], v[84:87], a[244:247]
  s_waitcnt vmcnt(16)
  v_mfma_f32_16x16x32_bf16 a[64:67], v[140:143], a[160:163], a[64:67]
  s_add_u32 s45, s42, 28672
  s_waitcnt vmcnt(15)
  v_mfma_f32_16x16x32_bf16 a[20:23], v[140:143], a[164:167], a[20:23]
  buffer_load_dwordx4 a[108:111], v216, s[8:11], s45 offen sc1
  s_waitcnt vmcnt(15)
  v_mfma_f32_16x16x32_bf16 a[40:43], v[140:143], a[180:183], a[40:43]
  ds_read_b128 a[104:107], v220 offset:3072
  s_waitcnt vmcnt(14)
  v_mfma_f32_16x16x32_bf16 a[60:63], v[140:143], a[184:187], a[60:63]
  v_mfma_f32_16x16x32_bf16 a[232:235], v[144:147], a[184:187], a[232:235]
  v_mfma_f32_16x16x32_bf16 a[44:47], v[144:147], a[180:183], a[44:47]
  buffer_load_dwordx4 a[112:115], v217, s[8:11], s45 offen sc1
  v_mfma_f32_16x16x32_bf16 a[24:27], v[144:147], a[164:167], a[24:27]
  v_mfma_f32_16x16x32_bf16 a[68:71], v[144:147], a[160:163], a[68:71]
  s_waitcnt lgkmcnt(1)
  v_mfma_f32_16x16x32_bf16 a[72:75], a[220:223], a[160:163], a[72:75]
  v_mfma_f32_16x16x32_bf16 a[28:31], a[220:223], a[164:167], a[28:31]
  buffer_load_dwordx4 a[116:119], v218, s[8:11], s45 offen sc1
  v_mfma_f32_16x16x32_bf16 a[48:51], a[220:223], a[180:183], a[48:51]
  v_mfma_f32_16x16x32_bf16 a[236:239], a[220:223], a[184:187], a[236:239]
  v_mfma_f32_16x16x32_bf16 a[240:243], a[224:227], a[184:187], a[240:243]
  v_mfma_f32_16x16x32_bf16 a[52:55], a[224:227], a[180:183], a[52:55]
  buffer_load_dwordx4 a[120:123], v219, s[8:11], s45 offen sc1
  v_mfma_f32_16x16x32_bf16 a[32:35], a[224:227], a[164:167], a[32:35]
  v_mfma_f32_16x16x32_bf16 a[76:79], a[224:227], a[160:163], a[76:79]
  v_mfma_f32_16x16x32_bf16 a[80:83], v[112:115], a[160:163], a[80:83]
  s_add_u32 s55, s41, 155648
  v_mfma_f32_16x16x32_bf16 a[36:39], v[112:115], a[164:167], a[36:39]
  buffer_load_dwordx4 v[156:159], v223, s[12:15], s55 offen offset:2048 sc1
  v_mfma_f32_16x16x32_bf16 a[56:59], v[112:115], a[180:183], a[56:59]
  v_mfma_f32_16x16x32_bf16 a[244:247], v[112:115], a[184:187], a[244:247]
  s_waitcnt lgkmcnt(0)
  s_waitcnt vmcnt(15)
  v_mfma_f32_16x16x32_bf16 a[64:67], a[104:107], a[84:87], a[64:67]
  s_xor_b32 s52, s52, 64
  s_waitcnt vmcnt(14)
  v_mfma_f32_16x16x32_bf16 a[20:23], a[104:107], a[88:91], a[20:23]
  buffer_load_dword v225, v226, s[20:23], s52 offen sc1
  s_waitcnt vmcnt(14)
  v_mfma_f32_16x16x32_bf16 a[40:43], a[104:107], a[192:195], a[40:43]
  s_add_u32 s45, s42, 45056
  s_waitcnt vmcnt(13)
  v_mfma_f32_16x16x32_bf16 a[60:63], a[104:107], a[196:199], a[60:63]
  buffer_load_dwordx4 v[160:163], v216, s[8:11], s45 offen sc1
  v_mfma_f32_16x16x32_bf16 a[232:235], v[148:151], a[196:199], a[232:235]
  v_mfma_f32_16x16x32_bf16 a[44:47], v[148:151], a[192:195], a[44:47]
  v_mfma_f32_16x16x32_bf16 a[24:27], v[148:151], a[88:91], a[24:27]
  buffer_load_dwordx4 a[92:95], v217, s[8:11], s45 offen sc1
  v_mfma_f32_16x16x32_bf16 a[68:71], v[148:151], a[84:87], a[68:71]
  v_mfma_f32_16x16x32_bf16 a[72:75], v[40:43], a[84:87], a[72:75]
  v_mfma_f32_16x16x32_bf16 a[28:31], v[40:43], a[88:91], a[28:31]
  buffer_load_dwordx4 v[180:183], v218, s[8:11], s45 offen sc1
  v_mfma_f32_16x16x32_bf16 a[48:51], v[40:43], a[192:195], a[48:51]
  v_mfma_f32_16x16x32_bf16 a[236:239], v[40:43], a[196:199], a[236:239]
  v_mfma_f32_16x16x32_bf16 a[240:243], v[44:47], a[196:199], a[240:243]
  buffer_load_dwordx4 v[176:179], v219, s[8:11], s45 offen sc1
  v_mfma_f32_16x16x32_bf16 a[52:55], v[44:47], a[192:195], a[52:55]
  v_mfma_f32_16x16x32_bf16 a[32:35], v[44:47], a[88:91], a[32:35]
  s_add_u32 s55, s41, 155648
  v_mfma_f32_16x16x32_bf16 a[76:79], v[44:47], a[84:87], a[76:79]
  buffer_load_dwordx4 v[108:111], v223, s[12:15], s55 offen offset:3072 sc1
  v_mfma_f32_16x16x32_bf16 a[80:83], v[48:51], a[84:87], a[80:83]
  v_mfma_f32_16x16x32_bf16 a[36:39], v[48:51], a[88:91], a[36:39]
  s_add_u32 s55, s41, 159744
  v_mfma_f32_16x16x32_bf16 a[56:59], v[48:51], a[192:195], a[56:59]
  buffer_load_dwordx4 v[80:83], v223, s[12:15], s55 offen offset:0 sc1
  v_mfma_f32_16x16x32_bf16 a[244:247], v[48:51], a[196:199], a[244:247]
  s_waitcnt vmcnt(17)
  v_mfma_f32_16x16x32_bf16 a[64:67], v[52:55], v[116:119], a[64:67]
  s_add_u32 s45, s42, 61440
  s_waitcnt vmcnt(16)
  v_mfma_f32_16x16x32_bf16 a[20:23], v[52:55], v[32:35], a[20:23]
  buffer_load_dwordx4 v[8:11], v216, s[8:11], s45 offen sc1
  s_waitcnt vmcnt(16)
  v_mfma_f32_16x16x32_bf16 a[40:43], v[52:55], v[152:155], a[40:43]
  s_waitcnt vmcnt(15)
  v_mfma_f32_16x16x32_bf16 a[60:63], v[52:55], a[128:131], a[60:63]
  v_mfma_f32_16x16x32_bf16 a[232:235], v[56:59], a[128:131], a[232:235]
  v_mfma_f32_16x16x32_bf16 a[44:47], v[56:59], v[152:155], a[44:47]
  buffer_load_dwordx4 v[12:15], v217, s[8:11], s45 offen sc1
  v_mfma_f32_16x16x32_bf16 a[24:27], v[56:59], v[32:35], a[24:27]
  v_mfma_f32_16x16x32_bf16 a[68:71], v[56:59], v[116:119], a[68:71]
  v_mfma_f32_16x16x32_bf16 a[72:75], v[60:63], v[116:119], a[72:75]
  v_mfma_f32_16x16x32_bf16 a[28:31], v[60:63], v[32:35], a[28:31]
  buffer_load_dwordx4 a[152:155], v218, s[8:11], s45 offen sc1
  v_mfma_f32_16x16x32_bf16 a[48:51], v[60:63], v[152:155], a[48:51]
  v_mfma_f32_16x16x32_bf16 a[236:239], v[60:63], a[128:131], a[236:239]
  v_mfma_f32_16x16x32_bf16 a[240:243], v[68:71], a[128:131], a[240:243]
  v_mfma_f32_16x16x32_bf16 a[52:55], v[68:71], v[152:155], a[52:55]
  buffer_load_dwordx4 a[156:159], v219, s[8:11], s45 offen sc1
  v_mfma_f32_16x16x32_bf16 a[32:35], v[68:71], v[32:35], a[32:35]
  v_mfma_f32_16x16x32_bf16 a[76:79], v[68:71], v[116:119], a[76:79]
  v_mfma_f32_16x16x32_bf16 a[80:83], v[72:75], v[116:119], a[80:83]
  s_add_u32 s55, s41, 159744
  v_mfma_f32_16x16x32_bf16 a[36:39], v[72:75], v[32:35], a[36:39]
  buffer_load_dwordx4 v[0:3], v223, s[12:15], s55 offen offset:1024 sc1
  v_mfma_f32_16x16x32_bf16 a[56:59], v[72:75], v[152:155], a[56:59]
  v_mfma_f32_16x16x32_bf16 a[244:247], v[72:75], a[128:131], a[244:247]
  s_mov_b32 s54, 0x100000
  s_waitcnt vmcnt(11)
  v_mov_b32 v225, v225
K1_spinEO3:
  v_cmp_gt_u32 vcc, 3, v225
  s_nop 4
  s_cbranch_vccz K1_spinEO3_ok
  s_sleep 2
  buffer_load_dword v225, v226, s[20:23], s52 offen sc1
  s_sub_u32 s54, s54, 1
  s_cmp_lg_u32 s54, 0
  s_waitcnt vmcnt(0)
  s_cbranch_scc1 K1_spinEO3
K1_spinEO3_ok:
  v_mfma_f32_16x16x32_bf16 a[64:67], v[92:95], a[108:111], a[64:67]
  s_add_u32 s45, s42, 77824
  v_mfma_f32_16x16x32_bf16 a[20:23], v[92:95], a[112:115], a[20:23]
  buffer_load_dwordx4 v[4:7], v216, s[8:11], s45 offen sc1
  v_mfma_f32_16x16x32_bf16 a[40:43], v[92:95], a[116:119], a[40:43]
  v_mfma_f32_16x16x32_bf16 a[60:63], v[92:95], a[120:123], a[60:63]
  v_mfma_f32_16x16x32_bf16 a[232:235], v[96:99], a[120:123], a[232:235]
  buffer_load_dwordx4 v[104:107], v217, s[8:11], s45 offen sc1
  v_mfma_f32_16x16x32_bf16 a[44:47], v[96:99], a[116:119], a[44:47]
  v_mfma_f32_16x16x32_bf16 a[24:27], v[96:99], a[112:115], a[24:27]
  v_mfma_f32_16x16x32_bf16 a[68:71], v[96:99], a[108:111], a[68:71]
  buffer_load_dwordx4 v[36:39], v218, s[8:11], s45 offen sc1
  v_mfma_f32_16x16x32_bf16 a[72:75], v[100:103], a[108:111], a[72:75]
  v_mfma_f32_16x16x32_bf16 a[28:31], v[100:103], a[112:115], a[28:31]
  v_mfma_f32_16x16x32_bf16 a[48:51], v[100:103], a[116:119], a[48:51]
  v_mfma_f32_16x16x32_bf16 a[236:239], v[100:103], a[120:123], a[236:239]
  buffer_load_dwordx4 v[28:31], v219, s[8:11], s45 offen sc1
  v_mfma_f32_16x16x32_bf16 a[240:243], v[120:123], a[120:123], a[240:243]
  v_mfma_f32_16x16x32_bf16 a[52:55], v[120:123], a[116:119], a[52:55]
  s_add_u32 s55, s41, 159744
  v_mfma_f32_16x16x32_bf16 a[32:35], v[120:123], a[112:115], a[32:35]
  buffer_load_dwordx4 a[248:251], v223, s[12:15], s55 offen offset:2048 sc1
  v_mfma_f32_16x16x32_bf16 a[76:79], v[120:123], a[108:111], a[76:79]
  v_mfma_f32_16x16x32_bf16 a[80:83], v[124:127], a[108:111], a[80:83]
  v_mfma_f32_16x16x32_bf16 a[36:39], v[124:127], a[112:115], a[36:39]
  buffer_load_dwordx4 a[252:255], v223, s[12:15], s55 offen offset:3072 sc1
  v_mfma_f32_16x16x32_bf16 a[56:59], v[124:127], a[116:119], a[56:59]
  v_mfma_f32_16x16x32_bf16 a[244:247], v[124:127], a[120:123], a[244:247]
  s_waitcnt vmcnt(16)
  v_mfma_f32_16x16x32_bf16 a[64:67], a[208:211], v[160:163], a[64:67]
  s_add_u32 s45, s42, 94208
  s_waitcnt vmcnt(15)
  v_mfma_f32_16x16x32_bf16 a[20:23], a[208:211], a[92:95], a[20:23]
  buffer_load_dwordx4 v[16:19], v216, s[8:11], s45 offen sc1
  s_waitcnt vmcnt(15)
  v_mfma_f32_16x16x32_bf16 a[40:43], a[208:211], v[180:183], a[40:43]
  s_waitcnt vmcnt(14)
  v_mfma_f32_16x16x32_bf16 a[60:63], a[208:211], v[176:179], a[60:63]
  v_mfma_f32_16x16x32_bf16 a[232:235], a[212:215], v[176:179], a[232:235]
  v_mfma_f32_16x16x32_bf16 a[44:47], a[212:215], v[180:183], a[44:47]
  v_mfma_f32_16x16x32_bf16 a[24:27], a[212:215], a[92:95], a[24:27]
  buffer_load_dwordx4 v[20:23], v217, s[8:11], s45 offen sc1
  v_mfma_f32_16x16x32_bf16 a[68:71], a[212:215], v[160:163], a[68:71]
  v_mfma_f32_16x16x32_bf16 a[72:75], a[216:219], v[160:163], a[72:75]
  v_mfma_f32_16x16x32_bf16 a[28:31], a[216:219], a[92:95], a[28:31]
  v_mfma_f32_16x16x32_bf16 a[48:51], a[216:219], v[180:183], a[48:51]
  v_mfma_f32_16x16x32_bf16 a[236:239], a[216:219], v[176:179], a[236:239]
  buffer_load_dwordx4 v[24:27], v218, s[8:11], s45 offen sc1
  v_mfma_f32_16x16x32_bf16 a[240:243], a[96:99], v[176:179], a[240:243]
  v_mfma_f32_16x16x32_bf16 a[52:55], a[96:99], v[180:183], a[52:55]
  v_mfma_f32_16x16x32_bf16 a[32:35], a[96:99], a[92:95], a[32:35]
  v_mfma_f32_16x16x32_bf16 a[76:79], a[96:99], v[160:163], a[76:79]
  v_mfma_f32_16x16x32_bf16 a[80:83], a[100:103], v[160:163], a[80:83]
  buffer_load_dwordx4 v[84:87], v219, s[8:11], s45 offen sc1
  v_mfma_f32_16x16x32_bf16 a[36:39], a[100:103], a[92:95], a[36:39]
  v_mfma_f32_16x16x32_bf16 a[56:59], a[100:103], v[180:183], a[56:59]
  v_mfma_f32_16x16x32_bf16 a[244:247], a[100:103], v[176:179], a[244:247]
  s_waitcnt vmcnt(14)
  v_mfma_f32_16x16x32_bf16 a[64:67], v[164:167], v[8:11], a[64:67]
  s_waitcnt vmcnt(13)
  v_mfma_f32_16x16x32_bf16 a[20:23], v[164:167], v[12:15], a[20:23]
  buffer_load_dword v225, v206, s[20:23], s61 offen sc1
  s_waitcnt vmcnt(13)
  v_mfma_f32_16x16x32_bf16 a[40:43], v[164:167], a[152:155], a[40:43]
  s_waitcnt vmcnt(12)
  v_mfma_f32_16x16x32_bf16 a[60:63], v[164:167], a[156:159], a[60:63]
  v_mfma_f32_16x16x32_bf16 a[232:235], v[168:171], a[156:159], a[232:235]
  s_add_u32 s45, s42, 110592
  v_mfma_f32_16x16x32_bf16 a[44:47], v[168:171], a[152:155], a[44:47]
  buffer_load_dwordx4 a[168:171], v216, s[8:11], s45 offen sc1
  v_mfma_f32_16x16x32_bf16 a[24:27], v[168:171], v[12:15], a[24:27]
  v_mfma_f32_16x16x32_bf16 a[68:71], v[168:171], v[8:11], a[68:71]
  v_mfma_f32_16x16x32_bf16 a[72:75], v[172:175], v[8:11], a[72:75]
  v_mfma_f32_16x16x32_bf16 a[28:31], v[172:175], v[12:15], a[28:31]
  buffer_load_dwordx4 a[172:175], v217, s[8:11], s45 offen sc1
  v_mfma_f32_16x16x32_bf16 a[48:51], v[172:175], a[152:155], a[48:51]
  v_mfma_f32_16x16x32_bf16 a[236:239], v[172:175], a[156:159], a[236:239]
  v_mfma_f32_16x16x32_bf16 a[240:243], v[64:67], a[156:159], a[240:243]
  v_mfma_f32_16x16x32_bf16 a[52:55], v[64:67], a[152:155], a[52:55]
  buffer_load_dwordx4 a[176:179], v218, s[8:11], s45 offen sc1
  v_mfma_f32_16x16x32_bf16 a[32:35], v[64:67], v[12:15], a[32:35]
  v_mfma_f32_16x16x32_bf16 a[76:79], v[64:67], v[8:11], a[76:79]
  v_mfma_f32_16x16x32_bf16 a[80:83], v[76:79], v[8:11], a[80:83]
  v_mfma_f32_16x16x32_bf16 a[36:39], v[76:79], v[12:15], a[36:39]
  buffer_load_dwordx4 v[128:131], v219, s[8:11], s45 offen sc1
K1_st19:
  s_cbranch_execz K1_st0
  v_mfma_f32_16x16x32_bf16 a[56:59], v[76:79], a[152:155], a[56:59]
  v_mfma_f32_16x16x32_bf16 a[244:247], v[76:79], a[156:159], a[244:247]
  s_waitcnt vmcnt(14)
  v_mfma_f32_16x16x32_bf16 a[64:67], a[204:207], v[4:7], a[64:67]
  s_add_u32 s45, s42, 126976
  s_waitcnt vmcnt(13)
  v_mfma_f32_16x16x32_bf16 a[20:23], a[204:207], v[104:107], a[20:23]
  buffer_load_dwordx4 v[132:135], v216, s[8:11], s45 offen sc1
  s_waitcnt vmcnt(13)
  v_mfma_f32_16x16x32_bf16 a[40:43], a[204:207], v[36:39], a[40:43]
  s_waitcnt vmcnt(12)
  v_mfma_f32_16x16x32_bf16 a[60:63], a[204:207], v[28:31], a[60:63]
  v_mfma_f32_16x16x32_bf16 a[232:235], a[228:231], v[28:31], a[232:235]
  v_mfma_f32_16x16x32_bf16 a[44:47], a[228:231], v[36:39], a[44:47]
  v_mfma_f32_16x16x32_bf16 a[24:27], a[228:231], v[104:107], a[24:27]
  buffer_load_dwordx4 a[160:163], v217, s[8:11], s45 offen sc1
  v_mfma_f32_16x16x32_bf16 a[68:71], a[228:231], v[4:7], a[68:71]
  v_mfma_f32_16x16x32_bf16 a[72:75], a[124:127], v[4:7], a[72:75]
  v_mfma_f32_16x16x32_bf16 a[28:31], a[124:127], v[104:107], a[28:31]
  v_mfma_f32_16x16x32_bf16 a[48:51], a[124:127], v[36:39], a[48:51]
  v_mfma_f32_16x16x32_bf16 a[236:239], a[124:127], v[28:31], a[236:239]
  buffer_load_dwordx4 a[164:167], v218, s[8:11], s45 offen sc1
  v_mfma_f32_16x16x32_bf16 a[240:243], a[140:143], v[28:31], a[240:243]
  v_mfma_f32_16x16x32_bf16 a[52:55], a[140:143], v[36:39], a[52:55]
  v_mfma_f32_16x16x32_bf16 a[32:35], a[140:143], v[104:107], a[32:35]
  v_mfma_f32_16x16x32_bf16 a[76:79], a[140:143], v[4:7], a[76:79]
  v_mfma_f32_16x16x32_bf16 a[80:83], a[144:147], v[4:7], a[80:83]
  buffer_load_dwordx4 a[180:183], v219, s[8:11], s45 offen sc1
  v_mfma_f32_16x16x32_bf16 a[36:39], a[144:147], v[104:107], a[36:39]
  v_mfma_f32_16x16x32_bf16 a[56:59], a[144:147], v[36:39], a[56:59]
  v_mfma_f32_16x16x32_bf16 a[244:247], a[144:147], v[28:31], a[244:247]
  s_barrier
  s_waitcnt vmcnt(12)
  v_mfma_f32_16x16x32_bf16 a[64:67], a[148:151], v[16:19], a[64:67]
  s_waitcnt vmcnt(11)
  v_mfma_f32_16x16x32_bf16 a[20:23], a[148:151], v[20:23], a[20:23]
  s_waitcnt vmcnt(10)
  v_mfma_f32_16x16x32_bf16 a[40:43], a[148:151], v[24:27], a[40:43]
  s_waitcnt vmcnt(9)
  v_mfma_f32_16x16x32_bf16 a[60:63], a[148:151], v[84:87], a[60:63]
  v_mfma_f32_16x16x32_bf16 a[232:235], v[184:187], v[84:87], a[232:235]
  v_mfma_f32_16x16x32_bf16 a[44:47], v[184:187], v[24:27], a[44:47]
  v_mfma_f32_16x16x32_bf16 a[24:27], v[184:187], v[20:23], a[24:27]
  v_mfma_f32_16x16x32_bf16 a[68:71], v[184:187], v[16:19], a[68:71]
  v_mfma_f32_16x16x32_bf16 a[72:75], v[188:191], v[16:19], a[72:75]
  v_mfma_f32_16x16x32_bf16 a[28:31], v[188:191], v[20:23], a[28:31]
  v_mfma_f32_16x16x32_bf16 a[48:51], v[188:191], v[24:27], a[48:51]
  v_mfma_f32_16x16x32_bf16 a[236:239], v[188:191], v[84:87], a[236:239]
  v_mfma_f32_16x16x32_bf16 a[240:243], v[88:91], v[84:87], a[240:243]
  v_mfma_f32_16x16x32_bf16 a[52:55], v[88:91], v[24:27], a[52:55]
  v_mfma_f32_16x16x32_bf16 a[32:35], v[88:91], v[20:23], a[32:35]
  v_mfma_f32_16x16x32_bf16 a[76:79], v[88:91], v[16:19], a[76:79]
  v_mfma_f32_16x16x32_bf16 a[80:83], a[188:191], v[16:19], a[80:83]
  v_mfma_f32_16x16x32_bf16 a[36:39], a[188:191], v[20:23], a[36:39]
  v_mfma_f32_16x16x32_bf16 a[56:59], a[188:191], v[24:27], a[56:59]
  v_mfma_f32_16x16x32_bf16 a[244:247], a[188:191], v[84:87], a[244:247]
  s_mov_b32 s54, 0x100000
  s_waitcnt vmcnt(8)
  v_mov_b32 v225, v225
K1_spinEX:
  v_cmp_gt_u32 vcc, 1, v225
  s_nop 4
  s_cbranch_vccz K1_spinEX_ok
  s_sleep 2
  buffer_load_dword v225, v206, s[20:23], s61 offen sc1
  s_sub_u32 s54, s54, 1
  s_cmp_lg_u32 s54, 0
  s_waitcnt vmcnt(0)
  s_cbranch_scc1 K1_spinEX
K1_spinEX_ok:
  s_waitcnt vmcnt(6)
  v_mfma_f32_16x16x32_bf16 a[20:23], a[200:203], a[172:175], a[20:23]
  s_waitcnt vmcnt(2)
  v_mfma_f32_16x16x32_bf16 a[20:23], v[108:111], a[160:163], a[20:23]
  buffer_load_dwordx4 v[112:115], v223, s[80:83], s65 offen offset:0 sc1
  v_mfma_f32_16x16x32_bf16 a[24:27], v[80:83], a[160:163], a[24:27]
  v_mfma_f32_16x16x32_bf16 a[24:27], v[136:139], a[172:175], a[24:27]
  v_mfma_f32_16x16x32_bf16 a[28:31], a[132:135], a[172:175], a[28:31]
  v_mfma_f32_16x16x32_bf16 a[28:31], v[0:3], a[160:163], a[28:31]
  buffer_load_dwordx4 v[116:119], v223, s[80:83], s65 offen offset:1024 sc1
  v_mfma_f32_16x16x32_bf16 a[32:35], a[248:251], a[160:163], a[32:35]
  v_mfma_f32_16x16x32_bf16 a[32:35], a[136:139], a[172:175], a[32:35]
  v_mfma_f32_16x16x32_bf16 a[36:39], v[156:159], a[172:175], a[36:39]
  v_mfma_f32_16x16x32_bf16 a[36:39], a[252:255], a[160:163], a[36:39]
  buffer_load_dwordx4 v[152:155], v223, s[80:83], s65 offen offset:2048 sc1
  ds_write_b128 v253, a[20:23] offset:0
  s_waitcnt vmcnt(4)
  v_mfma_f32_16x16x32_bf16 a[40:43], v[108:111], a[164:167], a[40:43]
  v_mfma_f32_16x16x32_bf16 a[40:43], a[200:203], a[176:179], a[40:43]
  ds_write_b128 v253, a[24:27] offset:1024
  v_mfma_f32_16x16x32_bf16 a[44:47], v[136:139], a[176:179], a[44:47]
  v_mfma_f32_16x16x32_bf16 a[44:47], v[80:83], a[164:167], a[44:47]
  buffer_load_dwordx4 v[92:95], v223, s[80:83], s65 offen offset:3072 sc1
  ds_write_b128 v253, a[28:31] offset:2048
  v_mfma_f32_16x16x32_bf16 a[48:51], v[0:3], a[164:167], a[48:51]
  v_mfma_f32_16x16x32_bf16 a[48:51], a[132:135], a[176:179], a[48:51]
  ds_write_b128 v253, a[32:35] offset:3072
  v_mfma_f32_16x16x32_bf16 a[52:55], a[136:139], a[176:179], a[52:55]
  v_mfma_f32_16x16x32_bf16 a[52:55], a[248:251], a[164:167], a[52:55]
  buffer_load_dwordx4 v[96:99], v224, s[80:83], s65 offen offset:0 sc1
  ds_write_b128 v253, a[36:39] offset:4096
  v_mfma_f32_16x16x32_bf16 a[56:59], a[252:255], a[164:167], a[56:59]
  v_mfma_f32_16x16x32_bf16 a[56:59], v[156:159], a[176:179], a[56:59]
  ds_write_b128 v254, a[40:43] offset:0
  v_mfma_f32_16x16x32_bf16 a[60:63], a[200:203], v[128:131], a[60:63]
  v_lshlrev_b32 v100, 16, v192
  v_and_b32 v101, 0xffff0000, v192
  s_waitcnt vmcnt(5)
  v_mfma_f32_16x16x32_bf16 a[60:63], v[108:111], a[180:183], a[60:63]
  ds_write_b128 v254, a[44:47] offset:1024
  v_mfma_f32_16x16x32_bf16 a[232:235], v[80:83], a[180:183], a[232:235]
  v_lshlrev_b32 v102, 16, v193
  v_and_b32 v103, 0xffff0000, v193
  v_mfma_f32_16x16x32_bf16 a[232:235], v[136:139], v[128:131], a[232:235]
  ds_write_b128 v254, a[48:51] offset:2048
  v_mfma_f32_16x16x32_bf16 a[236:239], a[132:135], v[128:131], a[236:239]
  v_lshlrev_b32 v160, 16, v194
  v_and_b32 v161, 0xffff0000, v194
  v_mfma_f32_16x16x32_bf16 a[236:239], v[0:3], a[180:183], a[236:239]
  ds_write_b128 v254, a[52:55] offset:3072
  v_mfma_f32_16x16x32_bf16 a[240:243], a[248:251], a[180:183], a[240:243]
  v_lshlrev_b32 v162, 16, v195
  v_and_b32 v163, 0xffff0000, v195
  v_mfma_f32_16x16x32_bf16 a[240:243], a[136:139], v[128:131], a[240:243]
  ds_write_b128 v254, a[56:59] offset:4096
  v_mfma_f32_16x16x32_bf16 a[244:247], v[156:159], v[128:131], a[244:247]
  v_lshlrev_b32 v180, 16, v196
  v_and_b32 v181, 0xffff0000, v196
  v_mfma_f32_16x16x32_bf16 a[244:247], a[252:255], a[180:183], a[244:247]
  ds_write_b128 v255, a[60:63] offset:0
  v_mfma_f32_16x16x32_bf16 a[64:67], v[108:111], v[132:135], a[64:67]
  v_lshlrev_b32 v182, 16, v197
  v_and_b32 v183, 0xffff0000, v197
  v_mfma_f32_16x16x32_bf16 a[64:67], a[200:203], a[168:171], a[64:67]
  ds_write_b128 v255, a[232:235] offset:1024
  v_mfma_f32_16x16x32_bf16 a[68:71], v[136:139], a[168:171], a[68:71]
  v_lshlrev_b32 v176, 16, v198
  v_and_b32 v177, 0xffff0000, v198
  v_mfma_f32_16x16x32_bf16 a[68:71], v[80:83], v[132:135], a[68:71]
  ds_write_b128 v255, a[236:239] offset:2048
  v_mfma_f32_16x16x32_bf16 a[72:75], v[0:3], v[132:135], a[72:75]
  v_lshlrev_b32 v178, 16, v199
  v_and_b32 v179, 0xffff0000, v199
  v_mfma_f32_16x16x32_bf16 a[72:75], a[132:135], a[168:171], a[72:75]
  ds_write_b128 v255, a[240:243] offset:3072
  v_mfma_f32_16x16x32_bf16 a[76:79], a[136:139], a[168:171], a[76:79]
  v_lshlrev_b32 v164, 16, v200
  v_and_b32 v165, 0xffff0000, v200
  v_mfma_f32_16x16x32_bf16 a[76:79], a[248:251], v[132:135], a[76:79]
  ds_write_b128 v255, a[244:247] offset:4096
  v_mfma_f32_16x16x32_bf16 a[80:83], a[252:255], v[132:135], a[80:83]
  v_lshlrev_b32 v166, 16, v201
  v_and_b32 v167, 0xffff0000, v201
  v_mfma_f32_16x16x32_bf16 a[80:83], v[156:159], a[168:171], a[80:83]
  s_waitcnt lgkmcnt(0)
  s_barrier
  ds_read_b128 v[4:7], v252 offset:0
  ds_read_b128 v[8:11], v252 offset:5120
  ds_read_b128 v[12:15], v252 offset:10240
  ds_read_b128 v[20:23], v252 offset:1024
  ds_read_b128 v[24:27], v252 offset:6144
  ds_read_b128 v[28:31], v252 offset:11264
  ds_read_b128 v[36:39], v252 offset:2048
  ds_read_b128 v[40:43], v252 offset:7168
  ds_read_b128 v[44:47], v252 offset:12288
  ds_read_b128 v[52:55], v252 offset:3072
  ds_read_b128 v[56:59], v252 offset:8192
  ds_read_b128 v[60:63], v252 offset:13312
  ds_read_b128 v[68:71], v252 offset:4096
  ds_read_b128 v[72:75], v252 offset:9216
  ds_read_b128 v[76:79], v252 offset:14336
  v_accvgpr_read_b32 v0, a64
  v_accvgpr_read_b32 v1, a65
  v_accvgpr_read_b32 v2, a66
  v_accvgpr_read_b32 v3, a67
  v_accvgpr_read_b32 v16, a68
  v_accvgpr_read_b32 v17, a69
  v_accvgpr_read_b32 v18, a70
  v_accvgpr_read_b32 v19, a71
  v_accvgpr_read_b32 v32, a72
  v_accvgpr_read_b32 v33, a73
  v_accvgpr_read_b32 v34, a74
  v_accvgpr_read_b32 v35, a75
  v_accvgpr_read_b32 v48, a76
  v_accvgpr_read_b32 v49, a77
  v_accvgpr_read_b32 v50, a78
  v_accvgpr_read_b32 v51, a79
  v_accvgpr_read_b32 v64, a80
  v_accvgpr_read_b32 v65, a81
  v_accvgpr_read_b32 v66, a82
  v_accvgpr_read_b32 v67, a83
  s_waitcnt vmcnt(4)
  v_pk_add_f32 v[0:1], v[0:1], v[112:113]
  v_pk_add_f32 v[2:3], v[2:3], v[114:115]
  s_waitcnt vmcnt(3)
  v_pk_add_f32 v[16:17], v[16:17], v[116:117]
  v_pk_add_f32 v[18:19], v[18:19], v[118:119]
  s_waitcnt vmcnt(2)
  v_pk_add_f32 v[32:33], v[32:33], v[152:153]
  v_pk_add_f32 v[34:35], v[34:35], v[154:155]
  s_waitcnt vmcnt(1)
  v_pk_add_f32 v[48:49], v[48:49], v[92:93]
  v_pk_add_f32 v[50:51], v[50:51], v[94:95]
  s_waitcnt vmcnt(0)
  v_pk_add_f32 v[64:65], v[64:65], v[96:97]
  v_pk_add_f32 v[66:67], v[66:67], v[98:99]
  s_waitcnt lgkmcnt(14)
  v_pk_add_f32 v[0:1], v[0:1], v[4:5]
  v_pk_add_f32 v[2:3], v[2:3], v[6:7]
  s_waitcnt lgkmcnt(12)
  v_pk_add_f32 v[8:9], v[8:9], v[12:13]
  v_pk_add_f32 v[10:11], v[10:11], v[14:15]
  v_pk_add_f32 v[0:1], v[0:1], v[8:9]
  v_pk_add_f32 v[2:3], v[2:3], v[10:11]
  v_pk_fma_f32 v[100:101], v[0:1], v[232:233], v[100:101]
  v_pk_fma_f32 v[102:103], v[2:3], v[234:235], v[102:103]
  v_cvt_pk_bf16_f32 v140, v100, v101
  v_cvt_pk_bf16_f32 v141, v102, v103
  ds_write_b64 v202, v[140:141] offset:0
  s_waitcnt lgkmcnt(12)
  v_pk_add_f32 v[16:17], v[16:17], v[20:21]
  v_pk_add_f32 v[18:19], v[18:19], v[22:23]
  s_waitcnt lgkmcnt(10)
  v_pk_add_f32 v[24:25], v[24:25], v[28:29]
  v_pk_add_f32 v[26:27], v[26:27], v[30:31]
  v_pk_add_f32 v[16:17], v[16:17], v[24:25]
  v_pk_add_f32 v[18:19], v[18:19], v[26:27]
  v_pk_fma_f32 v[160:161], v[16:17], v[236:237], v[160:161]
  v_pk_fma_f32 v[162:163], v[18:19], v[238:239], v[162:163]
  v_cvt_pk_bf16_f32 v142, v160, v161
  v_cvt_pk_bf16_f32 v143, v162, v163
  ds_write_b64 v202, v[142:143] offset:8
  s_waitcnt lgkmcnt(10)
  v_pk_add_f32 v[32:33], v[32:33], v[36:37]
  v_pk_add_f32 v[34:35], v[34:35], v[38:39]
  s_waitcnt lgkmcnt(8)
  v_pk_add_f32 v[40:41], v[40:41], v[44:45]
  v_pk_add_f32 v[42:43], v[42:43], v[46:47]
  v_pk_add_f32 v[32:33], v[32:33], v[40:41]
  v_pk_add_f32 v[34:35], v[34:35], v[42:43]
  v_pk_fma_f32 v[180:181], v[32:33], v[240:241], v[180:181]
  v_pk_fma_f32 v[182:183], v[34:35], v[242:243], v[182:183]
  v_cvt_pk_bf16_f32 v144, v180, v181
  v_cvt_pk_bf16_f32 v145, v182, v183
  ds_write_b64 v202, v[144:145] offset:16
  s_waitcnt lgkmcnt(8)
  v_pk_add_f32 v[48:49], v[48:49], v[52:53]
  v_pk_add_f32 v[50:51], v[50:51], v[54:55]
  s_waitcnt lgkmcnt(6)
  v_pk_add_f32 v[56:57], v[56:57], v[60:61]
  v_pk_add_f32 v[58:59], v[58:59], v[62:63]
  v_pk_add_f32 v[48:49], v[48:49], v[56:57]
  v_pk_add_f32 v[50:51], v[50:51], v[58:59]
  v_pk_fma_f32 v[176:177], v[48:49], v[244:245], v[176:177]
  v_pk_fma_f32 v[178:179], v[50:51], v[246:247], v[178:179]
  v_cvt_pk_bf16_f32 v146, v176, v177
  v_cvt_pk_bf16_f32 v147, v178, v179
  ds_write_b64 v202, v[146:147] offset:24
  s_waitcnt lgkmcnt(6)
  v_pk_add_f32 v[64:65], v[64:65], v[68:69]
  v_pk_add_f32 v[66:67], v[66:67], v[70:71]
  s_waitcnt lgkmcnt(4)
  v_pk_add_f32 v[72:73], v[72:73], v[76:77]
  v_pk_add_f32 v[74:75], v[74:75], v[78:79]
  v_pk_add_f32 v[64:65], v[64:65], v[72:73]
  v_pk_add_f32 v[66:67], v[66:67], v[74:75]
  v_pk_fma_f32 v[164:165], v[64:65], v[248:249], v[164:165]
  v_pk_fma_f32 v[166:167], v[66:67], v[250:251], v[166:167]
  v_cvt_pk_bf16_f32 v148, v164, v165
  v_cvt_pk_bf16_f32 v149, v166, v167
  ds_write_b64 v202, v[148:149] offset:32
  ds_read_b128 v[120:123], v207 offset:0
  ds_read_b128 v[124:127], v207 offset:1024
  ds_read_b128 v[128:131], v207 offset:2048
  s_waitcnt lgkmcnt(2)
  buffer_store_dwordx4 v[120:123], v228, s[76:79], s58 offen offset:0 nt
  s_waitcnt lgkmcnt(1)
  buffer_store_dwordx4 v[124:127], v229, s[76:79], s58 offen offset:1024 nt
  s_mov_b32 exec_hi, 0
  s_waitcnt lgkmcnt(0)
  buffer_store_dwordx4 v[128:131], v230, s[76:79], s58 offen offset:2048 nt
  s_mov_b64 exec, -1
  s_branch K1_c1
K1_fb:
  s_waitcnt vmcnt(0) lgkmcnt(0)
  s_nop 15
  v_and_b32 v204, 15, v222
  v_lshlrev_b32 v204, 8, v204
  v_lshrrev_b32 v205, 4, v222
  v_lshl_add_u32 v204, v205, 4, v204
  s_xor_b32 s51, s36, 0
  s_lshl_b32 s51, s51, 6
  v_add_u32 v96, s51, v204
  s_xor_b32 s51, s36, 1
  s_lshl_b32 s51, s51, 6
  v_add_u32 v97, s51, v204
  s_xor_b32 s51, s36, 2
  s_lshl_b32 s51, s51, 6
  v_add_u32 v98, s51, v204
  s_xor_b32 s51, s36, 3
  s_lshl_b32 s51, s51, 6
  v_add_u32 v99, s51, v204
  v_lshrrev_b32 v204, 2, v222
  v_lshlrev_b32 v204, 8, v204
  v_and_b32 v205, 3, v222
  v_lshl_add_u32 v204, v205, 3, v204
  v_add_u32 v100, s44, v204
  v_mov_b32 v192, 0xff7fffff
  v_mov_b32 v196, 0
  v_mov_b32 v193, 0xff7fffff
  v_mov_b32 v197, 0
  v_mov_b32 v194, 0xff7fffff
  v_mov_b32 v198, 0
  v_mov_b32 v195, 0xff7fffff
  v_mov_b32 v199, 0
  v_accvgpr_write_b32 a0, 0
  v_accvgpr_write_b32 a1, 0
  v_accvgpr_write_b32 a2, 0
  v_accvgpr_write_b32 a3, 0
  v_accvgpr_write_b32 a4, 0
  v_accvgpr_write_b32 a5, 0
  v_accvgpr_write_b32 a6, 0
  v_accvgpr_write_b32 a7, 0
  v_accvgpr_write_b32 a8, 0
  v_accvgpr_write_b32 a9, 0
  v_accvgpr_write_b32 a10, 0
  v_accvgpr_write_b32 a11, 0
  v_accvgpr_write_b32 a12, 0
  v_accvgpr_write_b32 a13, 0
  v_accvgpr_write_b32 a14, 0
  v_accvgpr_write_b32 a15, 0
  v_accvgpr_write_b32 a16, 0
  v_accvgpr_write_b32 a17, 0
  v_accvgpr_write_b32 a18, 0
  v_accvgpr_write_b32 a19, 0
  v_accvgpr_write_b32 a20, 0
  v_accvgpr_write_b32 a21, 0
  v_accvgpr_write_b32 a22, 0
  v_accvgpr_write_b32 a23, 0
  v_accvgpr_write_b32 a24, 0
  v_accvgpr_write_b32 a25, 0
  v_accvgpr_write_b32 a26, 0
  v_accvgpr_write_b32 a27, 0
  v_accvgpr_write_b32 a28, 0
  v_accvgpr_write_b32 a29, 0
  v_accvgpr_write_b32 a30, 0
  v_accvgpr_write_b32 a31, 0
  v_accvgpr_write_b32 a32, 0
  v_accvgpr_write_b32 a33, 0
  v_accvgpr_write_b32 a34, 0
  v_accvgpr_write_b32 a35, 0
  v_accvgpr_write_b32 a36, 0
  v_accvgpr_write_b32 a37, 0
  v_accvgpr_write_b32 a38, 0
  v_accvgpr_write_b32 a39, 0
  v_accvgpr_write_b32 a40, 0
  v_accvgpr_write_b32 a41, 0
  v_accvgpr_write_b32 a42, 0
  v_accvgpr_write_b32 a43, 0
  v_accvgpr_write_b32 a44, 0
  v_accvgpr_write_b32 a45, 0
  v_accvgpr_write_b32 a46, 0
  v_accvgpr_write_b32 a47, 0
  v_accvgpr_write_b32 a48, 0
  v_accvgpr_write_b32 a49, 0
  v_accvgpr_write_b32 a50, 0
  v_accvgpr_write_b32 a51, 0
  v_accvgpr_write_b32 a52, 0
  v_accvgpr_write_b32 a53, 0
  v_accvgpr_write_b32 a54, 0
  v_accvgpr_write_b32 a55, 0
  v_accvgpr_write_b32 a56, 0
  v_accvgpr_write_b32 a57, 0
  v_accvgpr_write_b32 a58, 0
  v_accvgpr_write_b32 a59, 0
  v_accvgpr_write_b32 a60, 0
  v_accvgpr_write_b32 a61, 0
  v_accvgpr_write_b32 a62, 0
  v_accvgpr_write_b32 a63, 0
  v_accvgpr_write_b32 a64, 0
  v_accvgpr_write_b32 a65, 0
  v_accvgpr_write_b32 a66, 0
  v_accvgpr_write_b32 a67, 0
  v_accvgpr_write_b32 a68, 0
  v_accvgpr_write_b32 a69, 0
  v_accvgpr_write_b32 a70, 0
  v_accvgpr_write_b32 a71, 0
  v_accvgpr_write_b32 a72, 0
  v_accvgpr_write_b32 a73, 0
  v_accvgpr_write_b32 a74, 0
  v_accvgpr_write_b32 a75, 0
  v_accvgpr_write_b32 a76, 0
  v_accvgpr_write_b32 a77, 0
  v_accvgpr_write_b32 a78, 0
  v_accvgpr_write_b32 a79, 0
  v_accvgpr_write_b32 a80, 0
  v_accvgpr_write_b32 a81, 0
  v_accvgpr_write_b32 a82, 0
  v_accvgpr_write_b32 a83, 0
  v_accvgpr_write_b32 a84, 0
  v_accvgpr_write_b32 a85, 0
  v_accvgpr_write_b32 a86, 0
  v_accvgpr_write_b32 a87, 0
  v_accvgpr_write_b32 a88, 0
  v_accvgpr_write_b32 a89, 0
  v_accvgpr_write_b32 a90, 0
  v_accvgpr_write_b32 a91, 0
  v_accvgpr_write_b32 a92, 0
  v_accvgpr_write_b32 a93, 0
  v_accvgpr_write_b32 a94, 0
  v_accvgpr_write_b32 a95, 0
  v_accvgpr_write_b32 a96, 0
  v_accvgpr_write_b32 a97, 0
  v_accvgpr_write_b32 a98, 0
  v_accvgpr_write_b32 a99, 0
  v_accvgpr_write_b32 a100, 0
  v_accvgpr_write_b32 a101, 0
  v_accvgpr_write_b32 a102, 0
  v_accvgpr_write_b32 a103, 0
  v_accvgpr_write_b32 a104, 0
  v_accvgpr_write_b32 a105, 0
  v_accvgpr_write_b32 a106, 0
  v_accvgpr_write_b32 a107, 0
  v_accvgpr_write_b32 a108, 0
  v_accvgpr_write_b32 a109, 0
  v_accvgpr_write_b32 a110, 0
  v_accvgpr_write_b32 a111, 0
  v_accvgpr_write_b32 a112, 0
  v_accvgpr_write_b32 a113, 0
  v_accvgpr_write_b32 a114, 0
  v_accvgpr_write_b32 a115, 0
  v_accvgpr_write_b32 a116, 0
  v_accvgpr_write_b32 a117, 0
  v_accvgpr_write_b32 a118, 0
  v_accvgpr_write_b32 a119, 0
  v_accvgpr_write_b32 a120, 0
  v_accvgpr_write_b32 a121, 0
  v_accvgpr_write_b32 a122, 0
  v_accvgpr_write_b32 a123, 0
  v_accvgpr_write_b32 a124, 0
  v_accvgpr_write_b32 a125, 0
  v_accvgpr_write_b32 a126, 0
  v_accvgpr_write_b32 a127, 0
  s_mov_b32 s52, 0
K1_fbloop:
  s_add_u32 s49, s52, 4096
  buffer_load_dwordx4 a[128:131], v96, s[24:27], s52 offen
  buffer_load_dwordx4 a[132:135], v97, s[24:27], s52 offen
  buffer_load_dwordx4 a[136:139], v98, s[24:27], s52 offen
  buffer_load_dwordx4 a[140:143], v99, s[24:27], s52 offen
  buffer_load_dwordx4 a[144:147], v96, s[24:27], s49 offen
  buffer_load_dwordx4 a[148:151], v97, s[24:27], s49 offen
  buffer_load_dwordx4 a[152:155], v98, s[24:27], s49 offen
  buffer_load_dwordx4 a[156:159], v99, s[24:27], s49 offen
  s_add_u32 m0, s44, 16384
  s_nop 0
  buffer_load_dwordx4 v223, s[28:31], s52 offen offset:0 lds
  buffer_load_dwordx4 v223, s[28:31], s52 offen offset:1024 lds
  buffer_load_dwordx4 v223, s[28:31], s52 offen offset:2048 lds
  buffer_load_dwordx4 v223, s[28:31], s52 offen offset:3072 lds
  s_add_u32 m0, s44, 32768
  s_nop 0
  buffer_load_dwordx4 v223, s[28:31], s49 offen offset:0 lds
  buffer_load_dwordx4 v223, s[28:31], s49 offen offset:1024 lds
  buffer_load_dwordx4 v223, s[28:31], s49 offen offset:2048 lds
  buffer_load_dwordx4 v223, s[28:31], s49 offen offset:3072 lds
  s_waitcnt vmcnt(0)
  v_mfma_f32_16x16x32_bf16 v[0:3], a[128:131], v[128:131], 0
  v_mfma_f32_16x16x32_bf16 v[0:3], a[132:135], v[132:135], v[0:3]
  v_mfma_f32_16x16x32_bf16 v[0:3], a[136:139], v[136:139], v[0:3]
  v_mfma_f32_16x16x32_bf16 v[0:3], a[140:143], v[140:143], v[0:3]
  v_mfma_f32_16x16x32_bf16 v[4:7], a[140:143], v[156:159], 0
  v_mfma_f32_16x16x32_bf16 v[4:7], a[136:139], v[152:155], v[4:7]
  v_mfma_f32_16x16x32_bf16 v[4:7], a[132:135], v[148:151], v[4:7]
  v_mfma_f32_16x16x32_bf16 v[4:7], a[128:131], v[144:147], v[4:7]
  v_mfma_f32_16x16x32_bf16 v[8:11], a[128:131], v[160:163], 0
  v_mfma_f32_16x16x32_bf16 v[8:11], a[132:135], v[164:167], v[8:11]
  v_mfma_f32_16x16x32_bf16 v[8:11], a[136:139], v[168:171], v[8:11]
  v_mfma_f32_16x16x32_bf16 v[8:11], a[140:143], v[172:175], v[8:11]
  v_mfma_f32_16x16x32_bf16 v[12:15], a[140:143], v[188:191], 0
  v_mfma_f32_16x16x32_bf16 v[12:15], a[136:139], v[184:187], v[12:15]
  v_mfma_f32_16x16x32_bf16 v[12:15], a[132:135], v[180:183], v[12:15]
  v_mfma_f32_16x16x32_bf16 v[12:15], a[128:131], v[176:179], v[12:15]
  v_mfma_f32_16x16x32_bf16 v[28:31], a[144:147], v[176:179], 0
  v_mfma_f32_16x16x32_bf16 v[28:31], a[148:151], v[180:183], v[28:31]
  v_mfma_f32_16x16x32_bf16 v[28:31], a[152:155], v[184:187], v[28:31]
  v_mfma_f32_16x16x32_bf16 v[28:31], a[156:159], v[188:191], v[28:31]
  v_mfma_f32_16x16x32_bf16 v[24:27], a[156:159], v[172:175], 0
  v_mfma_f32_16x16x32_bf16 v[24:27], a[152:155], v[168:171], v[24:27]
  v_mfma_f32_16x16x32_bf16 v[24:27], a[148:151], v[164:167], v[24:27]
  v_mfma_f32_16x16x32_bf16 v[24:27], a[144:147], v[160:163], v[24:27]
  v_mfma_f32_16x16x32_bf16 v[20:23], a[144:147], v[144:147], 0
  v_mfma_f32_16x16x32_bf16 v[20:23], a[148:151], v[148:151], v[20:23]
  v_mfma_f32_16x16x32_bf16 v[20:23], a[152:155], v[152:155], v[20:23]
  v_mfma_f32_16x16x32_bf16 v[20:23], a[156:159], v[156:159], v[20:23]
  v_mfma_f32_16x16x32_bf16 v[16:19], a[156:159], v[140:143], 0
  v_mfma_f32_16x16x32_bf16 v[16:19], a[152:155], v[136:139], v[16:19]
  v_mfma_f32_16x16x32_bf16 v[16:19], a[148:151], v[132:135], v[16:19]
  v_mfma_f32_16x16x32_bf16 v[16:19], a[144:147], v[128:131], v[16:19]
  ds_read_b64_tr_b16 a[160:161], v100 offset:16384
  ds_read_b64_tr_b16 a[162:163], v100 offset:32768
  ds_read_b64_tr_b16 a[164:165], v100 offset:16416
  ds_read_b64_tr_b16 a[166:167], v100 offset:32800
  ds_read_b64_tr_b16 a[168:169], v100 offset:16448
  ds_read_b64_tr_b16 a[170:171], v100 offset:32832
  ds_read_b64_tr_b16 a[172:173], v100 offset:16480
  ds_read_b64_tr_b16 a[174:175], v100 offset:32864
  ds_read_b64_tr_b16 a[176:177], v100 offset:16512
  ds_read_b64_tr_b16 a[178:179], v100 offset:32896
  ds_read_b64_tr_b16 a[180:181], v100 offset:16544
  ds_read_b64_tr_b16 a[182:183], v100 offset:32928
  ds_read_b64_tr_b16 a[184:185], v100 offset:16576
  ds_read_b64_tr_b16 a[186:187], v100 offset:32960
  ds_read_b64_tr_b16 a[188:189], v100 offset:16608
  ds_read_b64_tr_b16 a[190:191], v100 offset:32992
  v_max3_f32 v204, v0, v1, v2
  v_max3_f32 v205, v3, v16, v17
  v_max3_f32 v204, v204, v18, v19
  v_max3_f32 v204, v204, v205, v192
  v_mov_b32 v205, v204
  s_nop 1
  v_permlane16_swap_b32 v204, v205
  v_max_f32 v204, v204, v205
  v_mov_b32 v205, v204
  s_nop 1
  v_permlane32_swap_b32 v204, v205
  v_max_f32 v204, v204, v205
  v_sub_f32 v200, v192, v204
  v_exp_f32 v200, v200
  v_mov_b32 v192, v204
  v_mul_f32 v196, v196, v200
  v_sub_f32 v0, v0, v204
  v_sub_f32 v1, v1, v204
  v_sub_f32 v2, v2, v204
  v_sub_f32 v3, v3, v204
  v_sub_f32 v16, v16, v204
  v_sub_f32 v17, v17, v204
  v_sub_f32 v18, v18, v204
  v_sub_f32 v19, v19, v204
  v_exp_f32 v0, v0
  v_exp_f32 v1, v1
  v_exp_f32 v2, v2
  v_exp_f32 v3, v3
  v_exp_f32 v16, v16
  v_exp_f32 v17, v17
  v_exp_f32 v18, v18
  v_exp_f32 v19, v19
  v_add_f32 v196, v196, v0
  v_add_f32 v196, v196, v1
  v_add_f32 v196, v196, v2
  v_add_f32 v196, v196, v3
  v_add_f32 v196, v196, v16
  v_add_f32 v196, v196, v17
  v_add_f32 v196, v196, v18
  v_add_f32 v196, v196, v19
  v_cvt_pk_bf16_f32 v64, v0, v1
  v_cvt_pk_bf16_f32 v65, v2, v3
  v_cvt_pk_bf16_f32 v66, v16, v17
  v_cvt_pk_bf16_f32 v67, v18, v19
  v_accvgpr_read_b32 v32, a0
  v_accvgpr_read_b32 v33, a1
  v_accvgpr_read_b32 v34, a2
  v_accvgpr_read_b32 v35, a3
  v_mul_f32 v32, v32, v200
  v_mul_f32 v33, v33, v200
  v_mul_f32 v34, v34, v200
  v_mul_f32 v35, v35, v200
  v_accvgpr_write_b32 a0, v32
  v_accvgpr_write_b32 a1, v33
  v_accvgpr_write_b32 a2, v34
  v_accvgpr_write_b32 a3, v35
  v_accvgpr_read_b32 v32, a16
  v_accvgpr_read_b32 v33, a17
  v_accvgpr_read_b32 v34, a18
  v_accvgpr_read_b32 v35, a19
  v_mul_f32 v32, v32, v200
  v_mul_f32 v33, v33, v200
  v_mul_f32 v34, v34, v200
  v_mul_f32 v35, v35, v200
  v_accvgpr_write_b32 a16, v32
  v_accvgpr_write_b32 a17, v33
  v_accvgpr_write_b32 a18, v34
  v_accvgpr_write_b32 a19, v35
  v_accvgpr_read_b32 v32, a32
  v_accvgpr_read_b32 v33, a33
  v_accvgpr_read_b32 v34, a34
  v_accvgpr_read_b32 v35, a35
  v_mul_f32 v32, v32, v200
  v_mul_f32 v33, v33, v200
  v_mul_f32 v34, v34, v200
  v_mul_f32 v35, v35, v200
  v_accvgpr_write_b32 a32, v32
  v_accvgpr_write_b32 a33, v33
  v_accvgpr_write_b32 a34, v34
  v_accvgpr_write_b32 a35, v35
  v_accvgpr_read_b32 v32, a48
  v_accvgpr_read_b32 v33, a49
  v_accvgpr_read_b32 v34, a50
  v_accvgpr_read_b32 v35, a51
  v_mul_f32 v32, v32, v200
  v_mul_f32 v33, v33, v200
  v_mul_f32 v34, v34, v200
  v_mul_f32 v35, v35, v200
  v_accvgpr_write_b32 a48, v32
  v_accvgpr_write_b32 a49, v33
  v_accvgpr_write_b32 a50, v34
  v_accvgpr_write_b32 a51, v35
  v_accvgpr_read_b32 v32, a64
  v_accvgpr_read_b32 v33, a65
  v_accvgpr_read_b32 v34, a66
  v_accvgpr_read_b32 v35, a67
  v_mul_f32 v32, v32, v200
  v_mul_f32 v33, v33, v200
  v_mul_f32 v34, v34, v200
  v_mul_f32 v35, v35, v200
  v_accvgpr_write_b32 a64, v32
  v_accvgpr_write_b32 a65, v33
  v_accvgpr_write_b32 a66, v34
  v_accvgpr_write_b32 a67, v35
  v_accvgpr_read_b32 v32, a80
  v_accvgpr_read_b32 v33, a81
  v_accvgpr_read_b32 v34, a82
  v_accvgpr_read_b32 v35, a83
  v_mul_f32 v32, v32, v200
  v_mul_f32 v33, v33, v200
  v_mul_f32 v34, v34, v200
  v_mul_f32 v35, v35, v200
  v_accvgpr_write_b32 a80, v32
  v_accvgpr_write_b32 a81, v33
  v_accvgpr_write_b32 a82, v34
  v_accvgpr_write_b32 a83, v35
  v_accvgpr_read_b32 v32, a96
  v_accvgpr_read_b32 v33, a97
  v_accvgpr_read_b32 v34, a98
  v_accvgpr_read_b32 v35, a99
  v_mul_f32 v32, v32, v200
  v_mul_f32 v33, v33, v200
  v_mul_f32 v34, v34, v200
  v_mul_f32 v35, v35, v200
  v_accvgpr_write_b32 a96, v32
  v_accvgpr_write_b32 a97, v33
  v_accvgpr_write_b32 a98, v34
  v_accvgpr_write_b32 a99, v35
  v_accvgpr_read_b32 v32, a112
  v_accvgpr_read_b32 v33, a113
  v_accvgpr_read_b32 v34, a114
  v_accvgpr_read_b32 v35, a115
  v_mul_f32 v32, v32, v200
  v_mul_f32 v33, v33, v200
  v_mul_f32 v34, v34, v200
  v_mul_f32 v35, v35, v200
  v_accvgpr_write_b32 a112, v32
  v_accvgpr_write_b32 a113, v33
  v_accvgpr_write_b32 a114, v34
  v_accvgpr_write_b32 a115, v35
  v_max3_f32 v204, v4, v5, v6
  v_max3_f32 v205, v7, v20, v21
  v_max3_f32 v204, v204, v22, v23
  v_max3_f32 v204, v204, v205, v193
  v_mov_b32 v205, v204
  s_nop 1
  v_permlane16_swap_b32 v204, v205
  v_max_f32 v204, v204, v205
  v_mov_b32 v205, v204
  s_nop 1
  v_permlane32_swap_b32 v204, v205
  v_max_f32 v204, v204, v205
  v_sub_f32 v201, v193, v204
  v_exp_f32 v201, v201
  v_mov_b32 v193, v204
  v_mul_f32 v197, v197, v201
  v_sub_f32 v4, v4, v204
  v_sub_f32 v5, v5, v204
  v_sub_f32 v6, v6, v204
  v_sub_f32 v7, v7, v204
  v_sub_f32 v20, v20, v204
  v_sub_f32 v21, v21, v204
  v_sub_f32 v22, v22, v204
  v_sub_f32 v23, v23, v204
  v_exp_f32 v4, v4
  v_exp_f32 v5, v5
  v_exp_f32 v6, v6
  v_exp_f32 v7, v7
  v_exp_f32 v20, v20
  v_exp_f32 v21, v21
  v_exp_f32 v22, v22
  v_exp_f32 v23, v23
  v_add_f32 v197, v197, v4
  v_add_f32 v197, v197, v5
  v_add_f32 v197, v197, v6
  v_add_f32 v197, v197, v7
  v_add_f32 v197, v197, v20
  v_add_f32 v197, v197, v21
  v_add_f32 v197, v197, v22
  v_add_f32 v197, v197, v23
  v_cvt_pk_bf16_f32 v68, v4, v5
  v_cvt_pk_bf16_f32 v69, v6, v7
  v_cvt_pk_bf16_f32 v70, v20, v21
  v_cvt_pk_bf16_f32 v71, v22, v23
  v_accvgpr_read_b32 v32, a4
  v_accvgpr_read_b32 v33, a5
  v_accvgpr_read_b32 v34, a6
  v_accvgpr_read_b32 v35, a7
  v_mul_f32 v32, v32, v201
  v_mul_f32 v33, v33, v201
  v_mul_f32 v34, v34, v201
  v_mul_f32 v35, v35, v201
  v_accvgpr_write_b32 a4, v32
  v_accvgpr_write_b32 a5, v33
  v_accvgpr_write_b32 a6, v34
  v_accvgpr_write_b32 a7, v35
  v_accvgpr_read_b32 v32, a20
  v_accvgpr_read_b32 v33, a21
  v_accvgpr_read_b32 v34, a22
  v_accvgpr_read_b32 v35, a23
  v_mul_f32 v32, v32, v201
  v_mul_f32 v33, v33, v201
  v_mul_f32 v34, v34, v201
  v_mul_f32 v35, v35, v201
  v_accvgpr_write_b32 a20, v32
  v_accvgpr_write_b32 a21, v33
  v_accvgpr_write_b32 a22, v34
  v_accvgpr_write_b32 a23, v35
  v_accvgpr_read_b32 v32, a36
  v_accvgpr_read_b32 v33, a37
  v_accvgpr_read_b32 v34, a38
  v_accvgpr_read_b32 v35, a39
  v_mul_f32 v32, v32, v201
  v_mul_f32 v33, v33, v201
  v_mul_f32 v34, v34, v201
  v_mul_f32 v35, v35, v201
  v_accvgpr_write_b32 a36, v32
  v_accvgpr_write_b32 a37, v33
  v_accvgpr_write_b32 a38, v34
  v_accvgpr_write_b32 a39, v35
  v_accvgpr_read_b32 v32, a52
  v_accvgpr_read_b32 v33, a53
  v_accvgpr_read_b32 v34, a54
  v_accvgpr_read_b32 v35, a55
  v_mul_f32 v32, v32, v201
  v_mul_f32 v33, v33, v201
  v_mul_f32 v34, v34, v201
  v_mul_f32 v35, v35, v201
  v_accvgpr_write_b32 a52, v32
  v_accvgpr_write_b32 a53, v33
  v_accvgpr_write_b32 a54, v34
  v_accvgpr_write_b32 a55, v35
  v_accvgpr_read_b32 v32, a68
  v_accvgpr_read_b32 v33, a69
  v_accvgpr_read_b32 v34, a70
  v_accvgpr_read_b32 v35, a71
  v_mul_f32 v32, v32, v201
  v_mul_f32 v33, v33, v201
  v_mul_f32 v34, v34, v201
  v_mul_f32 v35, v35, v201
  v_accvgpr_write_b32 a68, v32
  v_accvgpr_write_b32 a69, v33
  v_accvgpr_write_b32 a70, v34
  v_accvgpr_write_b32 a71, v35
  v_accvgpr_read_b32 v32, a84
  v_accvgpr_read_b32 v33, a85
  v_accvgpr_read_b32 v34, a86
  v_accvgpr_read_b32 v35, a87
  v_mul_f32 v32, v32, v201
  v_mul_f32 v33, v33, v201
  v_mul_f32 v34, v34, v201
  v_mul_f32 v35, v35, v201
  v_accvgpr_write_b32 a84, v32
  v_accvgpr_write_b32 a85, v33
  v_accvgpr_write_b32 a86, v34
  v_accvgpr_write_b32 a87, v35
  v_accvgpr_read_b32 v32, a100
  v_accvgpr_read_b32 v33, a101
  v_accvgpr_read_b32 v34, a102
  v_accvgpr_read_b32 v35, a103
  v_mul_f32 v32, v32, v201
  v_mul_f32 v33, v33, v201
  v_mul_f32 v34, v34, v201
  v_mul_f32 v35, v35, v201
  v_accvgpr_write_b32 a100, v32
  v_accvgpr_write_b32 a101, v33
  v_accvgpr_write_b32 a102, v34
  v_accvgpr_write_b32 a103, v35
  v_accvgpr_read_b32 v32, a116
  v_accvgpr_read_b32 v33, a117
  v_accvgpr_read_b32 v34, a118
  v_accvgpr_read_b32 v35, a119
  v_mul_f32 v32, v32, v201
  v_mul_f32 v33, v33, v201
  v_mul_f32 v34, v34, v201
  v_mul_f32 v35, v35, v201
  v_accvgpr_write_b32 a116, v32
  v_accvgpr_write_b32 a117, v33
  v_accvgpr_write_b32 a118, v34
  v_accvgpr_write_b32 a119, v35
  v_max3_f32 v204, v8, v9, v10
  v_max3_f32 v205, v11, v24, v25
  v_max3_f32 v204, v204, v26, v27
  v_max3_f32 v204, v204, v205, v194
  v_mov_b32 v205, v204
  s_nop 1
  v_permlane16_swap_b32 v204, v205
  v_max_f32 v204, v204, v205
  v_mov_b32 v205, v204
  s_nop 1
  v_permlane32_swap_b32 v204, v205
  v_max_f32 v204, v204, v205
  v_sub_f32 v202, v194, v204
  v_exp_f32 v202, v202
  v_mov_b32 v194, v204
  v_mul_f32 v198, v198, v202
  v_sub_f32 v8, v8, v204
  v_sub_f32 v9, v9, v204
  v_sub_f32 v10, v10, v204
  v_sub_f32 v11, v11, v204
  v_sub_f32 v24, v24, v204
  v_sub_f32 v25, v25, v204
  v_sub_f32 v26, v26, v204
  v_sub_f32 v27, v27, v204
  v_exp_f32 v8, v8
  v_exp_f32 v9, v9
  v_exp_f32 v10, v10
  v_exp_f32 v11, v11
  v_exp_f32 v24, v24
  v_exp_f32 v25, v25
  v_exp_f32 v26, v26
  v_exp_f32 v27, v27
  v_add_f32 v198, v198, v8
  v_add_f32 v198, v198, v9
  v_add_f32 v198, v198, v10
  v_add_f32 v198, v198, v11
  v_add_f32 v198, v198, v24
  v_add_f32 v198, v198, v25
  v_add_f32 v198, v198, v26
  v_add_f32 v198, v198, v27
  v_cvt_pk_bf16_f32 v72, v8, v9
  v_cvt_pk_bf16_f32 v73, v10, v11
  v_cvt_pk_bf16_f32 v74, v24, v25
  v_cvt_pk_bf16_f32 v75, v26, v27
  v_accvgpr_read_b32 v32, a8
  v_accvgpr_read_b32 v33, a9
  v_accvgpr_read_b32 v34, a10
  v_accvgpr_read_b32 v35, a11
  v_mul_f32 v32, v32, v202
  v_mul_f32 v33, v33, v202
  v_mul_f32 v34, v34, v202
  v_mul_f32 v35, v35, v202
  v_accvgpr_write_b32 a8, v32
  v_accvgpr_write_b32 a9, v33
  v_accvgpr_write_b32 a10, v34
  v_accvgpr_write_b32 a11, v35
  v_accvgpr_read_b32 v32, a24
  v_accvgpr_read_b32 v33, a25
  v_accvgpr_read_b32 v34, a26
  v_accvgpr_read_b32 v35, a27
  v_mul_f32 v32, v32, v202
  v_mul_f32 v33, v33, v202
  v_mul_f32 v34, v34, v202
  v_mul_f32 v35, v35, v202
  v_accvgpr_write_b32 a24, v32
  v_accvgpr_write_b32 a25, v33
  v_accvgpr_write_b32 a26, v34
  v_accvgpr_write_b32 a27, v35
  v_accvgpr_read_b32 v32, a40
  v_accvgpr_read_b32 v33, a41
  v_accvgpr_read_b32 v34, a42
  v_accvgpr_read_b32 v35, a43
  v_mul_f32 v32, v32, v202
  v_mul_f32 v33, v33, v202
  v_mul_f32 v34, v34, v202
  v_mul_f32 v35, v35, v202
  v_accvgpr_write_b32 a40, v32
  v_accvgpr_write_b32 a41, v33
  v_accvgpr_write_b32 a42, v34
  v_accvgpr_write_b32 a43, v35
  v_accvgpr_read_b32 v32, a56
  v_accvgpr_read_b32 v33, a57
  v_accvgpr_read_b32 v34, a58
  v_accvgpr_read_b32 v35, a59
  v_mul_f32 v32, v32, v202
  v_mul_f32 v33, v33, v202
  v_mul_f32 v34, v34, v202
  v_mul_f32 v35, v35, v202
  v_accvgpr_write_b32 a56, v32
  v_accvgpr_write_b32 a57, v33
  v_accvgpr_write_b32 a58, v34
  v_accvgpr_write_b32 a59, v35
  v_accvgpr_read_b32 v32, a72
  v_accvgpr_read_b32 v33, a73
  v_accvgpr_read_b32 v34, a74
  v_accvgpr_read_b32 v35, a75
  v_mul_f32 v32, v32, v202
  v_mul_f32 v33, v33, v202
  v_mul_f32 v34, v34, v202
  v_mul_f32 v35, v35, v202
  v_accvgpr_write_b32 a72, v32
  v_accvgpr_write_b32 a73, v33
  v_accvgpr_write_b32 a74, v34
  v_accvgpr_write_b32 a75, v35
  v_accvgpr_read_b32 v32, a88
  v_accvgpr_read_b32 v33, a89
  v_accvgpr_read_b32 v34, a90
  v_accvgpr_read_b32 v35, a91
  v_mul_f32 v32, v32, v202
  v_mul_f32 v33, v33, v202
  v_mul_f32 v34, v34, v202
  v_mul_f32 v35, v35, v202
  v_accvgpr_write_b32 a88, v32
  v_accvgpr_write_b32 a89, v33
  v_accvgpr_write_b32 a90, v34
  v_accvgpr_write_b32 a91, v35
  v_accvgpr_read_b32 v32, a104
  v_accvgpr_read_b32 v33, a105
  v_accvgpr_read_b32 v34, a106
  v_accvgpr_read_b32 v35, a107
  v_mul_f32 v32, v32, v202
  v_mul_f32 v33, v33, v202
  v_mul_f32 v34, v34, v202
  v_mul_f32 v35, v35, v202
  v_accvgpr_write_b32 a104, v32
  v_accvgpr_write_b32 a105, v33
  v_accvgpr_write_b32 a106, v34
  v_accvgpr_write_b32 a107, v35
  v_accvgpr_read_b32 v32, a120
  v_accvgpr_read_b32 v33, a121
  v_accvgpr_read_b32 v34, a122
  v_accvgpr_read_b32 v35, a123
  v_mul_f32 v32, v32, v202
  v_mul_f32 v33, v33, v202
  v_mul_f32 v34, v34, v202
  v_mul_f32 v35, v35, v202
  v_accvgpr_write_b32 a120, v32
  v_accvgpr_write_b32 a121, v33
  v_accvgpr_write_b32 a122, v34
  v_accvgpr_write_b32 a123, v35
  v_max3_f32 v204, v12, v13, v14
  v_max3_f32 v205, v15, v28, v29
  v_max3_f32 v204, v204, v30, v31
  v_max3_f32 v204, v204, v205, v195
  v_mov_b32 v205, v204
  s_nop 1
  v_permlane16_swap_b32 v204, v205
  v_max_f32 v204, v204, v205
  v_mov_b32 v205, v204
  s_nop 1
  v_permlane32_swap_b32 v204, v205
  v_max_f32 v204, v204, v205
  v_sub_f32 v203, v195, v204
  v_exp_f32 v203, v203
  v_mov_b32 v195, v204
  v_mul_f32 v199, v199, v203
  v_sub_f32 v12, v12, v204
  v_sub_f32 v13, v13, v204
  v_sub_f32 v14, v14, v204
  v_sub_f32 v15, v15, v204
  v_sub_f32 v28, v28, v204
  v_sub_f32 v29, v29, v204
  v_sub_f32 v30, v30, v204
  v_sub_f32 v31, v31, v204
  v_exp_f32 v12, v12
  v_exp_f32 v13, v13
  v_exp_f32 v14, v14
  v_exp_f32 v15, v15
  v_exp_f32 v28, v28
  v_exp_f32 v29, v29
  v_exp_f32 v30, v30
  v_exp_f32 v31, v31
  v_add_f32 v199, v199, v12
  v_add_f32 v199, v199, v13
  v_add_f32 v199, v199, v14
  v_add_f32 v199, v199, v15
  v_add_f32 v199, v199, v28
  v_add_f32 v199, v199, v29
  v_add_f32 v199, v199, v30
  v_add_f32 v199, v199, v31
  v_cvt_pk_bf16_f32 v76, v12, v13
  v_cvt_pk_bf16_f32 v77, v14, v15
  v_cvt_pk_bf16_f32 v78, v28, v29
  v_cvt_pk_bf16_f32 v79, v30, v31
  v_accvgpr_read_b32 v32, a12
  v_accvgpr_read_b32 v33, a13
  v_accvgpr_read_b32 v34, a14
  v_accvgpr_read_b32 v35, a15
  v_mul_f32 v32, v32, v203
  v_mul_f32 v33, v33, v203
  v_mul_f32 v34, v34, v203
  v_mul_f32 v35, v35, v203
  v_accvgpr_write_b32 a12, v32
  v_accvgpr_write_b32 a13, v33
  v_accvgpr_write_b32 a14, v34
  v_accvgpr_write_b32 a15, v35
  v_accvgpr_read_b32 v32, a28
  v_accvgpr_read_b32 v33, a29
  v_accvgpr_read_b32 v34, a30
  v_accvgpr_read_b32 v35, a31
  v_mul_f32 v32, v32, v203
  v_mul_f32 v33, v33, v203
  v_mul_f32 v34, v34, v203
  v_mul_f32 v35, v35, v203
  v_accvgpr_write_b32 a28, v32
  v_accvgpr_write_b32 a29, v33
  v_accvgpr_write_b32 a30, v34
  v_accvgpr_write_b32 a31, v35
  v_accvgpr_read_b32 v32, a44
  v_accvgpr_read_b32 v33, a45
  v_accvgpr_read_b32 v34, a46
  v_accvgpr_read_b32 v35, a47
  v_mul_f32 v32, v32, v203
  v_mul_f32 v33, v33, v203
  v_mul_f32 v34, v34, v203
  v_mul_f32 v35, v35, v203
  v_accvgpr_write_b32 a44, v32
  v_accvgpr_write_b32 a45, v33
  v_accvgpr_write_b32 a46, v34
  v_accvgpr_write_b32 a47, v35
  v_accvgpr_read_b32 v32, a60
  v_accvgpr_read_b32 v33, a61
  v_accvgpr_read_b32 v34, a62
  v_accvgpr_read_b32 v35, a63
  v_mul_f32 v32, v32, v203
  v_mul_f32 v33, v33, v203
  v_mul_f32 v34, v34, v203
  v_mul_f32 v35, v35, v203
  v_accvgpr_write_b32 a60, v32
  v_accvgpr_write_b32 a61, v33
  v_accvgpr_write_b32 a62, v34
  v_accvgpr_write_b32 a63, v35
  v_accvgpr_read_b32 v32, a76
  v_accvgpr_read_b32 v33, a77
  v_accvgpr_read_b32 v34, a78
  v_accvgpr_read_b32 v35, a79
  v_mul_f32 v32, v32, v203
  v_mul_f32 v33, v33, v203
  v_mul_f32 v34, v34, v203
  v_mul_f32 v35, v35, v203
  v_accvgpr_write_b32 a76, v32
  v_accvgpr_write_b32 a77, v33
  v_accvgpr_write_b32 a78, v34
  v_accvgpr_write_b32 a79, v35
  v_accvgpr_read_b32 v32, a92
  v_accvgpr_read_b32 v33, a93
  v_accvgpr_read_b32 v34, a94
  v_accvgpr_read_b32 v35, a95
  v_mul_f32 v32, v32, v203
  v_mul_f32 v33, v33, v203
  v_mul_f32 v34, v34, v203
  v_mul_f32 v35, v35, v203
  v_accvgpr_write_b32 a92, v32
  v_accvgpr_write_b32 a93, v33
  v_accvgpr_write_b32 a94, v34
  v_accvgpr_write_b32 a95, v35
  v_accvgpr_read_b32 v32, a108
  v_accvgpr_read_b32 v33, a109
  v_accvgpr_read_b32 v34, a110
  v_accvgpr_read_b32 v35, a111
  v_mul_f32 v32, v32, v203
  v_mul_f32 v33, v33, v203
  v_mul_f32 v34, v34, v203
  v_mul_f32 v35, v35, v203
  v_accvgpr_write_b32 a108, v32
  v_accvgpr_write_b32 a109, v33
  v_accvgpr_write_b32 a110, v34
  v_accvgpr_write_b32 a111, v35
  v_accvgpr_read_b32 v32, a124
  v_accvgpr_read_b32 v33, a125
  v_accvgpr_read_b32 v34, a126
  v_accvgpr_read_b32 v35, a127
  v_mul_f32 v32, v32, v203
  v_mul_f32 v33, v33, v203
  v_mul_f32 v34, v34, v203
  v_mul_f32 v35, v35, v203
  v_accvgpr_write_b32 a124, v32
  v_accvgpr_write_b32 a125, v33
  v_accvgpr_write_b32 a126, v34
  v_accvgpr_write_b32 a127, v35
  s_waitcnt lgkmcnt(14)
  v_mfma_f32_16x16x32_bf16 a[0:3], a[160:163], v[64:67], a[0:3]
  v_mfma_f32_16x16x32_bf16 a[4:7], a[160:163], v[68:71], a[4:7]
  v_mfma_f32_16x16x32_bf16 a[8:11], a[160:163], v[72:75], a[8:11]
  v_mfma_f32_16x16x32_bf16 a[12:15], a[160:163], v[76:79], a[12:15]
  s_waitcnt lgkmcnt(12)
  v_mfma_f32_16x16x32_bf16 a[16:19], a[164:167], v[64:67], a[16:19]
  v_mfma_f32_16x16x32_bf16 a[20:23], a[164:167], v[68:71], a[20:23]
  v_mfma_f32_16x16x32_bf16 a[24:27], a[164:167], v[72:75], a[24:27]
  v_mfma_f32_16x16x32_bf16 a[28:31], a[164:167], v[76:79], a[28:31]
  s_waitcnt lgkmcnt(10)
  v_mfma_f32_16x16x32_bf16 a[32:35], a[168:171], v[64:67], a[32:35]
  v_mfma_f32_16x16x32_bf16 a[36:39], a[168:171], v[68:71], a[36:39]
  v_mfma_f32_16x16x32_bf16 a[40:43], a[168:171], v[72:75], a[40:43]
  v_mfma_f32_16x16x32_bf16 a[44:47], a[168:171], v[76:79], a[44:47]
  s_waitcnt lgkmcnt(8)
  v_mfma_f32_16x16x32_bf16 a[48:51], a[172:175], v[64:67], a[48:51]
  v_mfma_f32_16x16x32_bf16 a[52:55], a[172:175], v[68:71], a[52:55]
  v_mfma_f32_16x16x32_bf16 a[56:59], a[172:175], v[72:75], a[56:59]
  v_mfma_f32_16x16x32_bf16 a[60:63], a[172:175], v[76:79], a[60:63]
  s_waitcnt lgkmcnt(6)
  v_mfma_f32_16x16x32_bf16 a[64:67], a[176:179], v[64:67], a[64:67]
  v_mfma_f32_16x16x32_bf16 a[68:71], a[176:179], v[68:71], a[68:71]
  v_mfma_f32_16x16x32_bf16 a[72:75], a[176:179], v[72:75], a[72:75]
  v_mfma_f32_16x16x32_bf16 a[76:79], a[176:179], v[76:79], a[76:79]
  s_waitcnt lgkmcnt(4)
  v_mfma_f32_16x16x32_bf16 a[80:83], a[180:183], v[64:67], a[80:83]
  v_mfma_f32_16x16x32_bf16 a[84:87], a[180:183], v[68:71], a[84:87]
  v_mfma_f32_16x16x32_bf16 a[88:91], a[180:183], v[72:75], a[88:91]
  v_mfma_f32_16x16x32_bf16 a[92:95], a[180:183], v[76:79], a[92:95]
  s_waitcnt lgkmcnt(2)
  v_mfma_f32_16x16x32_bf16 a[96:99], a[184:187], v[64:67], a[96:99]
  v_mfma_f32_16x16x32_bf16 a[100:103], a[184:187], v[68:71], a[100:103]
  v_mfma_f32_16x16x32_bf16 a[104:107], a[184:187], v[72:75], a[104:107]
  v_mfma_f32_16x16x32_bf16 a[108:111], a[184:187], v[76:79], a[108:111]
  s_waitcnt lgkmcnt(0)
  v_mfma_f32_16x16x32_bf16 a[112:115], a[188:191], v[64:67], a[112:115]
  v_mfma_f32_16x16x32_bf16 a[116:119], a[188:191], v[68:71], a[116:119]
  v_mfma_f32_16x16x32_bf16 a[120:123], a[188:191], v[72:75], a[120:123]
  v_mfma_f32_16x16x32_bf16 a[124:127], a[188:191], v[76:79], a[124:127]
  s_nop 15
  s_add_u32 s52, s52, 8192
  s_cmp_lt_u32 s52, 524288
  s_cbranch_scc1 K1_fbloop
  v_mov_b32 v204, v196
  s_nop 1
  v_permlane16_swap_b32 v196, v204
  v_add_f32 v196, v196, v204
  v_mov_b32 v204, v196
  s_nop 1
  v_permlane32_swap_b32 v196, v204
  v_add_f32 v196, v196, v204
  v_rcp_f32 v192, v196
  v_mov_b32 v204, v197
  s_nop 1
  v_permlane16_swap_b32 v197, v204
  v_add_f32 v197, v197, v204
  v_mov_b32 v204, v197
  s_nop 1
  v_permlane32_swap_b32 v197, v204
  v_add_f32 v197, v197, v204
  v_rcp_f32 v193, v197
  v_mov_b32 v204, v198
  s_nop 1
  v_permlane16_swap_b32 v198, v204
  v_add_f32 v198, v198, v204
  v_mov_b32 v204, v198
  s_nop 1
  v_permlane32_swap_b32 v198, v204
  v_add_f32 v198, v198, v204
  v_rcp_f32 v194, v198
  v_mov_b32 v204, v199
  s_nop 1
  v_permlane16_swap_b32 v199, v204
  v_add_f32 v199, v199, v204
  v_mov_b32 v204, v199
  s_nop 1
  v_permlane32_swap_b32 v199, v204
  v_add_f32 v199, v199, v204
  v_rcp_f32 v195, v199
  s_add_u32 m0, s44, 16384
  s_add_u32 s55, s41, 36864
  buffer_load_dwordx4 v223, s[12:15], s55 offen offset:0 sc1 lds
  buffer_load_dwordx4 v223, s[12:15], s55 offen offset:1024 sc1 lds
  buffer_load_dwordx4 v223, s[12:15], s55 offen offset:2048 sc1 lds
  buffer_load_dwordx4 v223, s[12:15], s55 offen offset:3072 sc1 lds
  s_add_u32 m0, s44, 32768
  s_add_u32 s55, s41, 45056
  buffer_load_dwordx4 v223, s[12:15], s55 offen offset:0 sc1 lds
  buffer_load_dwordx4 v223, s[12:15], s55 offen offset:1024 sc1 lds
  buffer_load_dwordx4 v223, s[12:15], s55 offen offset:2048 sc1 lds
  buffer_load_dwordx4 v223, s[12:15], s55 offen offset:3072 sc1 lds
  s_add_u32 s55, s41, 0
  buffer_load_dwordx4 a[128:131], v223, s[12:15], s55 offen offset:0 sc1
  s_add_u32 s55, s41, 0
  buffer_load_dwordx4 a[132:135], v223, s[12:15], s55 offen offset:1024 sc1
  s_add_u32 s55, s41, 0
  buffer_load_dwordx4 a[136:139], v223, s[12:15], s55 offen offset:2048 sc1
  s_add_u32 s55, s41, 0
  buffer_load_dwordx4 a[140:143], v223, s[12:15], s55 offen offset:3072 sc1
  s_add_u32 s55, s41, 4096
  buffer_load_dwordx4 a[144:147], v223, s[12:15], s55 offen offset:0 sc1
  s_add_u32 s55, s41, 4096
  buffer_load_dwordx4 a[148:151], v223, s[12:15], s55 offen offset:1024 sc1
  s_add_u32 s55, s41, 4096
  buffer_load_dwordx4 a[152:155], v223, s[12:15], s55 offen offset:2048 sc1
  s_add_u32 s55, s41, 4096
  buffer_load_dwordx4 a[156:159], v223, s[12:15], s55 offen offset:3072 sc1
  s_add_u32 s55, s41, 16384
  buffer_load_dwordx4 a[248:251], v223, s[12:15], s55 offen offset:0 sc1
  s_add_u32 s55, s41, 16384
  buffer_load_dwordx4 a[252:255], v223, s[12:15], s55 offen offset:1024 sc1
  s_add_u32 s55, s41, 16384
  buffer_load_dwordx4 a[160:163], v223, s[12:15], s55 offen offset:2048 sc1
  s_add_u32 s55, s41, 16384
  buffer_load_dwordx4 a[164:167], v223, s[12:15], s55 offen offset:3072 sc1
  s_add_u32 s55, s41, 20480
  buffer_load_dwordx4 a[168:171], v223, s[12:15], s55 offen offset:0 sc1
  s_add_u32 s55, s41, 20480
  buffer_load_dwordx4 a[172:175], v223, s[12:15], s55 offen offset:1024 sc1
  s_add_u32 s55, s41, 20480
  buffer_load_dwordx4 a[176:179], v223, s[12:15], s55 offen offset:2048 sc1
  s_add_u32 s55, s41, 8192
  buffer_load_dwordx4 v[0:3], v223, s[12:15], s55 offen offset:0 sc1
  s_add_u32 s55, s41, 8192
  buffer_load_dwordx4 v[4:7], v223, s[12:15], s55 offen offset:1024 sc1
  s_add_u32 s55, s41, 8192
  buffer_load_dwordx4 v[8:11], v223, s[12:15], s55 offen offset:2048 sc1
  s_add_u32 s55, s41, 8192
  buffer_load_dwordx4 v[12:15], v223, s[12:15], s55 offen offset:3072 sc1
  s_add_u32 s55, s41, 12288
  buffer_load_dwordx4 v[16:19], v223, s[12:15], s55 offen offset:0 sc1
  s_add_u32 s55, s41, 12288
  buffer_load_dwordx4 v[20:23], v223, s[12:15], s55 offen offset:1024 sc1
  s_add_u32 s55, s41, 12288
  buffer_load_dwordx4 v[24:27], v223, s[12:15], s55 offen offset:2048 sc1
  s_add_u32 s55, s41, 12288
  buffer_load_dwordx4 v[28:31], v223, s[12:15], s55 offen offset:3072 sc1
  v_accvgpr_read_b32 v200, a0
  v_accvgpr_read_b32 v201, a1
  v_accvgpr_read_b32 v202, a2
  v_accvgpr_read_b32 v203, a3
  v_accvgpr_read_b32 v204, a16
  v_accvgpr_read_b32 v205, a17
  v_accvgpr_read_b32 v206, a18
  v_accvgpr_read_b32 v207, a19
  v_pk_mul_f32 v[200:201], v[200:201], v[192:193] op_sel:[0,0] op_sel_hi:[1,0]
  v_pk_mul_f32 v[202:203], v[202:203], v[192:193] op_sel:[0,0] op_sel_hi:[1,0]
  v_pk_mul_f32 v[204:205], v[204:205], v[192:193] op_sel:[0,0] op_sel_hi:[1,0]
  v_pk_mul_f32 v[206:207], v[206:207], v[192:193] op_sel:[0,0] op_sel_hi:[1,0]
  v_cvt_pk_bf16_f32 v208, v200, v201
  v_cvt_pk_bf16_f32 v209, v202, v203
  v_cvt_pk_bf16_f32 v210, v204, v205
  v_cvt_pk_bf16_f32 v211, v206, v207
  s_lshl_b32 s51, s37, 14
  s_add_u32 s51, s51, 0
  buffer_store_dwordx4 v[208:211], v223, s[32:35], s51 offen offset:0 sc1
  v_accvgpr_read_b32 v200, a4
  v_accvgpr_read_b32 v201, a5
  v_accvgpr_read_b32 v202, a6
  v_accvgpr_read_b32 v203, a7
  v_accvgpr_read_b32 v204, a20
  v_accvgpr_read_b32 v205, a21
  v_accvgpr_read_b32 v206, a22
  v_accvgpr_read_b32 v207, a23
  v_pk_mul_f32 v[200:201], v[200:201], v[192:193] op_sel:[0,1] op_sel_hi:[1,1]
  v_pk_mul_f32 v[202:203], v[202:203], v[192:193] op_sel:[0,1] op_sel_hi:[1,1]
  v_pk_mul_f32 v[204:205], v[204:205], v[192:193] op_sel:[0,1] op_sel_hi:[1,1]
  v_pk_mul_f32 v[206:207], v[206:207], v[192:193] op_sel:[0,1] op_sel_hi:[1,1]
  v_cvt_pk_bf16_f32 v212, v200, v201
  v_cvt_pk_bf16_f32 v213, v202, v203
  v_cvt_pk_bf16_f32 v214, v204, v205
  v_cvt_pk_bf16_f32 v215, v206, v207
  s_lshl_b32 s51, s37, 14
  s_add_u32 s51, s51, 0
  buffer_store_dwordx4 v[212:215], v223, s[32:35], s51 offen offset:1024 sc1
  v_accvgpr_read_b32 v200, a8
  v_accvgpr_read_b32 v201, a9
  v_accvgpr_read_b32 v202, a10
  v_accvgpr_read_b32 v203, a11
  v_accvgpr_read_b32 v204, a24
  v_accvgpr_read_b32 v205, a25
  v_accvgpr_read_b32 v206, a26
  v_accvgpr_read_b32 v207, a27
  v_pk_mul_f32 v[200:201], v[200:201], v[194:195] op_sel:[0,0] op_sel_hi:[1,0]
  v_pk_mul_f32 v[202:203], v[202:203], v[194:195] op_sel:[0,0] op_sel_hi:[1,0]
  v_pk_mul_f32 v[204:205], v[204:205], v[194:195] op_sel:[0,0] op_sel_hi:[1,0]
  v_pk_mul_f32 v[206:207], v[206:207], v[194:195] op_sel:[0,0] op_sel_hi:[1,0]
  v_cvt_pk_bf16_f32 v208, v200, v201
  v_cvt_pk_bf16_f32 v209, v202, v203
  v_cvt_pk_bf16_f32 v210, v204, v205
  v_cvt_pk_bf16_f32 v211, v206, v207
  s_lshl_b32 s51, s37, 14
  s_add_u32 s51, s51, 0
  buffer_store_dwordx4 v[208:211], v223, s[32:35], s51 offen offset:2048 sc1
  v_accvgpr_read_b32 v200, a12
  v_accvgpr_read_b32 v201, a13
  v_accvgpr_read_b32 v202, a14
  v_accvgpr_read_b32 v203, a15
  v_accvgpr_read_b32 v204, a28
  v_accvgpr_read_b32 v205, a29
  v_accvgpr_read_b32 v206, a30
  v_accvgpr_read_b32 v207, a31
  v_pk_mul_f32 v[200:201], v[200:201], v[194:195] op_sel:[0,1] op_sel_hi:[1,1]
  v_pk_mul_f32 v[202:203], v[202:203], v[194:195] op_sel:[0,1] op_sel_hi:[1,1]
  v_pk_mul_f32 v[204:205], v[204:205], v[194:195] op_sel:[0,1] op_sel_hi:[1,1]
  v_pk_mul_f32 v[206:207], v[206:207], v[194:195] op_sel:[0,1] op_sel_hi:[1,1]
  v_cvt_pk_bf16_f32 v212, v200, v201
  v_cvt_pk_bf16_f32 v213, v202, v203
  v_cvt_pk_bf16_f32 v214, v204, v205
  v_cvt_pk_bf16_f32 v215, v206, v207
  s_lshl_b32 s51, s37, 14
  s_add_u32 s51, s51, 0
  buffer_store_dwordx4 v[212:215], v223, s[32:35], s51 offen offset:3072 sc1
  v_accvgpr_read_b32 v200, a32
  v_accvgpr_read_b32 v201, a33
  v_accvgpr_read_b32 v202, a34
  v_accvgpr_read_b32 v203, a35
  v_accvgpr_read_b32 v204, a48
  v_accvgpr_read_b32 v205, a49
  v_accvgpr_read_b32 v206, a50
  v_accvgpr_read_b32 v207, a51
  v_pk_mul_f32 v[200:201], v[200:201], v[192:193] op_sel:[0,0] op_sel_hi:[1,0]
  v_pk_mul_f32 v[202:203], v[202:203], v[192:193] op_sel:[0,0] op_sel_hi:[1,0]
  v_pk_mul_f32 v[204:205], v[204:205], v[192:193] op_sel:[0,0] op_sel_hi:[1,0]
  v_pk_mul_f32 v[206:207], v[206:207], v[192:193] op_sel:[0,0] op_sel_hi:[1,0]
  v_cvt_pk_bf16_f32 v208, v200, v201
  v_cvt_pk_bf16_f32 v209, v202, v203
  v_cvt_pk_bf16_f32 v210, v204, v205
  v_cvt_pk_bf16_f32 v211, v206, v207
  s_lshl_b32 s51, s37, 14
  s_add_u32 s51, s51, 4096
  buffer_store_dwordx4 v[208:211], v223, s[32:35], s51 offen offset:0 sc1
  v_accvgpr_read_b32 v200, a36
  v_accvgpr_read_b32 v201, a37
  v_accvgpr_read_b32 v202, a38
  v_accvgpr_read_b32 v203, a39
  v_accvgpr_read_b32 v204, a52
  v_accvgpr_read_b32 v205, a53
  v_accvgpr_read_b32 v206, a54
  v_accvgpr_read_b32 v207, a55
  v_pk_mul_f32 v[200:201], v[200:201], v[192:193] op_sel:[0,1] op_sel_hi:[1,1]
  v_pk_mul_f32 v[202:203], v[202:203], v[192:193] op_sel:[0,1] op_sel_hi:[1,1]
  v_pk_mul_f32 v[204:205], v[204:205], v[192:193] op_sel:[0,1] op_sel_hi:[1,1]
  v_pk_mul_f32 v[206:207], v[206:207], v[192:193] op_sel:[0,1] op_sel_hi:[1,1]
  v_cvt_pk_bf16_f32 v212, v200, v201
  v_cvt_pk_bf16_f32 v213, v202, v203
  v_cvt_pk_bf16_f32 v214, v204, v205
  v_cvt_pk_bf16_f32 v215, v206, v207
  s_lshl_b32 s51, s37, 14
  s_add_u32 s51, s51, 4096
  buffer_store_dwordx4 v[212:215], v223, s[32:35], s51 offen offset:1024 sc1
  v_accvgpr_read_b32 v200, a40
  v_accvgpr_read_b32 v201, a41
  v_accvgpr_read_b32 v202, a42
  v_accvgpr_read_b32 v203, a43
  v_accvgpr_read_b32 v204, a56
  v_accvgpr_read_b32 v205, a57
  v_accvgpr_read_b32 v206, a58
  v_accvgpr_read_b32 v207, a59
  v_pk_mul_f32 v[200:201], v[200:201], v[194:195] op_sel:[0,0] op_sel_hi:[1,0]
  v_pk_mul_f32 v[202:203], v[202:203], v[194:195] op_sel:[0,0] op_sel_hi:[1,0]
  v_pk_mul_f32 v[204:205], v[204:205], v[194:195] op_sel:[0,0] op_sel_hi:[1,0]
  v_pk_mul_f32 v[206:207], v[206:207], v[194:195] op_sel:[0,0] op_sel_hi:[1,0]
  v_cvt_pk_bf16_f32 v208, v200, v201
  v_cvt_pk_bf16_f32 v209, v202, v203
  v_cvt_pk_bf16_f32 v210, v204, v205
  v_cvt_pk_bf16_f32 v211, v206, v207
  s_lshl_b32 s51, s37, 14
  s_add_u32 s51, s51, 4096
  buffer_store_dwordx4 v[208:211], v223, s[32:35], s51 offen offset:2048 sc1
  v_accvgpr_read_b32 v200, a44
  v_accvgpr_read_b32 v201, a45
  v_accvgpr_read_b32 v202, a46
  v_accvgpr_read_b32 v203, a47
  v_accvgpr_read_b32 v204, a60
  v_accvgpr_read_b32 v205, a61
  v_accvgpr_read_b32 v206, a62
  v_accvgpr_read_b32 v207, a63
  v_pk_mul_f32 v[200:201], v[200:201], v[194:195] op_sel:[0,1] op_sel_hi:[1,1]
  v_pk_mul_f32 v[202:203], v[202:203], v[194:195] op_sel:[0,1] op_sel_hi:[1,1]
  v_pk_mul_f32 v[204:205], v[204:205], v[194:195] op_sel:[0,1] op_sel_hi:[1,1]
  v_pk_mul_f32 v[206:207], v[206:207], v[194:195] op_sel:[0,1] op_sel_hi:[1,1]
  v_cvt_pk_bf16_f32 v212, v200, v201
  v_cvt_pk_bf16_f32 v213, v202, v203
  v_cvt_pk_bf16_f32 v214, v204, v205
  v_cvt_pk_bf16_f32 v215, v206, v207
  s_lshl_b32 s51, s37, 14
  s_add_u32 s51, s51, 4096
  buffer_store_dwordx4 v[212:215], v223, s[32:35], s51 offen offset:3072 sc1
  s_lshl_b32 s49, s70, 2
  s_add_u32 s49, s49, s36
  s_lshl_b32 s49, s49, 7
  s_add_u32 s49, s49, 327684
  buffer_load_dword v220, v221, s[20:23], s49 offen sc1
  s_add_u32 s55, s41, 20480
  buffer_load_dwordx4 v[128:131], v223, s[12:15], s55 offen offset:3072 sc1
  s_add_u32 s55, s41, 24576
  buffer_load_dwordx4 v[132:135], v223, s[12:15], s55 offen offset:0 sc1
  buffer_load_dwordx4 v[136:139], v223, s[12:15], s55 offen offset:1024 sc1
  buffer_load_dwordx4 v[140:143], v223, s[12:15], s55 offen offset:2048 sc1
  buffer_load_dwordx4 v[144:147], v223, s[12:15], s55 offen offset:3072 sc1
  s_add_u32 s55, s41, 57344
  buffer_load_dwordx4 v[148:151], v223, s[12:15], s55 offen offset:0 sc1
  s_waitcnt vmcnt(0)
  s_branch K1_T0
K1_sd0:
  s_nop 1
  s_add_u32 m0, s44, 65536
  s_mov_b32 s41, 1048576
  buffer_load_dwordx4 v240, s[12:15], s41 offen offset:0  lds
  buffer_load_dwordx4 v241, s[12:15], s41 offen offset:1024  lds
  buffer_load_dwordx4 v242, s[12:15], s41 offen offset:2048  lds
  buffer_load_dwordx4 v243, s[12:15], s41 offen offset:3072  lds
  s_add_u32 m0, s44, 81920
  s_mov_b32 s42, 442368
  buffer_load_dwordx4 v244, s[16:19], s42 offen offset:0  lds
  buffer_load_dwordx4 v245, s[16:19], s42 offen offset:1024  lds
  buffer_load_dwordx4 v246, s[16:19], s42 offen offset:2048  lds
  s_waitcnt vmcnt(7) lgkmcnt(0)
  s_barrier
  ds_read_b128 a[160:163], v152 offset:32768
  ds_read_b128 a[164:167], v153 offset:32768
  ds_read_b64_tr_b16 a[192:193], v132 offset:0
  ds_read_b64_tr_b16 a[194:195], v132 offset:1024
  ds_read_b64_tr_b16 a[196:197], v132 offset:8192
  ds_read_b64_tr_b16 a[198:199], v132 offset:9216
  ds_read_b128 a[168:171], v152 offset:34816
  buffer_load_dwordx4 v247, s[16:19], s42 offen offset:3072  lds
  ds_read_b128 a[172:175], v153 offset:34816
  ds_read_b128 a[176:179], v152 offset:36864
  ds_read_b128 a[180:183], v153 offset:36864
  ds_read_b128 a[184:187], v152 offset:38912
  ds_read_b128 a[188:191], v153 offset:38912
  ds_read_b64_tr_b16 a[200:201], v132 offset:8
  ds_read_b64_tr_b16 a[202:203], v132 offset:1032
  ds_read_b64_tr_b16 a[204:205], v132 offset:8200
  ds_read_b64_tr_b16 a[206:207], v132 offset:9224
  s_nop 1
  s_branch K1_rj0
K1_sd1:
  s_nop 1
  s_add_u32 m0, s44, 98304
  s_mov_b32 s41, 1572864
  v_fmac_f32 v159, v179, v179
  buffer_load_dwordx4 v240, s[12:15], s41 offen offset:0  lds
  v_fmac_f32 v191, v180, v180
  v_fmac_f32 v159, v181, v181
  v_fmac_f32 v191, v182, v182
  v_fmac_f32 v159, v183, v183
  v_fmac_f32 v191, v184, v184
  v_fmac_f32 v159, v185, v185
  v_fmac_f32 v191, v186, v186
  v_fmac_f32 v159, v187, v187
  v_fmac_f32 v191, v188, v188
  v_fmac_f32 v159, v189, v189
  v_add_f32 v191, v191, v159
  buffer_load_dwordx4 v241, s[12:15], s41 offen offset:1024  lds
  s_nop 0
  v_add_f32_dpp v191, v191, v191 quad_perm:[1,0,3,2] row_mask:0xf bank_mask:0xf
  s_nop 1
  v_add_f32_dpp v191, v191, v191 quad_perm:[2,3,0,1] row_mask:0xf bank_mask:0xf
  s_nop 1
  v_add_f32_dpp v191, v191, v191 row_half_mirror row_mask:0xf bank_mask:0xf
  s_nop 1
  v_add_f32_dpp v191, v191, v191 row_mirror row_mask:0xf bank_mask:0xf
  buffer_load_dwordx4 v242, s[12:15], s41 offen offset:2048  lds
  v_mov_b32 v159, v191
  s_nop 1
  v_permlane16_swap_b32 v191, v159
  v_add_f32 v191, v191, v159
  v_mul_f32 v191, 0x3acccccd, v191
  v_cvt_pk_bf16_f32 v190, v190, v190
  v_and_b32 v190, 0xffff0000, v190
  v_cvt_pk_bf16_f32 v191, v191, v191
  v_and_b32 v191, 0xffff0000, v191
  buffer_load_dwordx4 v243, s[12:15], s41 offen offset:3072  lds
  v_add_f32 v191, 0x3727c5ac, v191
  v_cvt_pk_bf16_f32 v191, v191, v191
  v_and_b32 v191, 0xffff0000, v191
  v_sqrt_f32 v191, v191
  s_nop 0
  v_cvt_pk_bf16_f32 v191, v191, v191
  v_and_b32 v191, 0xffff0000, v191
  v_rcp_f32 v191, v191
  v_lshlrev_b32 v156, 3, v156
  s_add_u32 m0, s44, 114688
  s_mov_b32 s42, 663552
  buffer_load_dwordx4 v244, s[16:19], s42 offen offset:0  lds
  buffer_load_dwordx4 v245, s[16:19], s42 offen offset:1024  lds
  buffer_load_dwordx4 v246, s[16:19], s42 offen offset:2048  lds
  s_waitcnt vmcnt(7) lgkmcnt(0)
  s_barrier
  ds_read_b128 a[128:131], v152 offset:0
  ds_read_b128 a[132:135], v153 offset:0
  ds_read_b64_tr_b16 a[192:193], v128 offset:0
  ds_read_b64_tr_b16 a[194:195], v128 offset:1024
  ds_read_b64_tr_b16 a[196:197], v128 offset:8192
  ds_read_b64_tr_b16 a[198:199], v128 offset:9216
  ds_read_b128 a[136:139], v152 offset:2048
  buffer_load_dwordx4 v247, s[16:19], s42 offen offset:3072  lds
  ds_read_b128 a[140:143], v153 offset:2048
  ds_read_b128 a[144:147], v152 offset:4096
  ds_read_b128 a[148:151], v153 offset:4096
  ds_read_b128 a[152:155], v152 offset:6144
  ds_read_b128 a[156:159], v153 offset:6144
  ds_read_b64_tr_b16 a[200:201], v128 offset:8
  ds_read_b64_tr_b16 a[202:203], v128 offset:1032
  ds_read_b64_tr_b16 a[204:205], v128 offset:8200
  ds_read_b64_tr_b16 a[206:207], v128 offset:9224
  s_nop 1
  s_branch K1_rj1
K1_sd2:
  s_nop 1
  s_add_u32 m0, s44, 131072
  s_mov_b32 s41, 2097152
  buffer_load_dwordx4 v240, s[12:15], s41 offen offset:0  lds
  buffer_load_dwordx4 v241, s[12:15], s41 offen offset:1024  lds
  buffer_load_dwordx4 v242, s[12:15], s41 offen offset:2048  lds
  buffer_load_dwordx4 v243, s[12:15], s41 offen offset:3072  lds
  s_add_u32 m0, s44, 147456
  s_mov_b32 s42, 884736
  buffer_load_dwordx4 v244, s[16:19], s42 offen offset:0  lds
  buffer_load_dwordx4 v245, s[16:19], s42 offen offset:1024  lds
  buffer_load_dwordx4 v246, s[16:19], s42 offen offset:2048  lds
  s_waitcnt vmcnt(7) lgkmcnt(0)
  s_barrier
  ds_read_b128 a[160:163], v152 offset:32768
  ds_read_b128 a[164:167], v153 offset:32768
  ds_read_b64_tr_b16 a[192:193], v128 offset:32768
  ds_read_b64_tr_b16 a[194:195], v128 offset:33792
  ds_read_b64_tr_b16 a[196:197], v128 offset:40960
  ds_read_b64_tr_b16 a[198:199], v128 offset:41984
  ds_read_b128 a[168:171], v152 offset:34816
  buffer_load_dwordx4 v247, s[16:19], s42 offen offset:3072  lds
  ds_read_b128 a[172:175], v153 offset:34816
  ds_read_b128 a[176:179], v152 offset:36864
  ds_read_b128 a[180:183], v153 offset:36864
  ds_read_b128 a[184:187], v152 offset:38912
  ds_read_b128 a[188:191], v153 offset:38912
  ds_read_b64_tr_b16 a[200:201], v128 offset:32776
  ds_read_b64_tr_b16 a[202:203], v128 offset:33800
  ds_read_b64_tr_b16 a[204:205], v128 offset:40968
  ds_read_b64_tr_b16 a[206:207], v128 offset:41992
  s_nop 1
  s_branch K1_rj2
K1_sd3:
  s_nop 1
  s_add_u32 m0, s44, 81920
  s_mov_b32 s42, 1105920
  buffer_load_dwordx4 v244, s[16:19], s42 offen offset:0  lds
  buffer_load_dwordx4 v245, s[16:19], s42 offen offset:1024  lds
  buffer_load_dwordx4 v246, s[16:19], s42 offen offset:2048  lds
  buffer_load_dwordx4 v247, s[16:19], s42 offen offset:3072  lds
  s_add_u32 m0, s43, 32768
  s_movk_i32 s40, 640
  buffer_load_dwordx4 v232, s[8:11], s40 offen offset:0  lds
  buffer_load_dwordx4 v233, s[8:11], s40 offen offset:1024  lds
  buffer_load_dwordx4 v234, s[8:11], s40 offen offset:2048  lds
  buffer_load_dwordx4 v235, s[8:11], s40 offen offset:3072  lds
  s_add_u32 m0, s43, 36864
  s_nop 0
  buffer_load_dwordx4 v236, s[8:11], s40 offen offset:0  lds
  buffer_load_dwordx4 v237, s[8:11], s40 offen offset:1024  lds
  s_waitcnt vmcnt(14) lgkmcnt(0)
  s_barrier
  ds_read_b128 a[128:131], v152 offset:0
  ds_read_b128 a[132:135], v153 offset:0
  ds_read_b64_tr_b16 a[192:193], v132 offset:0
  ds_read_b64_tr_b16 a[194:195], v132 offset:1024
  ds_read_b64_tr_b16 a[196:197], v132 offset:8192
  buffer_load_dwordx4 v238, s[8:11], s40 offen offset:2048  lds
  ds_read_b64_tr_b16 a[198:199], v132 offset:9216
  ds_read_b128 a[136:139], v152 offset:2048
  ds_read_b128 a[140:143], v153 offset:2048
  ds_read_b128 a[144:147], v152 offset:4096
  buffer_load_dwordx4 v239, s[8:11], s40 offen offset:3072  lds
  ds_read_b128 a[148:151], v153 offset:4096
  ds_read_b128 a[152:155], v152 offset:6144
  ds_read_b128 a[156:159], v153 offset:6144
  ds_read_b64_tr_b16 a[200:201], v132 offset:8
  ds_read_b64_tr_b16 a[202:203], v132 offset:1032
  ds_read_b64_tr_b16 a[204:205], v132 offset:8200
  ds_read_b64_tr_b16 a[206:207], v132 offset:9224
  s_nop 1
  s_branch K1_rj3
K1_sd4:
  s_nop 1
  s_add_u32 m0, s43, 0
  s_movk_i32 s40, 768
  buffer_load_dwordx4 v232, s[8:11], s40 offen offset:0  lds
  buffer_load_dwordx4 v233, s[8:11], s40 offen offset:1024  lds
  buffer_load_dwordx4 v234, s[8:11], s40 offen offset:2048  lds
  buffer_load_dwordx4 v235, s[8:11], s40 offen offset:3072  lds
  s_add_u32 m0, s43, 4096
  s_nop 0
  buffer_load_dwordx4 v236, s[8:11], s40 offen offset:0  lds
  buffer_load_dwordx4 v237, s[8:11], s40 offen offset:1024  lds
  buffer_load_dwordx4 v238, s[8:11], s40 offen offset:2048  lds
  s_waitcnt vmcnt(15) lgkmcnt(0)
  s_barrier
  ds_read_b128 a[160:163], v152 offset:32768
  ds_read_b128 a[164:167], v153 offset:32768
  ds_read_b64_tr_b16 a[192:193], v128 offset:0
  ds_read_b64_tr_b16 a[194:195], v128 offset:1024
  ds_read_b64_tr_b16 a[196:197], v128 offset:8192
  ds_read_b64_tr_b16 a[198:199], v128 offset:9216
  ds_read_b128 a[168:171], v152 offset:34816
  buffer_load_dwordx4 v239, s[8:11], s40 offen offset:3072  lds
  ds_read_b128 a[172:175], v153 offset:34816
  ds_read_b128 a[176:179], v152 offset:36864
  ds_read_b128 a[180:183], v153 offset:36864
  ds_read_b128 a[184:187], v152 offset:38912
  ds_read_b128 a[188:191], v153 offset:38912
  ds_read_b64_tr_b16 a[200:201], v128 offset:8
  ds_read_b64_tr_b16 a[202:203], v128 offset:1032
  ds_read_b64_tr_b16 a[204:205], v128 offset:8200
  ds_read_b64_tr_b16 a[206:207], v128 offset:9224
  s_nop 1
  s_branch K1_rj4
K1_sd5:
  s_nop 1
  s_add_u32 m0, s43, 32768
  s_movk_i32 s40, 896
  buffer_load_dwordx4 v232, s[8:11], s40 offen offset:0  lds
  buffer_load_dwordx4 v233, s[8:11], s40 offen offset:1024  lds
  buffer_load_dwordx4 v234, s[8:11], s40 offen offset:2048  lds
  buffer_load_dwordx4 v235, s[8:11], s40 offen offset:3072  lds
  s_add_u32 m0, s43, 36864
  s_nop 0
  buffer_load_dwordx4 v236, s[8:11], s40 offen offset:0  lds
  buffer_load_dwordx4 v237, s[8:11], s40 offen offset:1024  lds
  buffer_load_dwordx4 v238, s[8:11], s40 offen offset:2048  lds
  s_waitcnt vmcnt(15) lgkmcnt(0)
  s_barrier
  ds_read_b128 a[128:131], v152 offset:0
  ds_read_b128 a[132:135], v153 offset:0
  ds_read_b64_tr_b16 a[192:193], v128 offset:32768
  ds_read_b64_tr_b16 a[194:195], v128 offset:33792
  ds_read_b64_tr_b16 a[196:197], v128 offset:40960
  ds_read_b64_tr_b16 a[198:199], v128 offset:41984
  ds_read_b128 a[136:139], v152 offset:2048
  buffer_load_dwordx4 v239, s[8:11], s40 offen offset:3072  lds
  ds_read_b128 a[140:143], v153 offset:2048
  ds_read_b128 a[144:147], v152 offset:4096
  ds_read_b128 a[148:151], v153 offset:4096
  ds_read_b128 a[152:155], v152 offset:6144
  ds_read_b128 a[156:159], v153 offset:6144
  ds_read_b64_tr_b16 a[200:201], v128 offset:32776
  ds_read_b64_tr_b16 a[202:203], v128 offset:33800
  ds_read_b64_tr_b16 a[204:205], v128 offset:40968
  ds_read_b64_tr_b16 a[206:207], v128 offset:41992
  s_nop 1
  s_branch K1_rj5
K1_sd6:
  s_nop 1
  s_add_u32 m0, s43, 0
  s_movk_i32 s40, 1024
  buffer_load_dwordx4 v232, s[8:11], s40 offen offset:0  lds
  buffer_load_dwordx4 v233, s[8:11], s40 offen offset:1024  lds
  buffer_load_dwordx4 v234, s[8:11], s40 offen offset:2048  lds
  buffer_load_dwordx4 v235, s[8:11], s40 offen offset:3072  lds
  s_add_u32 m0, s43, 4096
  s_nop 0
  buffer_load_dwordx4 v236, s[8:11], s40 offen offset:0  lds
  buffer_load_dwordx4 v237, s[8:11], s40 offen offset:1024  lds
  buffer_load_dwordx4 v238, s[8:11], s40 offen offset:2048  lds
  s_waitcnt vmcnt(15) lgkmcnt(0)
  s_barrier
  ds_read_b128 a[160:163], v152 offset:32768
  ds_read_b128 a[164:167], v153 offset:32768
  ds_read_b64_tr_b16 a[192:193], v132 offset:0
  ds_read_b64_tr_b16 a[194:195], v132 offset:1024
  ds_read_b64_tr_b16 a[196:197], v132 offset:8192
  ds_read_b64_tr_b16 a[198:199], v132 offset:9216
  ds_read_b128 a[168:171], v152 offset:34816
  buffer_load_dwordx4 v239, s[8:11], s40 offen offset:3072  lds
  ds_read_b128 a[172:175], v153 offset:34816
  ds_read_b128 a[176:179], v152 offset:36864
  ds_read_b128 a[180:183], v153 offset:36864
  ds_read_b128 a[184:187], v152 offset:38912
  ds_read_b128 a[188:191], v153 offset:38912
  ds_read_b64_tr_b16 a[200:201], v132 offset:8
  ds_read_b64_tr_b16 a[202:203], v132 offset:1032
  ds_read_b64_tr_b16 a[204:205], v132 offset:8200
  ds_read_b64_tr_b16 a[206:207], v132 offset:9224
  s_nop 1
  s_branch K1_rj6
K1_sd7:
  s_nop 1
  s_add_u32 m0, s43, 32768
  s_movk_i32 s40, 1152
  buffer_load_dwordx4 v232, s[8:11], s40 offen offset:0  lds
  buffer_load_dwordx4 v233, s[8:11], s40 offen offset:1024  lds
  buffer_load_dwordx4 v234, s[8:11], s40 offen offset:2048  lds
  buffer_load_dwordx4 v235, s[8:11], s40 offen offset:3072  lds
  s_add_u32 m0, s43, 36864
  s_nop 0
  buffer_load_dwordx4 v236, s[8:11], s40 offen offset:0  lds
  buffer_load_dwordx4 v237, s[8:11], s40 offen offset:1024  lds
  buffer_load_dwordx4 v238, s[8:11], s40 offen offset:2048  lds
  s_waitcnt vmcnt(16) lgkmcnt(0)
  s_barrier
  ds_read_b128 a[128:131], v152 offset:0
  ds_read_b128 a[132:135], v153 offset:0
  ds_read_b64_tr_b16 a[192:193], v128 offset:0
  ds_read_b64_tr_b16 a[194:195], v128 offset:1024
  ds_read_b64_tr_b16 a[196:197], v128 offset:8192
  ds_read_b64_tr_b16 a[198:199], v128 offset:9216
  ds_read_b128 a[136:139], v152 offset:2048
  buffer_load_dwordx4 v239, s[8:11], s40 offen offset:3072  lds
  ds_read_b128 a[140:143], v153 offset:2048
  ds_read_b128 a[144:147], v152 offset:4096
  ds_read_b128 a[148:151], v153 offset:4096
  ds_read_b128 a[152:155], v152 offset:6144
  ds_read_b128 a[156:159], v153 offset:6144
  ds_read_b64_tr_b16 a[200:201], v128 offset:8
  ds_read_b64_tr_b16 a[202:203], v128 offset:1032
  ds_read_b64_tr_b16 a[204:205], v128 offset:8200
  ds_read_b64_tr_b16 a[206:207], v128 offset:9224
  s_nop 1
  s_branch K1_rj7
K1_sd8:
  s_nop 1
  buffer_load_dwordx4 v230, s[72:75], s52 offen offset:2048 lds
  s_add_u32 m0, s43, 133632
  s_movk_i32 s52, 20480
  buffer_load_dwordx4 v228, s[72:75], s52 offen offset:0 lds
  buffer_load_dwordx4 v229, s[72:75], s52 offen offset:1024 lds
  buffer_load_dwordx4 v230, s[72:75], s52 offen offset:2048 lds
  s_waitcnt vmcnt(10) lgkmcnt(0)
  s_barrier
  ds_read_b128 a[160:163], v152 offset:32768
  ds_read_b128 a[164:167], v153 offset:32768
  ds_read_b64_tr_b16 a[192:193], v128 offset:32768
  ds_read_b64_tr_b16 a[194:195], v128 offset:33792
  ds_read_b64_tr_b16 a[196:197], v128 offset:40960
  ds_read_b64_tr_b16 a[198:199], v128 offset:41984
  ds_read_b128 a[168:171], v152 offset:34816
  ds_read_b128 a[172:175], v153 offset:34816
  ds_read_b128 a[176:179], v152 offset:36864
  ds_read_b128 a[180:183], v153 offset:36864
  ds_read_b128 a[184:187], v152 offset:38912
  ds_read_b128 a[188:191], v153 offset:38912
  ds_read_b64_tr_b16 a[200:201], v128 offset:32776
  ds_read_b64_tr_b16 a[202:203], v128 offset:33800
  ds_read_b64_tr_b16 a[204:205], v128 offset:40968
  ds_read_b64_tr_b16 a[206:207], v128 offset:41992
  s_nop 1
  s_branch K1_rj8
.p2align 8
.fill 2048, 4, 0xbf800000
.section .rodata,"a"
.p2align 6
.amdhsa_kernel recurrent_scan__mha_block_cached__glu_gated_reglu__prompt_kernel
  .amdhsa_next_free_vgpr 512
  .amdhsa_next_free_sgpr 102
  .amdhsa_accum_offset 256
  .amdhsa_group_segment_fixed_size 0
  .amdhsa_kernarg_size 96
  .amdhsa_user_sgpr_count 2
  .amdhsa_user_sgpr_kernarg_segment_ptr 1
  .amdhsa_system_sgpr_workgroup_id_x 1
.end_amdhsa_kernel
.text
```
